```python
import torch

def _softmax(x, axis=-1):
    return torch.softmax(x, dim=axis)

def _gelu(x):
    return torch.nn.functional.gelu(x, approximate='tanh')

def _silu(x):
    return torch.nn.functional.silu(x)

def _sigmoid(x):
    return torch.sigmoid(x)

def _layernorm(x, axis=-1, eps=1e-05):
    m = x.mean(dim=axis, keepdim=True)
    v = x.var(dim=axis, keepdim=True, unbiased=False)
    return (x - m) / torch.sqrt(v + eps)

def _scatter_add(tgt, idx, src, axis=0):
    return tgt.clone().index_add_(axis, idx, src)

def _segment_sum(src, seg, n):
    out = torch.zeros((n,) + src.shape[1:], dtype=src.dtype)
    return out.index_add_(0, seg, src)

def _pad(x, pw):
    flat = tuple((v for pair in reversed(pw) for v in pair))
    return torch.nn.functional.pad(x, flat)
kernel_name = 'parallel_sum__memory_aug_recurrent_mem_tr__dense_activation_squared_relu__prompt'

def setup_inputs():

    _w = lambda a: (lambda t: t.to(torch.bfloat16) if t.is_floating_point() else t)(torch.as_tensor(a))

    def _A_setup():
        B, S, Dm = (1, 2048, 512)
        H, Dh = (32, 128)
        M, seg = (8, 32)
        seg = min(seg, S)
        S = S // seg * seg
        return {'x': _w((lambda *s: torch.randn(*s, dtype=torch.bfloat16) * 0.05)(B, S, Dm)), 'mem0': _w((lambda *s: torch.randn(*s, dtype=torch.bfloat16) * 1.6)(B, M, Dm)), 'Wq': _w((lambda *s: torch.randn(*s, dtype=torch.bfloat16) * 0.8)(Dm, H, Dh) * Dm ** (-0.5)), 'Wk': _w((lambda *s: torch.randn(*s, dtype=torch.bfloat16) * 0.8)(Dm, H, Dh) * Dm ** (-0.5)), 'Wv': _w((lambda *s: torch.randn(*s, dtype=torch.bfloat16) * 1.6)(Dm, H, Dh) * Dm ** (-0.5)), 'Wo': _w((lambda *s: torch.randn(*s, dtype=torch.bfloat16) * 1.6)(H, Dh, Dm) * (H * Dh) ** (-0.5)), 'seg_len': seg}
    _A_in = _A_setup()

    def _B_setup():
        B, S, D, F = (1, 2048, 512, 1792)
        return {'x': _w((lambda *s: torch.randn(*s, dtype=torch.bfloat16) * 0.05)(B, S, D)), 'w1': _w((lambda *s: torch.randn(*s, dtype=torch.bfloat16) * 0.05)(D, F)), 'b1': _w((lambda *s: torch.randn(*s, dtype=torch.bfloat16) * 0.2)(F)), 'w2': _w((lambda *s: torch.randn(*s, dtype=torch.bfloat16) * 0.05)(F, D)), 'b2': _w((lambda *s: torch.randn(*s, dtype=torch.bfloat16) * 0.8)(D))}
    _B_in = _B_setup()
    return {'A_x': _A_in['x'], 'A_mem0': _A_in['mem0'], 'A_Wq': _A_in['Wq'], 'A_Wk': _A_in['Wk'], 'A_Wv': _A_in['Wv'], 'A_Wo': _A_in['Wo'], 'A_seg_len': _A_in['seg_len'], 'B_x': _B_in['x'], 'B_w1': _B_in['w1'], 'B_b1': _B_in['b1'], 'B_w2': _B_in['w2'], 'B_b2': _B_in['b2']}

def reference(A_x, A_mem0, A_Wq, A_Wk, A_Wv, A_Wo, A_seg_len, B_x, B_w1, B_b1, B_w2, B_b2):

    def _A_ref(x, mem0, Wq, Wk, Wv, Wo, seg_len):
        B, S, Dm = x.shape
        H, Dh = (Wq.shape[1], Wq.shape[2])
        M = mem0.shape[1]
        scale = Dh ** (-0.5)
        n_seg = S // seg_len
        L = M + seg_len
        idx = torch.arange(L)
        mask = (idx[:, None] < M) | (idx[:, None] >= idx[None, :])
        mem = mem0
        outs = []
        for s in range(n_seg):
            xs = x[:, s * seg_len:(s + 1) * seg_len, :].clone()
            h = torch.concatenate([mem, xs], axis=1)
            q = torch.einsum('btd,dhe->bhte', h, Wq)
            k = torch.einsum('btd,dhe->bhte', h, Wk)
            v = torch.einsum('btd,dhe->bhte', h, Wv)
            scores = torch.einsum('bhqe,bhke->bhqk', q, k) * scale
            scores = torch.where(mask[None, None], scores, -1000000000.0)
            p = _softmax(scores, axis=-1)
            o = torch.einsum('bhqk,bhke->bhqe', p, v)
            o = torch.einsum('bhte,hed->btd', o, Wo)
            mem = o[:, :M, :].clone()
            outs.append(o[:, M:, :])
        return torch.concatenate(outs, axis=1)

    def _B_ref(x, w1, b1, w2, b2):
        h = torch.einsum('bsd,df->bsf', x, w1) + b1
        zero = torch.zeros_like(h)
        r = torch.where(h > zero, h, zero)
        h = r * r
        out = torch.einsum('bsf,fd->bsd', h, w2) + b2
        return out
    x = A_x
    xn = _layernorm(x, axis=-1)
    return x + _A_ref(xn, A_mem0, A_Wq, A_Wk, A_Wv, A_Wo, A_seg_len) + _B_ref(xn, B_w1, B_b1, B_w2, B_b2)
```

```asm
; @launch grid=(256,1,1) block=(256,1,1) lds=163840
.amdgcn_target "amdgcn-amd-amdhsa--gfx950"
.text
.globl parallel_sum__memory_aug_recurrent_mem_tr__dense_activation_squared_relu__prompt_kernel
.p2align 8
.type parallel_sum__memory_aug_recurrent_mem_tr__dense_activation_squared_relu__prompt_kernel,@function
parallel_sum__memory_aug_recurrent_mem_tr__dense_activation_squared_relu__prompt_kernel:
    s_cmp_ge_u32 s2, 256
    s_cbranch_scc1 L_end
    s_load_dwordx16 s[4:19], s[0:1], 0
    s_load_dwordx8 s[20:27], s[0:1], 64
    s_load_dwordx4 s[28:31], s[0:1], 96
    s_load_dwordx2 s[32:33], s[0:1], 112
    s_getreg_b32 s3, hwreg(HW_REG_XCC_ID, 0, 3)
    v_lshrrev_b32 v1, 6, v0
    v_and_b32 v0, 63, v0
    v_readfirstlane_b32 s34, v1
    s_mov_b32 s100, 262144
    s_mov_b32 s101, 0
    s_waitcnt lgkmcnt(0)
    s_mov_b32 s36, s32
    s_mov_b32 s37, s33
    s_mov_b32 s38, 0x10000000
    s_mov_b32 s39, 0x20000
    v_lshlrev_b32 v2, 4, v0
    v_mov_b32 v4, 0x7f817f81
    v_mov_b32 v5, v4
    v_mov_b32 v6, v4
    v_mov_b32 v7, v4
    s_lshl_b32 s40, s2, 11
    s_lshl_b32 s41, s34, 10
    s_add_u32 s40, s40, s41
    s_add_u32 s40, s40, 0x400000
    s_cmp_lt_u32 s34, 2
    s_cselect_b32 s40, s40, 0x80000000
    buffer_store_dwordx4 v[4:7], v2, s[36:39], s40 offen sc1
    v_mov_b32 v8, 0
    v_lshlrev_b32 v2, 2, v0
    v_and_b32 v2, 63, v2
    s_lshl_b32 s40, s2, 6
    s_add_u32 s40, s40, 0x40000
    s_cmp_eq_u32 s34, 2
    s_cselect_b32 s40, s40, 0x80000000
    buffer_store_dword v8, v2, s[36:39], s40 offen sc1
    s_sub_u32 s43, s3, s2
    s_and_b32 s43, s43, 7
    s_mov_b32 s40, 0x3424140c
    s_mov_b32 s41, 0x3525150d
    s_lshl_b32 s42, s43, 3
    s_lshr_b64 s[40:41], s[40:41], s42
    s_and_b32 s16, s40, 0xff
    s_lshr_b32 s40, s2, 3
    s_mov_b32 s19, 0
    s_branch L_role_go
L_role_ticket:
    s_waitcnt vmcnt(0) lgkmcnt(0)
    s_barrier
    v_mbcnt_lo_u32_b32 v0, -1, 0
    v_mbcnt_hi_u32_b32 v0, -1, v0
    s_mov_b32 s19, 1
    s_cmp_eq_u32 s34, 0
    s_cbranch_scc0 L_role_wait
    s_mov_b64 exec, 1
    s_mov_b32 s40, 0x38281808
    s_mov_b32 s41, 0x39291909
    s_lshl_b32 s42, s3, 3
    s_lshr_b64 s[40:41], s[40:41], s42
    s_and_b32 s40, s40, 0xff
    s_lshl_b32 s40, s40, 2
    v_mov_b32 v1, s40
    v_mov_b32 v2, 1
    global_atomic_add v4, v1, v2, s[30:31] sc0
    v_mov_b32 v1, 0
    s_waitcnt vmcnt(0)
    ds_write_b32 v1, v4
    s_waitcnt lgkmcnt(0)
    s_mov_b64 exec, -1
L_role_wait:
    s_barrier
    v_mov_b32 v1, 0
    ds_read_b32 v4, v1
    s_waitcnt lgkmcnt(0)
    v_readfirstlane_b32 s40, v4
    s_barrier
    s_mov_b32 s16, s40
    s_and_b32 s40, s40, 31
L_role_go:
    s_mov_b32 s17, 0
    s_mov_b32 s18, 0
    s_mov_b32 s35, s40
    s_cmp_eq_u32 s3, 0
    s_cbranch_scc1 L_chain0
    s_sub_u32 s41, s3, 1
    s_lshl_b32 s41, s41, 5
    s_add_u32 s35, s40, s41
    s_branch L_worker
L_role_mixed:
    s_waitcnt vmcnt(0) lgkmcnt(0)
    s_barrier
    v_mbcnt_lo_u32_b32 v0, -1, 0
    v_mbcnt_hi_u32_b32 v0, -1, v0
    s_mov_b32 s17, 1
    s_mov_b32 s18, 1
    v_readlane_b32 s40, v1, 8
    s_cmp_gt_u32 s3, 0
    s_cselect_b32 s40, s40, 0
    s_add_u32 s16, s16, s40
    v_readlane_b32 s40, v1, 24
    s_cmp_gt_u32 s3, 1
    s_cselect_b32 s40, s40, 0
    s_add_u32 s16, s16, s40
    v_readlane_b32 s40, v1, 40
    s_cmp_gt_u32 s3, 2
    s_cselect_b32 s40, s40, 0
    s_add_u32 s16, s16, s40
    v_readlane_b32 s40, v1, 56
    s_cmp_gt_u32 s3, 3
    s_cselect_b32 s40, s40, 0
    s_add_u32 s16, s16, s40
    v_readlane_b32 s40, v1, 9
    s_cmp_gt_u32 s3, 4
    s_cselect_b32 s40, s40, 0
    s_add_u32 s16, s16, s40
    v_readlane_b32 s40, v1, 25
    s_cmp_gt_u32 s3, 5
    s_cselect_b32 s40, s40, 0
    s_add_u32 s16, s16, s40
    v_readlane_b32 s40, v1, 41
    s_cmp_gt_u32 s3, 6
    s_cselect_b32 s40, s40, 0
    s_add_u32 s16, s16, s40
    s_mov_b32 s35, s16
    s_cmp_lt_u32 s16, 32
    s_cbranch_scc1 L_chain1
    s_sub_u32 s35, s16, 32
    s_branch L_worker
L_worker:
    s_mov_b32 s40, s4
    s_mov_b32 s41, s5
    s_mov_b32 s42, 0x200000
    s_mov_b32 s43, 0x20000
    v_lshlrev_b32 v1, 4, v0
    v_lshrrev_b32 v6, 4, v0
    v_and_b32 v7, 15, v0
    v_lshlrev_b32 v5, 10, v7
    v_lshl_add_u32 v5, v6, 6, v5
    v_lshrrev_b32 v8, 2, v7
    v_and_b32 v9, 1, v7
    v_lshl_add_u32 v8, v8, 1, v9
    v_lshlrev_b32 v8, 4, v8
    v_lshl_add_u32 v8, v6, 7, v8
    v_bfe_u32 v9, v7, 1, 1
    v_lshl_add_u32 v0, v9, 9, v8
    v_and_b32 v9, 1, v6
    v_lshlrev_b32 v9, 6, v9
    v_xor_b32 v0, v0, v9
    s_mov_b32 s76, 0x05040100
    s_mov_b32 s77, 0x07060302
    s_mov_b32 s52, 0
    s_mul_i32 s87, s35, 1171
    s_lshr_b32 s87, s87, 16
    s_mul_i32 s79, s87, 56
    s_sub_u32 s79, s35, s79
    s_lshr_b32 s88, s79, 2
    s_and_b32 s89, s79, 3
    s_lshl_b32 s54, s87, 2
    s_add_u32 s54, s54, s89
    s_mov_b32 s91, 0
    s_sub_u32 s53, s88, 2
    s_mov_b32 s90, 0
    s_cmp_lt_u32 s88, 4
    s_cbranch_scc0 L_dec2
    s_lshr_b32 s53, s88, 1
    s_and_b32 s90, s88, 1
    s_add_u32 s90, s90, 1
    s_branch L_dec2
L_task:
    s_mov_b32 s90, 0
    s_cmp_eq_u32 s52, 1
    s_cbranch_scc0 L_dec1
    s_cmp_lt_u32 s88, 4
    s_cbranch_scc0 L_dec1
    s_add_u32 s53, s88, 12
    s_branch L_dec2
L_dec1:
    s_mov_b32 s52, 2
    s_mov_b32 s91, 1
    s_mov_b32 s79, s89
    s_cmp_lt_u32 s89, 3
    s_cbranch_scc0 L_dec1a
    s_lshr_b32 s80, s88, 2
    s_or_b32 s80, s80, s89
    s_cmp_eq_u32 s80, 0
    s_cbranch_scc1 L_g1_end
    s_branch L_dec1b
L_dec1a:
    s_mov_b32 s91, 0
    s_sub_u32 s79, s88, 4
    s_cmp_lt_u32 s79, 10
    s_cbranch_scc0 L_g1_end
    s_cmp_lt_u32 s79, 6
    s_cbranch_scc1 L_dec1c
    s_add_u32 s53, s79, 6
    s_mov_b32 s79, 0
    s_branch L_dec1b
L_dec1c:
    s_cmp_ge_u32 s79, 3
    s_cselect_b32 s53, 1, 0
    s_cselect_b32 s80, 3, 0
    s_sub_u32 s79, s79, s80
L_dec1b:
    s_lshl_b32 s80, s87, 1
    s_add_u32 s80, s80, s79
    s_add_u32 s54, s80, 15
    s_add_u32 s80, s87, 24
    s_cmp_eq_u32 s79, 0
    s_cselect_b32 s54, s80, s54
L_dec2:
    s_and_b32 s78, s54, 7
    s_lshl_b32 s78, s78, 2
    s_add_u32 s78, s78, s34
    s_lshl_b32 s79, s78, 8
    s_mov_b32 s56, 8192
    s_mov_b32 s46, 0x400000
    s_mov_b32 s47, 0x20000
    s_mov_b32 s57, 4
    s_mov_b32 s55, 0
    s_mov_b32 s44, s10
    s_mov_b32 s45, s11
    s_cmp_lt_u32 s54, 8
    s_cbranch_scc1 L_dec3
    s_mov_b32 s55, 1
    s_mov_b32 s44, s12
    s_mov_b32 s45, s13
    s_cmp_lt_u32 s54, 16
    s_cbranch_scc1 L_dec3
    s_mov_b32 s55, 4
    s_mov_b32 s44, s8
    s_mov_b32 s45, s9
    s_cmp_lt_u32 s54, 24
    s_cbranch_scc1 L_dec3
    s_mov_b32 s55, 2
    s_mov_b32 s44, s20
    s_mov_b32 s45, s21
    s_mov_b32 s56, 3584
    s_mov_b32 s46, 1835008
L_dec3:
    s_cmp_eq_u32 s91, 1
    s_cbranch_scc0 L_ln
    v_lshlrev_b32 v8, 4, v7
    s_lshl_b32 s80, s56, 5
    v_mul_lo_u32 v9, s80, v6
    v_add3_u32 v4, v8, v9, s79
    s_mul_i32 s64, s56, 0
    s_mul_i32 s65, s56, 1
    s_mul_i32 s66, s56, 8
    s_mul_i32 s67, s56, 9
    s_mul_i32 s68, s56, 16
    s_mul_i32 s69, s56, 17
    s_mul_i32 s70, s56, 24
    s_mul_i32 s71, s56, 25
    s_mul_i32 s61, s56, 2
    s_mul_i32 s62, s56, 4
    s_mul_i32 s63, s56, 6
    s_lshl_b32 s75, s56, 7
    buffer_load_dwordx4 v[160:163], v4, s[44:47], s64 offen
    buffer_load_dwordx4 v[164:167], v4, s[44:47], s65 offen
    buffer_load_dwordx4 v[168:171], v4, s[44:47], s66 offen
    buffer_load_dwordx4 v[172:175], v4, s[44:47], s67 offen
    buffer_load_dwordx4 v[176:179], v4, s[44:47], s68 offen
    buffer_load_dwordx4 v[180:183], v4, s[44:47], s69 offen
    buffer_load_dwordx4 v[184:187], v4, s[44:47], s70 offen
    buffer_load_dwordx4 v[188:191], v4, s[44:47], s71 offen
    s_add_u32 s73, s61, s64
    buffer_load_dwordx4 v[192:195], v4, s[44:47], s73 offen
    s_add_u32 s73, s61, s65
    buffer_load_dwordx4 v[196:199], v4, s[44:47], s73 offen
    s_add_u32 s73, s61, s66
    buffer_load_dwordx4 v[200:203], v4, s[44:47], s73 offen
    s_add_u32 s73, s61, s67
    buffer_load_dwordx4 v[204:207], v4, s[44:47], s73 offen
    s_add_u32 s73, s61, s68
    buffer_load_dwordx4 v[208:211], v4, s[44:47], s73 offen
    s_add_u32 s73, s61, s69
    buffer_load_dwordx4 v[212:215], v4, s[44:47], s73 offen
    s_add_u32 s73, s61, s70
    buffer_load_dwordx4 v[216:219], v4, s[44:47], s73 offen
    s_add_u32 s73, s61, s71
    buffer_load_dwordx4 v[220:223], v4, s[44:47], s73 offen
    s_add_u32 s73, s62, s64
    buffer_load_dwordx4 v[224:227], v4, s[44:47], s73 offen
    s_add_u32 s73, s62, s65
    buffer_load_dwordx4 v[228:231], v4, s[44:47], s73 offen
    s_add_u32 s73, s62, s66
    buffer_load_dwordx4 v[232:235], v4, s[44:47], s73 offen
    s_add_u32 s73, s62, s67
    buffer_load_dwordx4 v[236:239], v4, s[44:47], s73 offen
    s_add_u32 s73, s62, s68
    buffer_load_dwordx4 v[240:243], v4, s[44:47], s73 offen
    s_add_u32 s73, s62, s69
    buffer_load_dwordx4 v[244:247], v4, s[44:47], s73 offen
    s_add_u32 s73, s62, s70
    buffer_load_dwordx4 v[248:251], v4, s[44:47], s73 offen
    s_add_u32 s73, s62, s71
    buffer_load_dwordx4 v[252:255], v4, s[44:47], s73 offen
    s_branch L_gemm
L_ln:
    s_cmp_eq_u32 s90, 0
    s_cselect_b32 s82, 15, 14
    s_lshl_b32 s82, s34, s82
    s_lshr_b32 s81, s90, 1
    s_lshl_b32 s81, s81, 16
    s_lshl_b32 s80, s53, 17
    s_add_u32 s80, s80, s81
    s_add_u32 s80, s80, s82
    v_add_u32 v2, s82, v1
    v_xor_b32 v16, 0, v1
    v_xor_b32 v17, 16, v1
    v_xor_b32 v18, 32, v1
    v_xor_b32 v19, 48, v1
    v_xor_b32 v20, 64, v1
    v_xor_b32 v21, 80, v1
    v_xor_b32 v22, 96, v1
    v_xor_b32 v23, 112, v1
    v_xor_b32 v24, 128, v1
    v_xor_b32 v25, 144, v1
    v_xor_b32 v26, 160, v1
    v_xor_b32 v27, 176, v1
    v_xor_b32 v28, 192, v1
    v_xor_b32 v29, 208, v1
    v_xor_b32 v30, 224, v1
    v_xor_b32 v31, 240, v1
    s_barrier
    s_add_u32 m0, s82, 0
    s_add_u32 s81, s80, 0
    buffer_load_dwordx4 v16, s[40:43], s81 offen offset:0 lds
    buffer_load_dwordx4 v17, s[40:43], s81 offen offset:1024 lds
    buffer_load_dwordx4 v18, s[40:43], s81 offen offset:2048 lds
    buffer_load_dwordx4 v19, s[40:43], s81 offen offset:3072 lds
    s_add_u32 m0, s82, 4096
    s_add_u32 s81, s80, 4096
    buffer_load_dwordx4 v20, s[40:43], s81 offen offset:0 lds
    buffer_load_dwordx4 v21, s[40:43], s81 offen offset:1024 lds
    buffer_load_dwordx4 v22, s[40:43], s81 offen offset:2048 lds
    buffer_load_dwordx4 v23, s[40:43], s81 offen offset:3072 lds
    s_add_u32 m0, s82, 8192
    s_add_u32 s81, s80, 8192
    buffer_load_dwordx4 v24, s[40:43], s81 offen offset:0 lds
    buffer_load_dwordx4 v25, s[40:43], s81 offen offset:1024 lds
    buffer_load_dwordx4 v26, s[40:43], s81 offen offset:2048 lds
    buffer_load_dwordx4 v27, s[40:43], s81 offen offset:3072 lds
    s_add_u32 m0, s82, 12288
    s_add_u32 s81, s80, 12288
    buffer_load_dwordx4 v28, s[40:43], s81 offen offset:0 lds
    buffer_load_dwordx4 v29, s[40:43], s81 offen offset:1024 lds
    buffer_load_dwordx4 v30, s[40:43], s81 offen offset:2048 lds
    buffer_load_dwordx4 v31, s[40:43], s81 offen offset:3072 lds
    s_cmp_eq_u32 s90, 0
    s_cbranch_scc0 L_ln_x
    s_add_u32 m0, s82, 16384
    s_add_u32 s81, s80, 16384
    buffer_load_dwordx4 v16, s[40:43], s81 offen offset:0 lds
    buffer_load_dwordx4 v17, s[40:43], s81 offen offset:1024 lds
    buffer_load_dwordx4 v18, s[40:43], s81 offen offset:2048 lds
    buffer_load_dwordx4 v19, s[40:43], s81 offen offset:3072 lds
    s_add_u32 m0, s82, 20480
    s_add_u32 s81, s80, 20480
    buffer_load_dwordx4 v20, s[40:43], s81 offen offset:0 lds
    buffer_load_dwordx4 v21, s[40:43], s81 offen offset:1024 lds
    buffer_load_dwordx4 v22, s[40:43], s81 offen offset:2048 lds
    buffer_load_dwordx4 v23, s[40:43], s81 offen offset:3072 lds
    s_add_u32 m0, s82, 24576
    s_add_u32 s81, s80, 24576
    buffer_load_dwordx4 v24, s[40:43], s81 offen offset:0 lds
    buffer_load_dwordx4 v25, s[40:43], s81 offen offset:1024 lds
    buffer_load_dwordx4 v26, s[40:43], s81 offen offset:2048 lds
    buffer_load_dwordx4 v27, s[40:43], s81 offen offset:3072 lds
    s_add_u32 m0, s82, 28672
    s_add_u32 s81, s80, 28672
    buffer_load_dwordx4 v28, s[40:43], s81 offen offset:0 lds
    buffer_load_dwordx4 v29, s[40:43], s81 offen offset:1024 lds
    buffer_load_dwordx4 v30, s[40:43], s81 offen offset:2048 lds
    buffer_load_dwordx4 v31, s[40:43], s81 offen offset:3072 lds
    s_cmp_eq_u32 s52, 0
    s_cbranch_scc0 L_ln_x
    s_mul_i32 s81, s87, 10
    s_add_u32 s81, s81, s88
    s_sub_u32 s81, s81, 4
    s_lshl_b32 s81, s81, 2
    s_add_u32 s81, s81, s89
    s_mul_i32 s81, s81, 28672
    s_mul_i32 s83, s34, 7168
    s_add_u32 s81, s81, s83
    s_mov_b32 s48, s12
    s_mov_b32 s49, s13
    s_mov_b32 s50, 0x400000
    s_mov_b32 s51, 0x20000
    s_add_u32 s83, s81, 4096
    buffer_load_dwordx4 v[252:255], v1, s[48:51], s81 offen offset:0
    buffer_load_dwordx4 v[252:255], v1, s[48:51], s81 offen offset:1024
    buffer_load_dwordx4 v[252:255], v1, s[48:51], s81 offen offset:2048
    buffer_load_dwordx4 v[252:255], v1, s[48:51], s81 offen offset:3072
    buffer_load_dwordx4 v[252:255], v1, s[48:51], s83 offen offset:0
    buffer_load_dwordx4 v[252:255], v1, s[48:51], s83 offen offset:1024
    buffer_load_dwordx4 v[252:255], v1, s[48:51], s83 offen offset:2048
    s_mov_b32 s48, s8
    s_mov_b32 s49, s9
    s_mov_b32 s50, 0x400000
    s_mov_b32 s51, 0x20000
    s_add_u32 s83, s81, 4096
    buffer_load_dwordx4 v[252:255], v1, s[48:51], s81 offen offset:0
    buffer_load_dwordx4 v[252:255], v1, s[48:51], s81 offen offset:1024
    buffer_load_dwordx4 v[252:255], v1, s[48:51], s81 offen offset:2048
    buffer_load_dwordx4 v[252:255], v1, s[48:51], s81 offen offset:3072
    buffer_load_dwordx4 v[252:255], v1, s[48:51], s83 offen offset:0
    buffer_load_dwordx4 v[252:255], v1, s[48:51], s83 offen offset:1024
    buffer_load_dwordx4 v[252:255], v1, s[48:51], s83 offen offset:2048
    s_mov_b32 s48, s10
    s_mov_b32 s49, s11
    s_mov_b32 s50, 0x400000
    s_mov_b32 s51, 0x20000
    s_add_u32 s83, s81, 4096
    buffer_load_dwordx4 v[252:255], v1, s[48:51], s81 offen offset:0
    buffer_load_dwordx4 v[252:255], v1, s[48:51], s81 offen offset:1024
    buffer_load_dwordx4 v[252:255], v1, s[48:51], s81 offen offset:2048
    buffer_load_dwordx4 v[252:255], v1, s[48:51], s81 offen offset:3072
    buffer_load_dwordx4 v[252:255], v1, s[48:51], s83 offen offset:0
    buffer_load_dwordx4 v[252:255], v1, s[48:51], s83 offen offset:1024
    buffer_load_dwordx4 v[252:255], v1, s[48:51], s83 offen offset:2048
    s_mov_b32 s48, s14
    s_mov_b32 s49, s15
    s_mov_b32 s50, 0x400000
    s_mov_b32 s51, 0x20000
    s_add_u32 s83, s81, 4096
    buffer_load_dwordx4 v[252:255], v1, s[48:51], s81 offen offset:0
    buffer_load_dwordx4 v[252:255], v1, s[48:51], s81 offen offset:1024
    buffer_load_dwordx4 v[252:255], v1, s[48:51], s81 offen offset:2048
    buffer_load_dwordx4 v[252:255], v1, s[48:51], s81 offen offset:3072
    buffer_load_dwordx4 v[252:255], v1, s[48:51], s83 offen offset:0
    buffer_load_dwordx4 v[252:255], v1, s[48:51], s83 offen offset:1024
    buffer_load_dwordx4 v[252:255], v1, s[48:51], s83 offen offset:2048
L_ln_x:
    v_lshlrev_b32 v8, 4, v7
    s_lshl_b32 s80, s56, 5
    v_mul_lo_u32 v9, s80, v6
    v_add3_u32 v4, v8, v9, s79
    s_mul_i32 s64, s56, 0
    s_mul_i32 s65, s56, 1
    s_mul_i32 s66, s56, 8
    s_mul_i32 s67, s56, 9
    s_mul_i32 s68, s56, 16
    s_mul_i32 s69, s56, 17
    s_mul_i32 s70, s56, 24
    s_mul_i32 s71, s56, 25
    s_mul_i32 s61, s56, 2
    s_mul_i32 s62, s56, 4
    s_mul_i32 s63, s56, 6
    s_lshl_b32 s75, s56, 7
    v_mov_b32 v8, 0x3f803f80
    v_accvgpr_write_b32 a0, v8
    v_accvgpr_write_b32 a1, v8
    v_accvgpr_write_b32 a2, v8
    v_accvgpr_write_b32 a3, v8
    v_lshlrev_b32 v12, 10, v7
    v_add_u32 v12, s82, v12
    v_lshlrev_b32 v13, 2, v6
    v_xor_b32 v13, v13, v7
    v_xor_b32 v14, 0, v13
    v_lshl_add_u32 v156, v14, 4, v12
    v_xor_b32 v14, 1, v13
    v_lshl_add_u32 v157, v14, 4, v12
    v_xor_b32 v14, 2, v13
    v_lshl_add_u32 v158, v14, 4, v12
    v_xor_b32 v14, 3, v13
    v_lshl_add_u32 v159, v14, 4, v12
    s_waitcnt vmcnt(44)
    s_cmp_eq_u32 s90, 0
    s_cbranch_scc0 L_ln_w0
    s_cmp_eq_u32 s52, 0
    s_cbranch_scc1 L_ln_w
    s_waitcnt vmcnt(16)
    s_branch L_ln_w
L_ln_w0:
    s_waitcnt vmcnt(0)
L_ln_w:
    ds_read_b128 v[16:19], v156 offset:0
    ds_read_b128 v[20:23], v157 offset:0
    ds_read_b128 v[24:27], v158 offset:0
    ds_read_b128 v[28:31], v159 offset:0
    ds_read_b128 v[32:35], v156 offset:256
    ds_read_b128 v[36:39], v157 offset:256
    ds_read_b128 v[40:43], v158 offset:256
    ds_read_b128 v[44:47], v159 offset:256
    ds_read_b128 v[48:51], v156 offset:512
    ds_read_b128 v[52:55], v157 offset:512
    ds_read_b128 v[56:59], v158 offset:512
    ds_read_b128 v[60:63], v159 offset:512
    ds_read_b128 v[64:67], v156 offset:768
    ds_read_b128 v[68:71], v157 offset:768
    ds_read_b128 v[72:75], v158 offset:768
    ds_read_b128 v[76:79], v159 offset:768
    s_barrier
    s_or_b32 s96, s19, s34
    s_or_b32 s96, s96, s17
    s_cmp_eq_u32 s96, 0
    s_cbranch_scc0 L_rp42x
    s_mov_b64 exec, 1
    s_lshl_b32 s96, s16, 2
    v_mov_b32 v8, s96
    v_mov_b32 v9, 1
    global_atomic_add v8, v9, s[30:31]
    s_mov_b64 exec, -1
L_rp42x:
    s_waitcnt lgkmcnt(15)
    v_mfma_f32_16x16x32_bf16 v[8:11], a[0:3], v[16:19], 0
    v_dot2_f32_bf16 v12, v16, v16, 0
    v_dot2_f32_bf16 v13, v17, v17, 0
    v_dot2_f32_bf16 v14, v18, v18, 0
    v_dot2_f32_bf16 v15, v19, v19, 0
    s_waitcnt lgkmcnt(14)
    v_mfma_f32_16x16x32_bf16 v[8:11], a[0:3], v[20:23], v[8:11]
    v_dot2_f32_bf16 v12, v20, v20, v12
    v_dot2_f32_bf16 v13, v21, v21, v13
    v_dot2_f32_bf16 v14, v22, v22, v14
    v_dot2_f32_bf16 v15, v23, v23, v15
    s_waitcnt lgkmcnt(13)
    v_mfma_f32_16x16x32_bf16 v[8:11], a[0:3], v[24:27], v[8:11]
    v_dot2_f32_bf16 v12, v24, v24, v12
    v_dot2_f32_bf16 v13, v25, v25, v13
    v_dot2_f32_bf16 v14, v26, v26, v14
    v_dot2_f32_bf16 v15, v27, v27, v15
    s_waitcnt lgkmcnt(12)
    v_mfma_f32_16x16x32_bf16 v[8:11], a[0:3], v[28:31], v[8:11]
    v_dot2_f32_bf16 v12, v28, v28, v12
    v_dot2_f32_bf16 v13, v29, v29, v13
    v_dot2_f32_bf16 v14, v30, v30, v14
    v_dot2_f32_bf16 v15, v31, v31, v15
    s_waitcnt lgkmcnt(11)
    v_mfma_f32_16x16x32_bf16 v[8:11], a[0:3], v[32:35], v[8:11]
    v_dot2_f32_bf16 v12, v32, v32, v12
    v_dot2_f32_bf16 v13, v33, v33, v13
    v_dot2_f32_bf16 v14, v34, v34, v14
    v_dot2_f32_bf16 v15, v35, v35, v15
    s_waitcnt lgkmcnt(10)
    v_mfma_f32_16x16x32_bf16 v[8:11], a[0:3], v[36:39], v[8:11]
    v_dot2_f32_bf16 v12, v36, v36, v12
    v_dot2_f32_bf16 v13, v37, v37, v13
    v_dot2_f32_bf16 v14, v38, v38, v14
    v_dot2_f32_bf16 v15, v39, v39, v15
    s_waitcnt lgkmcnt(9)
    v_mfma_f32_16x16x32_bf16 v[8:11], a[0:3], v[40:43], v[8:11]
    v_dot2_f32_bf16 v12, v40, v40, v12
    v_dot2_f32_bf16 v13, v41, v41, v13
    v_dot2_f32_bf16 v14, v42, v42, v14
    v_dot2_f32_bf16 v15, v43, v43, v15
    s_waitcnt lgkmcnt(8)
    v_mfma_f32_16x16x32_bf16 v[8:11], a[0:3], v[44:47], v[8:11]
    v_dot2_f32_bf16 v12, v44, v44, v12
    v_dot2_f32_bf16 v13, v45, v45, v13
    v_dot2_f32_bf16 v14, v46, v46, v14
    v_dot2_f32_bf16 v15, v47, v47, v15
    s_waitcnt lgkmcnt(7)
    v_mfma_f32_16x16x32_bf16 v[8:11], a[0:3], v[48:51], v[8:11]
    v_dot2_f32_bf16 v12, v48, v48, v12
    v_dot2_f32_bf16 v13, v49, v49, v13
    v_dot2_f32_bf16 v14, v50, v50, v14
    v_dot2_f32_bf16 v15, v51, v51, v15
    s_waitcnt lgkmcnt(6)
    v_mfma_f32_16x16x32_bf16 v[8:11], a[0:3], v[52:55], v[8:11]
    v_dot2_f32_bf16 v12, v52, v52, v12
    v_dot2_f32_bf16 v13, v53, v53, v13
    v_dot2_f32_bf16 v14, v54, v54, v14
    v_dot2_f32_bf16 v15, v55, v55, v15
    s_waitcnt lgkmcnt(5)
    v_mfma_f32_16x16x32_bf16 v[8:11], a[0:3], v[56:59], v[8:11]
    v_dot2_f32_bf16 v12, v56, v56, v12
    v_dot2_f32_bf16 v13, v57, v57, v13
    v_dot2_f32_bf16 v14, v58, v58, v14
    v_dot2_f32_bf16 v15, v59, v59, v15
    s_waitcnt lgkmcnt(4)
    v_mfma_f32_16x16x32_bf16 v[8:11], a[0:3], v[60:63], v[8:11]
    v_dot2_f32_bf16 v12, v60, v60, v12
    v_dot2_f32_bf16 v13, v61, v61, v13
    v_dot2_f32_bf16 v14, v62, v62, v14
    v_dot2_f32_bf16 v15, v63, v63, v15
    s_waitcnt lgkmcnt(3)
    v_mfma_f32_16x16x32_bf16 v[8:11], a[0:3], v[64:67], v[8:11]
    v_dot2_f32_bf16 v12, v64, v64, v12
    v_dot2_f32_bf16 v13, v65, v65, v13
    v_dot2_f32_bf16 v14, v66, v66, v14
    v_dot2_f32_bf16 v15, v67, v67, v15
    s_waitcnt lgkmcnt(2)
    v_mfma_f32_16x16x32_bf16 v[8:11], a[0:3], v[68:71], v[8:11]
    v_dot2_f32_bf16 v12, v68, v68, v12
    v_dot2_f32_bf16 v13, v69, v69, v13
    v_dot2_f32_bf16 v14, v70, v70, v14
    v_dot2_f32_bf16 v15, v71, v71, v15
    s_waitcnt lgkmcnt(1)
    v_mfma_f32_16x16x32_bf16 v[8:11], a[0:3], v[72:75], v[8:11]
    v_dot2_f32_bf16 v12, v72, v72, v12
    v_dot2_f32_bf16 v13, v73, v73, v13
    v_dot2_f32_bf16 v14, v74, v74, v14
    v_dot2_f32_bf16 v15, v75, v75, v15
    s_waitcnt lgkmcnt(0)
    v_mfma_f32_16x16x32_bf16 v[8:11], a[0:3], v[76:79], v[8:11]
    v_dot2_f32_bf16 v12, v76, v76, v12
    v_dot2_f32_bf16 v13, v77, v77, v13
    v_dot2_f32_bf16 v14, v78, v78, v14
    v_dot2_f32_bf16 v15, v79, v79, v15
    buffer_load_dwordx4 v[160:163], v4, s[44:47], s64 offen
    buffer_load_dwordx4 v[164:167], v4, s[44:47], s65 offen
    buffer_load_dwordx4 v[168:171], v4, s[44:47], s66 offen
    buffer_load_dwordx4 v[172:175], v4, s[44:47], s67 offen
    buffer_load_dwordx4 v[176:179], v4, s[44:47], s68 offen
    buffer_load_dwordx4 v[180:183], v4, s[44:47], s69 offen
    buffer_load_dwordx4 v[184:187], v4, s[44:47], s70 offen
    buffer_load_dwordx4 v[188:191], v4, s[44:47], s71 offen
    s_add_u32 s73, s61, s64
    buffer_load_dwordx4 v[192:195], v4, s[44:47], s73 offen
    s_add_u32 s73, s61, s65
    buffer_load_dwordx4 v[196:199], v4, s[44:47], s73 offen
    s_add_u32 s73, s61, s66
    buffer_load_dwordx4 v[200:203], v4, s[44:47], s73 offen
    s_add_u32 s73, s61, s67
    buffer_load_dwordx4 v[204:207], v4, s[44:47], s73 offen
    s_add_u32 s73, s61, s68
    buffer_load_dwordx4 v[208:211], v4, s[44:47], s73 offen
    s_add_u32 s73, s61, s69
    buffer_load_dwordx4 v[212:215], v4, s[44:47], s73 offen
    s_add_u32 s73, s61, s70
    buffer_load_dwordx4 v[216:219], v4, s[44:47], s73 offen
    s_add_u32 s73, s61, s71
    buffer_load_dwordx4 v[220:223], v4, s[44:47], s73 offen
    s_add_u32 s73, s62, s64
    buffer_load_dwordx4 v[224:227], v4, s[44:47], s73 offen
    s_add_u32 s73, s62, s65
    buffer_load_dwordx4 v[228:231], v4, s[44:47], s73 offen
    s_add_u32 s73, s62, s66
    buffer_load_dwordx4 v[232:235], v4, s[44:47], s73 offen
    s_add_u32 s73, s62, s67
    buffer_load_dwordx4 v[236:239], v4, s[44:47], s73 offen
    s_add_u32 s73, s62, s68
    buffer_load_dwordx4 v[240:243], v4, s[44:47], s73 offen
    s_add_u32 s73, s62, s69
    buffer_load_dwordx4 v[244:247], v4, s[44:47], s73 offen
    s_add_u32 s73, s62, s70
    buffer_load_dwordx4 v[248:251], v4, s[44:47], s73 offen
    s_add_u32 s73, s62, s71
    buffer_load_dwordx4 v[252:255], v4, s[44:47], s73 offen
    v_add_f32 v12, v12, v13
    v_add_f32 v14, v14, v15
    v_add_f32 v12, v12, v14
    v_mov_b32 v13, v12
    s_nop 1
    v_permlane32_swap_b32 v12, v13
    v_add_f32 v12, v12, v13
    v_mov_b32 v13, v12
    s_nop 1
    v_permlane16_swap_b32 v12, v13
    v_add_f32 v12, v12, v13
    v_mul_f32 v8, 0x3b000000, v8
    v_mul_f32 v12, 0x3b000000, v12
    v_fma_f32 v12, -v8, v8, v12
    v_max_f32 v12, 0, v12
    v_add_f32 v12, 0x3727c5ac, v12
    v_rsq_f32 v144, v12
    s_nop 0
    v_mul_f32_e64 v146, -v8, v144
    v_lshlrev_b32 v148, 16, v16
    v_and_b32 v149, 0xffff0000, v16
    v_pk_fma_f32 v[148:149], v[148:149], v[144:145], v[146:147] op_sel_hi:[1,0,0]
    v_cvt_pk_bf16_f32 v12, v148, v149
    v_lshlrev_b32 v150, 16, v20
    v_and_b32 v151, 0xffff0000, v20
    v_pk_fma_f32 v[150:151], v[150:151], v[144:145], v[146:147] op_sel_hi:[1,0,0]
    v_cvt_pk_bf16_f32 v13, v150, v151
    v_lshlrev_b32 v148, 16, v24
    v_and_b32 v149, 0xffff0000, v24
    v_pk_fma_f32 v[148:149], v[148:149], v[144:145], v[146:147] op_sel_hi:[1,0,0]
    v_cvt_pk_bf16_f32 v14, v148, v149
    v_lshlrev_b32 v150, 16, v28
    v_and_b32 v151, 0xffff0000, v28
    v_pk_fma_f32 v[150:151], v[150:151], v[144:145], v[146:147] op_sel_hi:[1,0,0]
    v_cvt_pk_bf16_f32 v15, v150, v151
    ds_write_b128 v2, v[12:15] offset:0
    v_lshlrev_b32 v148, 16, v17
    v_and_b32 v149, 0xffff0000, v17
    v_pk_fma_f32 v[148:149], v[148:149], v[144:145], v[146:147] op_sel_hi:[1,0,0]
    v_cvt_pk_bf16_f32 v152, v148, v149
    v_lshlrev_b32 v150, 16, v21
    v_and_b32 v151, 0xffff0000, v21
    v_pk_fma_f32 v[150:151], v[150:151], v[144:145], v[146:147] op_sel_hi:[1,0,0]
    v_cvt_pk_bf16_f32 v153, v150, v151
    v_lshlrev_b32 v148, 16, v25
    v_and_b32 v149, 0xffff0000, v25
    v_pk_fma_f32 v[148:149], v[148:149], v[144:145], v[146:147] op_sel_hi:[1,0,0]
    v_cvt_pk_bf16_f32 v154, v148, v149
    v_lshlrev_b32 v150, 16, v29
    v_and_b32 v151, 0xffff0000, v29
    v_pk_fma_f32 v[150:151], v[150:151], v[144:145], v[146:147] op_sel_hi:[1,0,0]
    v_cvt_pk_bf16_f32 v155, v150, v151
    ds_write_b128 v2, v[152:155] offset:1024
    v_lshlrev_b32 v148, 16, v18
    v_and_b32 v149, 0xffff0000, v18
    v_pk_fma_f32 v[148:149], v[148:149], v[144:145], v[146:147] op_sel_hi:[1,0,0]
    v_cvt_pk_bf16_f32 v12, v148, v149
    v_lshlrev_b32 v150, 16, v22
    v_and_b32 v151, 0xffff0000, v22
    v_pk_fma_f32 v[150:151], v[150:151], v[144:145], v[146:147] op_sel_hi:[1,0,0]
    v_cvt_pk_bf16_f32 v13, v150, v151
    v_lshlrev_b32 v148, 16, v26
    v_and_b32 v149, 0xffff0000, v26
    v_pk_fma_f32 v[148:149], v[148:149], v[144:145], v[146:147] op_sel_hi:[1,0,0]
    v_cvt_pk_bf16_f32 v14, v148, v149
    v_lshlrev_b32 v150, 16, v30
    v_and_b32 v151, 0xffff0000, v30
    v_pk_fma_f32 v[150:151], v[150:151], v[144:145], v[146:147] op_sel_hi:[1,0,0]
    v_cvt_pk_bf16_f32 v15, v150, v151
    ds_write_b128 v2, v[12:15] offset:2048
    v_lshlrev_b32 v148, 16, v19
    v_and_b32 v149, 0xffff0000, v19
    v_pk_fma_f32 v[148:149], v[148:149], v[144:145], v[146:147] op_sel_hi:[1,0,0]
    v_cvt_pk_bf16_f32 v152, v148, v149
    v_lshlrev_b32 v150, 16, v23
    v_and_b32 v151, 0xffff0000, v23
    v_pk_fma_f32 v[150:151], v[150:151], v[144:145], v[146:147] op_sel_hi:[1,0,0]
    v_cvt_pk_bf16_f32 v153, v150, v151
    v_lshlrev_b32 v148, 16, v27
    v_and_b32 v149, 0xffff0000, v27
    v_pk_fma_f32 v[148:149], v[148:149], v[144:145], v[146:147] op_sel_hi:[1,0,0]
    v_cvt_pk_bf16_f32 v154, v148, v149
    v_lshlrev_b32 v150, 16, v31
    v_and_b32 v151, 0xffff0000, v31
    v_pk_fma_f32 v[150:151], v[150:151], v[144:145], v[146:147] op_sel_hi:[1,0,0]
    v_cvt_pk_bf16_f32 v155, v150, v151
    ds_write_b128 v2, v[152:155] offset:3072
    v_lshlrev_b32 v148, 16, v32
    v_and_b32 v149, 0xffff0000, v32
    v_pk_fma_f32 v[148:149], v[148:149], v[144:145], v[146:147] op_sel_hi:[1,0,0]
    v_cvt_pk_bf16_f32 v12, v148, v149
    v_lshlrev_b32 v150, 16, v36
    v_and_b32 v151, 0xffff0000, v36
    v_pk_fma_f32 v[150:151], v[150:151], v[144:145], v[146:147] op_sel_hi:[1,0,0]
    v_cvt_pk_bf16_f32 v13, v150, v151
    v_lshlrev_b32 v148, 16, v40
    v_and_b32 v149, 0xffff0000, v40
    v_pk_fma_f32 v[148:149], v[148:149], v[144:145], v[146:147] op_sel_hi:[1,0,0]
    v_cvt_pk_bf16_f32 v14, v148, v149
    v_lshlrev_b32 v150, 16, v44
    v_and_b32 v151, 0xffff0000, v44
    v_pk_fma_f32 v[150:151], v[150:151], v[144:145], v[146:147] op_sel_hi:[1,0,0]
    v_cvt_pk_bf16_f32 v15, v150, v151
    ds_write_b128 v2, v[12:15] offset:4096
    v_lshlrev_b32 v148, 16, v33
    v_and_b32 v149, 0xffff0000, v33
    v_pk_fma_f32 v[148:149], v[148:149], v[144:145], v[146:147] op_sel_hi:[1,0,0]
    v_cvt_pk_bf16_f32 v152, v148, v149
    v_lshlrev_b32 v150, 16, v37
    v_and_b32 v151, 0xffff0000, v37
    v_pk_fma_f32 v[150:151], v[150:151], v[144:145], v[146:147] op_sel_hi:[1,0,0]
    v_cvt_pk_bf16_f32 v153, v150, v151
    v_lshlrev_b32 v148, 16, v41
    v_and_b32 v149, 0xffff0000, v41
    v_pk_fma_f32 v[148:149], v[148:149], v[144:145], v[146:147] op_sel_hi:[1,0,0]
    v_cvt_pk_bf16_f32 v154, v148, v149
    v_lshlrev_b32 v150, 16, v45
    v_and_b32 v151, 0xffff0000, v45
    v_pk_fma_f32 v[150:151], v[150:151], v[144:145], v[146:147] op_sel_hi:[1,0,0]
    v_cvt_pk_bf16_f32 v155, v150, v151
    ds_write_b128 v2, v[152:155] offset:5120
    v_lshlrev_b32 v148, 16, v34
    v_and_b32 v149, 0xffff0000, v34
    v_pk_fma_f32 v[148:149], v[148:149], v[144:145], v[146:147] op_sel_hi:[1,0,0]
    v_cvt_pk_bf16_f32 v12, v148, v149
    v_lshlrev_b32 v150, 16, v38
    v_and_b32 v151, 0xffff0000, v38
    v_pk_fma_f32 v[150:151], v[150:151], v[144:145], v[146:147] op_sel_hi:[1,0,0]
    v_cvt_pk_bf16_f32 v13, v150, v151
    v_lshlrev_b32 v148, 16, v42
    v_and_b32 v149, 0xffff0000, v42
    v_pk_fma_f32 v[148:149], v[148:149], v[144:145], v[146:147] op_sel_hi:[1,0,0]
    v_cvt_pk_bf16_f32 v14, v148, v149
    v_lshlrev_b32 v150, 16, v46
    v_and_b32 v151, 0xffff0000, v46
    v_pk_fma_f32 v[150:151], v[150:151], v[144:145], v[146:147] op_sel_hi:[1,0,0]
    v_cvt_pk_bf16_f32 v15, v150, v151
    ds_write_b128 v2, v[12:15] offset:6144
    v_lshlrev_b32 v148, 16, v35
    v_and_b32 v149, 0xffff0000, v35
    v_pk_fma_f32 v[148:149], v[148:149], v[144:145], v[146:147] op_sel_hi:[1,0,0]
    v_cvt_pk_bf16_f32 v152, v148, v149
    v_lshlrev_b32 v150, 16, v39
    v_and_b32 v151, 0xffff0000, v39
    v_pk_fma_f32 v[150:151], v[150:151], v[144:145], v[146:147] op_sel_hi:[1,0,0]
    v_cvt_pk_bf16_f32 v153, v150, v151
    v_lshlrev_b32 v148, 16, v43
    v_and_b32 v149, 0xffff0000, v43
    v_pk_fma_f32 v[148:149], v[148:149], v[144:145], v[146:147] op_sel_hi:[1,0,0]
    v_cvt_pk_bf16_f32 v154, v148, v149
    v_lshlrev_b32 v150, 16, v47
    v_and_b32 v151, 0xffff0000, v47
    v_pk_fma_f32 v[150:151], v[150:151], v[144:145], v[146:147] op_sel_hi:[1,0,0]
    v_cvt_pk_bf16_f32 v155, v150, v151
    ds_write_b128 v2, v[152:155] offset:7168
    v_lshlrev_b32 v148, 16, v48
    v_and_b32 v149, 0xffff0000, v48
    v_pk_fma_f32 v[148:149], v[148:149], v[144:145], v[146:147] op_sel_hi:[1,0,0]
    v_cvt_pk_bf16_f32 v12, v148, v149
    v_lshlrev_b32 v150, 16, v52
    v_and_b32 v151, 0xffff0000, v52
    v_pk_fma_f32 v[150:151], v[150:151], v[144:145], v[146:147] op_sel_hi:[1,0,0]
    v_cvt_pk_bf16_f32 v13, v150, v151
    v_lshlrev_b32 v148, 16, v56
    v_and_b32 v149, 0xffff0000, v56
    v_pk_fma_f32 v[148:149], v[148:149], v[144:145], v[146:147] op_sel_hi:[1,0,0]
    v_cvt_pk_bf16_f32 v14, v148, v149
    v_lshlrev_b32 v150, 16, v60
    v_and_b32 v151, 0xffff0000, v60
    v_pk_fma_f32 v[150:151], v[150:151], v[144:145], v[146:147] op_sel_hi:[1,0,0]
    v_cvt_pk_bf16_f32 v15, v150, v151
    ds_write_b128 v2, v[12:15] offset:8192
    v_lshlrev_b32 v148, 16, v49
    v_and_b32 v149, 0xffff0000, v49
    v_pk_fma_f32 v[148:149], v[148:149], v[144:145], v[146:147] op_sel_hi:[1,0,0]
    v_cvt_pk_bf16_f32 v152, v148, v149
    v_lshlrev_b32 v150, 16, v53
    v_and_b32 v151, 0xffff0000, v53
    v_pk_fma_f32 v[150:151], v[150:151], v[144:145], v[146:147] op_sel_hi:[1,0,0]
    v_cvt_pk_bf16_f32 v153, v150, v151
    v_lshlrev_b32 v148, 16, v57
    v_and_b32 v149, 0xffff0000, v57
    v_pk_fma_f32 v[148:149], v[148:149], v[144:145], v[146:147] op_sel_hi:[1,0,0]
    v_cvt_pk_bf16_f32 v154, v148, v149
    v_lshlrev_b32 v150, 16, v61
    v_and_b32 v151, 0xffff0000, v61
    v_pk_fma_f32 v[150:151], v[150:151], v[144:145], v[146:147] op_sel_hi:[1,0,0]
    v_cvt_pk_bf16_f32 v155, v150, v151
    ds_write_b128 v2, v[152:155] offset:9216
    v_lshlrev_b32 v148, 16, v50
    v_and_b32 v149, 0xffff0000, v50
    v_pk_fma_f32 v[148:149], v[148:149], v[144:145], v[146:147] op_sel_hi:[1,0,0]
    v_cvt_pk_bf16_f32 v12, v148, v149
    v_lshlrev_b32 v150, 16, v54
    v_and_b32 v151, 0xffff0000, v54
    v_pk_fma_f32 v[150:151], v[150:151], v[144:145], v[146:147] op_sel_hi:[1,0,0]
    v_cvt_pk_bf16_f32 v13, v150, v151
    v_lshlrev_b32 v148, 16, v58
    v_and_b32 v149, 0xffff0000, v58
    v_pk_fma_f32 v[148:149], v[148:149], v[144:145], v[146:147] op_sel_hi:[1,0,0]
    v_cvt_pk_bf16_f32 v14, v148, v149
    v_lshlrev_b32 v150, 16, v62
    v_and_b32 v151, 0xffff0000, v62
    v_pk_fma_f32 v[150:151], v[150:151], v[144:145], v[146:147] op_sel_hi:[1,0,0]
    v_cvt_pk_bf16_f32 v15, v150, v151
    ds_write_b128 v2, v[12:15] offset:10240
    v_lshlrev_b32 v148, 16, v51
    v_and_b32 v149, 0xffff0000, v51
    v_pk_fma_f32 v[148:149], v[148:149], v[144:145], v[146:147] op_sel_hi:[1,0,0]
    v_cvt_pk_bf16_f32 v152, v148, v149
    v_lshlrev_b32 v150, 16, v55
    v_and_b32 v151, 0xffff0000, v55
    v_pk_fma_f32 v[150:151], v[150:151], v[144:145], v[146:147] op_sel_hi:[1,0,0]
    v_cvt_pk_bf16_f32 v153, v150, v151
    v_lshlrev_b32 v148, 16, v59
    v_and_b32 v149, 0xffff0000, v59
    v_pk_fma_f32 v[148:149], v[148:149], v[144:145], v[146:147] op_sel_hi:[1,0,0]
    v_cvt_pk_bf16_f32 v154, v148, v149
    v_lshlrev_b32 v150, 16, v63
    v_and_b32 v151, 0xffff0000, v63
    v_pk_fma_f32 v[150:151], v[150:151], v[144:145], v[146:147] op_sel_hi:[1,0,0]
    v_cvt_pk_bf16_f32 v155, v150, v151
    ds_write_b128 v2, v[152:155] offset:11264
    v_lshlrev_b32 v148, 16, v64
    v_and_b32 v149, 0xffff0000, v64
    v_pk_fma_f32 v[148:149], v[148:149], v[144:145], v[146:147] op_sel_hi:[1,0,0]
    v_cvt_pk_bf16_f32 v12, v148, v149
    v_lshlrev_b32 v150, 16, v68
    v_and_b32 v151, 0xffff0000, v68
    v_pk_fma_f32 v[150:151], v[150:151], v[144:145], v[146:147] op_sel_hi:[1,0,0]
    v_cvt_pk_bf16_f32 v13, v150, v151
    v_lshlrev_b32 v148, 16, v72
    v_and_b32 v149, 0xffff0000, v72
    v_pk_fma_f32 v[148:149], v[148:149], v[144:145], v[146:147] op_sel_hi:[1,0,0]
    v_cvt_pk_bf16_f32 v14, v148, v149
    v_lshlrev_b32 v150, 16, v76
    v_and_b32 v151, 0xffff0000, v76
    v_pk_fma_f32 v[150:151], v[150:151], v[144:145], v[146:147] op_sel_hi:[1,0,0]
    v_cvt_pk_bf16_f32 v15, v150, v151
    ds_write_b128 v2, v[12:15] offset:12288
    v_lshlrev_b32 v148, 16, v65
    v_and_b32 v149, 0xffff0000, v65
    v_pk_fma_f32 v[148:149], v[148:149], v[144:145], v[146:147] op_sel_hi:[1,0,0]
    v_cvt_pk_bf16_f32 v152, v148, v149
    v_lshlrev_b32 v150, 16, v69
    v_and_b32 v151, 0xffff0000, v69
    v_pk_fma_f32 v[150:151], v[150:151], v[144:145], v[146:147] op_sel_hi:[1,0,0]
    v_cvt_pk_bf16_f32 v153, v150, v151
    v_lshlrev_b32 v148, 16, v73
    v_and_b32 v149, 0xffff0000, v73
    v_pk_fma_f32 v[148:149], v[148:149], v[144:145], v[146:147] op_sel_hi:[1,0,0]
    v_cvt_pk_bf16_f32 v154, v148, v149
    v_lshlrev_b32 v150, 16, v77
    v_and_b32 v151, 0xffff0000, v77
    v_pk_fma_f32 v[150:151], v[150:151], v[144:145], v[146:147] op_sel_hi:[1,0,0]
    v_cvt_pk_bf16_f32 v155, v150, v151
    ds_write_b128 v2, v[152:155] offset:13312
    v_lshlrev_b32 v148, 16, v66
    v_and_b32 v149, 0xffff0000, v66
    v_pk_fma_f32 v[148:149], v[148:149], v[144:145], v[146:147] op_sel_hi:[1,0,0]
    v_cvt_pk_bf16_f32 v12, v148, v149
    v_lshlrev_b32 v150, 16, v70
    v_and_b32 v151, 0xffff0000, v70
    v_pk_fma_f32 v[150:151], v[150:151], v[144:145], v[146:147] op_sel_hi:[1,0,0]
    v_cvt_pk_bf16_f32 v13, v150, v151
    v_lshlrev_b32 v148, 16, v74
    v_and_b32 v149, 0xffff0000, v74
    v_pk_fma_f32 v[148:149], v[148:149], v[144:145], v[146:147] op_sel_hi:[1,0,0]
    v_cvt_pk_bf16_f32 v14, v148, v149
    v_lshlrev_b32 v150, 16, v78
    v_and_b32 v151, 0xffff0000, v78
    v_pk_fma_f32 v[150:151], v[150:151], v[144:145], v[146:147] op_sel_hi:[1,0,0]
    v_cvt_pk_bf16_f32 v15, v150, v151
    ds_write_b128 v2, v[12:15] offset:14336
    v_lshlrev_b32 v148, 16, v67
    v_and_b32 v149, 0xffff0000, v67
    v_pk_fma_f32 v[148:149], v[148:149], v[144:145], v[146:147] op_sel_hi:[1,0,0]
    v_cvt_pk_bf16_f32 v152, v148, v149
    v_lshlrev_b32 v150, 16, v71
    v_and_b32 v151, 0xffff0000, v71
    v_pk_fma_f32 v[150:151], v[150:151], v[144:145], v[146:147] op_sel_hi:[1,0,0]
    v_cvt_pk_bf16_f32 v153, v150, v151
    v_lshlrev_b32 v148, 16, v75
    v_and_b32 v149, 0xffff0000, v75
    v_pk_fma_f32 v[148:149], v[148:149], v[144:145], v[146:147] op_sel_hi:[1,0,0]
    v_cvt_pk_bf16_f32 v154, v148, v149
    v_lshlrev_b32 v150, 16, v79
    v_and_b32 v151, 0xffff0000, v79
    v_pk_fma_f32 v[150:151], v[150:151], v[144:145], v[146:147] op_sel_hi:[1,0,0]
    v_cvt_pk_bf16_f32 v155, v150, v151
    ds_write_b128 v2, v[152:155] offset:15360
    s_cmp_eq_u32 s90, 0
    s_cbranch_scc0 L_ln_end
    s_waitcnt vmcnt(24)
    ds_read_b128 v[80:83], v156 offset:16384
    ds_read_b128 v[84:87], v157 offset:16384
    ds_read_b128 v[88:91], v158 offset:16384
    ds_read_b128 v[92:95], v159 offset:16384
    ds_read_b128 v[96:99], v156 offset:16640
    ds_read_b128 v[100:103], v157 offset:16640
    ds_read_b128 v[104:107], v158 offset:16640
    ds_read_b128 v[108:111], v159 offset:16640
    ds_read_b128 v[112:115], v156 offset:16896
    ds_read_b128 v[116:119], v157 offset:16896
    ds_read_b128 v[120:123], v158 offset:16896
    ds_read_b128 v[124:127], v159 offset:16896
    ds_read_b128 v[128:131], v156 offset:17152
    ds_read_b128 v[132:135], v157 offset:17152
    ds_read_b128 v[136:139], v158 offset:17152
    ds_read_b128 v[140:143], v159 offset:17152
    s_waitcnt lgkmcnt(15)
    v_mfma_f32_16x16x32_bf16 v[8:11], a[0:3], v[80:83], 0
    v_dot2_f32_bf16 v12, v80, v80, 0
    v_dot2_f32_bf16 v13, v81, v81, 0
    v_dot2_f32_bf16 v14, v82, v82, 0
    v_dot2_f32_bf16 v15, v83, v83, 0
    s_waitcnt lgkmcnt(14)
    v_mfma_f32_16x16x32_bf16 v[8:11], a[0:3], v[84:87], v[8:11]
    v_dot2_f32_bf16 v12, v84, v84, v12
    v_dot2_f32_bf16 v13, v85, v85, v13
    v_dot2_f32_bf16 v14, v86, v86, v14
    v_dot2_f32_bf16 v15, v87, v87, v15
    s_waitcnt lgkmcnt(13)
    v_mfma_f32_16x16x32_bf16 v[8:11], a[0:3], v[88:91], v[8:11]
    v_dot2_f32_bf16 v12, v88, v88, v12
    v_dot2_f32_bf16 v13, v89, v89, v13
    v_dot2_f32_bf16 v14, v90, v90, v14
    v_dot2_f32_bf16 v15, v91, v91, v15
    s_waitcnt lgkmcnt(12)
    v_mfma_f32_16x16x32_bf16 v[8:11], a[0:3], v[92:95], v[8:11]
    v_dot2_f32_bf16 v12, v92, v92, v12
    v_dot2_f32_bf16 v13, v93, v93, v13
    v_dot2_f32_bf16 v14, v94, v94, v14
    v_dot2_f32_bf16 v15, v95, v95, v15
    s_waitcnt lgkmcnt(11)
    v_mfma_f32_16x16x32_bf16 v[8:11], a[0:3], v[96:99], v[8:11]
    v_dot2_f32_bf16 v12, v96, v96, v12
    v_dot2_f32_bf16 v13, v97, v97, v13
    v_dot2_f32_bf16 v14, v98, v98, v14
    v_dot2_f32_bf16 v15, v99, v99, v15
    s_waitcnt lgkmcnt(10)
    v_mfma_f32_16x16x32_bf16 v[8:11], a[0:3], v[100:103], v[8:11]
    v_dot2_f32_bf16 v12, v100, v100, v12
    v_dot2_f32_bf16 v13, v101, v101, v13
    v_dot2_f32_bf16 v14, v102, v102, v14
    v_dot2_f32_bf16 v15, v103, v103, v15
    s_waitcnt lgkmcnt(9)
    v_mfma_f32_16x16x32_bf16 v[8:11], a[0:3], v[104:107], v[8:11]
    v_dot2_f32_bf16 v12, v104, v104, v12
    v_dot2_f32_bf16 v13, v105, v105, v13
    v_dot2_f32_bf16 v14, v106, v106, v14
    v_dot2_f32_bf16 v15, v107, v107, v15
    s_waitcnt lgkmcnt(8)
    v_mfma_f32_16x16x32_bf16 v[8:11], a[0:3], v[108:111], v[8:11]
    v_dot2_f32_bf16 v12, v108, v108, v12
    v_dot2_f32_bf16 v13, v109, v109, v13
    v_dot2_f32_bf16 v14, v110, v110, v14
    v_dot2_f32_bf16 v15, v111, v111, v15
    s_waitcnt lgkmcnt(7)
    v_mfma_f32_16x16x32_bf16 v[8:11], a[0:3], v[112:115], v[8:11]
    v_dot2_f32_bf16 v12, v112, v112, v12
    v_dot2_f32_bf16 v13, v113, v113, v13
    v_dot2_f32_bf16 v14, v114, v114, v14
    v_dot2_f32_bf16 v15, v115, v115, v15
    s_waitcnt lgkmcnt(6)
    v_mfma_f32_16x16x32_bf16 v[8:11], a[0:3], v[116:119], v[8:11]
    v_dot2_f32_bf16 v12, v116, v116, v12
    v_dot2_f32_bf16 v13, v117, v117, v13
    v_dot2_f32_bf16 v14, v118, v118, v14
    v_dot2_f32_bf16 v15, v119, v119, v15
    s_waitcnt lgkmcnt(5)
    v_mfma_f32_16x16x32_bf16 v[8:11], a[0:3], v[120:123], v[8:11]
    v_dot2_f32_bf16 v12, v120, v120, v12
    v_dot2_f32_bf16 v13, v121, v121, v13
    v_dot2_f32_bf16 v14, v122, v122, v14
    v_dot2_f32_bf16 v15, v123, v123, v15
    s_waitcnt lgkmcnt(4)
    v_mfma_f32_16x16x32_bf16 v[8:11], a[0:3], v[124:127], v[8:11]
    v_dot2_f32_bf16 v12, v124, v124, v12
    v_dot2_f32_bf16 v13, v125, v125, v13
    v_dot2_f32_bf16 v14, v126, v126, v14
    v_dot2_f32_bf16 v15, v127, v127, v15
    s_waitcnt lgkmcnt(3)
    v_mfma_f32_16x16x32_bf16 v[8:11], a[0:3], v[128:131], v[8:11]
    v_dot2_f32_bf16 v12, v128, v128, v12
    v_dot2_f32_bf16 v13, v129, v129, v13
    v_dot2_f32_bf16 v14, v130, v130, v14
    v_dot2_f32_bf16 v15, v131, v131, v15
    s_waitcnt lgkmcnt(2)
    v_mfma_f32_16x16x32_bf16 v[8:11], a[0:3], v[132:135], v[8:11]
    v_dot2_f32_bf16 v12, v132, v132, v12
    v_dot2_f32_bf16 v13, v133, v133, v13
    v_dot2_f32_bf16 v14, v134, v134, v14
    v_dot2_f32_bf16 v15, v135, v135, v15
    s_waitcnt lgkmcnt(1)
    v_mfma_f32_16x16x32_bf16 v[8:11], a[0:3], v[136:139], v[8:11]
    v_dot2_f32_bf16 v12, v136, v136, v12
    v_dot2_f32_bf16 v13, v137, v137, v13
    v_dot2_f32_bf16 v14, v138, v138, v14
    v_dot2_f32_bf16 v15, v139, v139, v15
    s_waitcnt lgkmcnt(0)
    v_mfma_f32_16x16x32_bf16 v[8:11], a[0:3], v[140:143], v[8:11]
    v_dot2_f32_bf16 v12, v140, v140, v12
    v_dot2_f32_bf16 v13, v141, v141, v13
    v_dot2_f32_bf16 v14, v142, v142, v14
    v_dot2_f32_bf16 v15, v143, v143, v15
    s_nop 0
    v_add_f32 v12, v12, v13
    s_nop 0
    v_add_f32 v14, v14, v15
    v_add_f32 v12, v12, v14
    v_mov_b32 v13, v12
    s_nop 1
    v_permlane32_swap_b32 v12, v13
    v_add_f32 v12, v12, v13
    v_mov_b32 v13, v12
    s_nop 1
    v_permlane16_swap_b32 v12, v13
    v_add_f32 v12, v12, v13
    v_mul_f32 v8, 0x3b000000, v8
    v_mul_f32 v12, 0x3b000000, v12
    v_fma_f32 v12, -v8, v8, v12
    v_max_f32 v12, 0, v12
    v_add_f32 v12, 0x3727c5ac, v12
    v_rsq_f32 v144, v12
    s_nop 0
    v_mul_f32_e64 v146, -v8, v144
    v_lshlrev_b32 v148, 16, v80
    v_and_b32 v149, 0xffff0000, v80
    v_pk_fma_f32 v[148:149], v[148:149], v[144:145], v[146:147] op_sel_hi:[1,0,0]
    v_cvt_pk_bf16_f32 v12, v148, v149
    v_lshlrev_b32 v150, 16, v84
    v_and_b32 v151, 0xffff0000, v84
    v_pk_fma_f32 v[150:151], v[150:151], v[144:145], v[146:147] op_sel_hi:[1,0,0]
    v_cvt_pk_bf16_f32 v13, v150, v151
    v_lshlrev_b32 v148, 16, v88
    v_and_b32 v149, 0xffff0000, v88
    v_pk_fma_f32 v[148:149], v[148:149], v[144:145], v[146:147] op_sel_hi:[1,0,0]
    v_cvt_pk_bf16_f32 v14, v148, v149
    v_lshlrev_b32 v150, 16, v92
    v_and_b32 v151, 0xffff0000, v92
    v_pk_fma_f32 v[150:151], v[150:151], v[144:145], v[146:147] op_sel_hi:[1,0,0]
    v_cvt_pk_bf16_f32 v15, v150, v151
    ds_write_b128 v2, v[12:15] offset:16384
    v_lshlrev_b32 v148, 16, v81
    v_and_b32 v149, 0xffff0000, v81
    v_pk_fma_f32 v[148:149], v[148:149], v[144:145], v[146:147] op_sel_hi:[1,0,0]
    v_cvt_pk_bf16_f32 v152, v148, v149
    v_lshlrev_b32 v150, 16, v85
    v_and_b32 v151, 0xffff0000, v85
    v_pk_fma_f32 v[150:151], v[150:151], v[144:145], v[146:147] op_sel_hi:[1,0,0]
    v_cvt_pk_bf16_f32 v153, v150, v151
    v_lshlrev_b32 v148, 16, v89
    v_and_b32 v149, 0xffff0000, v89
    v_pk_fma_f32 v[148:149], v[148:149], v[144:145], v[146:147] op_sel_hi:[1,0,0]
    v_cvt_pk_bf16_f32 v154, v148, v149
    v_lshlrev_b32 v150, 16, v93
    v_and_b32 v151, 0xffff0000, v93
    v_pk_fma_f32 v[150:151], v[150:151], v[144:145], v[146:147] op_sel_hi:[1,0,0]
    v_cvt_pk_bf16_f32 v155, v150, v151
    ds_write_b128 v2, v[152:155] offset:17408
    v_lshlrev_b32 v148, 16, v82
    v_and_b32 v149, 0xffff0000, v82
    v_pk_fma_f32 v[148:149], v[148:149], v[144:145], v[146:147] op_sel_hi:[1,0,0]
    v_cvt_pk_bf16_f32 v12, v148, v149
    v_lshlrev_b32 v150, 16, v86
    v_and_b32 v151, 0xffff0000, v86
    v_pk_fma_f32 v[150:151], v[150:151], v[144:145], v[146:147] op_sel_hi:[1,0,0]
    v_cvt_pk_bf16_f32 v13, v150, v151
    v_lshlrev_b32 v148, 16, v90
    v_and_b32 v149, 0xffff0000, v90
    v_pk_fma_f32 v[148:149], v[148:149], v[144:145], v[146:147] op_sel_hi:[1,0,0]
    v_cvt_pk_bf16_f32 v14, v148, v149
    v_lshlrev_b32 v150, 16, v94
    v_and_b32 v151, 0xffff0000, v94
    v_pk_fma_f32 v[150:151], v[150:151], v[144:145], v[146:147] op_sel_hi:[1,0,0]
    v_cvt_pk_bf16_f32 v15, v150, v151
    ds_write_b128 v2, v[12:15] offset:18432
    v_lshlrev_b32 v148, 16, v83
    v_and_b32 v149, 0xffff0000, v83
    v_pk_fma_f32 v[148:149], v[148:149], v[144:145], v[146:147] op_sel_hi:[1,0,0]
    v_cvt_pk_bf16_f32 v152, v148, v149
    v_lshlrev_b32 v150, 16, v87
    v_and_b32 v151, 0xffff0000, v87
    v_pk_fma_f32 v[150:151], v[150:151], v[144:145], v[146:147] op_sel_hi:[1,0,0]
    v_cvt_pk_bf16_f32 v153, v150, v151
    v_lshlrev_b32 v148, 16, v91
    v_and_b32 v149, 0xffff0000, v91
    v_pk_fma_f32 v[148:149], v[148:149], v[144:145], v[146:147] op_sel_hi:[1,0,0]
    v_cvt_pk_bf16_f32 v154, v148, v149
    v_lshlrev_b32 v150, 16, v95
    v_and_b32 v151, 0xffff0000, v95
    v_pk_fma_f32 v[150:151], v[150:151], v[144:145], v[146:147] op_sel_hi:[1,0,0]
    v_cvt_pk_bf16_f32 v155, v150, v151
    ds_write_b128 v2, v[152:155] offset:19456
    v_lshlrev_b32 v148, 16, v96
    v_and_b32 v149, 0xffff0000, v96
    v_pk_fma_f32 v[148:149], v[148:149], v[144:145], v[146:147] op_sel_hi:[1,0,0]
    v_cvt_pk_bf16_f32 v12, v148, v149
    v_lshlrev_b32 v150, 16, v100
    v_and_b32 v151, 0xffff0000, v100
    v_pk_fma_f32 v[150:151], v[150:151], v[144:145], v[146:147] op_sel_hi:[1,0,0]
    v_cvt_pk_bf16_f32 v13, v150, v151
    v_lshlrev_b32 v148, 16, v104
    v_and_b32 v149, 0xffff0000, v104
    v_pk_fma_f32 v[148:149], v[148:149], v[144:145], v[146:147] op_sel_hi:[1,0,0]
    v_cvt_pk_bf16_f32 v14, v148, v149
    v_lshlrev_b32 v150, 16, v108
    v_and_b32 v151, 0xffff0000, v108
    v_pk_fma_f32 v[150:151], v[150:151], v[144:145], v[146:147] op_sel_hi:[1,0,0]
    v_cvt_pk_bf16_f32 v15, v150, v151
    ds_write_b128 v2, v[12:15] offset:20480
    v_lshlrev_b32 v148, 16, v97
    v_and_b32 v149, 0xffff0000, v97
    v_pk_fma_f32 v[148:149], v[148:149], v[144:145], v[146:147] op_sel_hi:[1,0,0]
    v_cvt_pk_bf16_f32 v152, v148, v149
    v_lshlrev_b32 v150, 16, v101
    v_and_b32 v151, 0xffff0000, v101
    v_pk_fma_f32 v[150:151], v[150:151], v[144:145], v[146:147] op_sel_hi:[1,0,0]
    v_cvt_pk_bf16_f32 v153, v150, v151
    v_lshlrev_b32 v148, 16, v105
    v_and_b32 v149, 0xffff0000, v105
    v_pk_fma_f32 v[148:149], v[148:149], v[144:145], v[146:147] op_sel_hi:[1,0,0]
    v_cvt_pk_bf16_f32 v154, v148, v149
    v_lshlrev_b32 v150, 16, v109
    v_and_b32 v151, 0xffff0000, v109
    v_pk_fma_f32 v[150:151], v[150:151], v[144:145], v[146:147] op_sel_hi:[1,0,0]
    v_cvt_pk_bf16_f32 v155, v150, v151
    ds_write_b128 v2, v[152:155] offset:21504
    v_lshlrev_b32 v148, 16, v98
    v_and_b32 v149, 0xffff0000, v98
    v_pk_fma_f32 v[148:149], v[148:149], v[144:145], v[146:147] op_sel_hi:[1,0,0]
    v_cvt_pk_bf16_f32 v12, v148, v149
    v_lshlrev_b32 v150, 16, v102
    v_and_b32 v151, 0xffff0000, v102
    v_pk_fma_f32 v[150:151], v[150:151], v[144:145], v[146:147] op_sel_hi:[1,0,0]
    v_cvt_pk_bf16_f32 v13, v150, v151
    v_lshlrev_b32 v148, 16, v106
    v_and_b32 v149, 0xffff0000, v106
    v_pk_fma_f32 v[148:149], v[148:149], v[144:145], v[146:147] op_sel_hi:[1,0,0]
    v_cvt_pk_bf16_f32 v14, v148, v149
    v_lshlrev_b32 v150, 16, v110
    v_and_b32 v151, 0xffff0000, v110
    v_pk_fma_f32 v[150:151], v[150:151], v[144:145], v[146:147] op_sel_hi:[1,0,0]
    v_cvt_pk_bf16_f32 v15, v150, v151
    ds_write_b128 v2, v[12:15] offset:22528
    v_lshlrev_b32 v148, 16, v99
    v_and_b32 v149, 0xffff0000, v99
    v_pk_fma_f32 v[148:149], v[148:149], v[144:145], v[146:147] op_sel_hi:[1,0,0]
    v_cvt_pk_bf16_f32 v152, v148, v149
    v_lshlrev_b32 v150, 16, v103
    v_and_b32 v151, 0xffff0000, v103
    v_pk_fma_f32 v[150:151], v[150:151], v[144:145], v[146:147] op_sel_hi:[1,0,0]
    v_cvt_pk_bf16_f32 v153, v150, v151
    v_lshlrev_b32 v148, 16, v107
    v_and_b32 v149, 0xffff0000, v107
    v_pk_fma_f32 v[148:149], v[148:149], v[144:145], v[146:147] op_sel_hi:[1,0,0]
    v_cvt_pk_bf16_f32 v154, v148, v149
    v_lshlrev_b32 v150, 16, v111
    v_and_b32 v151, 0xffff0000, v111
    v_pk_fma_f32 v[150:151], v[150:151], v[144:145], v[146:147] op_sel_hi:[1,0,0]
    v_cvt_pk_bf16_f32 v155, v150, v151
    ds_write_b128 v2, v[152:155] offset:23552
    v_lshlrev_b32 v148, 16, v112
    v_and_b32 v149, 0xffff0000, v112
    v_pk_fma_f32 v[148:149], v[148:149], v[144:145], v[146:147] op_sel_hi:[1,0,0]
    v_cvt_pk_bf16_f32 v12, v148, v149
    v_lshlrev_b32 v150, 16, v116
    v_and_b32 v151, 0xffff0000, v116
    v_pk_fma_f32 v[150:151], v[150:151], v[144:145], v[146:147] op_sel_hi:[1,0,0]
    v_cvt_pk_bf16_f32 v13, v150, v151
    v_lshlrev_b32 v148, 16, v120
    v_and_b32 v149, 0xffff0000, v120
    v_pk_fma_f32 v[148:149], v[148:149], v[144:145], v[146:147] op_sel_hi:[1,0,0]
    v_cvt_pk_bf16_f32 v14, v148, v149
    v_lshlrev_b32 v150, 16, v124
    v_and_b32 v151, 0xffff0000, v124
    v_pk_fma_f32 v[150:151], v[150:151], v[144:145], v[146:147] op_sel_hi:[1,0,0]
    v_cvt_pk_bf16_f32 v15, v150, v151
    ds_write_b128 v2, v[12:15] offset:24576
    v_lshlrev_b32 v148, 16, v113
    v_and_b32 v149, 0xffff0000, v113
    v_pk_fma_f32 v[148:149], v[148:149], v[144:145], v[146:147] op_sel_hi:[1,0,0]
    v_cvt_pk_bf16_f32 v152, v148, v149
    v_lshlrev_b32 v150, 16, v117
    v_and_b32 v151, 0xffff0000, v117
    v_pk_fma_f32 v[150:151], v[150:151], v[144:145], v[146:147] op_sel_hi:[1,0,0]
    v_cvt_pk_bf16_f32 v153, v150, v151
    v_lshlrev_b32 v148, 16, v121
    v_and_b32 v149, 0xffff0000, v121
    v_pk_fma_f32 v[148:149], v[148:149], v[144:145], v[146:147] op_sel_hi:[1,0,0]
    v_cvt_pk_bf16_f32 v154, v148, v149
    v_lshlrev_b32 v150, 16, v125
    v_and_b32 v151, 0xffff0000, v125
    v_pk_fma_f32 v[150:151], v[150:151], v[144:145], v[146:147] op_sel_hi:[1,0,0]
    v_cvt_pk_bf16_f32 v155, v150, v151
    ds_write_b128 v2, v[152:155] offset:25600
    v_lshlrev_b32 v148, 16, v114
    v_and_b32 v149, 0xffff0000, v114
    v_pk_fma_f32 v[148:149], v[148:149], v[144:145], v[146:147] op_sel_hi:[1,0,0]
    v_cvt_pk_bf16_f32 v12, v148, v149
    v_lshlrev_b32 v150, 16, v118
    v_and_b32 v151, 0xffff0000, v118
    v_pk_fma_f32 v[150:151], v[150:151], v[144:145], v[146:147] op_sel_hi:[1,0,0]
    v_cvt_pk_bf16_f32 v13, v150, v151
    v_lshlrev_b32 v148, 16, v122
    v_and_b32 v149, 0xffff0000, v122
    v_pk_fma_f32 v[148:149], v[148:149], v[144:145], v[146:147] op_sel_hi:[1,0,0]
    v_cvt_pk_bf16_f32 v14, v148, v149
    v_lshlrev_b32 v150, 16, v126
    v_and_b32 v151, 0xffff0000, v126
    v_pk_fma_f32 v[150:151], v[150:151], v[144:145], v[146:147] op_sel_hi:[1,0,0]
    v_cvt_pk_bf16_f32 v15, v150, v151
    ds_write_b128 v2, v[12:15] offset:26624
    v_lshlrev_b32 v148, 16, v115
    v_and_b32 v149, 0xffff0000, v115
    v_pk_fma_f32 v[148:149], v[148:149], v[144:145], v[146:147] op_sel_hi:[1,0,0]
    v_cvt_pk_bf16_f32 v152, v148, v149
    v_lshlrev_b32 v150, 16, v119
    v_and_b32 v151, 0xffff0000, v119
    v_pk_fma_f32 v[150:151], v[150:151], v[144:145], v[146:147] op_sel_hi:[1,0,0]
    v_cvt_pk_bf16_f32 v153, v150, v151
    v_lshlrev_b32 v148, 16, v123
    v_and_b32 v149, 0xffff0000, v123
    v_pk_fma_f32 v[148:149], v[148:149], v[144:145], v[146:147] op_sel_hi:[1,0,0]
    v_cvt_pk_bf16_f32 v154, v148, v149
    v_lshlrev_b32 v150, 16, v127
    v_and_b32 v151, 0xffff0000, v127
    v_pk_fma_f32 v[150:151], v[150:151], v[144:145], v[146:147] op_sel_hi:[1,0,0]
    v_cvt_pk_bf16_f32 v155, v150, v151
    ds_write_b128 v2, v[152:155] offset:27648
    v_lshlrev_b32 v148, 16, v128
    v_and_b32 v149, 0xffff0000, v128
    v_pk_fma_f32 v[148:149], v[148:149], v[144:145], v[146:147] op_sel_hi:[1,0,0]
    v_cvt_pk_bf16_f32 v12, v148, v149
    v_lshlrev_b32 v150, 16, v132
    v_and_b32 v151, 0xffff0000, v132
    v_pk_fma_f32 v[150:151], v[150:151], v[144:145], v[146:147] op_sel_hi:[1,0,0]
    v_cvt_pk_bf16_f32 v13, v150, v151
    v_lshlrev_b32 v148, 16, v136
    v_and_b32 v149, 0xffff0000, v136
    v_pk_fma_f32 v[148:149], v[148:149], v[144:145], v[146:147] op_sel_hi:[1,0,0]
    v_cvt_pk_bf16_f32 v14, v148, v149
    v_lshlrev_b32 v150, 16, v140
    v_and_b32 v151, 0xffff0000, v140
    v_pk_fma_f32 v[150:151], v[150:151], v[144:145], v[146:147] op_sel_hi:[1,0,0]
    v_cvt_pk_bf16_f32 v15, v150, v151
    ds_write_b128 v2, v[12:15] offset:28672
    v_lshlrev_b32 v148, 16, v129
    v_and_b32 v149, 0xffff0000, v129
    v_pk_fma_f32 v[148:149], v[148:149], v[144:145], v[146:147] op_sel_hi:[1,0,0]
    v_cvt_pk_bf16_f32 v152, v148, v149
    v_lshlrev_b32 v150, 16, v133
    v_and_b32 v151, 0xffff0000, v133
    v_pk_fma_f32 v[150:151], v[150:151], v[144:145], v[146:147] op_sel_hi:[1,0,0]
    v_cvt_pk_bf16_f32 v153, v150, v151
    v_lshlrev_b32 v148, 16, v137
    v_and_b32 v149, 0xffff0000, v137
    v_pk_fma_f32 v[148:149], v[148:149], v[144:145], v[146:147] op_sel_hi:[1,0,0]
    v_cvt_pk_bf16_f32 v154, v148, v149
    v_lshlrev_b32 v150, 16, v141
    v_and_b32 v151, 0xffff0000, v141
    v_pk_fma_f32 v[150:151], v[150:151], v[144:145], v[146:147] op_sel_hi:[1,0,0]
    v_cvt_pk_bf16_f32 v155, v150, v151
    ds_write_b128 v2, v[152:155] offset:29696
    v_lshlrev_b32 v148, 16, v130
    v_and_b32 v149, 0xffff0000, v130
    v_pk_fma_f32 v[148:149], v[148:149], v[144:145], v[146:147] op_sel_hi:[1,0,0]
    v_cvt_pk_bf16_f32 v12, v148, v149
    v_lshlrev_b32 v150, 16, v134
    v_and_b32 v151, 0xffff0000, v134
    v_pk_fma_f32 v[150:151], v[150:151], v[144:145], v[146:147] op_sel_hi:[1,0,0]
    v_cvt_pk_bf16_f32 v13, v150, v151
    v_lshlrev_b32 v148, 16, v138
    v_and_b32 v149, 0xffff0000, v138
    v_pk_fma_f32 v[148:149], v[148:149], v[144:145], v[146:147] op_sel_hi:[1,0,0]
    v_cvt_pk_bf16_f32 v14, v148, v149
    v_lshlrev_b32 v150, 16, v142
    v_and_b32 v151, 0xffff0000, v142
    v_pk_fma_f32 v[150:151], v[150:151], v[144:145], v[146:147] op_sel_hi:[1,0,0]
    v_cvt_pk_bf16_f32 v15, v150, v151
    ds_write_b128 v2, v[12:15] offset:30720
    v_lshlrev_b32 v148, 16, v131
    v_and_b32 v149, 0xffff0000, v131
    v_pk_fma_f32 v[148:149], v[148:149], v[144:145], v[146:147] op_sel_hi:[1,0,0]
    v_cvt_pk_bf16_f32 v152, v148, v149
    v_lshlrev_b32 v150, 16, v135
    v_and_b32 v151, 0xffff0000, v135
    v_pk_fma_f32 v[150:151], v[150:151], v[144:145], v[146:147] op_sel_hi:[1,0,0]
    v_cvt_pk_bf16_f32 v153, v150, v151
    v_lshlrev_b32 v148, 16, v139
    v_and_b32 v149, 0xffff0000, v139
    v_pk_fma_f32 v[148:149], v[148:149], v[144:145], v[146:147] op_sel_hi:[1,0,0]
    v_cvt_pk_bf16_f32 v154, v148, v149
    v_lshlrev_b32 v150, 16, v143
    v_and_b32 v151, 0xffff0000, v143
    v_pk_fma_f32 v[150:151], v[150:151], v[144:145], v[146:147] op_sel_hi:[1,0,0]
    v_cvt_pk_bf16_f32 v155, v150, v151
    ds_write_b128 v2, v[152:155] offset:31744
L_ln_end:
L_gemm:
    v_accvgpr_write_b32 a0, 0
    v_accvgpr_write_b32 a1, 0
    v_accvgpr_write_b32 a2, 0
    v_accvgpr_write_b32 a3, 0
    v_accvgpr_write_b32 a4, 0
    v_accvgpr_write_b32 a5, 0
    v_accvgpr_write_b32 a6, 0
    v_accvgpr_write_b32 a7, 0
    v_accvgpr_write_b32 a8, 0
    v_accvgpr_write_b32 a9, 0
    v_accvgpr_write_b32 a10, 0
    v_accvgpr_write_b32 a11, 0
    v_accvgpr_write_b32 a12, 0
    v_accvgpr_write_b32 a13, 0
    v_accvgpr_write_b32 a14, 0
    v_accvgpr_write_b32 a15, 0
    v_accvgpr_write_b32 a16, 0
    v_accvgpr_write_b32 a17, 0
    v_accvgpr_write_b32 a18, 0
    v_accvgpr_write_b32 a19, 0
    v_accvgpr_write_b32 a20, 0
    v_accvgpr_write_b32 a21, 0
    v_accvgpr_write_b32 a22, 0
    v_accvgpr_write_b32 a23, 0
    v_accvgpr_write_b32 a24, 0
    v_accvgpr_write_b32 a25, 0
    v_accvgpr_write_b32 a26, 0
    v_accvgpr_write_b32 a27, 0
    v_accvgpr_write_b32 a28, 0
    v_accvgpr_write_b32 a29, 0
    v_accvgpr_write_b32 a30, 0
    v_accvgpr_write_b32 a31, 0
    v_accvgpr_write_b32 a32, 0
    v_accvgpr_write_b32 a33, 0
    v_accvgpr_write_b32 a34, 0
    v_accvgpr_write_b32 a35, 0
    v_accvgpr_write_b32 a36, 0
    v_accvgpr_write_b32 a37, 0
    v_accvgpr_write_b32 a38, 0
    v_accvgpr_write_b32 a39, 0
    v_accvgpr_write_b32 a40, 0
    v_accvgpr_write_b32 a41, 0
    v_accvgpr_write_b32 a42, 0
    v_accvgpr_write_b32 a43, 0
    v_accvgpr_write_b32 a44, 0
    v_accvgpr_write_b32 a45, 0
    v_accvgpr_write_b32 a46, 0
    v_accvgpr_write_b32 a47, 0
    v_accvgpr_write_b32 a48, 0
    v_accvgpr_write_b32 a49, 0
    v_accvgpr_write_b32 a50, 0
    v_accvgpr_write_b32 a51, 0
    v_accvgpr_write_b32 a52, 0
    v_accvgpr_write_b32 a53, 0
    v_accvgpr_write_b32 a54, 0
    v_accvgpr_write_b32 a55, 0
    v_accvgpr_write_b32 a56, 0
    v_accvgpr_write_b32 a57, 0
    v_accvgpr_write_b32 a58, 0
    v_accvgpr_write_b32 a59, 0
    v_accvgpr_write_b32 a60, 0
    v_accvgpr_write_b32 a61, 0
    v_accvgpr_write_b32 a62, 0
    v_accvgpr_write_b32 a63, 0
    v_accvgpr_write_b32 a64, 0
    v_accvgpr_write_b32 a65, 0
    v_accvgpr_write_b32 a66, 0
    v_accvgpr_write_b32 a67, 0
    v_accvgpr_write_b32 a68, 0
    v_accvgpr_write_b32 a69, 0
    v_accvgpr_write_b32 a70, 0
    v_accvgpr_write_b32 a71, 0
    v_accvgpr_write_b32 a72, 0
    v_accvgpr_write_b32 a73, 0
    v_accvgpr_write_b32 a74, 0
    v_accvgpr_write_b32 a75, 0
    v_accvgpr_write_b32 a76, 0
    v_accvgpr_write_b32 a77, 0
    v_accvgpr_write_b32 a78, 0
    v_accvgpr_write_b32 a79, 0
    v_accvgpr_write_b32 a80, 0
    v_accvgpr_write_b32 a81, 0
    v_accvgpr_write_b32 a82, 0
    v_accvgpr_write_b32 a83, 0
    v_accvgpr_write_b32 a84, 0
    v_accvgpr_write_b32 a85, 0
    v_accvgpr_write_b32 a86, 0
    v_accvgpr_write_b32 a87, 0
    v_accvgpr_write_b32 a88, 0
    v_accvgpr_write_b32 a89, 0
    v_accvgpr_write_b32 a90, 0
    v_accvgpr_write_b32 a91, 0
    v_accvgpr_write_b32 a92, 0
    v_accvgpr_write_b32 a93, 0
    v_accvgpr_write_b32 a94, 0
    v_accvgpr_write_b32 a95, 0
    v_accvgpr_write_b32 a96, 0
    v_accvgpr_write_b32 a97, 0
    v_accvgpr_write_b32 a98, 0
    v_accvgpr_write_b32 a99, 0
    v_accvgpr_write_b32 a100, 0
    v_accvgpr_write_b32 a101, 0
    v_accvgpr_write_b32 a102, 0
    v_accvgpr_write_b32 a103, 0
    v_accvgpr_write_b32 a104, 0
    v_accvgpr_write_b32 a105, 0
    v_accvgpr_write_b32 a106, 0
    v_accvgpr_write_b32 a107, 0
    v_accvgpr_write_b32 a108, 0
    v_accvgpr_write_b32 a109, 0
    v_accvgpr_write_b32 a110, 0
    v_accvgpr_write_b32 a111, 0
    v_accvgpr_write_b32 a112, 0
    v_accvgpr_write_b32 a113, 0
    v_accvgpr_write_b32 a114, 0
    v_accvgpr_write_b32 a115, 0
    v_accvgpr_write_b32 a116, 0
    v_accvgpr_write_b32 a117, 0
    v_accvgpr_write_b32 a118, 0
    v_accvgpr_write_b32 a119, 0
    v_accvgpr_write_b32 a120, 0
    v_accvgpr_write_b32 a121, 0
    v_accvgpr_write_b32 a122, 0
    v_accvgpr_write_b32 a123, 0
    v_accvgpr_write_b32 a124, 0
    v_accvgpr_write_b32 a125, 0
    v_accvgpr_write_b32 a126, 0
    v_accvgpr_write_b32 a127, 0
    v_accvgpr_write_b32 a128, 0
    v_accvgpr_write_b32 a129, 0
    v_accvgpr_write_b32 a130, 0
    v_accvgpr_write_b32 a131, 0
    v_accvgpr_write_b32 a132, 0
    v_accvgpr_write_b32 a133, 0
    v_accvgpr_write_b32 a134, 0
    v_accvgpr_write_b32 a135, 0
    v_accvgpr_write_b32 a136, 0
    v_accvgpr_write_b32 a137, 0
    v_accvgpr_write_b32 a138, 0
    v_accvgpr_write_b32 a139, 0
    v_accvgpr_write_b32 a140, 0
    v_accvgpr_write_b32 a141, 0
    v_accvgpr_write_b32 a142, 0
    v_accvgpr_write_b32 a143, 0
    v_accvgpr_write_b32 a144, 0
    v_accvgpr_write_b32 a145, 0
    v_accvgpr_write_b32 a146, 0
    v_accvgpr_write_b32 a147, 0
    v_accvgpr_write_b32 a148, 0
    v_accvgpr_write_b32 a149, 0
    v_accvgpr_write_b32 a150, 0
    v_accvgpr_write_b32 a151, 0
    v_accvgpr_write_b32 a152, 0
    v_accvgpr_write_b32 a153, 0
    v_accvgpr_write_b32 a154, 0
    v_accvgpr_write_b32 a155, 0
    v_accvgpr_write_b32 a156, 0
    v_accvgpr_write_b32 a157, 0
    v_accvgpr_write_b32 a158, 0
    v_accvgpr_write_b32 a159, 0
    v_accvgpr_write_b32 a160, 0
    v_accvgpr_write_b32 a161, 0
    v_accvgpr_write_b32 a162, 0
    v_accvgpr_write_b32 a163, 0
    v_accvgpr_write_b32 a164, 0
    v_accvgpr_write_b32 a165, 0
    v_accvgpr_write_b32 a166, 0
    v_accvgpr_write_b32 a167, 0
    v_accvgpr_write_b32 a168, 0
    v_accvgpr_write_b32 a169, 0
    v_accvgpr_write_b32 a170, 0
    v_accvgpr_write_b32 a171, 0
    v_accvgpr_write_b32 a172, 0
    v_accvgpr_write_b32 a173, 0
    v_accvgpr_write_b32 a174, 0
    v_accvgpr_write_b32 a175, 0
    v_accvgpr_write_b32 a176, 0
    v_accvgpr_write_b32 a177, 0
    v_accvgpr_write_b32 a178, 0
    v_accvgpr_write_b32 a179, 0
    v_accvgpr_write_b32 a180, 0
    v_accvgpr_write_b32 a181, 0
    v_accvgpr_write_b32 a182, 0
    v_accvgpr_write_b32 a183, 0
    v_accvgpr_write_b32 a184, 0
    v_accvgpr_write_b32 a185, 0
    v_accvgpr_write_b32 a186, 0
    v_accvgpr_write_b32 a187, 0
    v_accvgpr_write_b32 a188, 0
    v_accvgpr_write_b32 a189, 0
    v_accvgpr_write_b32 a190, 0
    v_accvgpr_write_b32 a191, 0
    v_accvgpr_write_b32 a192, 0
    v_accvgpr_write_b32 a193, 0
    v_accvgpr_write_b32 a194, 0
    v_accvgpr_write_b32 a195, 0
    v_accvgpr_write_b32 a196, 0
    v_accvgpr_write_b32 a197, 0
    v_accvgpr_write_b32 a198, 0
    v_accvgpr_write_b32 a199, 0
    v_accvgpr_write_b32 a200, 0
    v_accvgpr_write_b32 a201, 0
    v_accvgpr_write_b32 a202, 0
    v_accvgpr_write_b32 a203, 0
    v_accvgpr_write_b32 a204, 0
    v_accvgpr_write_b32 a205, 0
    v_accvgpr_write_b32 a206, 0
    v_accvgpr_write_b32 a207, 0
    v_accvgpr_write_b32 a208, 0
    v_accvgpr_write_b32 a209, 0
    v_accvgpr_write_b32 a210, 0
    v_accvgpr_write_b32 a211, 0
    v_accvgpr_write_b32 a212, 0
    v_accvgpr_write_b32 a213, 0
    v_accvgpr_write_b32 a214, 0
    v_accvgpr_write_b32 a215, 0
    v_accvgpr_write_b32 a216, 0
    v_accvgpr_write_b32 a217, 0
    v_accvgpr_write_b32 a218, 0
    v_accvgpr_write_b32 a219, 0
    v_accvgpr_write_b32 a220, 0
    v_accvgpr_write_b32 a221, 0
    v_accvgpr_write_b32 a222, 0
    v_accvgpr_write_b32 a223, 0
    v_accvgpr_write_b32 a224, 0
    v_accvgpr_write_b32 a225, 0
    v_accvgpr_write_b32 a226, 0
    v_accvgpr_write_b32 a227, 0
    v_accvgpr_write_b32 a228, 0
    v_accvgpr_write_b32 a229, 0
    v_accvgpr_write_b32 a230, 0
    v_accvgpr_write_b32 a231, 0
    v_accvgpr_write_b32 a232, 0
    v_accvgpr_write_b32 a233, 0
    v_accvgpr_write_b32 a234, 0
    v_accvgpr_write_b32 a235, 0
    v_accvgpr_write_b32 a236, 0
    v_accvgpr_write_b32 a237, 0
    v_accvgpr_write_b32 a238, 0
    v_accvgpr_write_b32 a239, 0
    v_accvgpr_write_b32 a240, 0
    v_accvgpr_write_b32 a241, 0
    v_accvgpr_write_b32 a242, 0
    v_accvgpr_write_b32 a243, 0
    v_accvgpr_write_b32 a244, 0
    v_accvgpr_write_b32 a245, 0
    v_accvgpr_write_b32 a246, 0
    v_accvgpr_write_b32 a247, 0
    v_accvgpr_write_b32 a248, 0
    v_accvgpr_write_b32 a249, 0
    v_accvgpr_write_b32 a250, 0
    v_accvgpr_write_b32 a251, 0
    v_accvgpr_write_b32 a252, 0
    v_accvgpr_write_b32 a253, 0
    v_accvgpr_write_b32 a254, 0
    v_accvgpr_write_b32 a255, 0
    v_mov_b32 v2, v1
    v_add_u32 v3, 0x10000, v1
    v_lshrrev_b32 v15, 2, v1
    v_mov_b32 v14, 0
    s_or_b32 s92, s34, s17
    s_cmp_eq_u32 s92, 0
    s_cselect_b32 s92, s57, 0
    s_mov_b32 s59, 0
    s_mov_b32 s58, 1
    s_waitcnt lgkmcnt(0)
    s_barrier
    s_cmp_eq_u32 s54, 27
    s_cselect_b32 s80, s34, 0
    s_cmp_eq_u32 s55, 2
    s_cselect_b32 s80, s80, 0
    s_cmp_ge_u32 s80, 2
    s_cbranch_scc1 L_epi
    ds_read_b128 v[16:19], v2 offset:0
    ds_read_b128 v[20:23], v2 offset:16384
    ds_read_b128 v[24:27], v2 offset:32768
    ds_read_b128 v[28:31], v2 offset:49152
    ds_read_b128 v[32:35], v3 offset:0
    ds_read_b128 v[36:39], v3 offset:16384
    ds_read_b128 v[40:43], v3 offset:32768
    ds_read_b128 v[44:47], v3 offset:49152
    s_waitcnt vmcnt(16)
    v_perm_b32 v80, v164, v160, s76
    v_perm_b32 v84, v164, v160, s77
    v_perm_b32 v81, v172, v168, s76
    v_perm_b32 v85, v172, v168, s77
    v_perm_b32 v82, v180, v176, s76
    v_perm_b32 v86, v180, v176, s77
    v_perm_b32 v83, v188, v184, s76
    v_perm_b32 v87, v188, v184, s77
    s_waitcnt lgkmcnt(0)
    s_cmp_eq_u32 s90, 0
    s_cbranch_scc0 L_halfsel
    s_cmp_eq_u32 s55, 1
    s_cbranch_scc1 L_loopB8
    s_branch L_loopA8
L_halfsel:
    s_cmp_eq_u32 s55, 1
    s_cbranch_scc1 L_loopB4
L_loopA4:
    s_add_u32 s60, s59, s75
    s_cmp_lt_u32 s58, s57
    s_cselect_b32 s60, s60, 0x80000000
    s_add_u32 s72, s59, s63
    v_mfma_f32_16x16x32_bf16 a[0:3], v[80:83], v[16:19], a[0:3]
    s_add_u32 s73, s72, s64
    buffer_load_dwordx4 v[128:131], v4, s[44:47], s73 offen
    v_perm_b32 v88, v165, v161, s76
    v_mfma_f32_16x16x32_bf16 a[4:7], v[80:83], v[20:23], a[4:7]
    ds_read_b128 v[48:51], v2 offset:1024
    v_perm_b32 v89, v173, v169, s76
    v_mfma_f32_16x16x32_bf16 a[8:11], v[80:83], v[24:27], a[8:11]
    s_add_u32 s73, s72, s65
    buffer_load_dwordx4 v[132:135], v4, s[44:47], s73 offen
    v_perm_b32 v90, v181, v177, s76
    v_mfma_f32_16x16x32_bf16 a[12:15], v[80:83], v[28:31], a[12:15]
    v_perm_b32 v91, v189, v185, s76
    v_mfma_f32_16x16x32_bf16 a[32:35], v[84:87], v[16:19], a[32:35]
    s_add_u32 s73, s72, s66
    buffer_load_dwordx4 v[136:139], v4, s[44:47], s73 offen
    v_perm_b32 v92, v165, v161, s77
    v_mfma_f32_16x16x32_bf16 a[36:39], v[84:87], v[20:23], a[36:39]
    ds_read_b128 v[52:55], v2 offset:17408
    v_perm_b32 v93, v173, v169, s77
    v_mfma_f32_16x16x32_bf16 a[40:43], v[84:87], v[24:27], a[40:43]
    s_add_u32 s73, s72, s67
    buffer_load_dwordx4 v[140:143], v4, s[44:47], s73 offen
    v_perm_b32 v94, v181, v177, s77
    v_mfma_f32_16x16x32_bf16 a[44:47], v[84:87], v[28:31], a[44:47]
    v_perm_b32 v95, v189, v185, s77
    v_mfma_f32_16x16x32_bf16 a[64:67], v[88:91], v[16:19], a[64:67]
    s_add_u32 s73, s72, s68
    buffer_load_dwordx4 v[144:147], v4, s[44:47], s73 offen
    v_perm_b32 v80, v166, v162, s76
    v_mfma_f32_16x16x32_bf16 a[68:71], v[88:91], v[20:23], a[68:71]
    ds_read_b128 v[56:59], v2 offset:33792
    v_perm_b32 v81, v174, v170, s76
    v_mfma_f32_16x16x32_bf16 a[72:75], v[88:91], v[24:27], a[72:75]
    s_add_u32 s73, s72, s69
    buffer_load_dwordx4 v[148:151], v4, s[44:47], s73 offen
    v_perm_b32 v82, v182, v178, s76
    v_mfma_f32_16x16x32_bf16 a[76:79], v[88:91], v[28:31], a[76:79]
    v_perm_b32 v83, v190, v186, s76
    v_mfma_f32_16x16x32_bf16 a[96:99], v[92:95], v[16:19], a[96:99]
    s_add_u32 s73, s72, s70
    buffer_load_dwordx4 v[152:155], v4, s[44:47], s73 offen
    v_perm_b32 v84, v166, v162, s77
    v_mfma_f32_16x16x32_bf16 a[100:103], v[92:95], v[20:23], a[100:103]
    ds_read_b128 v[60:63], v2 offset:50176
    v_perm_b32 v85, v174, v170, s77
    v_mfma_f32_16x16x32_bf16 a[104:107], v[92:95], v[24:27], a[104:107]
    s_add_u32 s73, s72, s71
    buffer_load_dwordx4 v[156:159], v4, s[44:47], s73 offen
    v_perm_b32 v86, v182, v178, s77
    v_mfma_f32_16x16x32_bf16 a[108:111], v[92:95], v[28:31], a[108:111]
    v_perm_b32 v87, v190, v186, s77
    v_mfma_f32_16x16x32_bf16 a[128:131], v[80:83], v[16:19], a[128:131]
    v_perm_b32 v88, v167, v163, s76
    v_mfma_f32_16x16x32_bf16 a[132:135], v[80:83], v[20:23], a[132:135]
    v_perm_b32 v89, v175, v171, s76
    v_mfma_f32_16x16x32_bf16 a[136:139], v[80:83], v[24:27], a[136:139]
    v_perm_b32 v90, v183, v179, s76
    v_mfma_f32_16x16x32_bf16 a[140:143], v[80:83], v[28:31], a[140:143]
    v_perm_b32 v91, v191, v187, s76
    v_mfma_f32_16x16x32_bf16 a[160:163], v[84:87], v[16:19], a[160:163]
    v_perm_b32 v92, v167, v163, s77
    v_mfma_f32_16x16x32_bf16 a[164:167], v[84:87], v[20:23], a[164:167]
    v_perm_b32 v93, v175, v171, s77
    v_mfma_f32_16x16x32_bf16 a[168:171], v[84:87], v[24:27], a[168:171]
    v_perm_b32 v94, v183, v179, s77
    v_mfma_f32_16x16x32_bf16 a[172:175], v[84:87], v[28:31], a[172:175]
    v_perm_b32 v95, v191, v187, s77
    v_mfma_f32_16x16x32_bf16 a[192:195], v[88:91], v[16:19], a[192:195]
    s_waitcnt vmcnt(16)
    v_perm_b32 v80, v196, v192, s76
    v_mfma_f32_16x16x32_bf16 a[196:199], v[88:91], v[20:23], a[196:199]
    v_perm_b32 v81, v204, v200, s76
    v_mfma_f32_16x16x32_bf16 a[200:203], v[88:91], v[24:27], a[200:203]
    v_perm_b32 v82, v212, v208, s76
    v_mfma_f32_16x16x32_bf16 a[204:207], v[88:91], v[28:31], a[204:207]
    v_perm_b32 v83, v220, v216, s76
    v_mfma_f32_16x16x32_bf16 a[224:227], v[92:95], v[16:19], a[224:227]
    v_perm_b32 v84, v196, v192, s77
    v_mfma_f32_16x16x32_bf16 a[228:231], v[92:95], v[20:23], a[228:231]
    v_perm_b32 v85, v204, v200, s77
    v_mfma_f32_16x16x32_bf16 a[232:235], v[92:95], v[24:27], a[232:235]
    v_perm_b32 v86, v212, v208, s77
    v_mfma_f32_16x16x32_bf16 a[236:239], v[92:95], v[28:31], a[236:239]
    s_waitcnt lgkmcnt(0)
    v_perm_b32 v87, v220, v216, s77
    s_mov_b32 s72, s60
    v_mfma_f32_16x16x32_bf16 a[0:3], v[80:83], v[48:51], a[0:3]
    s_add_u32 s73, s72, s64
    buffer_load_dwordx4 v[160:163], v4, s[44:47], s73 offen
    v_perm_b32 v88, v197, v193, s76
    v_mfma_f32_16x16x32_bf16 a[4:7], v[80:83], v[52:55], a[4:7]
    ds_read_b128 v[16:19], v2 offset:2048
    v_perm_b32 v89, v205, v201, s76
    v_mfma_f32_16x16x32_bf16 a[8:11], v[80:83], v[56:59], a[8:11]
    s_add_u32 s73, s72, s65
    buffer_load_dwordx4 v[164:167], v4, s[44:47], s73 offen
    v_perm_b32 v90, v213, v209, s76
    v_mfma_f32_16x16x32_bf16 a[12:15], v[80:83], v[60:63], a[12:15]
    v_perm_b32 v91, v221, v217, s76
    v_mfma_f32_16x16x32_bf16 a[32:35], v[84:87], v[48:51], a[32:35]
    s_add_u32 s73, s72, s66
    buffer_load_dwordx4 v[168:171], v4, s[44:47], s73 offen
    v_perm_b32 v92, v197, v193, s77
    v_mfma_f32_16x16x32_bf16 a[36:39], v[84:87], v[52:55], a[36:39]
    ds_read_b128 v[20:23], v2 offset:18432
    v_perm_b32 v93, v205, v201, s77
    v_mfma_f32_16x16x32_bf16 a[40:43], v[84:87], v[56:59], a[40:43]
    s_add_u32 s73, s72, s67
    buffer_load_dwordx4 v[172:175], v4, s[44:47], s73 offen
    v_perm_b32 v94, v213, v209, s77
    v_mfma_f32_16x16x32_bf16 a[44:47], v[84:87], v[60:63], a[44:47]
    v_perm_b32 v95, v221, v217, s77
    v_mfma_f32_16x16x32_bf16 a[64:67], v[88:91], v[48:51], a[64:67]
    s_add_u32 s73, s72, s68
    buffer_load_dwordx4 v[176:179], v4, s[44:47], s73 offen
    v_perm_b32 v80, v198, v194, s76
    v_mfma_f32_16x16x32_bf16 a[68:71], v[88:91], v[52:55], a[68:71]
    ds_read_b128 v[24:27], v2 offset:34816
    v_perm_b32 v81, v206, v202, s76
    v_mfma_f32_16x16x32_bf16 a[72:75], v[88:91], v[56:59], a[72:75]
    s_add_u32 s73, s72, s69
    buffer_load_dwordx4 v[180:183], v4, s[44:47], s73 offen
    v_perm_b32 v82, v214, v210, s76
    v_mfma_f32_16x16x32_bf16 a[76:79], v[88:91], v[60:63], a[76:79]
    v_perm_b32 v83, v222, v218, s76
    v_mfma_f32_16x16x32_bf16 a[96:99], v[92:95], v[48:51], a[96:99]
    s_add_u32 s73, s72, s70
    buffer_load_dwordx4 v[184:187], v4, s[44:47], s73 offen
    v_perm_b32 v84, v198, v194, s77
    v_mfma_f32_16x16x32_bf16 a[100:103], v[92:95], v[52:55], a[100:103]
    ds_read_b128 v[28:31], v2 offset:51200
    v_perm_b32 v85, v206, v202, s77
    v_mfma_f32_16x16x32_bf16 a[104:107], v[92:95], v[56:59], a[104:107]
    s_add_u32 s73, s72, s71
    buffer_load_dwordx4 v[188:191], v4, s[44:47], s73 offen
    v_perm_b32 v86, v214, v210, s77
    v_mfma_f32_16x16x32_bf16 a[108:111], v[92:95], v[60:63], a[108:111]
    v_perm_b32 v87, v222, v218, s77
    v_mfma_f32_16x16x32_bf16 a[128:131], v[80:83], v[48:51], a[128:131]
    v_perm_b32 v88, v199, v195, s76
    v_mfma_f32_16x16x32_bf16 a[132:135], v[80:83], v[52:55], a[132:135]
    v_perm_b32 v89, v207, v203, s76
    v_mfma_f32_16x16x32_bf16 a[136:139], v[80:83], v[56:59], a[136:139]
    v_perm_b32 v90, v215, v211, s76
    v_mfma_f32_16x16x32_bf16 a[140:143], v[80:83], v[60:63], a[140:143]
    v_perm_b32 v91, v223, v219, s76
    v_mfma_f32_16x16x32_bf16 a[160:163], v[84:87], v[48:51], a[160:163]
    s_cmp_eq_u32 s58, s92
    s_cbranch_scc0 L_ncA4
    global_load_dword v14, v15, s[30:31] sc1
L_ncA4:
    v_perm_b32 v92, v199, v195, s77
    v_mfma_f32_16x16x32_bf16 a[164:167], v[84:87], v[52:55], a[164:167]
    v_perm_b32 v93, v207, v203, s77
    v_mfma_f32_16x16x32_bf16 a[168:171], v[84:87], v[56:59], a[168:171]
    v_perm_b32 v94, v215, v211, s77
    v_mfma_f32_16x16x32_bf16 a[172:175], v[84:87], v[60:63], a[172:175]
    v_perm_b32 v95, v223, v219, s77
    v_mfma_f32_16x16x32_bf16 a[192:195], v[88:91], v[48:51], a[192:195]
    s_waitcnt vmcnt(16)
    v_perm_b32 v80, v228, v224, s76
    v_mfma_f32_16x16x32_bf16 a[196:199], v[88:91], v[52:55], a[196:199]
    v_perm_b32 v81, v236, v232, s76
    v_mfma_f32_16x16x32_bf16 a[200:203], v[88:91], v[56:59], a[200:203]
    v_perm_b32 v82, v244, v240, s76
    v_mfma_f32_16x16x32_bf16 a[204:207], v[88:91], v[60:63], a[204:207]
    v_perm_b32 v83, v252, v248, s76
    v_mfma_f32_16x16x32_bf16 a[224:227], v[92:95], v[48:51], a[224:227]
    v_perm_b32 v84, v228, v224, s77
    v_mfma_f32_16x16x32_bf16 a[228:231], v[92:95], v[52:55], a[228:231]
    v_perm_b32 v85, v236, v232, s77
    v_mfma_f32_16x16x32_bf16 a[232:235], v[92:95], v[56:59], a[232:235]
    v_perm_b32 v86, v244, v240, s77
    v_mfma_f32_16x16x32_bf16 a[236:239], v[92:95], v[60:63], a[236:239]
    s_waitcnt lgkmcnt(0)
    v_perm_b32 v87, v252, v248, s77
    s_add_u32 s72, s60, s61
    v_mfma_f32_16x16x32_bf16 a[0:3], v[80:83], v[16:19], a[0:3]
    s_add_u32 s73, s72, s64
    buffer_load_dwordx4 v[192:195], v4, s[44:47], s73 offen
    v_perm_b32 v88, v229, v225, s76
    v_mfma_f32_16x16x32_bf16 a[4:7], v[80:83], v[20:23], a[4:7]
    ds_read_b128 v[48:51], v2 offset:3072
    v_perm_b32 v89, v237, v233, s76
    v_mfma_f32_16x16x32_bf16 a[8:11], v[80:83], v[24:27], a[8:11]
    s_add_u32 s73, s72, s65
    buffer_load_dwordx4 v[196:199], v4, s[44:47], s73 offen
    v_perm_b32 v90, v245, v241, s76
    v_mfma_f32_16x16x32_bf16 a[12:15], v[80:83], v[28:31], a[12:15]
    v_perm_b32 v91, v253, v249, s76
    v_mfma_f32_16x16x32_bf16 a[32:35], v[84:87], v[16:19], a[32:35]
    s_add_u32 s73, s72, s66
    buffer_load_dwordx4 v[200:203], v4, s[44:47], s73 offen
    v_perm_b32 v92, v229, v225, s77
    v_mfma_f32_16x16x32_bf16 a[36:39], v[84:87], v[20:23], a[36:39]
    ds_read_b128 v[52:55], v2 offset:19456
    v_perm_b32 v93, v237, v233, s77
    v_mfma_f32_16x16x32_bf16 a[40:43], v[84:87], v[24:27], a[40:43]
    s_add_u32 s73, s72, s67
    buffer_load_dwordx4 v[204:207], v4, s[44:47], s73 offen
    v_perm_b32 v94, v245, v241, s77
    v_mfma_f32_16x16x32_bf16 a[44:47], v[84:87], v[28:31], a[44:47]
    v_perm_b32 v95, v253, v249, s77
    v_mfma_f32_16x16x32_bf16 a[64:67], v[88:91], v[16:19], a[64:67]
    s_add_u32 s73, s72, s68
    buffer_load_dwordx4 v[208:211], v4, s[44:47], s73 offen
    v_perm_b32 v80, v230, v226, s76
    v_mfma_f32_16x16x32_bf16 a[68:71], v[88:91], v[20:23], a[68:71]
    ds_read_b128 v[56:59], v2 offset:35840
    v_perm_b32 v81, v238, v234, s76
    v_mfma_f32_16x16x32_bf16 a[72:75], v[88:91], v[24:27], a[72:75]
    s_add_u32 s73, s72, s69
    buffer_load_dwordx4 v[212:215], v4, s[44:47], s73 offen
    v_perm_b32 v82, v246, v242, s76
    v_mfma_f32_16x16x32_bf16 a[76:79], v[88:91], v[28:31], a[76:79]
    v_perm_b32 v83, v254, v250, s76
    v_mfma_f32_16x16x32_bf16 a[96:99], v[92:95], v[16:19], a[96:99]
    s_add_u32 s73, s72, s70
    buffer_load_dwordx4 v[216:219], v4, s[44:47], s73 offen
    v_perm_b32 v84, v230, v226, s77
    v_mfma_f32_16x16x32_bf16 a[100:103], v[92:95], v[20:23], a[100:103]
    ds_read_b128 v[60:63], v2 offset:52224
    v_perm_b32 v85, v238, v234, s77
    v_mfma_f32_16x16x32_bf16 a[104:107], v[92:95], v[24:27], a[104:107]
    s_add_u32 s73, s72, s71
    buffer_load_dwordx4 v[220:223], v4, s[44:47], s73 offen
    v_perm_b32 v86, v246, v242, s77
    v_mfma_f32_16x16x32_bf16 a[108:111], v[92:95], v[28:31], a[108:111]
    v_perm_b32 v87, v254, v250, s77
    v_mfma_f32_16x16x32_bf16 a[128:131], v[80:83], v[16:19], a[128:131]
    v_perm_b32 v88, v231, v227, s76
    v_mfma_f32_16x16x32_bf16 a[132:135], v[80:83], v[20:23], a[132:135]
    v_perm_b32 v89, v239, v235, s76
    v_mfma_f32_16x16x32_bf16 a[136:139], v[80:83], v[24:27], a[136:139]
    v_perm_b32 v90, v247, v243, s76
    v_mfma_f32_16x16x32_bf16 a[140:143], v[80:83], v[28:31], a[140:143]
    v_perm_b32 v91, v255, v251, s76
    v_mfma_f32_16x16x32_bf16 a[160:163], v[84:87], v[16:19], a[160:163]
    v_perm_b32 v92, v231, v227, s77
    v_mfma_f32_16x16x32_bf16 a[164:167], v[84:87], v[20:23], a[164:167]
    v_perm_b32 v93, v239, v235, s77
    v_mfma_f32_16x16x32_bf16 a[168:171], v[84:87], v[24:27], a[168:171]
    v_perm_b32 v94, v247, v243, s77
    v_mfma_f32_16x16x32_bf16 a[172:175], v[84:87], v[28:31], a[172:175]
    v_perm_b32 v95, v255, v251, s77
    v_mfma_f32_16x16x32_bf16 a[192:195], v[88:91], v[16:19], a[192:195]
    s_waitcnt vmcnt(16)
    v_perm_b32 v80, v132, v128, s76
    v_mfma_f32_16x16x32_bf16 a[196:199], v[88:91], v[20:23], a[196:199]
    v_perm_b32 v81, v140, v136, s76
    v_mfma_f32_16x16x32_bf16 a[200:203], v[88:91], v[24:27], a[200:203]
    v_perm_b32 v82, v148, v144, s76
    v_mfma_f32_16x16x32_bf16 a[204:207], v[88:91], v[28:31], a[204:207]
    v_perm_b32 v83, v156, v152, s76
    v_mfma_f32_16x16x32_bf16 a[224:227], v[92:95], v[16:19], a[224:227]
    v_perm_b32 v84, v132, v128, s77
    v_mfma_f32_16x16x32_bf16 a[228:231], v[92:95], v[20:23], a[228:231]
    v_perm_b32 v85, v140, v136, s77
    v_mfma_f32_16x16x32_bf16 a[232:235], v[92:95], v[24:27], a[232:235]
    v_perm_b32 v86, v148, v144, s77
    v_mfma_f32_16x16x32_bf16 a[236:239], v[92:95], v[28:31], a[236:239]
    s_waitcnt lgkmcnt(0)
    v_perm_b32 v87, v156, v152, s77
    s_add_u32 s72, s60, s62
    v_mfma_f32_16x16x32_bf16 a[0:3], v[80:83], v[48:51], a[0:3]
    s_add_u32 s73, s72, s64
    buffer_load_dwordx4 v[224:227], v4, s[44:47], s73 offen
    v_perm_b32 v88, v133, v129, s76
    v_mfma_f32_16x16x32_bf16 a[4:7], v[80:83], v[52:55], a[4:7]
    ds_read_b128 v[16:19], v2 offset:4096
    v_perm_b32 v89, v141, v137, s76
    v_mfma_f32_16x16x32_bf16 a[8:11], v[80:83], v[56:59], a[8:11]
    s_add_u32 s73, s72, s65
    buffer_load_dwordx4 v[228:231], v4, s[44:47], s73 offen
    v_perm_b32 v90, v149, v145, s76
    v_mfma_f32_16x16x32_bf16 a[12:15], v[80:83], v[60:63], a[12:15]
    v_perm_b32 v91, v157, v153, s76
    v_mfma_f32_16x16x32_bf16 a[32:35], v[84:87], v[48:51], a[32:35]
    s_add_u32 s73, s72, s66
    buffer_load_dwordx4 v[232:235], v4, s[44:47], s73 offen
    v_perm_b32 v92, v133, v129, s77
    v_mfma_f32_16x16x32_bf16 a[36:39], v[84:87], v[52:55], a[36:39]
    ds_read_b128 v[20:23], v2 offset:20480
    v_perm_b32 v93, v141, v137, s77
    v_mfma_f32_16x16x32_bf16 a[40:43], v[84:87], v[56:59], a[40:43]
    s_add_u32 s73, s72, s67
    buffer_load_dwordx4 v[236:239], v4, s[44:47], s73 offen
    v_perm_b32 v94, v149, v145, s77
    v_mfma_f32_16x16x32_bf16 a[44:47], v[84:87], v[60:63], a[44:47]
    v_perm_b32 v95, v157, v153, s77
    v_mfma_f32_16x16x32_bf16 a[64:67], v[88:91], v[48:51], a[64:67]
    s_add_u32 s73, s72, s68
    buffer_load_dwordx4 v[240:243], v4, s[44:47], s73 offen
    v_perm_b32 v80, v134, v130, s76
    v_mfma_f32_16x16x32_bf16 a[68:71], v[88:91], v[52:55], a[68:71]
    ds_read_b128 v[24:27], v2 offset:36864
    v_perm_b32 v81, v142, v138, s76
    v_mfma_f32_16x16x32_bf16 a[72:75], v[88:91], v[56:59], a[72:75]
    s_add_u32 s73, s72, s69
    buffer_load_dwordx4 v[244:247], v4, s[44:47], s73 offen
    v_perm_b32 v82, v150, v146, s76
    v_mfma_f32_16x16x32_bf16 a[76:79], v[88:91], v[60:63], a[76:79]
    v_perm_b32 v83, v158, v154, s76
    v_mfma_f32_16x16x32_bf16 a[96:99], v[92:95], v[48:51], a[96:99]
    s_add_u32 s73, s72, s70
    buffer_load_dwordx4 v[248:251], v4, s[44:47], s73 offen
    v_perm_b32 v84, v134, v130, s77
    v_mfma_f32_16x16x32_bf16 a[100:103], v[92:95], v[52:55], a[100:103]
    ds_read_b128 v[28:31], v2 offset:53248
    v_perm_b32 v85, v142, v138, s77
    v_mfma_f32_16x16x32_bf16 a[104:107], v[92:95], v[56:59], a[104:107]
    s_add_u32 s73, s72, s71
    buffer_load_dwordx4 v[252:255], v4, s[44:47], s73 offen
    v_perm_b32 v86, v150, v146, s77
    v_mfma_f32_16x16x32_bf16 a[108:111], v[92:95], v[60:63], a[108:111]
    v_perm_b32 v87, v158, v154, s77
    v_mfma_f32_16x16x32_bf16 a[128:131], v[80:83], v[48:51], a[128:131]
    v_perm_b32 v88, v135, v131, s76
    v_mfma_f32_16x16x32_bf16 a[132:135], v[80:83], v[52:55], a[132:135]
    v_perm_b32 v89, v143, v139, s76
    v_mfma_f32_16x16x32_bf16 a[136:139], v[80:83], v[56:59], a[136:139]
    v_perm_b32 v90, v151, v147, s76
    v_mfma_f32_16x16x32_bf16 a[140:143], v[80:83], v[60:63], a[140:143]
    v_perm_b32 v91, v159, v155, s76
    v_mfma_f32_16x16x32_bf16 a[160:163], v[84:87], v[48:51], a[160:163]
    v_perm_b32 v92, v135, v131, s77
    v_mfma_f32_16x16x32_bf16 a[164:167], v[84:87], v[52:55], a[164:167]
    v_perm_b32 v93, v143, v139, s77
    v_mfma_f32_16x16x32_bf16 a[168:171], v[84:87], v[56:59], a[168:171]
    v_perm_b32 v94, v151, v147, s77
    v_mfma_f32_16x16x32_bf16 a[172:175], v[84:87], v[60:63], a[172:175]
    v_perm_b32 v95, v159, v155, s77
    v_mfma_f32_16x16x32_bf16 a[192:195], v[88:91], v[48:51], a[192:195]
    s_waitcnt vmcnt(16)
    v_perm_b32 v80, v164, v160, s76
    v_mfma_f32_16x16x32_bf16 a[196:199], v[88:91], v[52:55], a[196:199]
    v_perm_b32 v81, v172, v168, s76
    v_mfma_f32_16x16x32_bf16 a[200:203], v[88:91], v[56:59], a[200:203]
    v_perm_b32 v82, v180, v176, s76
    v_mfma_f32_16x16x32_bf16 a[204:207], v[88:91], v[60:63], a[204:207]
    v_perm_b32 v83, v188, v184, s76
    v_mfma_f32_16x16x32_bf16 a[224:227], v[92:95], v[48:51], a[224:227]
    v_perm_b32 v84, v164, v160, s77
    v_mfma_f32_16x16x32_bf16 a[228:231], v[92:95], v[52:55], a[228:231]
    v_perm_b32 v85, v172, v168, s77
    v_mfma_f32_16x16x32_bf16 a[232:235], v[92:95], v[56:59], a[232:235]
    v_perm_b32 v86, v180, v176, s77
    v_mfma_f32_16x16x32_bf16 a[236:239], v[92:95], v[60:63], a[236:239]
    s_waitcnt lgkmcnt(0)
    v_perm_b32 v87, v188, v184, s77
    v_add_u32 v2, 0x1000, v2
    v_add_u32 v3, 0x1000, v3
    s_mov_b32 s59, s60
    s_add_u32 s58, s58, 1
    s_cmp_le_u32 s58, s57
    s_cbranch_scc1 L_loopA4
    s_branch L_epi
L_loopB4:
    s_add_u32 s60, s59, s75
    s_cmp_lt_u32 s58, s57
    s_cselect_b32 s60, s60, 0x80000000
    s_add_u32 s72, s59, s63
    v_mfma_f32_16x16x32_bf16 a[0:3], v[16:19], v[80:83], a[0:3]
    s_add_u32 s73, s72, s64
    buffer_load_dwordx4 v[128:131], v4, s[44:47], s73 offen
    v_perm_b32 v88, v165, v161, s76
    v_mfma_f32_16x16x32_bf16 a[4:7], v[20:23], v[80:83], a[4:7]
    ds_read_b128 v[48:51], v2 offset:1024
    v_perm_b32 v89, v173, v169, s76
    v_mfma_f32_16x16x32_bf16 a[8:11], v[24:27], v[80:83], a[8:11]
    s_add_u32 s73, s72, s65
    buffer_load_dwordx4 v[132:135], v4, s[44:47], s73 offen
    v_perm_b32 v90, v181, v177, s76
    v_mfma_f32_16x16x32_bf16 a[12:15], v[28:31], v[80:83], a[12:15]
    v_perm_b32 v91, v189, v185, s76
    v_mfma_f32_16x16x32_bf16 a[32:35], v[16:19], v[84:87], a[32:35]
    s_add_u32 s73, s72, s66
    buffer_load_dwordx4 v[136:139], v4, s[44:47], s73 offen
    v_perm_b32 v92, v165, v161, s77
    v_mfma_f32_16x16x32_bf16 a[36:39], v[20:23], v[84:87], a[36:39]
    ds_read_b128 v[52:55], v2 offset:17408
    v_perm_b32 v93, v173, v169, s77
    v_mfma_f32_16x16x32_bf16 a[40:43], v[24:27], v[84:87], a[40:43]
    s_add_u32 s73, s72, s67
    buffer_load_dwordx4 v[140:143], v4, s[44:47], s73 offen
    v_perm_b32 v94, v181, v177, s77
    v_mfma_f32_16x16x32_bf16 a[44:47], v[28:31], v[84:87], a[44:47]
    v_perm_b32 v95, v189, v185, s77
    v_mfma_f32_16x16x32_bf16 a[64:67], v[16:19], v[88:91], a[64:67]
    s_add_u32 s73, s72, s68
    buffer_load_dwordx4 v[144:147], v4, s[44:47], s73 offen
    v_perm_b32 v80, v166, v162, s76
    v_mfma_f32_16x16x32_bf16 a[68:71], v[20:23], v[88:91], a[68:71]
    ds_read_b128 v[56:59], v2 offset:33792
    v_perm_b32 v81, v174, v170, s76
    v_mfma_f32_16x16x32_bf16 a[72:75], v[24:27], v[88:91], a[72:75]
    s_add_u32 s73, s72, s69
    buffer_load_dwordx4 v[148:151], v4, s[44:47], s73 offen
    v_perm_b32 v82, v182, v178, s76
    v_mfma_f32_16x16x32_bf16 a[76:79], v[28:31], v[88:91], a[76:79]
    v_perm_b32 v83, v190, v186, s76
    v_mfma_f32_16x16x32_bf16 a[96:99], v[16:19], v[92:95], a[96:99]
    s_add_u32 s73, s72, s70
    buffer_load_dwordx4 v[152:155], v4, s[44:47], s73 offen
    v_perm_b32 v84, v166, v162, s77
    v_mfma_f32_16x16x32_bf16 a[100:103], v[20:23], v[92:95], a[100:103]
    ds_read_b128 v[60:63], v2 offset:50176
    v_perm_b32 v85, v174, v170, s77
    v_mfma_f32_16x16x32_bf16 a[104:107], v[24:27], v[92:95], a[104:107]
    s_add_u32 s73, s72, s71
    buffer_load_dwordx4 v[156:159], v4, s[44:47], s73 offen
    v_perm_b32 v86, v182, v178, s77
    v_mfma_f32_16x16x32_bf16 a[108:111], v[28:31], v[92:95], a[108:111]
    v_perm_b32 v87, v190, v186, s77
    v_mfma_f32_16x16x32_bf16 a[128:131], v[16:19], v[80:83], a[128:131]
    v_perm_b32 v88, v167, v163, s76
    v_mfma_f32_16x16x32_bf16 a[132:135], v[20:23], v[80:83], a[132:135]
    v_perm_b32 v89, v175, v171, s76
    v_mfma_f32_16x16x32_bf16 a[136:139], v[24:27], v[80:83], a[136:139]
    v_perm_b32 v90, v183, v179, s76
    v_mfma_f32_16x16x32_bf16 a[140:143], v[28:31], v[80:83], a[140:143]
    v_perm_b32 v91, v191, v187, s76
    v_mfma_f32_16x16x32_bf16 a[160:163], v[16:19], v[84:87], a[160:163]
    v_perm_b32 v92, v167, v163, s77
    v_mfma_f32_16x16x32_bf16 a[164:167], v[20:23], v[84:87], a[164:167]
    v_perm_b32 v93, v175, v171, s77
    v_mfma_f32_16x16x32_bf16 a[168:171], v[24:27], v[84:87], a[168:171]
    v_perm_b32 v94, v183, v179, s77
    v_mfma_f32_16x16x32_bf16 a[172:175], v[28:31], v[84:87], a[172:175]
    v_perm_b32 v95, v191, v187, s77
    v_mfma_f32_16x16x32_bf16 a[192:195], v[16:19], v[88:91], a[192:195]
    s_waitcnt vmcnt(16)
    v_perm_b32 v80, v196, v192, s76
    v_mfma_f32_16x16x32_bf16 a[196:199], v[20:23], v[88:91], a[196:199]
    v_perm_b32 v81, v204, v200, s76
    v_mfma_f32_16x16x32_bf16 a[200:203], v[24:27], v[88:91], a[200:203]
    v_perm_b32 v82, v212, v208, s76
    v_mfma_f32_16x16x32_bf16 a[204:207], v[28:31], v[88:91], a[204:207]
    v_perm_b32 v83, v220, v216, s76
    v_mfma_f32_16x16x32_bf16 a[224:227], v[16:19], v[92:95], a[224:227]
    v_perm_b32 v84, v196, v192, s77
    v_mfma_f32_16x16x32_bf16 a[228:231], v[20:23], v[92:95], a[228:231]
    v_perm_b32 v85, v204, v200, s77
    v_mfma_f32_16x16x32_bf16 a[232:235], v[24:27], v[92:95], a[232:235]
    v_perm_b32 v86, v212, v208, s77
    v_mfma_f32_16x16x32_bf16 a[236:239], v[28:31], v[92:95], a[236:239]
    s_waitcnt lgkmcnt(0)
    v_perm_b32 v87, v220, v216, s77
    s_mov_b32 s72, s60
    v_mfma_f32_16x16x32_bf16 a[0:3], v[48:51], v[80:83], a[0:3]
    s_add_u32 s73, s72, s64
    buffer_load_dwordx4 v[160:163], v4, s[44:47], s73 offen
    v_perm_b32 v88, v197, v193, s76
    v_mfma_f32_16x16x32_bf16 a[4:7], v[52:55], v[80:83], a[4:7]
    ds_read_b128 v[16:19], v2 offset:2048
    v_perm_b32 v89, v205, v201, s76
    v_mfma_f32_16x16x32_bf16 a[8:11], v[56:59], v[80:83], a[8:11]
    s_add_u32 s73, s72, s65
    buffer_load_dwordx4 v[164:167], v4, s[44:47], s73 offen
    v_perm_b32 v90, v213, v209, s76
    v_mfma_f32_16x16x32_bf16 a[12:15], v[60:63], v[80:83], a[12:15]
    v_perm_b32 v91, v221, v217, s76
    v_mfma_f32_16x16x32_bf16 a[32:35], v[48:51], v[84:87], a[32:35]
    s_add_u32 s73, s72, s66
    buffer_load_dwordx4 v[168:171], v4, s[44:47], s73 offen
    v_perm_b32 v92, v197, v193, s77
    v_mfma_f32_16x16x32_bf16 a[36:39], v[52:55], v[84:87], a[36:39]
    ds_read_b128 v[20:23], v2 offset:18432
    v_perm_b32 v93, v205, v201, s77
    v_mfma_f32_16x16x32_bf16 a[40:43], v[56:59], v[84:87], a[40:43]
    s_add_u32 s73, s72, s67
    buffer_load_dwordx4 v[172:175], v4, s[44:47], s73 offen
    v_perm_b32 v94, v213, v209, s77
    v_mfma_f32_16x16x32_bf16 a[44:47], v[60:63], v[84:87], a[44:47]
    v_perm_b32 v95, v221, v217, s77
    v_mfma_f32_16x16x32_bf16 a[64:67], v[48:51], v[88:91], a[64:67]
    s_add_u32 s73, s72, s68
    buffer_load_dwordx4 v[176:179], v4, s[44:47], s73 offen
    v_perm_b32 v80, v198, v194, s76
    v_mfma_f32_16x16x32_bf16 a[68:71], v[52:55], v[88:91], a[68:71]
    ds_read_b128 v[24:27], v2 offset:34816
    v_perm_b32 v81, v206, v202, s76
    v_mfma_f32_16x16x32_bf16 a[72:75], v[56:59], v[88:91], a[72:75]
    s_add_u32 s73, s72, s69
    buffer_load_dwordx4 v[180:183], v4, s[44:47], s73 offen
    v_perm_b32 v82, v214, v210, s76
    v_mfma_f32_16x16x32_bf16 a[76:79], v[60:63], v[88:91], a[76:79]
    v_perm_b32 v83, v222, v218, s76
    v_mfma_f32_16x16x32_bf16 a[96:99], v[48:51], v[92:95], a[96:99]
    s_add_u32 s73, s72, s70
    buffer_load_dwordx4 v[184:187], v4, s[44:47], s73 offen
    v_perm_b32 v84, v198, v194, s77
    v_mfma_f32_16x16x32_bf16 a[100:103], v[52:55], v[92:95], a[100:103]
    ds_read_b128 v[28:31], v2 offset:51200
    v_perm_b32 v85, v206, v202, s77
    v_mfma_f32_16x16x32_bf16 a[104:107], v[56:59], v[92:95], a[104:107]
    s_add_u32 s73, s72, s71
    buffer_load_dwordx4 v[188:191], v4, s[44:47], s73 offen
    v_perm_b32 v86, v214, v210, s77
    v_mfma_f32_16x16x32_bf16 a[108:111], v[60:63], v[92:95], a[108:111]
    v_perm_b32 v87, v222, v218, s77
    v_mfma_f32_16x16x32_bf16 a[128:131], v[48:51], v[80:83], a[128:131]
    v_perm_b32 v88, v199, v195, s76
    v_mfma_f32_16x16x32_bf16 a[132:135], v[52:55], v[80:83], a[132:135]
    v_perm_b32 v89, v207, v203, s76
    v_mfma_f32_16x16x32_bf16 a[136:139], v[56:59], v[80:83], a[136:139]
    v_perm_b32 v90, v215, v211, s76
    v_mfma_f32_16x16x32_bf16 a[140:143], v[60:63], v[80:83], a[140:143]
    v_perm_b32 v91, v223, v219, s76
    v_mfma_f32_16x16x32_bf16 a[160:163], v[48:51], v[84:87], a[160:163]
    s_cmp_eq_u32 s58, s92
    s_cbranch_scc0 L_ncB4
    global_load_dword v14, v15, s[30:31] sc1
L_ncB4:
    v_perm_b32 v92, v199, v195, s77
    v_mfma_f32_16x16x32_bf16 a[164:167], v[52:55], v[84:87], a[164:167]
    v_perm_b32 v93, v207, v203, s77
    v_mfma_f32_16x16x32_bf16 a[168:171], v[56:59], v[84:87], a[168:171]
    v_perm_b32 v94, v215, v211, s77
    v_mfma_f32_16x16x32_bf16 a[172:175], v[60:63], v[84:87], a[172:175]
    v_perm_b32 v95, v223, v219, s77
    v_mfma_f32_16x16x32_bf16 a[192:195], v[48:51], v[88:91], a[192:195]
    s_waitcnt vmcnt(16)
    v_perm_b32 v80, v228, v224, s76
    v_mfma_f32_16x16x32_bf16 a[196:199], v[52:55], v[88:91], a[196:199]
    v_perm_b32 v81, v236, v232, s76
    v_mfma_f32_16x16x32_bf16 a[200:203], v[56:59], v[88:91], a[200:203]
    v_perm_b32 v82, v244, v240, s76
    v_mfma_f32_16x16x32_bf16 a[204:207], v[60:63], v[88:91], a[204:207]
    v_perm_b32 v83, v252, v248, s76
    v_mfma_f32_16x16x32_bf16 a[224:227], v[48:51], v[92:95], a[224:227]
    v_perm_b32 v84, v228, v224, s77
    v_mfma_f32_16x16x32_bf16 a[228:231], v[52:55], v[92:95], a[228:231]
    v_perm_b32 v85, v236, v232, s77
    v_mfma_f32_16x16x32_bf16 a[232:235], v[56:59], v[92:95], a[232:235]
    v_perm_b32 v86, v244, v240, s77
    v_mfma_f32_16x16x32_bf16 a[236:239], v[60:63], v[92:95], a[236:239]
    s_waitcnt lgkmcnt(0)
    v_perm_b32 v87, v252, v248, s77
    s_add_u32 s72, s60, s61
    v_mfma_f32_16x16x32_bf16 a[0:3], v[16:19], v[80:83], a[0:3]
    s_add_u32 s73, s72, s64
    buffer_load_dwordx4 v[192:195], v4, s[44:47], s73 offen
    v_perm_b32 v88, v229, v225, s76
    v_mfma_f32_16x16x32_bf16 a[4:7], v[20:23], v[80:83], a[4:7]
    ds_read_b128 v[48:51], v2 offset:3072
    v_perm_b32 v89, v237, v233, s76
    v_mfma_f32_16x16x32_bf16 a[8:11], v[24:27], v[80:83], a[8:11]
    s_add_u32 s73, s72, s65
    buffer_load_dwordx4 v[196:199], v4, s[44:47], s73 offen
    v_perm_b32 v90, v245, v241, s76
    v_mfma_f32_16x16x32_bf16 a[12:15], v[28:31], v[80:83], a[12:15]
    v_perm_b32 v91, v253, v249, s76
    v_mfma_f32_16x16x32_bf16 a[32:35], v[16:19], v[84:87], a[32:35]
    s_add_u32 s73, s72, s66
    buffer_load_dwordx4 v[200:203], v4, s[44:47], s73 offen
    v_perm_b32 v92, v229, v225, s77
    v_mfma_f32_16x16x32_bf16 a[36:39], v[20:23], v[84:87], a[36:39]
    ds_read_b128 v[52:55], v2 offset:19456
    v_perm_b32 v93, v237, v233, s77
    v_mfma_f32_16x16x32_bf16 a[40:43], v[24:27], v[84:87], a[40:43]
    s_add_u32 s73, s72, s67
    buffer_load_dwordx4 v[204:207], v4, s[44:47], s73 offen
    v_perm_b32 v94, v245, v241, s77
    v_mfma_f32_16x16x32_bf16 a[44:47], v[28:31], v[84:87], a[44:47]
    v_perm_b32 v95, v253, v249, s77
    v_mfma_f32_16x16x32_bf16 a[64:67], v[16:19], v[88:91], a[64:67]
    s_add_u32 s73, s72, s68
    buffer_load_dwordx4 v[208:211], v4, s[44:47], s73 offen
    v_perm_b32 v80, v230, v226, s76
    v_mfma_f32_16x16x32_bf16 a[68:71], v[20:23], v[88:91], a[68:71]
    ds_read_b128 v[56:59], v2 offset:35840
    v_perm_b32 v81, v238, v234, s76
    v_mfma_f32_16x16x32_bf16 a[72:75], v[24:27], v[88:91], a[72:75]
    s_add_u32 s73, s72, s69
    buffer_load_dwordx4 v[212:215], v4, s[44:47], s73 offen
    v_perm_b32 v82, v246, v242, s76
    v_mfma_f32_16x16x32_bf16 a[76:79], v[28:31], v[88:91], a[76:79]
    v_perm_b32 v83, v254, v250, s76
    v_mfma_f32_16x16x32_bf16 a[96:99], v[16:19], v[92:95], a[96:99]
    s_add_u32 s73, s72, s70
    buffer_load_dwordx4 v[216:219], v4, s[44:47], s73 offen
    v_perm_b32 v84, v230, v226, s77
    v_mfma_f32_16x16x32_bf16 a[100:103], v[20:23], v[92:95], a[100:103]
    ds_read_b128 v[60:63], v2 offset:52224
    v_perm_b32 v85, v238, v234, s77
    v_mfma_f32_16x16x32_bf16 a[104:107], v[24:27], v[92:95], a[104:107]
    s_add_u32 s73, s72, s71
    buffer_load_dwordx4 v[220:223], v4, s[44:47], s73 offen
    v_perm_b32 v86, v246, v242, s77
    v_mfma_f32_16x16x32_bf16 a[108:111], v[28:31], v[92:95], a[108:111]
    v_perm_b32 v87, v254, v250, s77
    v_mfma_f32_16x16x32_bf16 a[128:131], v[16:19], v[80:83], a[128:131]
    v_perm_b32 v88, v231, v227, s76
    v_mfma_f32_16x16x32_bf16 a[132:135], v[20:23], v[80:83], a[132:135]
    v_perm_b32 v89, v239, v235, s76
    v_mfma_f32_16x16x32_bf16 a[136:139], v[24:27], v[80:83], a[136:139]
    v_perm_b32 v90, v247, v243, s76
    v_mfma_f32_16x16x32_bf16 a[140:143], v[28:31], v[80:83], a[140:143]
    v_perm_b32 v91, v255, v251, s76
    v_mfma_f32_16x16x32_bf16 a[160:163], v[16:19], v[84:87], a[160:163]
    v_perm_b32 v92, v231, v227, s77
    v_mfma_f32_16x16x32_bf16 a[164:167], v[20:23], v[84:87], a[164:167]
    v_perm_b32 v93, v239, v235, s77
    v_mfma_f32_16x16x32_bf16 a[168:171], v[24:27], v[84:87], a[168:171]
    v_perm_b32 v94, v247, v243, s77
    v_mfma_f32_16x16x32_bf16 a[172:175], v[28:31], v[84:87], a[172:175]
    v_perm_b32 v95, v255, v251, s77
    v_mfma_f32_16x16x32_bf16 a[192:195], v[16:19], v[88:91], a[192:195]
    s_waitcnt vmcnt(16)
    v_perm_b32 v80, v132, v128, s76
    v_mfma_f32_16x16x32_bf16 a[196:199], v[20:23], v[88:91], a[196:199]
    v_perm_b32 v81, v140, v136, s76
    v_mfma_f32_16x16x32_bf16 a[200:203], v[24:27], v[88:91], a[200:203]
    v_perm_b32 v82, v148, v144, s76
    v_mfma_f32_16x16x32_bf16 a[204:207], v[28:31], v[88:91], a[204:207]
    v_perm_b32 v83, v156, v152, s76
    v_mfma_f32_16x16x32_bf16 a[224:227], v[16:19], v[92:95], a[224:227]
    v_perm_b32 v84, v132, v128, s77
    v_mfma_f32_16x16x32_bf16 a[228:231], v[20:23], v[92:95], a[228:231]
    v_perm_b32 v85, v140, v136, s77
    v_mfma_f32_16x16x32_bf16 a[232:235], v[24:27], v[92:95], a[232:235]
    v_perm_b32 v86, v148, v144, s77
    v_mfma_f32_16x16x32_bf16 a[236:239], v[28:31], v[92:95], a[236:239]
    s_waitcnt lgkmcnt(0)
    v_perm_b32 v87, v156, v152, s77
    s_add_u32 s72, s60, s62
    v_mfma_f32_16x16x32_bf16 a[0:3], v[48:51], v[80:83], a[0:3]
    s_add_u32 s73, s72, s64
    buffer_load_dwordx4 v[224:227], v4, s[44:47], s73 offen
    v_perm_b32 v88, v133, v129, s76
    v_mfma_f32_16x16x32_bf16 a[4:7], v[52:55], v[80:83], a[4:7]
    ds_read_b128 v[16:19], v2 offset:4096
    v_perm_b32 v89, v141, v137, s76
    v_mfma_f32_16x16x32_bf16 a[8:11], v[56:59], v[80:83], a[8:11]
    s_add_u32 s73, s72, s65
    buffer_load_dwordx4 v[228:231], v4, s[44:47], s73 offen
    v_perm_b32 v90, v149, v145, s76
    v_mfma_f32_16x16x32_bf16 a[12:15], v[60:63], v[80:83], a[12:15]
    v_perm_b32 v91, v157, v153, s76
    v_mfma_f32_16x16x32_bf16 a[32:35], v[48:51], v[84:87], a[32:35]
    s_add_u32 s73, s72, s66
    buffer_load_dwordx4 v[232:235], v4, s[44:47], s73 offen
    v_perm_b32 v92, v133, v129, s77
    v_mfma_f32_16x16x32_bf16 a[36:39], v[52:55], v[84:87], a[36:39]
    ds_read_b128 v[20:23], v2 offset:20480
    v_perm_b32 v93, v141, v137, s77
    v_mfma_f32_16x16x32_bf16 a[40:43], v[56:59], v[84:87], a[40:43]
    s_add_u32 s73, s72, s67
    buffer_load_dwordx4 v[236:239], v4, s[44:47], s73 offen
    v_perm_b32 v94, v149, v145, s77
    v_mfma_f32_16x16x32_bf16 a[44:47], v[60:63], v[84:87], a[44:47]
    v_perm_b32 v95, v157, v153, s77
    v_mfma_f32_16x16x32_bf16 a[64:67], v[48:51], v[88:91], a[64:67]
    s_add_u32 s73, s72, s68
    buffer_load_dwordx4 v[240:243], v4, s[44:47], s73 offen
    v_perm_b32 v80, v134, v130, s76
    v_mfma_f32_16x16x32_bf16 a[68:71], v[52:55], v[88:91], a[68:71]
    ds_read_b128 v[24:27], v2 offset:36864
    v_perm_b32 v81, v142, v138, s76
    v_mfma_f32_16x16x32_bf16 a[72:75], v[56:59], v[88:91], a[72:75]
    s_add_u32 s73, s72, s69
    buffer_load_dwordx4 v[244:247], v4, s[44:47], s73 offen
    v_perm_b32 v82, v150, v146, s76
    v_mfma_f32_16x16x32_bf16 a[76:79], v[60:63], v[88:91], a[76:79]
    v_perm_b32 v83, v158, v154, s76
    v_mfma_f32_16x16x32_bf16 a[96:99], v[48:51], v[92:95], a[96:99]
    s_add_u32 s73, s72, s70
    buffer_load_dwordx4 v[248:251], v4, s[44:47], s73 offen
    v_perm_b32 v84, v134, v130, s77
    v_mfma_f32_16x16x32_bf16 a[100:103], v[52:55], v[92:95], a[100:103]
    ds_read_b128 v[28:31], v2 offset:53248
    v_perm_b32 v85, v142, v138, s77
    v_mfma_f32_16x16x32_bf16 a[104:107], v[56:59], v[92:95], a[104:107]
    s_add_u32 s73, s72, s71
    buffer_load_dwordx4 v[252:255], v4, s[44:47], s73 offen
    v_perm_b32 v86, v150, v146, s77
    v_mfma_f32_16x16x32_bf16 a[108:111], v[60:63], v[92:95], a[108:111]
    v_perm_b32 v87, v158, v154, s77
    v_mfma_f32_16x16x32_bf16 a[128:131], v[48:51], v[80:83], a[128:131]
    v_perm_b32 v88, v135, v131, s76
    v_mfma_f32_16x16x32_bf16 a[132:135], v[52:55], v[80:83], a[132:135]
    v_perm_b32 v89, v143, v139, s76
    v_mfma_f32_16x16x32_bf16 a[136:139], v[56:59], v[80:83], a[136:139]
    v_perm_b32 v90, v151, v147, s76
    v_mfma_f32_16x16x32_bf16 a[140:143], v[60:63], v[80:83], a[140:143]
    v_perm_b32 v91, v159, v155, s76
    v_mfma_f32_16x16x32_bf16 a[160:163], v[48:51], v[84:87], a[160:163]
    v_perm_b32 v92, v135, v131, s77
    v_mfma_f32_16x16x32_bf16 a[164:167], v[52:55], v[84:87], a[164:167]
    v_perm_b32 v93, v143, v139, s77
    v_mfma_f32_16x16x32_bf16 a[168:171], v[56:59], v[84:87], a[168:171]
    v_perm_b32 v94, v151, v147, s77
    v_mfma_f32_16x16x32_bf16 a[172:175], v[60:63], v[84:87], a[172:175]
    v_perm_b32 v95, v159, v155, s77
    v_mfma_f32_16x16x32_bf16 a[192:195], v[48:51], v[88:91], a[192:195]
    s_waitcnt vmcnt(16)
    v_perm_b32 v80, v164, v160, s76
    v_mfma_f32_16x16x32_bf16 a[196:199], v[52:55], v[88:91], a[196:199]
    v_perm_b32 v81, v172, v168, s76
    v_mfma_f32_16x16x32_bf16 a[200:203], v[56:59], v[88:91], a[200:203]
    v_perm_b32 v82, v180, v176, s76
    v_mfma_f32_16x16x32_bf16 a[204:207], v[60:63], v[88:91], a[204:207]
    v_perm_b32 v83, v188, v184, s76
    v_mfma_f32_16x16x32_bf16 a[224:227], v[48:51], v[92:95], a[224:227]
    v_perm_b32 v84, v164, v160, s77
    v_mfma_f32_16x16x32_bf16 a[228:231], v[52:55], v[92:95], a[228:231]
    v_perm_b32 v85, v172, v168, s77
    v_mfma_f32_16x16x32_bf16 a[232:235], v[56:59], v[92:95], a[232:235]
    v_perm_b32 v86, v180, v176, s77
    v_mfma_f32_16x16x32_bf16 a[236:239], v[60:63], v[92:95], a[236:239]
    s_waitcnt lgkmcnt(0)
    v_perm_b32 v87, v188, v184, s77
    v_add_u32 v2, 0x1000, v2
    v_add_u32 v3, 0x1000, v3
    s_mov_b32 s59, s60
    s_add_u32 s58, s58, 1
    s_cmp_le_u32 s58, s57
    s_cbranch_scc1 L_loopB4
    s_branch L_epi
L_loopA8:
    s_add_u32 s60, s59, s75
    s_cmp_lt_u32 s58, s57
    s_cselect_b32 s60, s60, 0x80000000
    s_add_u32 s72, s59, s63
    v_mfma_f32_16x16x32_bf16 a[0:3], v[80:83], v[16:19], a[0:3]
    v_mfma_f32_16x16x32_bf16 a[4:7], v[80:83], v[20:23], a[4:7]
    v_mfma_f32_16x16x32_bf16 a[8:11], v[80:83], v[24:27], a[8:11]
    v_perm_b32 v84, v164, v160, s77
    v_mfma_f32_16x16x32_bf16 a[12:15], v[80:83], v[28:31], a[12:15]
    v_perm_b32 v85, v172, v168, s77
    v_mfma_f32_16x16x32_bf16 a[16:19], v[80:83], v[32:35], a[16:19]
    v_perm_b32 v86, v180, v176, s77
    v_mfma_f32_16x16x32_bf16 a[20:23], v[80:83], v[36:39], a[20:23]
    v_perm_b32 v87, v188, v184, s77
    v_mfma_f32_16x16x32_bf16 a[24:27], v[80:83], v[40:43], a[24:27]
    v_mfma_f32_16x16x32_bf16 a[28:31], v[80:83], v[44:47], a[28:31]
    ds_read_b128 v[48:51], v2 offset:1024
    v_mfma_f32_16x16x32_bf16 a[32:35], v[84:87], v[16:19], a[32:35]
    s_add_u32 s73, s72, s64
    buffer_load_dwordx4 v[128:131], v4, s[44:47], s73 offen
    v_mfma_f32_16x16x32_bf16 a[36:39], v[84:87], v[20:23], a[36:39]
    v_mfma_f32_16x16x32_bf16 a[40:43], v[84:87], v[24:27], a[40:43]
    v_perm_b32 v80, v165, v161, s76
    v_mfma_f32_16x16x32_bf16 a[44:47], v[84:87], v[28:31], a[44:47]
    v_perm_b32 v81, v173, v169, s76
    v_mfma_f32_16x16x32_bf16 a[48:51], v[84:87], v[32:35], a[48:51]
    v_perm_b32 v82, v181, v177, s76
    v_mfma_f32_16x16x32_bf16 a[52:55], v[84:87], v[36:39], a[52:55]
    v_perm_b32 v83, v189, v185, s76
    v_mfma_f32_16x16x32_bf16 a[56:59], v[84:87], v[40:43], a[56:59]
    s_add_u32 s73, s72, s65
    buffer_load_dwordx4 v[132:135], v4, s[44:47], s73 offen
    v_mfma_f32_16x16x32_bf16 a[60:63], v[84:87], v[44:47], a[60:63]
    ds_read_b128 v[52:55], v2 offset:17408
    v_mfma_f32_16x16x32_bf16 a[64:67], v[80:83], v[16:19], a[64:67]
    s_add_u32 s73, s72, s66
    buffer_load_dwordx4 v[136:139], v4, s[44:47], s73 offen
    v_mfma_f32_16x16x32_bf16 a[68:71], v[80:83], v[20:23], a[68:71]
    v_mfma_f32_16x16x32_bf16 a[72:75], v[80:83], v[24:27], a[72:75]
    v_perm_b32 v84, v165, v161, s77
    v_mfma_f32_16x16x32_bf16 a[76:79], v[80:83], v[28:31], a[76:79]
    v_perm_b32 v85, v173, v169, s77
    v_mfma_f32_16x16x32_bf16 a[80:83], v[80:83], v[32:35], a[80:83]
    v_perm_b32 v86, v181, v177, s77
    v_mfma_f32_16x16x32_bf16 a[84:87], v[80:83], v[36:39], a[84:87]
    v_perm_b32 v87, v189, v185, s77
    v_mfma_f32_16x16x32_bf16 a[88:91], v[80:83], v[40:43], a[88:91]
    s_add_u32 s73, s72, s67
    buffer_load_dwordx4 v[140:143], v4, s[44:47], s73 offen
    v_mfma_f32_16x16x32_bf16 a[92:95], v[80:83], v[44:47], a[92:95]
    ds_read_b128 v[56:59], v2 offset:33792
    v_mfma_f32_16x16x32_bf16 a[96:99], v[84:87], v[16:19], a[96:99]
    s_add_u32 s73, s72, s68
    buffer_load_dwordx4 v[144:147], v4, s[44:47], s73 offen
    v_mfma_f32_16x16x32_bf16 a[100:103], v[84:87], v[20:23], a[100:103]
    v_mfma_f32_16x16x32_bf16 a[104:107], v[84:87], v[24:27], a[104:107]
    v_perm_b32 v80, v166, v162, s76
    v_mfma_f32_16x16x32_bf16 a[108:111], v[84:87], v[28:31], a[108:111]
    v_perm_b32 v81, v174, v170, s76
    v_mfma_f32_16x16x32_bf16 a[112:115], v[84:87], v[32:35], a[112:115]
    v_perm_b32 v82, v182, v178, s76
    v_mfma_f32_16x16x32_bf16 a[116:119], v[84:87], v[36:39], a[116:119]
    v_perm_b32 v83, v190, v186, s76
    v_mfma_f32_16x16x32_bf16 a[120:123], v[84:87], v[40:43], a[120:123]
    s_add_u32 s73, s72, s69
    buffer_load_dwordx4 v[148:151], v4, s[44:47], s73 offen
    v_mfma_f32_16x16x32_bf16 a[124:127], v[84:87], v[44:47], a[124:127]
    ds_read_b128 v[60:63], v2 offset:50176
    v_mfma_f32_16x16x32_bf16 a[128:131], v[80:83], v[16:19], a[128:131]
    s_add_u32 s73, s72, s70
    buffer_load_dwordx4 v[152:155], v4, s[44:47], s73 offen
    v_mfma_f32_16x16x32_bf16 a[132:135], v[80:83], v[20:23], a[132:135]
    v_mfma_f32_16x16x32_bf16 a[136:139], v[80:83], v[24:27], a[136:139]
    v_perm_b32 v84, v166, v162, s77
    v_mfma_f32_16x16x32_bf16 a[140:143], v[80:83], v[28:31], a[140:143]
    v_perm_b32 v85, v174, v170, s77
    v_mfma_f32_16x16x32_bf16 a[144:147], v[80:83], v[32:35], a[144:147]
    v_perm_b32 v86, v182, v178, s77
    v_mfma_f32_16x16x32_bf16 a[148:151], v[80:83], v[36:39], a[148:151]
    v_perm_b32 v87, v190, v186, s77
    v_mfma_f32_16x16x32_bf16 a[152:155], v[80:83], v[40:43], a[152:155]
    s_add_u32 s73, s72, s71
    buffer_load_dwordx4 v[156:159], v4, s[44:47], s73 offen
    v_mfma_f32_16x16x32_bf16 a[156:159], v[80:83], v[44:47], a[156:159]
    ds_read_b128 v[64:67], v3 offset:1024
    v_mfma_f32_16x16x32_bf16 a[160:163], v[84:87], v[16:19], a[160:163]
    v_mfma_f32_16x16x32_bf16 a[164:167], v[84:87], v[20:23], a[164:167]
    v_mfma_f32_16x16x32_bf16 a[168:171], v[84:87], v[24:27], a[168:171]
    v_perm_b32 v80, v167, v163, s76
    v_mfma_f32_16x16x32_bf16 a[172:175], v[84:87], v[28:31], a[172:175]
    v_perm_b32 v81, v175, v171, s76
    v_mfma_f32_16x16x32_bf16 a[176:179], v[84:87], v[32:35], a[176:179]
    v_perm_b32 v82, v183, v179, s76
    v_mfma_f32_16x16x32_bf16 a[180:183], v[84:87], v[36:39], a[180:183]
    v_perm_b32 v83, v191, v187, s76
    v_mfma_f32_16x16x32_bf16 a[184:187], v[84:87], v[40:43], a[184:187]
    v_mfma_f32_16x16x32_bf16 a[188:191], v[84:87], v[44:47], a[188:191]
    ds_read_b128 v[68:71], v3 offset:17408
    v_mfma_f32_16x16x32_bf16 a[192:195], v[80:83], v[16:19], a[192:195]
    v_mfma_f32_16x16x32_bf16 a[196:199], v[80:83], v[20:23], a[196:199]
    ds_read_b128 v[76:79], v3 offset:50176
    v_mfma_f32_16x16x32_bf16 a[200:203], v[80:83], v[24:27], a[200:203]
    v_perm_b32 v84, v167, v163, s77
    v_mfma_f32_16x16x32_bf16 a[204:207], v[80:83], v[28:31], a[204:207]
    v_perm_b32 v85, v175, v171, s77
    v_mfma_f32_16x16x32_bf16 a[208:211], v[80:83], v[32:35], a[208:211]
    v_perm_b32 v86, v183, v179, s77
    v_mfma_f32_16x16x32_bf16 a[212:215], v[80:83], v[36:39], a[212:215]
    v_perm_b32 v87, v191, v187, s77
    v_mfma_f32_16x16x32_bf16 a[216:219], v[80:83], v[40:43], a[216:219]
    v_mfma_f32_16x16x32_bf16 a[220:223], v[80:83], v[44:47], a[220:223]
    ds_read_b128 v[72:75], v3 offset:33792
    v_mfma_f32_16x16x32_bf16 a[224:227], v[84:87], v[16:19], a[224:227]
    s_waitcnt vmcnt(16)
    v_mfma_f32_16x16x32_bf16 a[228:231], v[84:87], v[20:23], a[228:231]
    v_mfma_f32_16x16x32_bf16 a[232:235], v[84:87], v[24:27], a[232:235]
    v_perm_b32 v80, v196, v192, s76
    v_mfma_f32_16x16x32_bf16 a[236:239], v[84:87], v[28:31], a[236:239]
    v_perm_b32 v81, v204, v200, s76
    v_mfma_f32_16x16x32_bf16 a[240:243], v[84:87], v[32:35], a[240:243]
    v_perm_b32 v82, v212, v208, s76
    v_mfma_f32_16x16x32_bf16 a[244:247], v[84:87], v[36:39], a[244:247]
    v_perm_b32 v83, v220, v216, s76
    v_mfma_f32_16x16x32_bf16 a[248:251], v[84:87], v[40:43], a[248:251]
    v_mfma_f32_16x16x32_bf16 a[252:255], v[84:87], v[44:47], a[252:255]
    s_waitcnt lgkmcnt(0)
    s_mov_b32 s72, s60
    v_mfma_f32_16x16x32_bf16 a[0:3], v[80:83], v[48:51], a[0:3]
    v_mfma_f32_16x16x32_bf16 a[4:7], v[80:83], v[52:55], a[4:7]
    v_mfma_f32_16x16x32_bf16 a[8:11], v[80:83], v[56:59], a[8:11]
    v_perm_b32 v84, v196, v192, s77
    v_mfma_f32_16x16x32_bf16 a[12:15], v[80:83], v[60:63], a[12:15]
    v_perm_b32 v85, v204, v200, s77
    v_mfma_f32_16x16x32_bf16 a[16:19], v[80:83], v[64:67], a[16:19]
    v_perm_b32 v86, v212, v208, s77
    v_mfma_f32_16x16x32_bf16 a[20:23], v[80:83], v[68:71], a[20:23]
    v_perm_b32 v87, v220, v216, s77
    v_mfma_f32_16x16x32_bf16 a[24:27], v[80:83], v[72:75], a[24:27]
    v_mfma_f32_16x16x32_bf16 a[28:31], v[80:83], v[76:79], a[28:31]
    ds_read_b128 v[16:19], v2 offset:2048
    v_mfma_f32_16x16x32_bf16 a[32:35], v[84:87], v[48:51], a[32:35]
    s_add_u32 s73, s72, s64
    buffer_load_dwordx4 v[160:163], v4, s[44:47], s73 offen
    v_mfma_f32_16x16x32_bf16 a[36:39], v[84:87], v[52:55], a[36:39]
    v_mfma_f32_16x16x32_bf16 a[40:43], v[84:87], v[56:59], a[40:43]
    v_perm_b32 v80, v197, v193, s76
    v_mfma_f32_16x16x32_bf16 a[44:47], v[84:87], v[60:63], a[44:47]
    v_perm_b32 v81, v205, v201, s76
    v_mfma_f32_16x16x32_bf16 a[48:51], v[84:87], v[64:67], a[48:51]
    v_perm_b32 v82, v213, v209, s76
    v_mfma_f32_16x16x32_bf16 a[52:55], v[84:87], v[68:71], a[52:55]
    v_perm_b32 v83, v221, v217, s76
    v_mfma_f32_16x16x32_bf16 a[56:59], v[84:87], v[72:75], a[56:59]
    s_add_u32 s73, s72, s65
    buffer_load_dwordx4 v[164:167], v4, s[44:47], s73 offen
    v_mfma_f32_16x16x32_bf16 a[60:63], v[84:87], v[76:79], a[60:63]
    ds_read_b128 v[20:23], v2 offset:18432
    v_mfma_f32_16x16x32_bf16 a[64:67], v[80:83], v[48:51], a[64:67]
    s_add_u32 s73, s72, s66
    buffer_load_dwordx4 v[168:171], v4, s[44:47], s73 offen
    v_mfma_f32_16x16x32_bf16 a[68:71], v[80:83], v[52:55], a[68:71]
    v_mfma_f32_16x16x32_bf16 a[72:75], v[80:83], v[56:59], a[72:75]
    v_perm_b32 v84, v197, v193, s77
    v_mfma_f32_16x16x32_bf16 a[76:79], v[80:83], v[60:63], a[76:79]
    v_perm_b32 v85, v205, v201, s77
    v_mfma_f32_16x16x32_bf16 a[80:83], v[80:83], v[64:67], a[80:83]
    v_perm_b32 v86, v213, v209, s77
    v_mfma_f32_16x16x32_bf16 a[84:87], v[80:83], v[68:71], a[84:87]
    v_perm_b32 v87, v221, v217, s77
    v_mfma_f32_16x16x32_bf16 a[88:91], v[80:83], v[72:75], a[88:91]
    s_add_u32 s73, s72, s67
    buffer_load_dwordx4 v[172:175], v4, s[44:47], s73 offen
    v_mfma_f32_16x16x32_bf16 a[92:95], v[80:83], v[76:79], a[92:95]
    ds_read_b128 v[24:27], v2 offset:34816
    v_mfma_f32_16x16x32_bf16 a[96:99], v[84:87], v[48:51], a[96:99]
    s_add_u32 s73, s72, s68
    buffer_load_dwordx4 v[176:179], v4, s[44:47], s73 offen
    v_mfma_f32_16x16x32_bf16 a[100:103], v[84:87], v[52:55], a[100:103]
    v_mfma_f32_16x16x32_bf16 a[104:107], v[84:87], v[56:59], a[104:107]
    v_perm_b32 v80, v198, v194, s76
    v_mfma_f32_16x16x32_bf16 a[108:111], v[84:87], v[60:63], a[108:111]
    v_perm_b32 v81, v206, v202, s76
    v_mfma_f32_16x16x32_bf16 a[112:115], v[84:87], v[64:67], a[112:115]
    v_perm_b32 v82, v214, v210, s76
    v_mfma_f32_16x16x32_bf16 a[116:119], v[84:87], v[68:71], a[116:119]
    v_perm_b32 v83, v222, v218, s76
    v_mfma_f32_16x16x32_bf16 a[120:123], v[84:87], v[72:75], a[120:123]
    s_add_u32 s73, s72, s69
    buffer_load_dwordx4 v[180:183], v4, s[44:47], s73 offen
    v_mfma_f32_16x16x32_bf16 a[124:127], v[84:87], v[76:79], a[124:127]
    ds_read_b128 v[28:31], v2 offset:51200
    v_mfma_f32_16x16x32_bf16 a[128:131], v[80:83], v[48:51], a[128:131]
    s_add_u32 s73, s72, s70
    buffer_load_dwordx4 v[184:187], v4, s[44:47], s73 offen
    v_mfma_f32_16x16x32_bf16 a[132:135], v[80:83], v[52:55], a[132:135]
    v_mfma_f32_16x16x32_bf16 a[136:139], v[80:83], v[56:59], a[136:139]
    v_perm_b32 v84, v198, v194, s77
    v_mfma_f32_16x16x32_bf16 a[140:143], v[80:83], v[60:63], a[140:143]
    v_perm_b32 v85, v206, v202, s77
    v_mfma_f32_16x16x32_bf16 a[144:147], v[80:83], v[64:67], a[144:147]
    v_perm_b32 v86, v214, v210, s77
    v_mfma_f32_16x16x32_bf16 a[148:151], v[80:83], v[68:71], a[148:151]
    v_perm_b32 v87, v222, v218, s77
    v_mfma_f32_16x16x32_bf16 a[152:155], v[80:83], v[72:75], a[152:155]
    s_add_u32 s73, s72, s71
    buffer_load_dwordx4 v[188:191], v4, s[44:47], s73 offen
    v_mfma_f32_16x16x32_bf16 a[156:159], v[80:83], v[76:79], a[156:159]
    ds_read_b128 v[32:35], v3 offset:2048
    v_mfma_f32_16x16x32_bf16 a[160:163], v[84:87], v[48:51], a[160:163]
    s_cmp_eq_u32 s58, s92
    s_cbranch_scc0 L_ncA8
    global_load_dword v14, v15, s[30:31] sc1
L_ncA8:
    v_mfma_f32_16x16x32_bf16 a[164:167], v[84:87], v[52:55], a[164:167]
    v_mfma_f32_16x16x32_bf16 a[168:171], v[84:87], v[56:59], a[168:171]
    v_perm_b32 v80, v199, v195, s76
    v_mfma_f32_16x16x32_bf16 a[172:175], v[84:87], v[60:63], a[172:175]
    v_perm_b32 v81, v207, v203, s76
    v_mfma_f32_16x16x32_bf16 a[176:179], v[84:87], v[64:67], a[176:179]
    v_perm_b32 v82, v215, v211, s76
    v_mfma_f32_16x16x32_bf16 a[180:183], v[84:87], v[68:71], a[180:183]
    v_perm_b32 v83, v223, v219, s76
    v_mfma_f32_16x16x32_bf16 a[184:187], v[84:87], v[72:75], a[184:187]
    v_mfma_f32_16x16x32_bf16 a[188:191], v[84:87], v[76:79], a[188:191]
    ds_read_b128 v[36:39], v3 offset:18432
    v_mfma_f32_16x16x32_bf16 a[192:195], v[80:83], v[48:51], a[192:195]
    v_mfma_f32_16x16x32_bf16 a[196:199], v[80:83], v[52:55], a[196:199]
    ds_read_b128 v[44:47], v3 offset:51200
    v_mfma_f32_16x16x32_bf16 a[200:203], v[80:83], v[56:59], a[200:203]
    v_perm_b32 v84, v199, v195, s77
    v_mfma_f32_16x16x32_bf16 a[204:207], v[80:83], v[60:63], a[204:207]
    v_perm_b32 v85, v207, v203, s77
    v_mfma_f32_16x16x32_bf16 a[208:211], v[80:83], v[64:67], a[208:211]
    v_perm_b32 v86, v215, v211, s77
    v_mfma_f32_16x16x32_bf16 a[212:215], v[80:83], v[68:71], a[212:215]
    v_perm_b32 v87, v223, v219, s77
    v_mfma_f32_16x16x32_bf16 a[216:219], v[80:83], v[72:75], a[216:219]
    v_mfma_f32_16x16x32_bf16 a[220:223], v[80:83], v[76:79], a[220:223]
    ds_read_b128 v[40:43], v3 offset:34816
    v_mfma_f32_16x16x32_bf16 a[224:227], v[84:87], v[48:51], a[224:227]
    s_waitcnt vmcnt(16)
    v_mfma_f32_16x16x32_bf16 a[228:231], v[84:87], v[52:55], a[228:231]
    v_mfma_f32_16x16x32_bf16 a[232:235], v[84:87], v[56:59], a[232:235]
    v_perm_b32 v80, v228, v224, s76
    v_mfma_f32_16x16x32_bf16 a[236:239], v[84:87], v[60:63], a[236:239]
    v_perm_b32 v81, v236, v232, s76
    v_mfma_f32_16x16x32_bf16 a[240:243], v[84:87], v[64:67], a[240:243]
    v_perm_b32 v82, v244, v240, s76
    v_mfma_f32_16x16x32_bf16 a[244:247], v[84:87], v[68:71], a[244:247]
    v_perm_b32 v83, v252, v248, s76
    v_mfma_f32_16x16x32_bf16 a[248:251], v[84:87], v[72:75], a[248:251]
    v_mfma_f32_16x16x32_bf16 a[252:255], v[84:87], v[76:79], a[252:255]
    s_waitcnt lgkmcnt(0)
    s_add_u32 s72, s60, s61
    v_mfma_f32_16x16x32_bf16 a[0:3], v[80:83], v[16:19], a[0:3]
    v_mfma_f32_16x16x32_bf16 a[4:7], v[80:83], v[20:23], a[4:7]
    v_mfma_f32_16x16x32_bf16 a[8:11], v[80:83], v[24:27], a[8:11]
    v_perm_b32 v84, v228, v224, s77
    v_mfma_f32_16x16x32_bf16 a[12:15], v[80:83], v[28:31], a[12:15]
    v_perm_b32 v85, v236, v232, s77
    v_mfma_f32_16x16x32_bf16 a[16:19], v[80:83], v[32:35], a[16:19]
    v_perm_b32 v86, v244, v240, s77
    v_mfma_f32_16x16x32_bf16 a[20:23], v[80:83], v[36:39], a[20:23]
    v_perm_b32 v87, v252, v248, s77
    v_mfma_f32_16x16x32_bf16 a[24:27], v[80:83], v[40:43], a[24:27]
    v_mfma_f32_16x16x32_bf16 a[28:31], v[80:83], v[44:47], a[28:31]
    ds_read_b128 v[48:51], v2 offset:3072
    v_mfma_f32_16x16x32_bf16 a[32:35], v[84:87], v[16:19], a[32:35]
    s_add_u32 s73, s72, s64
    buffer_load_dwordx4 v[192:195], v4, s[44:47], s73 offen
    v_mfma_f32_16x16x32_bf16 a[36:39], v[84:87], v[20:23], a[36:39]
    v_mfma_f32_16x16x32_bf16 a[40:43], v[84:87], v[24:27], a[40:43]
    v_perm_b32 v80, v229, v225, s76
    v_mfma_f32_16x16x32_bf16 a[44:47], v[84:87], v[28:31], a[44:47]
    v_perm_b32 v81, v237, v233, s76
    v_mfma_f32_16x16x32_bf16 a[48:51], v[84:87], v[32:35], a[48:51]
    v_perm_b32 v82, v245, v241, s76
    v_mfma_f32_16x16x32_bf16 a[52:55], v[84:87], v[36:39], a[52:55]
    v_perm_b32 v83, v253, v249, s76
    v_mfma_f32_16x16x32_bf16 a[56:59], v[84:87], v[40:43], a[56:59]
    s_add_u32 s73, s72, s65
    buffer_load_dwordx4 v[196:199], v4, s[44:47], s73 offen
    v_mfma_f32_16x16x32_bf16 a[60:63], v[84:87], v[44:47], a[60:63]
    ds_read_b128 v[52:55], v2 offset:19456
    v_mfma_f32_16x16x32_bf16 a[64:67], v[80:83], v[16:19], a[64:67]
    s_add_u32 s73, s72, s66
    buffer_load_dwordx4 v[200:203], v4, s[44:47], s73 offen
    v_mfma_f32_16x16x32_bf16 a[68:71], v[80:83], v[20:23], a[68:71]
    v_mfma_f32_16x16x32_bf16 a[72:75], v[80:83], v[24:27], a[72:75]
    v_perm_b32 v84, v229, v225, s77
    v_mfma_f32_16x16x32_bf16 a[76:79], v[80:83], v[28:31], a[76:79]
    v_perm_b32 v85, v237, v233, s77
    v_mfma_f32_16x16x32_bf16 a[80:83], v[80:83], v[32:35], a[80:83]
    v_perm_b32 v86, v245, v241, s77
    v_mfma_f32_16x16x32_bf16 a[84:87], v[80:83], v[36:39], a[84:87]
    v_perm_b32 v87, v253, v249, s77
    v_mfma_f32_16x16x32_bf16 a[88:91], v[80:83], v[40:43], a[88:91]
    s_add_u32 s73, s72, s67
    buffer_load_dwordx4 v[204:207], v4, s[44:47], s73 offen
    v_mfma_f32_16x16x32_bf16 a[92:95], v[80:83], v[44:47], a[92:95]
    ds_read_b128 v[56:59], v2 offset:35840
    v_mfma_f32_16x16x32_bf16 a[96:99], v[84:87], v[16:19], a[96:99]
    s_add_u32 s73, s72, s68
    buffer_load_dwordx4 v[208:211], v4, s[44:47], s73 offen
    v_mfma_f32_16x16x32_bf16 a[100:103], v[84:87], v[20:23], a[100:103]
    v_mfma_f32_16x16x32_bf16 a[104:107], v[84:87], v[24:27], a[104:107]
    v_perm_b32 v80, v230, v226, s76
    v_mfma_f32_16x16x32_bf16 a[108:111], v[84:87], v[28:31], a[108:111]
    v_perm_b32 v81, v238, v234, s76
    v_mfma_f32_16x16x32_bf16 a[112:115], v[84:87], v[32:35], a[112:115]
    v_perm_b32 v82, v246, v242, s76
    v_mfma_f32_16x16x32_bf16 a[116:119], v[84:87], v[36:39], a[116:119]
    v_perm_b32 v83, v254, v250, s76
    v_mfma_f32_16x16x32_bf16 a[120:123], v[84:87], v[40:43], a[120:123]
    s_add_u32 s73, s72, s69
    buffer_load_dwordx4 v[212:215], v4, s[44:47], s73 offen
    v_mfma_f32_16x16x32_bf16 a[124:127], v[84:87], v[44:47], a[124:127]
    ds_read_b128 v[60:63], v2 offset:52224
    v_mfma_f32_16x16x32_bf16 a[128:131], v[80:83], v[16:19], a[128:131]
    s_add_u32 s73, s72, s70
    buffer_load_dwordx4 v[216:219], v4, s[44:47], s73 offen
    v_mfma_f32_16x16x32_bf16 a[132:135], v[80:83], v[20:23], a[132:135]
    v_mfma_f32_16x16x32_bf16 a[136:139], v[80:83], v[24:27], a[136:139]
    v_perm_b32 v84, v230, v226, s77
    v_mfma_f32_16x16x32_bf16 a[140:143], v[80:83], v[28:31], a[140:143]
    v_perm_b32 v85, v238, v234, s77
    v_mfma_f32_16x16x32_bf16 a[144:147], v[80:83], v[32:35], a[144:147]
    v_perm_b32 v86, v246, v242, s77
    v_mfma_f32_16x16x32_bf16 a[148:151], v[80:83], v[36:39], a[148:151]
    v_perm_b32 v87, v254, v250, s77
    v_mfma_f32_16x16x32_bf16 a[152:155], v[80:83], v[40:43], a[152:155]
    s_add_u32 s73, s72, s71
    buffer_load_dwordx4 v[220:223], v4, s[44:47], s73 offen
    v_mfma_f32_16x16x32_bf16 a[156:159], v[80:83], v[44:47], a[156:159]
    ds_read_b128 v[64:67], v3 offset:3072
    v_mfma_f32_16x16x32_bf16 a[160:163], v[84:87], v[16:19], a[160:163]
    v_mfma_f32_16x16x32_bf16 a[164:167], v[84:87], v[20:23], a[164:167]
    v_mfma_f32_16x16x32_bf16 a[168:171], v[84:87], v[24:27], a[168:171]
    v_perm_b32 v80, v231, v227, s76
    v_mfma_f32_16x16x32_bf16 a[172:175], v[84:87], v[28:31], a[172:175]
    v_perm_b32 v81, v239, v235, s76
    v_mfma_f32_16x16x32_bf16 a[176:179], v[84:87], v[32:35], a[176:179]
    v_perm_b32 v82, v247, v243, s76
    v_mfma_f32_16x16x32_bf16 a[180:183], v[84:87], v[36:39], a[180:183]
    v_perm_b32 v83, v255, v251, s76
    v_mfma_f32_16x16x32_bf16 a[184:187], v[84:87], v[40:43], a[184:187]
    v_mfma_f32_16x16x32_bf16 a[188:191], v[84:87], v[44:47], a[188:191]
    ds_read_b128 v[68:71], v3 offset:19456
    v_mfma_f32_16x16x32_bf16 a[192:195], v[80:83], v[16:19], a[192:195]
    v_mfma_f32_16x16x32_bf16 a[196:199], v[80:83], v[20:23], a[196:199]
    ds_read_b128 v[76:79], v3 offset:52224
    v_mfma_f32_16x16x32_bf16 a[200:203], v[80:83], v[24:27], a[200:203]
    v_perm_b32 v84, v231, v227, s77
    v_mfma_f32_16x16x32_bf16 a[204:207], v[80:83], v[28:31], a[204:207]
    v_perm_b32 v85, v239, v235, s77
    v_mfma_f32_16x16x32_bf16 a[208:211], v[80:83], v[32:35], a[208:211]
    v_perm_b32 v86, v247, v243, s77
    v_mfma_f32_16x16x32_bf16 a[212:215], v[80:83], v[36:39], a[212:215]
    v_perm_b32 v87, v255, v251, s77
    v_mfma_f32_16x16x32_bf16 a[216:219], v[80:83], v[40:43], a[216:219]
    v_mfma_f32_16x16x32_bf16 a[220:223], v[80:83], v[44:47], a[220:223]
    ds_read_b128 v[72:75], v3 offset:35840
    v_mfma_f32_16x16x32_bf16 a[224:227], v[84:87], v[16:19], a[224:227]
    s_waitcnt vmcnt(16)
    v_mfma_f32_16x16x32_bf16 a[228:231], v[84:87], v[20:23], a[228:231]
    v_mfma_f32_16x16x32_bf16 a[232:235], v[84:87], v[24:27], a[232:235]
    v_perm_b32 v80, v132, v128, s76
    v_mfma_f32_16x16x32_bf16 a[236:239], v[84:87], v[28:31], a[236:239]
    v_perm_b32 v81, v140, v136, s76
    v_mfma_f32_16x16x32_bf16 a[240:243], v[84:87], v[32:35], a[240:243]
    v_perm_b32 v82, v148, v144, s76
    v_mfma_f32_16x16x32_bf16 a[244:247], v[84:87], v[36:39], a[244:247]
    v_perm_b32 v83, v156, v152, s76
    v_mfma_f32_16x16x32_bf16 a[248:251], v[84:87], v[40:43], a[248:251]
    v_mfma_f32_16x16x32_bf16 a[252:255], v[84:87], v[44:47], a[252:255]
    s_waitcnt lgkmcnt(0)
    s_add_u32 s72, s60, s62
    v_mfma_f32_16x16x32_bf16 a[0:3], v[80:83], v[48:51], a[0:3]
    v_mfma_f32_16x16x32_bf16 a[4:7], v[80:83], v[52:55], a[4:7]
    v_mfma_f32_16x16x32_bf16 a[8:11], v[80:83], v[56:59], a[8:11]
    v_perm_b32 v84, v132, v128, s77
    v_mfma_f32_16x16x32_bf16 a[12:15], v[80:83], v[60:63], a[12:15]
    v_perm_b32 v85, v140, v136, s77
    v_mfma_f32_16x16x32_bf16 a[16:19], v[80:83], v[64:67], a[16:19]
    v_perm_b32 v86, v148, v144, s77
    v_mfma_f32_16x16x32_bf16 a[20:23], v[80:83], v[68:71], a[20:23]
    v_perm_b32 v87, v156, v152, s77
    v_mfma_f32_16x16x32_bf16 a[24:27], v[80:83], v[72:75], a[24:27]
    v_mfma_f32_16x16x32_bf16 a[28:31], v[80:83], v[76:79], a[28:31]
    ds_read_b128 v[16:19], v2 offset:4096
    v_mfma_f32_16x16x32_bf16 a[32:35], v[84:87], v[48:51], a[32:35]
    s_add_u32 s73, s72, s64
    buffer_load_dwordx4 v[224:227], v4, s[44:47], s73 offen
    v_mfma_f32_16x16x32_bf16 a[36:39], v[84:87], v[52:55], a[36:39]
    v_mfma_f32_16x16x32_bf16 a[40:43], v[84:87], v[56:59], a[40:43]
    v_perm_b32 v80, v133, v129, s76
    v_mfma_f32_16x16x32_bf16 a[44:47], v[84:87], v[60:63], a[44:47]
    v_perm_b32 v81, v141, v137, s76
    v_mfma_f32_16x16x32_bf16 a[48:51], v[84:87], v[64:67], a[48:51]
    v_perm_b32 v82, v149, v145, s76
    v_mfma_f32_16x16x32_bf16 a[52:55], v[84:87], v[68:71], a[52:55]
    v_perm_b32 v83, v157, v153, s76
    v_mfma_f32_16x16x32_bf16 a[56:59], v[84:87], v[72:75], a[56:59]
    s_add_u32 s73, s72, s65
    buffer_load_dwordx4 v[228:231], v4, s[44:47], s73 offen
    v_mfma_f32_16x16x32_bf16 a[60:63], v[84:87], v[76:79], a[60:63]
    ds_read_b128 v[20:23], v2 offset:20480
    v_mfma_f32_16x16x32_bf16 a[64:67], v[80:83], v[48:51], a[64:67]
    s_add_u32 s73, s72, s66
    buffer_load_dwordx4 v[232:235], v4, s[44:47], s73 offen
    v_mfma_f32_16x16x32_bf16 a[68:71], v[80:83], v[52:55], a[68:71]
    v_mfma_f32_16x16x32_bf16 a[72:75], v[80:83], v[56:59], a[72:75]
    v_perm_b32 v84, v133, v129, s77
    v_mfma_f32_16x16x32_bf16 a[76:79], v[80:83], v[60:63], a[76:79]
    v_perm_b32 v85, v141, v137, s77
    v_mfma_f32_16x16x32_bf16 a[80:83], v[80:83], v[64:67], a[80:83]
    v_perm_b32 v86, v149, v145, s77
    v_mfma_f32_16x16x32_bf16 a[84:87], v[80:83], v[68:71], a[84:87]
    v_perm_b32 v87, v157, v153, s77
    v_mfma_f32_16x16x32_bf16 a[88:91], v[80:83], v[72:75], a[88:91]
    s_add_u32 s73, s72, s67
    buffer_load_dwordx4 v[236:239], v4, s[44:47], s73 offen
    v_mfma_f32_16x16x32_bf16 a[92:95], v[80:83], v[76:79], a[92:95]
    ds_read_b128 v[24:27], v2 offset:36864
    v_mfma_f32_16x16x32_bf16 a[96:99], v[84:87], v[48:51], a[96:99]
    s_add_u32 s73, s72, s68
    buffer_load_dwordx4 v[240:243], v4, s[44:47], s73 offen
    v_mfma_f32_16x16x32_bf16 a[100:103], v[84:87], v[52:55], a[100:103]
    v_mfma_f32_16x16x32_bf16 a[104:107], v[84:87], v[56:59], a[104:107]
    v_perm_b32 v80, v134, v130, s76
    v_mfma_f32_16x16x32_bf16 a[108:111], v[84:87], v[60:63], a[108:111]
    v_perm_b32 v81, v142, v138, s76
    v_mfma_f32_16x16x32_bf16 a[112:115], v[84:87], v[64:67], a[112:115]
    v_perm_b32 v82, v150, v146, s76
    v_mfma_f32_16x16x32_bf16 a[116:119], v[84:87], v[68:71], a[116:119]
    v_perm_b32 v83, v158, v154, s76
    v_mfma_f32_16x16x32_bf16 a[120:123], v[84:87], v[72:75], a[120:123]
    s_add_u32 s73, s72, s69
    buffer_load_dwordx4 v[244:247], v4, s[44:47], s73 offen
    v_mfma_f32_16x16x32_bf16 a[124:127], v[84:87], v[76:79], a[124:127]
    ds_read_b128 v[28:31], v2 offset:53248
    v_mfma_f32_16x16x32_bf16 a[128:131], v[80:83], v[48:51], a[128:131]
    s_add_u32 s73, s72, s70
    buffer_load_dwordx4 v[248:251], v4, s[44:47], s73 offen
    v_mfma_f32_16x16x32_bf16 a[132:135], v[80:83], v[52:55], a[132:135]
    v_mfma_f32_16x16x32_bf16 a[136:139], v[80:83], v[56:59], a[136:139]
    v_perm_b32 v84, v134, v130, s77
    v_mfma_f32_16x16x32_bf16 a[140:143], v[80:83], v[60:63], a[140:143]
    v_perm_b32 v85, v142, v138, s77
    v_mfma_f32_16x16x32_bf16 a[144:147], v[80:83], v[64:67], a[144:147]
    v_perm_b32 v86, v150, v146, s77
    v_mfma_f32_16x16x32_bf16 a[148:151], v[80:83], v[68:71], a[148:151]
    v_perm_b32 v87, v158, v154, s77
    v_mfma_f32_16x16x32_bf16 a[152:155], v[80:83], v[72:75], a[152:155]
    s_add_u32 s73, s72, s71
    buffer_load_dwordx4 v[252:255], v4, s[44:47], s73 offen
    v_mfma_f32_16x16x32_bf16 a[156:159], v[80:83], v[76:79], a[156:159]
    ds_read_b128 v[32:35], v3 offset:4096
    v_mfma_f32_16x16x32_bf16 a[160:163], v[84:87], v[48:51], a[160:163]
    v_mfma_f32_16x16x32_bf16 a[164:167], v[84:87], v[52:55], a[164:167]
    v_mfma_f32_16x16x32_bf16 a[168:171], v[84:87], v[56:59], a[168:171]
    v_perm_b32 v80, v135, v131, s76
    v_mfma_f32_16x16x32_bf16 a[172:175], v[84:87], v[60:63], a[172:175]
    v_perm_b32 v81, v143, v139, s76
    v_mfma_f32_16x16x32_bf16 a[176:179], v[84:87], v[64:67], a[176:179]
    v_perm_b32 v82, v151, v147, s76
    v_mfma_f32_16x16x32_bf16 a[180:183], v[84:87], v[68:71], a[180:183]
    v_perm_b32 v83, v159, v155, s76
    v_mfma_f32_16x16x32_bf16 a[184:187], v[84:87], v[72:75], a[184:187]
    v_mfma_f32_16x16x32_bf16 a[188:191], v[84:87], v[76:79], a[188:191]
    ds_read_b128 v[36:39], v3 offset:20480
    v_mfma_f32_16x16x32_bf16 a[192:195], v[80:83], v[48:51], a[192:195]
    v_mfma_f32_16x16x32_bf16 a[196:199], v[80:83], v[52:55], a[196:199]
    ds_read_b128 v[44:47], v3 offset:53248
    v_mfma_f32_16x16x32_bf16 a[200:203], v[80:83], v[56:59], a[200:203]
    v_perm_b32 v84, v135, v131, s77
    v_mfma_f32_16x16x32_bf16 a[204:207], v[80:83], v[60:63], a[204:207]
    v_perm_b32 v85, v143, v139, s77
    v_mfma_f32_16x16x32_bf16 a[208:211], v[80:83], v[64:67], a[208:211]
    v_perm_b32 v86, v151, v147, s77
    v_mfma_f32_16x16x32_bf16 a[212:215], v[80:83], v[68:71], a[212:215]
    v_perm_b32 v87, v159, v155, s77
    v_mfma_f32_16x16x32_bf16 a[216:219], v[80:83], v[72:75], a[216:219]
    v_mfma_f32_16x16x32_bf16 a[220:223], v[80:83], v[76:79], a[220:223]
    ds_read_b128 v[40:43], v3 offset:36864
    v_mfma_f32_16x16x32_bf16 a[224:227], v[84:87], v[48:51], a[224:227]
    s_waitcnt vmcnt(16)
    v_mfma_f32_16x16x32_bf16 a[228:231], v[84:87], v[52:55], a[228:231]
    v_mfma_f32_16x16x32_bf16 a[232:235], v[84:87], v[56:59], a[232:235]
    v_perm_b32 v80, v164, v160, s76
    v_mfma_f32_16x16x32_bf16 a[236:239], v[84:87], v[60:63], a[236:239]
    v_perm_b32 v81, v172, v168, s76
    v_mfma_f32_16x16x32_bf16 a[240:243], v[84:87], v[64:67], a[240:243]
    v_perm_b32 v82, v180, v176, s76
    v_mfma_f32_16x16x32_bf16 a[244:247], v[84:87], v[68:71], a[244:247]
    v_perm_b32 v83, v188, v184, s76
    v_mfma_f32_16x16x32_bf16 a[248:251], v[84:87], v[72:75], a[248:251]
    v_mfma_f32_16x16x32_bf16 a[252:255], v[84:87], v[76:79], a[252:255]
    s_waitcnt lgkmcnt(0)
    v_add_u32 v2, 0x1000, v2
    v_add_u32 v3, 0x1000, v3
    s_mov_b32 s59, s60
    s_add_u32 s58, s58, 1
    s_cmp_le_u32 s58, s57
    s_cbranch_scc1 L_loopA8
    s_branch L_epi
L_loopB8:
    s_add_u32 s60, s59, s75
    s_cmp_lt_u32 s58, s57
    s_cselect_b32 s60, s60, 0x80000000
    s_add_u32 s72, s59, s63
    v_mfma_f32_16x16x32_bf16 a[0:3], v[16:19], v[80:83], a[0:3]
    v_mfma_f32_16x16x32_bf16 a[4:7], v[20:23], v[80:83], a[4:7]
    v_mfma_f32_16x16x32_bf16 a[8:11], v[24:27], v[80:83], a[8:11]
    v_perm_b32 v84, v164, v160, s77
    v_mfma_f32_16x16x32_bf16 a[12:15], v[28:31], v[80:83], a[12:15]
    v_perm_b32 v85, v172, v168, s77
    v_mfma_f32_16x16x32_bf16 a[16:19], v[32:35], v[80:83], a[16:19]
    v_perm_b32 v86, v180, v176, s77
    v_mfma_f32_16x16x32_bf16 a[20:23], v[36:39], v[80:83], a[20:23]
    v_perm_b32 v87, v188, v184, s77
    v_mfma_f32_16x16x32_bf16 a[24:27], v[40:43], v[80:83], a[24:27]
    v_mfma_f32_16x16x32_bf16 a[28:31], v[44:47], v[80:83], a[28:31]
    ds_read_b128 v[48:51], v2 offset:1024
    v_mfma_f32_16x16x32_bf16 a[32:35], v[16:19], v[84:87], a[32:35]
    s_add_u32 s73, s72, s64
    buffer_load_dwordx4 v[128:131], v4, s[44:47], s73 offen
    v_mfma_f32_16x16x32_bf16 a[36:39], v[20:23], v[84:87], a[36:39]
    v_mfma_f32_16x16x32_bf16 a[40:43], v[24:27], v[84:87], a[40:43]
    v_perm_b32 v80, v165, v161, s76
    v_mfma_f32_16x16x32_bf16 a[44:47], v[28:31], v[84:87], a[44:47]
    v_perm_b32 v81, v173, v169, s76
    v_mfma_f32_16x16x32_bf16 a[48:51], v[32:35], v[84:87], a[48:51]
    v_perm_b32 v82, v181, v177, s76
    v_mfma_f32_16x16x32_bf16 a[52:55], v[36:39], v[84:87], a[52:55]
    v_perm_b32 v83, v189, v185, s76
    v_mfma_f32_16x16x32_bf16 a[56:59], v[40:43], v[84:87], a[56:59]
    s_add_u32 s73, s72, s65
    buffer_load_dwordx4 v[132:135], v4, s[44:47], s73 offen
    v_mfma_f32_16x16x32_bf16 a[60:63], v[44:47], v[84:87], a[60:63]
    ds_read_b128 v[52:55], v2 offset:17408
    v_mfma_f32_16x16x32_bf16 a[64:67], v[16:19], v[80:83], a[64:67]
    s_add_u32 s73, s72, s66
    buffer_load_dwordx4 v[136:139], v4, s[44:47], s73 offen
    v_mfma_f32_16x16x32_bf16 a[68:71], v[20:23], v[80:83], a[68:71]
    v_mfma_f32_16x16x32_bf16 a[72:75], v[24:27], v[80:83], a[72:75]
    v_perm_b32 v84, v165, v161, s77
    v_mfma_f32_16x16x32_bf16 a[76:79], v[28:31], v[80:83], a[76:79]
    v_perm_b32 v85, v173, v169, s77
    v_mfma_f32_16x16x32_bf16 a[80:83], v[32:35], v[80:83], a[80:83]
    v_perm_b32 v86, v181, v177, s77
    v_mfma_f32_16x16x32_bf16 a[84:87], v[36:39], v[80:83], a[84:87]
    v_perm_b32 v87, v189, v185, s77
    v_mfma_f32_16x16x32_bf16 a[88:91], v[40:43], v[80:83], a[88:91]
    s_add_u32 s73, s72, s67
    buffer_load_dwordx4 v[140:143], v4, s[44:47], s73 offen
    v_mfma_f32_16x16x32_bf16 a[92:95], v[44:47], v[80:83], a[92:95]
    ds_read_b128 v[56:59], v2 offset:33792
    v_mfma_f32_16x16x32_bf16 a[96:99], v[16:19], v[84:87], a[96:99]
    s_add_u32 s73, s72, s68
    buffer_load_dwordx4 v[144:147], v4, s[44:47], s73 offen
    v_mfma_f32_16x16x32_bf16 a[100:103], v[20:23], v[84:87], a[100:103]
    v_mfma_f32_16x16x32_bf16 a[104:107], v[24:27], v[84:87], a[104:107]
    v_perm_b32 v80, v166, v162, s76
    v_mfma_f32_16x16x32_bf16 a[108:111], v[28:31], v[84:87], a[108:111]
    v_perm_b32 v81, v174, v170, s76
    v_mfma_f32_16x16x32_bf16 a[112:115], v[32:35], v[84:87], a[112:115]
    v_perm_b32 v82, v182, v178, s76
    v_mfma_f32_16x16x32_bf16 a[116:119], v[36:39], v[84:87], a[116:119]
    v_perm_b32 v83, v190, v186, s76
    v_mfma_f32_16x16x32_bf16 a[120:123], v[40:43], v[84:87], a[120:123]
    s_add_u32 s73, s72, s69
    buffer_load_dwordx4 v[148:151], v4, s[44:47], s73 offen
    v_mfma_f32_16x16x32_bf16 a[124:127], v[44:47], v[84:87], a[124:127]
    ds_read_b128 v[60:63], v2 offset:50176
    v_mfma_f32_16x16x32_bf16 a[128:131], v[16:19], v[80:83], a[128:131]
    s_add_u32 s73, s72, s70
    buffer_load_dwordx4 v[152:155], v4, s[44:47], s73 offen
    v_mfma_f32_16x16x32_bf16 a[132:135], v[20:23], v[80:83], a[132:135]
    v_mfma_f32_16x16x32_bf16 a[136:139], v[24:27], v[80:83], a[136:139]
    v_perm_b32 v84, v166, v162, s77
    v_mfma_f32_16x16x32_bf16 a[140:143], v[28:31], v[80:83], a[140:143]
    v_perm_b32 v85, v174, v170, s77
    v_mfma_f32_16x16x32_bf16 a[144:147], v[32:35], v[80:83], a[144:147]
    v_perm_b32 v86, v182, v178, s77
    v_mfma_f32_16x16x32_bf16 a[148:151], v[36:39], v[80:83], a[148:151]
    v_perm_b32 v87, v190, v186, s77
    v_mfma_f32_16x16x32_bf16 a[152:155], v[40:43], v[80:83], a[152:155]
    s_add_u32 s73, s72, s71
    buffer_load_dwordx4 v[156:159], v4, s[44:47], s73 offen
    v_mfma_f32_16x16x32_bf16 a[156:159], v[44:47], v[80:83], a[156:159]
    ds_read_b128 v[64:67], v3 offset:1024
    v_mfma_f32_16x16x32_bf16 a[160:163], v[16:19], v[84:87], a[160:163]
    v_mfma_f32_16x16x32_bf16 a[164:167], v[20:23], v[84:87], a[164:167]
    v_mfma_f32_16x16x32_bf16 a[168:171], v[24:27], v[84:87], a[168:171]
    v_perm_b32 v80, v167, v163, s76
    v_mfma_f32_16x16x32_bf16 a[172:175], v[28:31], v[84:87], a[172:175]
    v_perm_b32 v81, v175, v171, s76
    v_mfma_f32_16x16x32_bf16 a[176:179], v[32:35], v[84:87], a[176:179]
    v_perm_b32 v82, v183, v179, s76
    v_mfma_f32_16x16x32_bf16 a[180:183], v[36:39], v[84:87], a[180:183]
    v_perm_b32 v83, v191, v187, s76
    v_mfma_f32_16x16x32_bf16 a[184:187], v[40:43], v[84:87], a[184:187]
    v_mfma_f32_16x16x32_bf16 a[188:191], v[44:47], v[84:87], a[188:191]
    ds_read_b128 v[68:71], v3 offset:17408
    v_mfma_f32_16x16x32_bf16 a[192:195], v[16:19], v[80:83], a[192:195]
    v_mfma_f32_16x16x32_bf16 a[196:199], v[20:23], v[80:83], a[196:199]
    ds_read_b128 v[76:79], v3 offset:50176
    v_mfma_f32_16x16x32_bf16 a[200:203], v[24:27], v[80:83], a[200:203]
    v_perm_b32 v84, v167, v163, s77
    v_mfma_f32_16x16x32_bf16 a[204:207], v[28:31], v[80:83], a[204:207]
    v_perm_b32 v85, v175, v171, s77
    v_mfma_f32_16x16x32_bf16 a[208:211], v[32:35], v[80:83], a[208:211]
    v_perm_b32 v86, v183, v179, s77
    v_mfma_f32_16x16x32_bf16 a[212:215], v[36:39], v[80:83], a[212:215]
    v_perm_b32 v87, v191, v187, s77
    v_mfma_f32_16x16x32_bf16 a[216:219], v[40:43], v[80:83], a[216:219]
    v_mfma_f32_16x16x32_bf16 a[220:223], v[44:47], v[80:83], a[220:223]
    ds_read_b128 v[72:75], v3 offset:33792
    v_mfma_f32_16x16x32_bf16 a[224:227], v[16:19], v[84:87], a[224:227]
    s_waitcnt vmcnt(16)
    v_mfma_f32_16x16x32_bf16 a[228:231], v[20:23], v[84:87], a[228:231]
    v_mfma_f32_16x16x32_bf16 a[232:235], v[24:27], v[84:87], a[232:235]
    v_perm_b32 v80, v196, v192, s76
    v_mfma_f32_16x16x32_bf16 a[236:239], v[28:31], v[84:87], a[236:239]
    v_perm_b32 v81, v204, v200, s76
    v_mfma_f32_16x16x32_bf16 a[240:243], v[32:35], v[84:87], a[240:243]
    v_perm_b32 v82, v212, v208, s76
    v_mfma_f32_16x16x32_bf16 a[244:247], v[36:39], v[84:87], a[244:247]
    v_perm_b32 v83, v220, v216, s76
    v_mfma_f32_16x16x32_bf16 a[248:251], v[40:43], v[84:87], a[248:251]
    v_mfma_f32_16x16x32_bf16 a[252:255], v[44:47], v[84:87], a[252:255]
    s_waitcnt lgkmcnt(0)
    s_mov_b32 s72, s60
    v_mfma_f32_16x16x32_bf16 a[0:3], v[48:51], v[80:83], a[0:3]
    v_mfma_f32_16x16x32_bf16 a[4:7], v[52:55], v[80:83], a[4:7]
    v_mfma_f32_16x16x32_bf16 a[8:11], v[56:59], v[80:83], a[8:11]
    v_perm_b32 v84, v196, v192, s77
    v_mfma_f32_16x16x32_bf16 a[12:15], v[60:63], v[80:83], a[12:15]
    v_perm_b32 v85, v204, v200, s77
    v_mfma_f32_16x16x32_bf16 a[16:19], v[64:67], v[80:83], a[16:19]
    v_perm_b32 v86, v212, v208, s77
    v_mfma_f32_16x16x32_bf16 a[20:23], v[68:71], v[80:83], a[20:23]
    v_perm_b32 v87, v220, v216, s77
    v_mfma_f32_16x16x32_bf16 a[24:27], v[72:75], v[80:83], a[24:27]
    v_mfma_f32_16x16x32_bf16 a[28:31], v[76:79], v[80:83], a[28:31]
    ds_read_b128 v[16:19], v2 offset:2048
    v_mfma_f32_16x16x32_bf16 a[32:35], v[48:51], v[84:87], a[32:35]
    s_add_u32 s73, s72, s64
    buffer_load_dwordx4 v[160:163], v4, s[44:47], s73 offen
    v_mfma_f32_16x16x32_bf16 a[36:39], v[52:55], v[84:87], a[36:39]
    v_mfma_f32_16x16x32_bf16 a[40:43], v[56:59], v[84:87], a[40:43]
    v_perm_b32 v80, v197, v193, s76
    v_mfma_f32_16x16x32_bf16 a[44:47], v[60:63], v[84:87], a[44:47]
    v_perm_b32 v81, v205, v201, s76
    v_mfma_f32_16x16x32_bf16 a[48:51], v[64:67], v[84:87], a[48:51]
    v_perm_b32 v82, v213, v209, s76
    v_mfma_f32_16x16x32_bf16 a[52:55], v[68:71], v[84:87], a[52:55]
    v_perm_b32 v83, v221, v217, s76
    v_mfma_f32_16x16x32_bf16 a[56:59], v[72:75], v[84:87], a[56:59]
    s_add_u32 s73, s72, s65
    buffer_load_dwordx4 v[164:167], v4, s[44:47], s73 offen
    v_mfma_f32_16x16x32_bf16 a[60:63], v[76:79], v[84:87], a[60:63]
    ds_read_b128 v[20:23], v2 offset:18432
    v_mfma_f32_16x16x32_bf16 a[64:67], v[48:51], v[80:83], a[64:67]
    s_add_u32 s73, s72, s66
    buffer_load_dwordx4 v[168:171], v4, s[44:47], s73 offen
    v_mfma_f32_16x16x32_bf16 a[68:71], v[52:55], v[80:83], a[68:71]
    v_mfma_f32_16x16x32_bf16 a[72:75], v[56:59], v[80:83], a[72:75]
    v_perm_b32 v84, v197, v193, s77
    v_mfma_f32_16x16x32_bf16 a[76:79], v[60:63], v[80:83], a[76:79]
    v_perm_b32 v85, v205, v201, s77
    v_mfma_f32_16x16x32_bf16 a[80:83], v[64:67], v[80:83], a[80:83]
    v_perm_b32 v86, v213, v209, s77
    v_mfma_f32_16x16x32_bf16 a[84:87], v[68:71], v[80:83], a[84:87]
    v_perm_b32 v87, v221, v217, s77
    v_mfma_f32_16x16x32_bf16 a[88:91], v[72:75], v[80:83], a[88:91]
    s_add_u32 s73, s72, s67
    buffer_load_dwordx4 v[172:175], v4, s[44:47], s73 offen
    v_mfma_f32_16x16x32_bf16 a[92:95], v[76:79], v[80:83], a[92:95]
    ds_read_b128 v[24:27], v2 offset:34816
    v_mfma_f32_16x16x32_bf16 a[96:99], v[48:51], v[84:87], a[96:99]
    s_add_u32 s73, s72, s68
    buffer_load_dwordx4 v[176:179], v4, s[44:47], s73 offen
    v_mfma_f32_16x16x32_bf16 a[100:103], v[52:55], v[84:87], a[100:103]
    v_mfma_f32_16x16x32_bf16 a[104:107], v[56:59], v[84:87], a[104:107]
    v_perm_b32 v80, v198, v194, s76
    v_mfma_f32_16x16x32_bf16 a[108:111], v[60:63], v[84:87], a[108:111]
    v_perm_b32 v81, v206, v202, s76
    v_mfma_f32_16x16x32_bf16 a[112:115], v[64:67], v[84:87], a[112:115]
    v_perm_b32 v82, v214, v210, s76
    v_mfma_f32_16x16x32_bf16 a[116:119], v[68:71], v[84:87], a[116:119]
    v_perm_b32 v83, v222, v218, s76
    v_mfma_f32_16x16x32_bf16 a[120:123], v[72:75], v[84:87], a[120:123]
    s_add_u32 s73, s72, s69
    buffer_load_dwordx4 v[180:183], v4, s[44:47], s73 offen
    v_mfma_f32_16x16x32_bf16 a[124:127], v[76:79], v[84:87], a[124:127]
    ds_read_b128 v[28:31], v2 offset:51200
    v_mfma_f32_16x16x32_bf16 a[128:131], v[48:51], v[80:83], a[128:131]
    s_add_u32 s73, s72, s70
    buffer_load_dwordx4 v[184:187], v4, s[44:47], s73 offen
    v_mfma_f32_16x16x32_bf16 a[132:135], v[52:55], v[80:83], a[132:135]
    v_mfma_f32_16x16x32_bf16 a[136:139], v[56:59], v[80:83], a[136:139]
    v_perm_b32 v84, v198, v194, s77
    v_mfma_f32_16x16x32_bf16 a[140:143], v[60:63], v[80:83], a[140:143]
    v_perm_b32 v85, v206, v202, s77
    v_mfma_f32_16x16x32_bf16 a[144:147], v[64:67], v[80:83], a[144:147]
    v_perm_b32 v86, v214, v210, s77
    v_mfma_f32_16x16x32_bf16 a[148:151], v[68:71], v[80:83], a[148:151]
    v_perm_b32 v87, v222, v218, s77
    v_mfma_f32_16x16x32_bf16 a[152:155], v[72:75], v[80:83], a[152:155]
    s_add_u32 s73, s72, s71
    buffer_load_dwordx4 v[188:191], v4, s[44:47], s73 offen
    v_mfma_f32_16x16x32_bf16 a[156:159], v[76:79], v[80:83], a[156:159]
    ds_read_b128 v[32:35], v3 offset:2048
    v_mfma_f32_16x16x32_bf16 a[160:163], v[48:51], v[84:87], a[160:163]
    s_cmp_eq_u32 s58, s92
    s_cbranch_scc0 L_ncB8
    global_load_dword v14, v15, s[30:31] sc1
L_ncB8:
    v_mfma_f32_16x16x32_bf16 a[164:167], v[52:55], v[84:87], a[164:167]
    v_mfma_f32_16x16x32_bf16 a[168:171], v[56:59], v[84:87], a[168:171]
    v_perm_b32 v80, v199, v195, s76
    v_mfma_f32_16x16x32_bf16 a[172:175], v[60:63], v[84:87], a[172:175]
    v_perm_b32 v81, v207, v203, s76
    v_mfma_f32_16x16x32_bf16 a[176:179], v[64:67], v[84:87], a[176:179]
    v_perm_b32 v82, v215, v211, s76
    v_mfma_f32_16x16x32_bf16 a[180:183], v[68:71], v[84:87], a[180:183]
    v_perm_b32 v83, v223, v219, s76
    v_mfma_f32_16x16x32_bf16 a[184:187], v[72:75], v[84:87], a[184:187]
    v_mfma_f32_16x16x32_bf16 a[188:191], v[76:79], v[84:87], a[188:191]
    ds_read_b128 v[36:39], v3 offset:18432
    v_mfma_f32_16x16x32_bf16 a[192:195], v[48:51], v[80:83], a[192:195]
    v_mfma_f32_16x16x32_bf16 a[196:199], v[52:55], v[80:83], a[196:199]
    ds_read_b128 v[44:47], v3 offset:51200
    v_mfma_f32_16x16x32_bf16 a[200:203], v[56:59], v[80:83], a[200:203]
    v_perm_b32 v84, v199, v195, s77
    v_mfma_f32_16x16x32_bf16 a[204:207], v[60:63], v[80:83], a[204:207]
    v_perm_b32 v85, v207, v203, s77
    v_mfma_f32_16x16x32_bf16 a[208:211], v[64:67], v[80:83], a[208:211]
    v_perm_b32 v86, v215, v211, s77
    v_mfma_f32_16x16x32_bf16 a[212:215], v[68:71], v[80:83], a[212:215]
    v_perm_b32 v87, v223, v219, s77
    v_mfma_f32_16x16x32_bf16 a[216:219], v[72:75], v[80:83], a[216:219]
    v_mfma_f32_16x16x32_bf16 a[220:223], v[76:79], v[80:83], a[220:223]
    ds_read_b128 v[40:43], v3 offset:34816
    v_mfma_f32_16x16x32_bf16 a[224:227], v[48:51], v[84:87], a[224:227]
    s_waitcnt vmcnt(16)
    v_mfma_f32_16x16x32_bf16 a[228:231], v[52:55], v[84:87], a[228:231]
    v_mfma_f32_16x16x32_bf16 a[232:235], v[56:59], v[84:87], a[232:235]
    v_perm_b32 v80, v228, v224, s76
    v_mfma_f32_16x16x32_bf16 a[236:239], v[60:63], v[84:87], a[236:239]
    v_perm_b32 v81, v236, v232, s76
    v_mfma_f32_16x16x32_bf16 a[240:243], v[64:67], v[84:87], a[240:243]
    v_perm_b32 v82, v244, v240, s76
    v_mfma_f32_16x16x32_bf16 a[244:247], v[68:71], v[84:87], a[244:247]
    v_perm_b32 v83, v252, v248, s76
    v_mfma_f32_16x16x32_bf16 a[248:251], v[72:75], v[84:87], a[248:251]
    v_mfma_f32_16x16x32_bf16 a[252:255], v[76:79], v[84:87], a[252:255]
    s_waitcnt lgkmcnt(0)
    s_add_u32 s72, s60, s61
    v_mfma_f32_16x16x32_bf16 a[0:3], v[16:19], v[80:83], a[0:3]
    v_mfma_f32_16x16x32_bf16 a[4:7], v[20:23], v[80:83], a[4:7]
    v_mfma_f32_16x16x32_bf16 a[8:11], v[24:27], v[80:83], a[8:11]
    v_perm_b32 v84, v228, v224, s77
    v_mfma_f32_16x16x32_bf16 a[12:15], v[28:31], v[80:83], a[12:15]
    v_perm_b32 v85, v236, v232, s77
    v_mfma_f32_16x16x32_bf16 a[16:19], v[32:35], v[80:83], a[16:19]
    v_perm_b32 v86, v244, v240, s77
    v_mfma_f32_16x16x32_bf16 a[20:23], v[36:39], v[80:83], a[20:23]
    v_perm_b32 v87, v252, v248, s77
    v_mfma_f32_16x16x32_bf16 a[24:27], v[40:43], v[80:83], a[24:27]
    v_mfma_f32_16x16x32_bf16 a[28:31], v[44:47], v[80:83], a[28:31]
    ds_read_b128 v[48:51], v2 offset:3072
    v_mfma_f32_16x16x32_bf16 a[32:35], v[16:19], v[84:87], a[32:35]
    s_add_u32 s73, s72, s64
    buffer_load_dwordx4 v[192:195], v4, s[44:47], s73 offen
    v_mfma_f32_16x16x32_bf16 a[36:39], v[20:23], v[84:87], a[36:39]
    v_mfma_f32_16x16x32_bf16 a[40:43], v[24:27], v[84:87], a[40:43]
    v_perm_b32 v80, v229, v225, s76
    v_mfma_f32_16x16x32_bf16 a[44:47], v[28:31], v[84:87], a[44:47]
    v_perm_b32 v81, v237, v233, s76
    v_mfma_f32_16x16x32_bf16 a[48:51], v[32:35], v[84:87], a[48:51]
    v_perm_b32 v82, v245, v241, s76
    v_mfma_f32_16x16x32_bf16 a[52:55], v[36:39], v[84:87], a[52:55]
    v_perm_b32 v83, v253, v249, s76
    v_mfma_f32_16x16x32_bf16 a[56:59], v[40:43], v[84:87], a[56:59]
    s_add_u32 s73, s72, s65
    buffer_load_dwordx4 v[196:199], v4, s[44:47], s73 offen
    v_mfma_f32_16x16x32_bf16 a[60:63], v[44:47], v[84:87], a[60:63]
    ds_read_b128 v[52:55], v2 offset:19456
    v_mfma_f32_16x16x32_bf16 a[64:67], v[16:19], v[80:83], a[64:67]
    s_add_u32 s73, s72, s66
    buffer_load_dwordx4 v[200:203], v4, s[44:47], s73 offen
    v_mfma_f32_16x16x32_bf16 a[68:71], v[20:23], v[80:83], a[68:71]
    v_mfma_f32_16x16x32_bf16 a[72:75], v[24:27], v[80:83], a[72:75]
    v_perm_b32 v84, v229, v225, s77
    v_mfma_f32_16x16x32_bf16 a[76:79], v[28:31], v[80:83], a[76:79]
    v_perm_b32 v85, v237, v233, s77
    v_mfma_f32_16x16x32_bf16 a[80:83], v[32:35], v[80:83], a[80:83]
    v_perm_b32 v86, v245, v241, s77
    v_mfma_f32_16x16x32_bf16 a[84:87], v[36:39], v[80:83], a[84:87]
    v_perm_b32 v87, v253, v249, s77
    v_mfma_f32_16x16x32_bf16 a[88:91], v[40:43], v[80:83], a[88:91]
    s_add_u32 s73, s72, s67
    buffer_load_dwordx4 v[204:207], v4, s[44:47], s73 offen
    v_mfma_f32_16x16x32_bf16 a[92:95], v[44:47], v[80:83], a[92:95]
    ds_read_b128 v[56:59], v2 offset:35840
    v_mfma_f32_16x16x32_bf16 a[96:99], v[16:19], v[84:87], a[96:99]
    s_add_u32 s73, s72, s68
    buffer_load_dwordx4 v[208:211], v4, s[44:47], s73 offen
    v_mfma_f32_16x16x32_bf16 a[100:103], v[20:23], v[84:87], a[100:103]
    v_mfma_f32_16x16x32_bf16 a[104:107], v[24:27], v[84:87], a[104:107]
    v_perm_b32 v80, v230, v226, s76
    v_mfma_f32_16x16x32_bf16 a[108:111], v[28:31], v[84:87], a[108:111]
    v_perm_b32 v81, v238, v234, s76
    v_mfma_f32_16x16x32_bf16 a[112:115], v[32:35], v[84:87], a[112:115]
    v_perm_b32 v82, v246, v242, s76
    v_mfma_f32_16x16x32_bf16 a[116:119], v[36:39], v[84:87], a[116:119]
    v_perm_b32 v83, v254, v250, s76
    v_mfma_f32_16x16x32_bf16 a[120:123], v[40:43], v[84:87], a[120:123]
    s_add_u32 s73, s72, s69
    buffer_load_dwordx4 v[212:215], v4, s[44:47], s73 offen
    v_mfma_f32_16x16x32_bf16 a[124:127], v[44:47], v[84:87], a[124:127]
    ds_read_b128 v[60:63], v2 offset:52224
    v_mfma_f32_16x16x32_bf16 a[128:131], v[16:19], v[80:83], a[128:131]
    s_add_u32 s73, s72, s70
    buffer_load_dwordx4 v[216:219], v4, s[44:47], s73 offen
    v_mfma_f32_16x16x32_bf16 a[132:135], v[20:23], v[80:83], a[132:135]
    v_mfma_f32_16x16x32_bf16 a[136:139], v[24:27], v[80:83], a[136:139]
    v_perm_b32 v84, v230, v226, s77
    v_mfma_f32_16x16x32_bf16 a[140:143], v[28:31], v[80:83], a[140:143]
    v_perm_b32 v85, v238, v234, s77
    v_mfma_f32_16x16x32_bf16 a[144:147], v[32:35], v[80:83], a[144:147]
    v_perm_b32 v86, v246, v242, s77
    v_mfma_f32_16x16x32_bf16 a[148:151], v[36:39], v[80:83], a[148:151]
    v_perm_b32 v87, v254, v250, s77
    v_mfma_f32_16x16x32_bf16 a[152:155], v[40:43], v[80:83], a[152:155]
    s_add_u32 s73, s72, s71
    buffer_load_dwordx4 v[220:223], v4, s[44:47], s73 offen
    v_mfma_f32_16x16x32_bf16 a[156:159], v[44:47], v[80:83], a[156:159]
    ds_read_b128 v[64:67], v3 offset:3072
    v_mfma_f32_16x16x32_bf16 a[160:163], v[16:19], v[84:87], a[160:163]
    v_mfma_f32_16x16x32_bf16 a[164:167], v[20:23], v[84:87], a[164:167]
    v_mfma_f32_16x16x32_bf16 a[168:171], v[24:27], v[84:87], a[168:171]
    v_perm_b32 v80, v231, v227, s76
    v_mfma_f32_16x16x32_bf16 a[172:175], v[28:31], v[84:87], a[172:175]
    v_perm_b32 v81, v239, v235, s76
    v_mfma_f32_16x16x32_bf16 a[176:179], v[32:35], v[84:87], a[176:179]
    v_perm_b32 v82, v247, v243, s76
    v_mfma_f32_16x16x32_bf16 a[180:183], v[36:39], v[84:87], a[180:183]
    v_perm_b32 v83, v255, v251, s76
    v_mfma_f32_16x16x32_bf16 a[184:187], v[40:43], v[84:87], a[184:187]
    v_mfma_f32_16x16x32_bf16 a[188:191], v[44:47], v[84:87], a[188:191]
    ds_read_b128 v[68:71], v3 offset:19456
    v_mfma_f32_16x16x32_bf16 a[192:195], v[16:19], v[80:83], a[192:195]
    v_mfma_f32_16x16x32_bf16 a[196:199], v[20:23], v[80:83], a[196:199]
    ds_read_b128 v[76:79], v3 offset:52224
    v_mfma_f32_16x16x32_bf16 a[200:203], v[24:27], v[80:83], a[200:203]
    v_perm_b32 v84, v231, v227, s77
    v_mfma_f32_16x16x32_bf16 a[204:207], v[28:31], v[80:83], a[204:207]
    v_perm_b32 v85, v239, v235, s77
    v_mfma_f32_16x16x32_bf16 a[208:211], v[32:35], v[80:83], a[208:211]
    v_perm_b32 v86, v247, v243, s77
    v_mfma_f32_16x16x32_bf16 a[212:215], v[36:39], v[80:83], a[212:215]
    v_perm_b32 v87, v255, v251, s77
    v_mfma_f32_16x16x32_bf16 a[216:219], v[40:43], v[80:83], a[216:219]
    v_mfma_f32_16x16x32_bf16 a[220:223], v[44:47], v[80:83], a[220:223]
    ds_read_b128 v[72:75], v3 offset:35840
    v_mfma_f32_16x16x32_bf16 a[224:227], v[16:19], v[84:87], a[224:227]
    s_waitcnt vmcnt(16)
    v_mfma_f32_16x16x32_bf16 a[228:231], v[20:23], v[84:87], a[228:231]
    v_mfma_f32_16x16x32_bf16 a[232:235], v[24:27], v[84:87], a[232:235]
    v_perm_b32 v80, v132, v128, s76
    v_mfma_f32_16x16x32_bf16 a[236:239], v[28:31], v[84:87], a[236:239]
    v_perm_b32 v81, v140, v136, s76
    v_mfma_f32_16x16x32_bf16 a[240:243], v[32:35], v[84:87], a[240:243]
    v_perm_b32 v82, v148, v144, s76
    v_mfma_f32_16x16x32_bf16 a[244:247], v[36:39], v[84:87], a[244:247]
    v_perm_b32 v83, v156, v152, s76
    v_mfma_f32_16x16x32_bf16 a[248:251], v[40:43], v[84:87], a[248:251]
    v_mfma_f32_16x16x32_bf16 a[252:255], v[44:47], v[84:87], a[252:255]
    s_waitcnt lgkmcnt(0)
    s_add_u32 s72, s60, s62
    v_mfma_f32_16x16x32_bf16 a[0:3], v[48:51], v[80:83], a[0:3]
    v_mfma_f32_16x16x32_bf16 a[4:7], v[52:55], v[80:83], a[4:7]
    v_mfma_f32_16x16x32_bf16 a[8:11], v[56:59], v[80:83], a[8:11]
    v_perm_b32 v84, v132, v128, s77
    v_mfma_f32_16x16x32_bf16 a[12:15], v[60:63], v[80:83], a[12:15]
    v_perm_b32 v85, v140, v136, s77
    v_mfma_f32_16x16x32_bf16 a[16:19], v[64:67], v[80:83], a[16:19]
    v_perm_b32 v86, v148, v144, s77
    v_mfma_f32_16x16x32_bf16 a[20:23], v[68:71], v[80:83], a[20:23]
    v_perm_b32 v87, v156, v152, s77
    v_mfma_f32_16x16x32_bf16 a[24:27], v[72:75], v[80:83], a[24:27]
    v_mfma_f32_16x16x32_bf16 a[28:31], v[76:79], v[80:83], a[28:31]
    ds_read_b128 v[16:19], v2 offset:4096
    v_mfma_f32_16x16x32_bf16 a[32:35], v[48:51], v[84:87], a[32:35]
    s_add_u32 s73, s72, s64
    buffer_load_dwordx4 v[224:227], v4, s[44:47], s73 offen
    v_mfma_f32_16x16x32_bf16 a[36:39], v[52:55], v[84:87], a[36:39]
    v_mfma_f32_16x16x32_bf16 a[40:43], v[56:59], v[84:87], a[40:43]
    v_perm_b32 v80, v133, v129, s76
    v_mfma_f32_16x16x32_bf16 a[44:47], v[60:63], v[84:87], a[44:47]
    v_perm_b32 v81, v141, v137, s76
    v_mfma_f32_16x16x32_bf16 a[48:51], v[64:67], v[84:87], a[48:51]
    v_perm_b32 v82, v149, v145, s76
    v_mfma_f32_16x16x32_bf16 a[52:55], v[68:71], v[84:87], a[52:55]
    v_perm_b32 v83, v157, v153, s76
    v_mfma_f32_16x16x32_bf16 a[56:59], v[72:75], v[84:87], a[56:59]
    s_add_u32 s73, s72, s65
    buffer_load_dwordx4 v[228:231], v4, s[44:47], s73 offen
    v_mfma_f32_16x16x32_bf16 a[60:63], v[76:79], v[84:87], a[60:63]
    ds_read_b128 v[20:23], v2 offset:20480
    v_mfma_f32_16x16x32_bf16 a[64:67], v[48:51], v[80:83], a[64:67]
    s_add_u32 s73, s72, s66
    buffer_load_dwordx4 v[232:235], v4, s[44:47], s73 offen
    v_mfma_f32_16x16x32_bf16 a[68:71], v[52:55], v[80:83], a[68:71]
    v_mfma_f32_16x16x32_bf16 a[72:75], v[56:59], v[80:83], a[72:75]
    v_perm_b32 v84, v133, v129, s77
    v_mfma_f32_16x16x32_bf16 a[76:79], v[60:63], v[80:83], a[76:79]
    v_perm_b32 v85, v141, v137, s77
    v_mfma_f32_16x16x32_bf16 a[80:83], v[64:67], v[80:83], a[80:83]
    v_perm_b32 v86, v149, v145, s77
    v_mfma_f32_16x16x32_bf16 a[84:87], v[68:71], v[80:83], a[84:87]
    v_perm_b32 v87, v157, v153, s77
    v_mfma_f32_16x16x32_bf16 a[88:91], v[72:75], v[80:83], a[88:91]
    s_add_u32 s73, s72, s67
    buffer_load_dwordx4 v[236:239], v4, s[44:47], s73 offen
    v_mfma_f32_16x16x32_bf16 a[92:95], v[76:79], v[80:83], a[92:95]
    ds_read_b128 v[24:27], v2 offset:36864
    v_mfma_f32_16x16x32_bf16 a[96:99], v[48:51], v[84:87], a[96:99]
    s_add_u32 s73, s72, s68
    buffer_load_dwordx4 v[240:243], v4, s[44:47], s73 offen
    v_mfma_f32_16x16x32_bf16 a[100:103], v[52:55], v[84:87], a[100:103]
    v_mfma_f32_16x16x32_bf16 a[104:107], v[56:59], v[84:87], a[104:107]
    v_perm_b32 v80, v134, v130, s76
    v_mfma_f32_16x16x32_bf16 a[108:111], v[60:63], v[84:87], a[108:111]
    v_perm_b32 v81, v142, v138, s76
    v_mfma_f32_16x16x32_bf16 a[112:115], v[64:67], v[84:87], a[112:115]
    v_perm_b32 v82, v150, v146, s76
    v_mfma_f32_16x16x32_bf16 a[116:119], v[68:71], v[84:87], a[116:119]
    v_perm_b32 v83, v158, v154, s76
    v_mfma_f32_16x16x32_bf16 a[120:123], v[72:75], v[84:87], a[120:123]
    s_add_u32 s73, s72, s69
    buffer_load_dwordx4 v[244:247], v4, s[44:47], s73 offen
    v_mfma_f32_16x16x32_bf16 a[124:127], v[76:79], v[84:87], a[124:127]
    ds_read_b128 v[28:31], v2 offset:53248
    v_mfma_f32_16x16x32_bf16 a[128:131], v[48:51], v[80:83], a[128:131]
    s_add_u32 s73, s72, s70
    buffer_load_dwordx4 v[248:251], v4, s[44:47], s73 offen
    v_mfma_f32_16x16x32_bf16 a[132:135], v[52:55], v[80:83], a[132:135]
    v_mfma_f32_16x16x32_bf16 a[136:139], v[56:59], v[80:83], a[136:139]
    v_perm_b32 v84, v134, v130, s77
    v_mfma_f32_16x16x32_bf16 a[140:143], v[60:63], v[80:83], a[140:143]
    v_perm_b32 v85, v142, v138, s77
    v_mfma_f32_16x16x32_bf16 a[144:147], v[64:67], v[80:83], a[144:147]
    v_perm_b32 v86, v150, v146, s77
    v_mfma_f32_16x16x32_bf16 a[148:151], v[68:71], v[80:83], a[148:151]
    v_perm_b32 v87, v158, v154, s77
    v_mfma_f32_16x16x32_bf16 a[152:155], v[72:75], v[80:83], a[152:155]
    s_add_u32 s73, s72, s71
    buffer_load_dwordx4 v[252:255], v4, s[44:47], s73 offen
    v_mfma_f32_16x16x32_bf16 a[156:159], v[76:79], v[80:83], a[156:159]
    ds_read_b128 v[32:35], v3 offset:4096
    v_mfma_f32_16x16x32_bf16 a[160:163], v[48:51], v[84:87], a[160:163]
    v_mfma_f32_16x16x32_bf16 a[164:167], v[52:55], v[84:87], a[164:167]
    v_mfma_f32_16x16x32_bf16 a[168:171], v[56:59], v[84:87], a[168:171]
    v_perm_b32 v80, v135, v131, s76
    v_mfma_f32_16x16x32_bf16 a[172:175], v[60:63], v[84:87], a[172:175]
    v_perm_b32 v81, v143, v139, s76
    v_mfma_f32_16x16x32_bf16 a[176:179], v[64:67], v[84:87], a[176:179]
    v_perm_b32 v82, v151, v147, s76
    v_mfma_f32_16x16x32_bf16 a[180:183], v[68:71], v[84:87], a[180:183]
    v_perm_b32 v83, v159, v155, s76
    v_mfma_f32_16x16x32_bf16 a[184:187], v[72:75], v[84:87], a[184:187]
    v_mfma_f32_16x16x32_bf16 a[188:191], v[76:79], v[84:87], a[188:191]
    ds_read_b128 v[36:39], v3 offset:20480
    v_mfma_f32_16x16x32_bf16 a[192:195], v[48:51], v[80:83], a[192:195]
    v_mfma_f32_16x16x32_bf16 a[196:199], v[52:55], v[80:83], a[196:199]
    ds_read_b128 v[44:47], v3 offset:53248
    v_mfma_f32_16x16x32_bf16 a[200:203], v[56:59], v[80:83], a[200:203]
    v_perm_b32 v84, v135, v131, s77
    v_mfma_f32_16x16x32_bf16 a[204:207], v[60:63], v[80:83], a[204:207]
    v_perm_b32 v85, v143, v139, s77
    v_mfma_f32_16x16x32_bf16 a[208:211], v[64:67], v[80:83], a[208:211]
    v_perm_b32 v86, v151, v147, s77
    v_mfma_f32_16x16x32_bf16 a[212:215], v[68:71], v[80:83], a[212:215]
    v_perm_b32 v87, v159, v155, s77
    v_mfma_f32_16x16x32_bf16 a[216:219], v[72:75], v[80:83], a[216:219]
    v_mfma_f32_16x16x32_bf16 a[220:223], v[76:79], v[80:83], a[220:223]
    ds_read_b128 v[40:43], v3 offset:36864
    v_mfma_f32_16x16x32_bf16 a[224:227], v[48:51], v[84:87], a[224:227]
    s_waitcnt vmcnt(16)
    v_mfma_f32_16x16x32_bf16 a[228:231], v[52:55], v[84:87], a[228:231]
    v_mfma_f32_16x16x32_bf16 a[232:235], v[56:59], v[84:87], a[232:235]
    v_perm_b32 v80, v164, v160, s76
    v_mfma_f32_16x16x32_bf16 a[236:239], v[60:63], v[84:87], a[236:239]
    v_perm_b32 v81, v172, v168, s76
    v_mfma_f32_16x16x32_bf16 a[240:243], v[64:67], v[84:87], a[240:243]
    v_perm_b32 v82, v180, v176, s76
    v_mfma_f32_16x16x32_bf16 a[244:247], v[68:71], v[84:87], a[244:247]
    v_perm_b32 v83, v188, v184, s76
    v_mfma_f32_16x16x32_bf16 a[248:251], v[72:75], v[84:87], a[248:251]
    v_mfma_f32_16x16x32_bf16 a[252:255], v[76:79], v[84:87], a[252:255]
    s_waitcnt lgkmcnt(0)
    v_add_u32 v2, 0x1000, v2
    v_add_u32 v3, 0x1000, v3
    s_mov_b32 s59, s60
    s_add_u32 s58, s58, 1
    s_cmp_le_u32 s58, s57
    s_cbranch_scc1 L_loopB8
L_epi:
    s_waitcnt vmcnt(0) lgkmcnt(0)
    s_nop 7
    s_cmp_eq_u32 s17, 1
    s_cbranch_scc1 L_cf42_ok
    v_add_u32 v15, 0x20000, v15
    s_cmp_eq_u32 s34, 0
    s_cbranch_scc0 L_cfb
    ds_write_b32 v15, v14
    s_waitcnt lgkmcnt(0)
L_cfb:
    s_barrier
    ds_read_b32 v14, v15
    s_waitcnt lgkmcnt(0)
    s_cmp_eq_u32 s17, 1
    s_cbranch_scc1 L_cf42_ok
L_cf42:
    s_mov_b32 s96, 0
    s_mov_b32 s98, 0
    v_readlane_b32 s97, v14, 8
    s_add_u32 s96, s96, s97
    v_readlane_b32 s97, v14, 12
    s_add_u32 s98, s98, s97
    v_readlane_b32 s97, v14, 24
    s_add_u32 s96, s96, s97
    v_readlane_b32 s97, v14, 20
    s_add_u32 s98, s98, s97
    v_readlane_b32 s97, v14, 40
    s_add_u32 s96, s96, s97
    v_readlane_b32 s97, v14, 36
    s_add_u32 s98, s98, s97
    v_readlane_b32 s97, v14, 56
    s_add_u32 s96, s96, s97
    v_readlane_b32 s97, v14, 52
    s_add_u32 s98, s98, s97
    v_readlane_b32 s97, v14, 9
    s_add_u32 s96, s96, s97
    v_readlane_b32 s97, v14, 13
    s_add_u32 s98, s98, s97
    v_readlane_b32 s97, v14, 25
    s_add_u32 s96, s96, s97
    v_readlane_b32 s97, v14, 21
    s_add_u32 s98, s98, s97
    v_readlane_b32 s97, v14, 41
    s_add_u32 s96, s96, s97
    v_readlane_b32 s97, v14, 37
    s_add_u32 s98, s98, s97
    v_readlane_b32 s97, v14, 57
    s_add_u32 s96, s96, s97
    v_readlane_b32 s97, v14, 53
    s_add_u32 s98, s98, s97
    s_cmp_eq_u32 s19, 0
    s_cselect_b32 s96, s98, s96
    s_cmp_eq_u32 s96, 0x100
    s_cbranch_scc1 L_cf42_all
    s_sub_u32 s100, s100, 1
    s_mov_b32 s101, 42
    s_cbranch_scc1 L_fail
    v_mbcnt_lo_u32_b32 v10, -1, 0
    v_mbcnt_hi_u32_b32 v10, -1, v10
    v_lshlrev_b32 v10, 2, v10
    global_load_dword v14, v10, s[30:31] sc1
    s_waitcnt vmcnt(0)
    s_branch L_cf42
L_cf42_all:
    s_cmp_eq_u32 s19, 0
    s_cbranch_scc0 L_cf42_t
    v_readlane_b32 s97, v14, s16
    s_cmp_eq_u32 s97, 256
    s_cbranch_scc1 L_cf42_std
    s_branch L_role_ticket
L_cf42_t:
    v_cmp_eq_u32 vcc, 32, v14
    s_and_b32 s96, vcc_lo, 0x3000300
    s_and_b32 s97, vcc_hi, 0x3000300
    s_xor_b32 s96, s96, 0x3000300
    s_xor_b32 s97, s97, 0x3000300
    s_or_b32 s96, s96, s97
    s_cmp_eq_u32 s96, 0
    s_cbranch_scc1 L_cf42_std
    v_mov_b32 v1, v14
    s_branch L_role_mixed
L_cf42_std:
    s_mov_b32 s17, 1
L_cf42_ok:
    s_lshl_b32 s82, s53, 21
    s_mul_i32 s83, s78, 0x4000
    s_add_u32 s82, s82, s83
    s_lshr_b32 s83, s90, 1
    s_lshl_b32 s83, s83, 20
    s_add_u32 s82, s82, s83
    s_cmp_eq_u32 s55, 1
    s_cbranch_scc1 L_epiV
    s_cmp_eq_u32 s55, 2
    s_cbranch_scc1 L_epiF1
    s_cmp_eq_u32 s55, 3
    s_cbranch_scc1 L_epiF2
    s_cmp_eq_u32 s55, 4
    s_cbranch_scc1 L_epiQ
L_epiK:
    s_add_u32 s83, s82, 0x1000000
    v_accvgpr_read_b32 v64, a0
    v_accvgpr_read_b32 v65, a32
    v_accvgpr_read_b32 v66, a1
    v_accvgpr_read_b32 v67, a33
    v_accvgpr_read_b32 v68, a2
    v_accvgpr_read_b32 v69, a34
    v_accvgpr_read_b32 v70, a3
    v_accvgpr_read_b32 v71, a35
    v_cvt_pk_bf16_f32 v80, v64, v65
    v_cvt_pk_bf16_f32 v81, v66, v67
    v_cvt_pk_bf16_f32 v82, v68, v69
    v_cvt_pk_bf16_f32 v83, v70, v71
    buffer_store_dwordx4 v[80:83], v0, s[36:39], s83 offen offset:0 sc1
    v_accvgpr_read_b32 v72, a64
    v_accvgpr_read_b32 v73, a96
    v_accvgpr_read_b32 v74, a65
    v_accvgpr_read_b32 v75, a97
    v_accvgpr_read_b32 v76, a66
    v_accvgpr_read_b32 v77, a98
    v_accvgpr_read_b32 v78, a67
    v_accvgpr_read_b32 v79, a99
    v_cvt_pk_bf16_f32 v84, v72, v73
    v_cvt_pk_bf16_f32 v85, v74, v75
    v_cvt_pk_bf16_f32 v86, v76, v77
    v_cvt_pk_bf16_f32 v87, v78, v79
    buffer_store_dwordx4 v[84:87], v0, s[36:39], s83 offen offset:1024 sc1
    v_accvgpr_read_b32 v64, a128
    v_accvgpr_read_b32 v65, a160
    v_accvgpr_read_b32 v66, a129
    v_accvgpr_read_b32 v67, a161
    v_accvgpr_read_b32 v68, a130
    v_accvgpr_read_b32 v69, a162
    v_accvgpr_read_b32 v70, a131
    v_accvgpr_read_b32 v71, a163
    v_cvt_pk_bf16_f32 v88, v64, v65
    v_cvt_pk_bf16_f32 v89, v66, v67
    v_cvt_pk_bf16_f32 v90, v68, v69
    v_cvt_pk_bf16_f32 v91, v70, v71
    buffer_store_dwordx4 v[88:91], v0, s[36:39], s83 offen offset:2048 sc1
    v_accvgpr_read_b32 v72, a192
    v_accvgpr_read_b32 v73, a224
    v_accvgpr_read_b32 v74, a193
    v_accvgpr_read_b32 v75, a225
    v_accvgpr_read_b32 v76, a194
    v_accvgpr_read_b32 v77, a226
    v_accvgpr_read_b32 v78, a195
    v_accvgpr_read_b32 v79, a227
    v_cvt_pk_bf16_f32 v92, v72, v73
    v_cvt_pk_bf16_f32 v93, v74, v75
    v_cvt_pk_bf16_f32 v94, v76, v77
    v_cvt_pk_bf16_f32 v95, v78, v79
    buffer_store_dwordx4 v[92:95], v0, s[36:39], s83 offen offset:3072 sc1
    s_add_u32 s83, s82, 0x1001000
    v_accvgpr_read_b32 v64, a4
    v_accvgpr_read_b32 v65, a36
    v_accvgpr_read_b32 v66, a5
    v_accvgpr_read_b32 v67, a37
    v_accvgpr_read_b32 v68, a6
    v_accvgpr_read_b32 v69, a38
    v_accvgpr_read_b32 v70, a7
    v_accvgpr_read_b32 v71, a39
    v_cvt_pk_bf16_f32 v80, v64, v65
    v_cvt_pk_bf16_f32 v81, v66, v67
    v_cvt_pk_bf16_f32 v82, v68, v69
    v_cvt_pk_bf16_f32 v83, v70, v71
    buffer_store_dwordx4 v[80:83], v0, s[36:39], s83 offen offset:0 sc1
    v_accvgpr_read_b32 v72, a68
    v_accvgpr_read_b32 v73, a100
    v_accvgpr_read_b32 v74, a69
    v_accvgpr_read_b32 v75, a101
    v_accvgpr_read_b32 v76, a70
    v_accvgpr_read_b32 v77, a102
    v_accvgpr_read_b32 v78, a71
    v_accvgpr_read_b32 v79, a103
    v_cvt_pk_bf16_f32 v84, v72, v73
    v_cvt_pk_bf16_f32 v85, v74, v75
    v_cvt_pk_bf16_f32 v86, v76, v77
    v_cvt_pk_bf16_f32 v87, v78, v79
    buffer_store_dwordx4 v[84:87], v0, s[36:39], s83 offen offset:1024 sc1
    v_accvgpr_read_b32 v64, a132
    v_accvgpr_read_b32 v65, a164
    v_accvgpr_read_b32 v66, a133
    v_accvgpr_read_b32 v67, a165
    v_accvgpr_read_b32 v68, a134
    v_accvgpr_read_b32 v69, a166
    v_accvgpr_read_b32 v70, a135
    v_accvgpr_read_b32 v71, a167
    v_cvt_pk_bf16_f32 v88, v64, v65
    v_cvt_pk_bf16_f32 v89, v66, v67
    v_cvt_pk_bf16_f32 v90, v68, v69
    v_cvt_pk_bf16_f32 v91, v70, v71
    buffer_store_dwordx4 v[88:91], v0, s[36:39], s83 offen offset:2048 sc1
    v_accvgpr_read_b32 v72, a196
    v_accvgpr_read_b32 v73, a228
    v_accvgpr_read_b32 v74, a197
    v_accvgpr_read_b32 v75, a229
    v_accvgpr_read_b32 v76, a198
    v_accvgpr_read_b32 v77, a230
    v_accvgpr_read_b32 v78, a199
    v_accvgpr_read_b32 v79, a231
    v_cvt_pk_bf16_f32 v92, v72, v73
    v_cvt_pk_bf16_f32 v93, v74, v75
    v_cvt_pk_bf16_f32 v94, v76, v77
    v_cvt_pk_bf16_f32 v95, v78, v79
    buffer_store_dwordx4 v[92:95], v0, s[36:39], s83 offen offset:3072 sc1
    s_add_u32 s83, s82, 0x1080000
    v_accvgpr_read_b32 v64, a8
    v_accvgpr_read_b32 v65, a40
    v_accvgpr_read_b32 v66, a9
    v_accvgpr_read_b32 v67, a41
    v_accvgpr_read_b32 v68, a10
    v_accvgpr_read_b32 v69, a42
    v_accvgpr_read_b32 v70, a11
    v_accvgpr_read_b32 v71, a43
    v_cvt_pk_bf16_f32 v80, v64, v65
    v_cvt_pk_bf16_f32 v81, v66, v67
    v_cvt_pk_bf16_f32 v82, v68, v69
    v_cvt_pk_bf16_f32 v83, v70, v71
    buffer_store_dwordx4 v[80:83], v0, s[36:39], s83 offen offset:0 sc1
    v_accvgpr_read_b32 v72, a72
    v_accvgpr_read_b32 v73, a104
    v_accvgpr_read_b32 v74, a73
    v_accvgpr_read_b32 v75, a105
    v_accvgpr_read_b32 v76, a74
    v_accvgpr_read_b32 v77, a106
    v_accvgpr_read_b32 v78, a75
    v_accvgpr_read_b32 v79, a107
    v_cvt_pk_bf16_f32 v84, v72, v73
    v_cvt_pk_bf16_f32 v85, v74, v75
    v_cvt_pk_bf16_f32 v86, v76, v77
    v_cvt_pk_bf16_f32 v87, v78, v79
    buffer_store_dwordx4 v[84:87], v0, s[36:39], s83 offen offset:1024 sc1
    v_accvgpr_read_b32 v64, a136
    v_accvgpr_read_b32 v65, a168
    v_accvgpr_read_b32 v66, a137
    v_accvgpr_read_b32 v67, a169
    v_accvgpr_read_b32 v68, a138
    v_accvgpr_read_b32 v69, a170
    v_accvgpr_read_b32 v70, a139
    v_accvgpr_read_b32 v71, a171
    v_cvt_pk_bf16_f32 v88, v64, v65
    v_cvt_pk_bf16_f32 v89, v66, v67
    v_cvt_pk_bf16_f32 v90, v68, v69
    v_cvt_pk_bf16_f32 v91, v70, v71
    buffer_store_dwordx4 v[88:91], v0, s[36:39], s83 offen offset:2048 sc1
    v_accvgpr_read_b32 v72, a200
    v_accvgpr_read_b32 v73, a232
    v_accvgpr_read_b32 v74, a201
    v_accvgpr_read_b32 v75, a233
    v_accvgpr_read_b32 v76, a202
    v_accvgpr_read_b32 v77, a234
    v_accvgpr_read_b32 v78, a203
    v_accvgpr_read_b32 v79, a235
    v_cvt_pk_bf16_f32 v92, v72, v73
    v_cvt_pk_bf16_f32 v93, v74, v75
    v_cvt_pk_bf16_f32 v94, v76, v77
    v_cvt_pk_bf16_f32 v95, v78, v79
    buffer_store_dwordx4 v[92:95], v0, s[36:39], s83 offen offset:3072 sc1
    s_add_u32 s83, s82, 0x1081000
    v_accvgpr_read_b32 v64, a12
    v_accvgpr_read_b32 v65, a44
    v_accvgpr_read_b32 v66, a13
    v_accvgpr_read_b32 v67, a45
    v_accvgpr_read_b32 v68, a14
    v_accvgpr_read_b32 v69, a46
    v_accvgpr_read_b32 v70, a15
    v_accvgpr_read_b32 v71, a47
    v_cvt_pk_bf16_f32 v80, v64, v65
    v_cvt_pk_bf16_f32 v81, v66, v67
    v_cvt_pk_bf16_f32 v82, v68, v69
    v_cvt_pk_bf16_f32 v83, v70, v71
    buffer_store_dwordx4 v[80:83], v0, s[36:39], s83 offen offset:0 sc1
    v_accvgpr_read_b32 v72, a76
    v_accvgpr_read_b32 v73, a108
    v_accvgpr_read_b32 v74, a77
    v_accvgpr_read_b32 v75, a109
    v_accvgpr_read_b32 v76, a78
    v_accvgpr_read_b32 v77, a110
    v_accvgpr_read_b32 v78, a79
    v_accvgpr_read_b32 v79, a111
    v_cvt_pk_bf16_f32 v84, v72, v73
    v_cvt_pk_bf16_f32 v85, v74, v75
    v_cvt_pk_bf16_f32 v86, v76, v77
    v_cvt_pk_bf16_f32 v87, v78, v79
    buffer_store_dwordx4 v[84:87], v0, s[36:39], s83 offen offset:1024 sc1
    v_accvgpr_read_b32 v64, a140
    v_accvgpr_read_b32 v65, a172
    v_accvgpr_read_b32 v66, a141
    v_accvgpr_read_b32 v67, a173
    v_accvgpr_read_b32 v68, a142
    v_accvgpr_read_b32 v69, a174
    v_accvgpr_read_b32 v70, a143
    v_accvgpr_read_b32 v71, a175
    v_cvt_pk_bf16_f32 v88, v64, v65
    v_cvt_pk_bf16_f32 v89, v66, v67
    v_cvt_pk_bf16_f32 v90, v68, v69
    v_cvt_pk_bf16_f32 v91, v70, v71
    buffer_store_dwordx4 v[88:91], v0, s[36:39], s83 offen offset:2048 sc1
    v_accvgpr_read_b32 v72, a204
    v_accvgpr_read_b32 v73, a236
    v_accvgpr_read_b32 v74, a205
    v_accvgpr_read_b32 v75, a237
    v_accvgpr_read_b32 v76, a206
    v_accvgpr_read_b32 v77, a238
    v_accvgpr_read_b32 v78, a207
    v_accvgpr_read_b32 v79, a239
    v_cvt_pk_bf16_f32 v92, v72, v73
    v_cvt_pk_bf16_f32 v93, v74, v75
    v_cvt_pk_bf16_f32 v94, v76, v77
    v_cvt_pk_bf16_f32 v95, v78, v79
    buffer_store_dwordx4 v[92:95], v0, s[36:39], s83 offen offset:3072 sc1
    s_cmp_eq_u32 s90, 0
    s_cbranch_scc0 L_kvdone
    s_add_u32 s83, s82, 0x1100000
    v_accvgpr_read_b32 v64, a16
    v_accvgpr_read_b32 v65, a48
    v_accvgpr_read_b32 v66, a17
    v_accvgpr_read_b32 v67, a49
    v_accvgpr_read_b32 v68, a18
    v_accvgpr_read_b32 v69, a50
    v_accvgpr_read_b32 v70, a19
    v_accvgpr_read_b32 v71, a51
    v_cvt_pk_bf16_f32 v80, v64, v65
    v_cvt_pk_bf16_f32 v81, v66, v67
    v_cvt_pk_bf16_f32 v82, v68, v69
    v_cvt_pk_bf16_f32 v83, v70, v71
    buffer_store_dwordx4 v[80:83], v0, s[36:39], s83 offen offset:0 sc1
    s_waitcnt vmcnt(2)
    v_accvgpr_read_b32 v72, a80
    v_accvgpr_read_b32 v73, a112
    v_accvgpr_read_b32 v74, a81
    v_accvgpr_read_b32 v75, a113
    v_accvgpr_read_b32 v76, a82
    v_accvgpr_read_b32 v77, a114
    v_accvgpr_read_b32 v78, a83
    v_accvgpr_read_b32 v79, a115
    v_cvt_pk_bf16_f32 v84, v72, v73
    v_cvt_pk_bf16_f32 v85, v74, v75
    v_cvt_pk_bf16_f32 v86, v76, v77
    v_cvt_pk_bf16_f32 v87, v78, v79
    buffer_store_dwordx4 v[84:87], v0, s[36:39], s83 offen offset:1024 sc1
    s_waitcnt vmcnt(2)
    v_accvgpr_read_b32 v64, a144
    v_accvgpr_read_b32 v65, a176
    v_accvgpr_read_b32 v66, a145
    v_accvgpr_read_b32 v67, a177
    v_accvgpr_read_b32 v68, a146
    v_accvgpr_read_b32 v69, a178
    v_accvgpr_read_b32 v70, a147
    v_accvgpr_read_b32 v71, a179
    v_cvt_pk_bf16_f32 v88, v64, v65
    v_cvt_pk_bf16_f32 v89, v66, v67
    v_cvt_pk_bf16_f32 v90, v68, v69
    v_cvt_pk_bf16_f32 v91, v70, v71
    buffer_store_dwordx4 v[88:91], v0, s[36:39], s83 offen offset:2048 sc1
    s_waitcnt vmcnt(2)
    v_accvgpr_read_b32 v72, a208
    v_accvgpr_read_b32 v73, a240
    v_accvgpr_read_b32 v74, a209
    v_accvgpr_read_b32 v75, a241
    v_accvgpr_read_b32 v76, a210
    v_accvgpr_read_b32 v77, a242
    v_accvgpr_read_b32 v78, a211
    v_accvgpr_read_b32 v79, a243
    v_cvt_pk_bf16_f32 v92, v72, v73
    v_cvt_pk_bf16_f32 v93, v74, v75
    v_cvt_pk_bf16_f32 v94, v76, v77
    v_cvt_pk_bf16_f32 v95, v78, v79
    buffer_store_dwordx4 v[92:95], v0, s[36:39], s83 offen offset:3072 sc1
    s_waitcnt vmcnt(2)
    s_add_u32 s83, s82, 0x1101000
    v_accvgpr_read_b32 v64, a20
    v_accvgpr_read_b32 v65, a52
    v_accvgpr_read_b32 v66, a21
    v_accvgpr_read_b32 v67, a53
    v_accvgpr_read_b32 v68, a22
    v_accvgpr_read_b32 v69, a54
    v_accvgpr_read_b32 v70, a23
    v_accvgpr_read_b32 v71, a55
    v_cvt_pk_bf16_f32 v80, v64, v65
    v_cvt_pk_bf16_f32 v81, v66, v67
    v_cvt_pk_bf16_f32 v82, v68, v69
    v_cvt_pk_bf16_f32 v83, v70, v71
    buffer_store_dwordx4 v[80:83], v0, s[36:39], s83 offen offset:0 sc1
    s_waitcnt vmcnt(2)
    v_accvgpr_read_b32 v72, a84
    v_accvgpr_read_b32 v73, a116
    v_accvgpr_read_b32 v74, a85
    v_accvgpr_read_b32 v75, a117
    v_accvgpr_read_b32 v76, a86
    v_accvgpr_read_b32 v77, a118
    v_accvgpr_read_b32 v78, a87
    v_accvgpr_read_b32 v79, a119
    v_cvt_pk_bf16_f32 v84, v72, v73
    v_cvt_pk_bf16_f32 v85, v74, v75
    v_cvt_pk_bf16_f32 v86, v76, v77
    v_cvt_pk_bf16_f32 v87, v78, v79
    buffer_store_dwordx4 v[84:87], v0, s[36:39], s83 offen offset:1024 sc1
    s_waitcnt vmcnt(2)
    v_accvgpr_read_b32 v64, a148
    v_accvgpr_read_b32 v65, a180
    v_accvgpr_read_b32 v66, a149
    v_accvgpr_read_b32 v67, a181
    v_accvgpr_read_b32 v68, a150
    v_accvgpr_read_b32 v69, a182
    v_accvgpr_read_b32 v70, a151
    v_accvgpr_read_b32 v71, a183
    v_cvt_pk_bf16_f32 v88, v64, v65
    v_cvt_pk_bf16_f32 v89, v66, v67
    v_cvt_pk_bf16_f32 v90, v68, v69
    v_cvt_pk_bf16_f32 v91, v70, v71
    buffer_store_dwordx4 v[88:91], v0, s[36:39], s83 offen offset:2048 sc1
    s_waitcnt vmcnt(2)
    v_accvgpr_read_b32 v72, a212
    v_accvgpr_read_b32 v73, a244
    v_accvgpr_read_b32 v74, a213
    v_accvgpr_read_b32 v75, a245
    v_accvgpr_read_b32 v76, a214
    v_accvgpr_read_b32 v77, a246
    v_accvgpr_read_b32 v78, a215
    v_accvgpr_read_b32 v79, a247
    v_cvt_pk_bf16_f32 v92, v72, v73
    v_cvt_pk_bf16_f32 v93, v74, v75
    v_cvt_pk_bf16_f32 v94, v76, v77
    v_cvt_pk_bf16_f32 v95, v78, v79
    buffer_store_dwordx4 v[92:95], v0, s[36:39], s83 offen offset:3072 sc1
    s_waitcnt vmcnt(2)
    s_add_u32 s83, s82, 0x1180000
    v_accvgpr_read_b32 v64, a24
    v_accvgpr_read_b32 v65, a56
    v_accvgpr_read_b32 v66, a25
    v_accvgpr_read_b32 v67, a57
    v_accvgpr_read_b32 v68, a26
    v_accvgpr_read_b32 v69, a58
    v_accvgpr_read_b32 v70, a27
    v_accvgpr_read_b32 v71, a59
    v_cvt_pk_bf16_f32 v80, v64, v65
    v_cvt_pk_bf16_f32 v81, v66, v67
    v_cvt_pk_bf16_f32 v82, v68, v69
    v_cvt_pk_bf16_f32 v83, v70, v71
    buffer_store_dwordx4 v[80:83], v0, s[36:39], s83 offen offset:0 sc1
    s_waitcnt vmcnt(2)
    v_accvgpr_read_b32 v72, a88
    v_accvgpr_read_b32 v73, a120
    v_accvgpr_read_b32 v74, a89
    v_accvgpr_read_b32 v75, a121
    v_accvgpr_read_b32 v76, a90
    v_accvgpr_read_b32 v77, a122
    v_accvgpr_read_b32 v78, a91
    v_accvgpr_read_b32 v79, a123
    v_cvt_pk_bf16_f32 v84, v72, v73
    v_cvt_pk_bf16_f32 v85, v74, v75
    v_cvt_pk_bf16_f32 v86, v76, v77
    v_cvt_pk_bf16_f32 v87, v78, v79
    buffer_store_dwordx4 v[84:87], v0, s[36:39], s83 offen offset:1024 sc1
    s_waitcnt vmcnt(2)
    v_accvgpr_read_b32 v64, a152
    v_accvgpr_read_b32 v65, a184
    v_accvgpr_read_b32 v66, a153
    v_accvgpr_read_b32 v67, a185
    v_accvgpr_read_b32 v68, a154
    v_accvgpr_read_b32 v69, a186
    v_accvgpr_read_b32 v70, a155
    v_accvgpr_read_b32 v71, a187
    v_cvt_pk_bf16_f32 v88, v64, v65
    v_cvt_pk_bf16_f32 v89, v66, v67
    v_cvt_pk_bf16_f32 v90, v68, v69
    v_cvt_pk_bf16_f32 v91, v70, v71
    buffer_store_dwordx4 v[88:91], v0, s[36:39], s83 offen offset:2048 sc1
    s_waitcnt vmcnt(2)
    v_accvgpr_read_b32 v72, a216
    v_accvgpr_read_b32 v73, a248
    v_accvgpr_read_b32 v74, a217
    v_accvgpr_read_b32 v75, a249
    v_accvgpr_read_b32 v76, a218
    v_accvgpr_read_b32 v77, a250
    v_accvgpr_read_b32 v78, a219
    v_accvgpr_read_b32 v79, a251
    v_cvt_pk_bf16_f32 v92, v72, v73
    v_cvt_pk_bf16_f32 v93, v74, v75
    v_cvt_pk_bf16_f32 v94, v76, v77
    v_cvt_pk_bf16_f32 v95, v78, v79
    buffer_store_dwordx4 v[92:95], v0, s[36:39], s83 offen offset:3072 sc1
    s_waitcnt vmcnt(2)
    s_add_u32 s83, s82, 0x1181000
    v_accvgpr_read_b32 v64, a28
    v_accvgpr_read_b32 v65, a60
    v_accvgpr_read_b32 v66, a29
    v_accvgpr_read_b32 v67, a61
    v_accvgpr_read_b32 v68, a30
    v_accvgpr_read_b32 v69, a62
    v_accvgpr_read_b32 v70, a31
    v_accvgpr_read_b32 v71, a63
    v_cvt_pk_bf16_f32 v80, v64, v65
    v_cvt_pk_bf16_f32 v81, v66, v67
    v_cvt_pk_bf16_f32 v82, v68, v69
    v_cvt_pk_bf16_f32 v83, v70, v71
    buffer_store_dwordx4 v[80:83], v0, s[36:39], s83 offen offset:0 sc1
    s_waitcnt vmcnt(2)
    v_accvgpr_read_b32 v72, a92
    v_accvgpr_read_b32 v73, a124
    v_accvgpr_read_b32 v74, a93
    v_accvgpr_read_b32 v75, a125
    v_accvgpr_read_b32 v76, a94
    v_accvgpr_read_b32 v77, a126
    v_accvgpr_read_b32 v78, a95
    v_accvgpr_read_b32 v79, a127
    v_cvt_pk_bf16_f32 v84, v72, v73
    v_cvt_pk_bf16_f32 v85, v74, v75
    v_cvt_pk_bf16_f32 v86, v76, v77
    v_cvt_pk_bf16_f32 v87, v78, v79
    buffer_store_dwordx4 v[84:87], v0, s[36:39], s83 offen offset:1024 sc1
    s_waitcnt vmcnt(2)
    v_accvgpr_read_b32 v64, a156
    v_accvgpr_read_b32 v65, a188
    v_accvgpr_read_b32 v66, a157
    v_accvgpr_read_b32 v67, a189
    v_accvgpr_read_b32 v68, a158
    v_accvgpr_read_b32 v69, a190
    v_accvgpr_read_b32 v70, a159
    v_accvgpr_read_b32 v71, a191
    v_cvt_pk_bf16_f32 v88, v64, v65
    v_cvt_pk_bf16_f32 v89, v66, v67
    v_cvt_pk_bf16_f32 v90, v68, v69
    v_cvt_pk_bf16_f32 v91, v70, v71
    buffer_store_dwordx4 v[88:91], v0, s[36:39], s83 offen offset:2048 sc1
    s_waitcnt vmcnt(2)
    v_accvgpr_read_b32 v72, a220
    v_accvgpr_read_b32 v73, a252
    v_accvgpr_read_b32 v74, a221
    v_accvgpr_read_b32 v75, a253
    v_accvgpr_read_b32 v76, a222
    v_accvgpr_read_b32 v77, a254
    v_accvgpr_read_b32 v78, a223
    v_accvgpr_read_b32 v79, a255
    v_cvt_pk_bf16_f32 v92, v72, v73
    v_cvt_pk_bf16_f32 v93, v74, v75
    v_cvt_pk_bf16_f32 v94, v76, v77
    v_cvt_pk_bf16_f32 v95, v78, v79
    buffer_store_dwordx4 v[92:95], v0, s[36:39], s83 offen offset:3072 sc1
    s_waitcnt vmcnt(2)
    s_mov_b32 s83, 0x40000
    s_branch L_done
L_epiQ:
    s_mov_b32 s84, 0x3e0293ee
    s_mov_b32 s85, 0x3e0293ee
    s_lshr_b32 s82, s82, 1
    s_add_u32 s83, s82, 0x3000000
    v_accvgpr_read_b32 v64, a0
    v_accvgpr_read_b32 v65, a32
    v_accvgpr_read_b32 v66, a1
    v_accvgpr_read_b32 v67, a33
    v_accvgpr_read_b32 v68, a2
    v_accvgpr_read_b32 v69, a34
    v_accvgpr_read_b32 v70, a3
    v_accvgpr_read_b32 v71, a35
    v_pk_mul_f32 v[64:65], v[64:65], s[84:85]
    v_pk_mul_f32 v[66:67], v[66:67], s[84:85]
    v_pk_mul_f32 v[68:69], v[68:69], s[84:85]
    v_pk_mul_f32 v[70:71], v[70:71], s[84:85]
    v_cvt_pk_bf16_f32 v80, v64, v65
    v_cvt_pk_bf16_f32 v81, v66, v67
    v_cvt_pk_bf16_f32 v82, v68, v69
    v_cvt_pk_bf16_f32 v83, v70, v71
    buffer_store_dwordx4 v[80:83], v1, s[36:39], s83 offen offset:0 sc1
    s_waitcnt vmcnt(2)
    v_accvgpr_read_b32 v72, a64
    v_accvgpr_read_b32 v73, a96
    v_accvgpr_read_b32 v74, a65
    v_accvgpr_read_b32 v75, a97
    v_accvgpr_read_b32 v76, a66
    v_accvgpr_read_b32 v77, a98
    v_accvgpr_read_b32 v78, a67
    v_accvgpr_read_b32 v79, a99
    v_pk_mul_f32 v[72:73], v[72:73], s[84:85]
    v_pk_mul_f32 v[74:75], v[74:75], s[84:85]
    v_pk_mul_f32 v[76:77], v[76:77], s[84:85]
    v_pk_mul_f32 v[78:79], v[78:79], s[84:85]
    v_cvt_pk_bf16_f32 v84, v72, v73
    v_cvt_pk_bf16_f32 v85, v74, v75
    v_cvt_pk_bf16_f32 v86, v76, v77
    v_cvt_pk_bf16_f32 v87, v78, v79
    buffer_store_dwordx4 v[84:87], v1, s[36:39], s83 offen offset:1024 sc1
    s_waitcnt vmcnt(2)
    v_accvgpr_read_b32 v64, a128
    v_accvgpr_read_b32 v65, a160
    v_accvgpr_read_b32 v66, a129
    v_accvgpr_read_b32 v67, a161
    v_accvgpr_read_b32 v68, a130
    v_accvgpr_read_b32 v69, a162
    v_accvgpr_read_b32 v70, a131
    v_accvgpr_read_b32 v71, a163
    v_pk_mul_f32 v[64:65], v[64:65], s[84:85]
    v_pk_mul_f32 v[66:67], v[66:67], s[84:85]
    v_pk_mul_f32 v[68:69], v[68:69], s[84:85]
    v_pk_mul_f32 v[70:71], v[70:71], s[84:85]
    v_cvt_pk_bf16_f32 v88, v64, v65
    v_cvt_pk_bf16_f32 v89, v66, v67
    v_cvt_pk_bf16_f32 v90, v68, v69
    v_cvt_pk_bf16_f32 v91, v70, v71
    buffer_store_dwordx4 v[88:91], v1, s[36:39], s83 offen offset:2048 sc1
    s_waitcnt vmcnt(2)
    v_accvgpr_read_b32 v72, a192
    v_accvgpr_read_b32 v73, a224
    v_accvgpr_read_b32 v74, a193
    v_accvgpr_read_b32 v75, a225
    v_accvgpr_read_b32 v76, a194
    v_accvgpr_read_b32 v77, a226
    v_accvgpr_read_b32 v78, a195
    v_accvgpr_read_b32 v79, a227
    v_pk_mul_f32 v[72:73], v[72:73], s[84:85]
    v_pk_mul_f32 v[74:75], v[74:75], s[84:85]
    v_pk_mul_f32 v[76:77], v[76:77], s[84:85]
    v_pk_mul_f32 v[78:79], v[78:79], s[84:85]
    v_cvt_pk_bf16_f32 v92, v72, v73
    v_cvt_pk_bf16_f32 v93, v74, v75
    v_cvt_pk_bf16_f32 v94, v76, v77
    v_cvt_pk_bf16_f32 v95, v78, v79
    buffer_store_dwordx4 v[92:95], v1, s[36:39], s83 offen offset:3072 sc1
    s_waitcnt vmcnt(2)
    s_add_u32 s83, s82, 0x3001000
    v_accvgpr_read_b32 v64, a4
    v_accvgpr_read_b32 v65, a36
    v_accvgpr_read_b32 v66, a5
    v_accvgpr_read_b32 v67, a37
    v_accvgpr_read_b32 v68, a6
    v_accvgpr_read_b32 v69, a38
    v_accvgpr_read_b32 v70, a7
    v_accvgpr_read_b32 v71, a39
    v_pk_mul_f32 v[64:65], v[64:65], s[84:85]
    v_pk_mul_f32 v[66:67], v[66:67], s[84:85]
    v_pk_mul_f32 v[68:69], v[68:69], s[84:85]
    v_pk_mul_f32 v[70:71], v[70:71], s[84:85]
    v_cvt_pk_bf16_f32 v80, v64, v65
    v_cvt_pk_bf16_f32 v81, v66, v67
    v_cvt_pk_bf16_f32 v82, v68, v69
    v_cvt_pk_bf16_f32 v83, v70, v71
    buffer_store_dwordx4 v[80:83], v1, s[36:39], s83 offen offset:0 sc1
    s_waitcnt vmcnt(2)
    v_accvgpr_read_b32 v72, a68
    v_accvgpr_read_b32 v73, a100
    v_accvgpr_read_b32 v74, a69
    v_accvgpr_read_b32 v75, a101
    v_accvgpr_read_b32 v76, a70
    v_accvgpr_read_b32 v77, a102
    v_accvgpr_read_b32 v78, a71
    v_accvgpr_read_b32 v79, a103
    v_pk_mul_f32 v[72:73], v[72:73], s[84:85]
    v_pk_mul_f32 v[74:75], v[74:75], s[84:85]
    v_pk_mul_f32 v[76:77], v[76:77], s[84:85]
    v_pk_mul_f32 v[78:79], v[78:79], s[84:85]
    v_cvt_pk_bf16_f32 v84, v72, v73
    v_cvt_pk_bf16_f32 v85, v74, v75
    v_cvt_pk_bf16_f32 v86, v76, v77
    v_cvt_pk_bf16_f32 v87, v78, v79
    buffer_store_dwordx4 v[84:87], v1, s[36:39], s83 offen offset:1024 sc1
    s_waitcnt vmcnt(2)
    v_accvgpr_read_b32 v64, a132
    v_accvgpr_read_b32 v65, a164
    v_accvgpr_read_b32 v66, a133
    v_accvgpr_read_b32 v67, a165
    v_accvgpr_read_b32 v68, a134
    v_accvgpr_read_b32 v69, a166
    v_accvgpr_read_b32 v70, a135
    v_accvgpr_read_b32 v71, a167
    v_pk_mul_f32 v[64:65], v[64:65], s[84:85]
    v_pk_mul_f32 v[66:67], v[66:67], s[84:85]
    v_pk_mul_f32 v[68:69], v[68:69], s[84:85]
    v_pk_mul_f32 v[70:71], v[70:71], s[84:85]
    v_cvt_pk_bf16_f32 v88, v64, v65
    v_cvt_pk_bf16_f32 v89, v66, v67
    v_cvt_pk_bf16_f32 v90, v68, v69
    v_cvt_pk_bf16_f32 v91, v70, v71
    buffer_store_dwordx4 v[88:91], v1, s[36:39], s83 offen offset:2048 sc1
    s_waitcnt vmcnt(2)
    v_accvgpr_read_b32 v72, a196
    v_accvgpr_read_b32 v73, a228
    v_accvgpr_read_b32 v74, a197
    v_accvgpr_read_b32 v75, a229
    v_accvgpr_read_b32 v76, a198
    v_accvgpr_read_b32 v77, a230
    v_accvgpr_read_b32 v78, a199
    v_accvgpr_read_b32 v79, a231
    v_pk_mul_f32 v[72:73], v[72:73], s[84:85]
    v_pk_mul_f32 v[74:75], v[74:75], s[84:85]
    v_pk_mul_f32 v[76:77], v[76:77], s[84:85]
    v_pk_mul_f32 v[78:79], v[78:79], s[84:85]
    v_cvt_pk_bf16_f32 v92, v72, v73
    v_cvt_pk_bf16_f32 v93, v74, v75
    v_cvt_pk_bf16_f32 v94, v76, v77
    v_cvt_pk_bf16_f32 v95, v78, v79
    buffer_store_dwordx4 v[92:95], v1, s[36:39], s83 offen offset:3072 sc1
    s_waitcnt vmcnt(2)
    s_add_u32 s83, s82, 0x3040000
    v_accvgpr_read_b32 v64, a8
    v_accvgpr_read_b32 v65, a40
    v_accvgpr_read_b32 v66, a9
    v_accvgpr_read_b32 v67, a41
    v_accvgpr_read_b32 v68, a10
    v_accvgpr_read_b32 v69, a42
    v_accvgpr_read_b32 v70, a11
    v_accvgpr_read_b32 v71, a43
    v_pk_mul_f32 v[64:65], v[64:65], s[84:85]
    v_pk_mul_f32 v[66:67], v[66:67], s[84:85]
    v_pk_mul_f32 v[68:69], v[68:69], s[84:85]
    v_pk_mul_f32 v[70:71], v[70:71], s[84:85]
    v_cvt_pk_bf16_f32 v80, v64, v65
    v_cvt_pk_bf16_f32 v81, v66, v67
    v_cvt_pk_bf16_f32 v82, v68, v69
    v_cvt_pk_bf16_f32 v83, v70, v71
    buffer_store_dwordx4 v[80:83], v1, s[36:39], s83 offen offset:0 sc1
    s_waitcnt vmcnt(2)
    v_accvgpr_read_b32 v72, a72
    v_accvgpr_read_b32 v73, a104
    v_accvgpr_read_b32 v74, a73
    v_accvgpr_read_b32 v75, a105
    v_accvgpr_read_b32 v76, a74
    v_accvgpr_read_b32 v77, a106
    v_accvgpr_read_b32 v78, a75
    v_accvgpr_read_b32 v79, a107
    v_pk_mul_f32 v[72:73], v[72:73], s[84:85]
    v_pk_mul_f32 v[74:75], v[74:75], s[84:85]
    v_pk_mul_f32 v[76:77], v[76:77], s[84:85]
    v_pk_mul_f32 v[78:79], v[78:79], s[84:85]
    v_cvt_pk_bf16_f32 v84, v72, v73
    v_cvt_pk_bf16_f32 v85, v74, v75
    v_cvt_pk_bf16_f32 v86, v76, v77
    v_cvt_pk_bf16_f32 v87, v78, v79
    buffer_store_dwordx4 v[84:87], v1, s[36:39], s83 offen offset:1024 sc1
    s_waitcnt vmcnt(2)
    v_accvgpr_read_b32 v64, a136
    v_accvgpr_read_b32 v65, a168
    v_accvgpr_read_b32 v66, a137
    v_accvgpr_read_b32 v67, a169
    v_accvgpr_read_b32 v68, a138
    v_accvgpr_read_b32 v69, a170
    v_accvgpr_read_b32 v70, a139
    v_accvgpr_read_b32 v71, a171
    v_pk_mul_f32 v[64:65], v[64:65], s[84:85]
    v_pk_mul_f32 v[66:67], v[66:67], s[84:85]
    v_pk_mul_f32 v[68:69], v[68:69], s[84:85]
    v_pk_mul_f32 v[70:71], v[70:71], s[84:85]
    v_cvt_pk_bf16_f32 v88, v64, v65
    v_cvt_pk_bf16_f32 v89, v66, v67
    v_cvt_pk_bf16_f32 v90, v68, v69
    v_cvt_pk_bf16_f32 v91, v70, v71
    buffer_store_dwordx4 v[88:91], v1, s[36:39], s83 offen offset:2048 sc1
    s_waitcnt vmcnt(2)
    v_accvgpr_read_b32 v72, a200
    v_accvgpr_read_b32 v73, a232
    v_accvgpr_read_b32 v74, a201
    v_accvgpr_read_b32 v75, a233
    v_accvgpr_read_b32 v76, a202
    v_accvgpr_read_b32 v77, a234
    v_accvgpr_read_b32 v78, a203
    v_accvgpr_read_b32 v79, a235
    v_pk_mul_f32 v[72:73], v[72:73], s[84:85]
    v_pk_mul_f32 v[74:75], v[74:75], s[84:85]
    v_pk_mul_f32 v[76:77], v[76:77], s[84:85]
    v_pk_mul_f32 v[78:79], v[78:79], s[84:85]
    v_cvt_pk_bf16_f32 v92, v72, v73
    v_cvt_pk_bf16_f32 v93, v74, v75
    v_cvt_pk_bf16_f32 v94, v76, v77
    v_cvt_pk_bf16_f32 v95, v78, v79
    buffer_store_dwordx4 v[92:95], v1, s[36:39], s83 offen offset:3072 sc1
    s_waitcnt vmcnt(2)
    s_add_u32 s83, s82, 0x3041000
    v_accvgpr_read_b32 v64, a12
    v_accvgpr_read_b32 v65, a44
    v_accvgpr_read_b32 v66, a13
    v_accvgpr_read_b32 v67, a45
    v_accvgpr_read_b32 v68, a14
    v_accvgpr_read_b32 v69, a46
    v_accvgpr_read_b32 v70, a15
    v_accvgpr_read_b32 v71, a47
    v_pk_mul_f32 v[64:65], v[64:65], s[84:85]
    v_pk_mul_f32 v[66:67], v[66:67], s[84:85]
    v_pk_mul_f32 v[68:69], v[68:69], s[84:85]
    v_pk_mul_f32 v[70:71], v[70:71], s[84:85]
    v_cvt_pk_bf16_f32 v80, v64, v65
    v_cvt_pk_bf16_f32 v81, v66, v67
    v_cvt_pk_bf16_f32 v82, v68, v69
    v_cvt_pk_bf16_f32 v83, v70, v71
    buffer_store_dwordx4 v[80:83], v1, s[36:39], s83 offen offset:0 sc1
    s_waitcnt vmcnt(2)
    v_accvgpr_read_b32 v72, a76
    v_accvgpr_read_b32 v73, a108
    v_accvgpr_read_b32 v74, a77
    v_accvgpr_read_b32 v75, a109
    v_accvgpr_read_b32 v76, a78
    v_accvgpr_read_b32 v77, a110
    v_accvgpr_read_b32 v78, a79
    v_accvgpr_read_b32 v79, a111
    v_pk_mul_f32 v[72:73], v[72:73], s[84:85]
    v_pk_mul_f32 v[74:75], v[74:75], s[84:85]
    v_pk_mul_f32 v[76:77], v[76:77], s[84:85]
    v_pk_mul_f32 v[78:79], v[78:79], s[84:85]
    v_cvt_pk_bf16_f32 v84, v72, v73
    v_cvt_pk_bf16_f32 v85, v74, v75
    v_cvt_pk_bf16_f32 v86, v76, v77
    v_cvt_pk_bf16_f32 v87, v78, v79
    buffer_store_dwordx4 v[84:87], v1, s[36:39], s83 offen offset:1024 sc1
    s_waitcnt vmcnt(2)
    v_accvgpr_read_b32 v64, a140
    v_accvgpr_read_b32 v65, a172
    v_accvgpr_read_b32 v66, a141
    v_accvgpr_read_b32 v67, a173
    v_accvgpr_read_b32 v68, a142
    v_accvgpr_read_b32 v69, a174
    v_accvgpr_read_b32 v70, a143
    v_accvgpr_read_b32 v71, a175
    v_pk_mul_f32 v[64:65], v[64:65], s[84:85]
    v_pk_mul_f32 v[66:67], v[66:67], s[84:85]
    v_pk_mul_f32 v[68:69], v[68:69], s[84:85]
    v_pk_mul_f32 v[70:71], v[70:71], s[84:85]
    v_cvt_pk_bf16_f32 v88, v64, v65
    v_cvt_pk_bf16_f32 v89, v66, v67
    v_cvt_pk_bf16_f32 v90, v68, v69
    v_cvt_pk_bf16_f32 v91, v70, v71
    buffer_store_dwordx4 v[88:91], v1, s[36:39], s83 offen offset:2048 sc1
    s_waitcnt vmcnt(2)
    v_accvgpr_read_b32 v72, a204
    v_accvgpr_read_b32 v73, a236
    v_accvgpr_read_b32 v74, a205
    v_accvgpr_read_b32 v75, a237
    v_accvgpr_read_b32 v76, a206
    v_accvgpr_read_b32 v77, a238
    v_accvgpr_read_b32 v78, a207
    v_accvgpr_read_b32 v79, a239
    v_pk_mul_f32 v[72:73], v[72:73], s[84:85]
    v_pk_mul_f32 v[74:75], v[74:75], s[84:85]
    v_pk_mul_f32 v[76:77], v[76:77], s[84:85]
    v_pk_mul_f32 v[78:79], v[78:79], s[84:85]
    v_cvt_pk_bf16_f32 v92, v72, v73
    v_cvt_pk_bf16_f32 v93, v74, v75
    v_cvt_pk_bf16_f32 v94, v76, v77
    v_cvt_pk_bf16_f32 v95, v78, v79
    buffer_store_dwordx4 v[92:95], v1, s[36:39], s83 offen offset:3072 sc1
    s_waitcnt vmcnt(2)
    s_add_u32 s83, s82, 0x3080000
    v_accvgpr_read_b32 v64, a16
    v_accvgpr_read_b32 v65, a48
    v_accvgpr_read_b32 v66, a17
    v_accvgpr_read_b32 v67, a49
    v_accvgpr_read_b32 v68, a18
    v_accvgpr_read_b32 v69, a50
    v_accvgpr_read_b32 v70, a19
    v_accvgpr_read_b32 v71, a51
    v_pk_mul_f32 v[64:65], v[64:65], s[84:85]
    v_pk_mul_f32 v[66:67], v[66:67], s[84:85]
    v_pk_mul_f32 v[68:69], v[68:69], s[84:85]
    v_pk_mul_f32 v[70:71], v[70:71], s[84:85]
    v_cvt_pk_bf16_f32 v80, v64, v65
    v_cvt_pk_bf16_f32 v81, v66, v67
    v_cvt_pk_bf16_f32 v82, v68, v69
    v_cvt_pk_bf16_f32 v83, v70, v71
    buffer_store_dwordx4 v[80:83], v1, s[36:39], s83 offen offset:0 sc1
    s_waitcnt vmcnt(2)
    v_accvgpr_read_b32 v72, a80
    v_accvgpr_read_b32 v73, a112
    v_accvgpr_read_b32 v74, a81
    v_accvgpr_read_b32 v75, a113
    v_accvgpr_read_b32 v76, a82
    v_accvgpr_read_b32 v77, a114
    v_accvgpr_read_b32 v78, a83
    v_accvgpr_read_b32 v79, a115
    v_pk_mul_f32 v[72:73], v[72:73], s[84:85]
    v_pk_mul_f32 v[74:75], v[74:75], s[84:85]
    v_pk_mul_f32 v[76:77], v[76:77], s[84:85]
    v_pk_mul_f32 v[78:79], v[78:79], s[84:85]
    v_cvt_pk_bf16_f32 v84, v72, v73
    v_cvt_pk_bf16_f32 v85, v74, v75
    v_cvt_pk_bf16_f32 v86, v76, v77
    v_cvt_pk_bf16_f32 v87, v78, v79
    buffer_store_dwordx4 v[84:87], v1, s[36:39], s83 offen offset:1024 sc1
    s_waitcnt vmcnt(2)
    v_accvgpr_read_b32 v64, a144
    v_accvgpr_read_b32 v65, a176
    v_accvgpr_read_b32 v66, a145
    v_accvgpr_read_b32 v67, a177
    v_accvgpr_read_b32 v68, a146
    v_accvgpr_read_b32 v69, a178
    v_accvgpr_read_b32 v70, a147
    v_accvgpr_read_b32 v71, a179
    v_pk_mul_f32 v[64:65], v[64:65], s[84:85]
    v_pk_mul_f32 v[66:67], v[66:67], s[84:85]
    v_pk_mul_f32 v[68:69], v[68:69], s[84:85]
    v_pk_mul_f32 v[70:71], v[70:71], s[84:85]
    v_cvt_pk_bf16_f32 v88, v64, v65
    v_cvt_pk_bf16_f32 v89, v66, v67
    v_cvt_pk_bf16_f32 v90, v68, v69
    v_cvt_pk_bf16_f32 v91, v70, v71
    buffer_store_dwordx4 v[88:91], v1, s[36:39], s83 offen offset:2048 sc1
    s_waitcnt vmcnt(2)
    v_accvgpr_read_b32 v72, a208
    v_accvgpr_read_b32 v73, a240
    v_accvgpr_read_b32 v74, a209
    v_accvgpr_read_b32 v75, a241
    v_accvgpr_read_b32 v76, a210
    v_accvgpr_read_b32 v77, a242
    v_accvgpr_read_b32 v78, a211
    v_accvgpr_read_b32 v79, a243
    v_pk_mul_f32 v[72:73], v[72:73], s[84:85]
    v_pk_mul_f32 v[74:75], v[74:75], s[84:85]
    v_pk_mul_f32 v[76:77], v[76:77], s[84:85]
    v_pk_mul_f32 v[78:79], v[78:79], s[84:85]
    v_cvt_pk_bf16_f32 v92, v72, v73
    v_cvt_pk_bf16_f32 v93, v74, v75
    v_cvt_pk_bf16_f32 v94, v76, v77
    v_cvt_pk_bf16_f32 v95, v78, v79
    buffer_store_dwordx4 v[92:95], v1, s[36:39], s83 offen offset:3072 sc1
    s_waitcnt vmcnt(2)
    s_add_u32 s83, s82, 0x3081000
    v_accvgpr_read_b32 v64, a20
    v_accvgpr_read_b32 v65, a52
    v_accvgpr_read_b32 v66, a21
    v_accvgpr_read_b32 v67, a53
    v_accvgpr_read_b32 v68, a22
    v_accvgpr_read_b32 v69, a54
    v_accvgpr_read_b32 v70, a23
    v_accvgpr_read_b32 v71, a55
    v_pk_mul_f32 v[64:65], v[64:65], s[84:85]
    v_pk_mul_f32 v[66:67], v[66:67], s[84:85]
    v_pk_mul_f32 v[68:69], v[68:69], s[84:85]
    v_pk_mul_f32 v[70:71], v[70:71], s[84:85]
    v_cvt_pk_bf16_f32 v80, v64, v65
    v_cvt_pk_bf16_f32 v81, v66, v67
    v_cvt_pk_bf16_f32 v82, v68, v69
    v_cvt_pk_bf16_f32 v83, v70, v71
    buffer_store_dwordx4 v[80:83], v1, s[36:39], s83 offen offset:0 sc1
    s_waitcnt vmcnt(2)
    v_accvgpr_read_b32 v72, a84
    v_accvgpr_read_b32 v73, a116
    v_accvgpr_read_b32 v74, a85
    v_accvgpr_read_b32 v75, a117
    v_accvgpr_read_b32 v76, a86
    v_accvgpr_read_b32 v77, a118
    v_accvgpr_read_b32 v78, a87
    v_accvgpr_read_b32 v79, a119
    v_pk_mul_f32 v[72:73], v[72:73], s[84:85]
    v_pk_mul_f32 v[74:75], v[74:75], s[84:85]
    v_pk_mul_f32 v[76:77], v[76:77], s[84:85]
    v_pk_mul_f32 v[78:79], v[78:79], s[84:85]
    v_cvt_pk_bf16_f32 v84, v72, v73
    v_cvt_pk_bf16_f32 v85, v74, v75
    v_cvt_pk_bf16_f32 v86, v76, v77
    v_cvt_pk_bf16_f32 v87, v78, v79
    buffer_store_dwordx4 v[84:87], v1, s[36:39], s83 offen offset:1024 sc1
    s_waitcnt vmcnt(2)
    v_accvgpr_read_b32 v64, a148
    v_accvgpr_read_b32 v65, a180
    v_accvgpr_read_b32 v66, a149
    v_accvgpr_read_b32 v67, a181
    v_accvgpr_read_b32 v68, a150
    v_accvgpr_read_b32 v69, a182
    v_accvgpr_read_b32 v70, a151
    v_accvgpr_read_b32 v71, a183
    v_pk_mul_f32 v[64:65], v[64:65], s[84:85]
    v_pk_mul_f32 v[66:67], v[66:67], s[84:85]
    v_pk_mul_f32 v[68:69], v[68:69], s[84:85]
    v_pk_mul_f32 v[70:71], v[70:71], s[84:85]
    v_cvt_pk_bf16_f32 v88, v64, v65
    v_cvt_pk_bf16_f32 v89, v66, v67
    v_cvt_pk_bf16_f32 v90, v68, v69
    v_cvt_pk_bf16_f32 v91, v70, v71
    buffer_store_dwordx4 v[88:91], v1, s[36:39], s83 offen offset:2048 sc1
    s_waitcnt vmcnt(2)
    v_accvgpr_read_b32 v72, a212
    v_accvgpr_read_b32 v73, a244
    v_accvgpr_read_b32 v74, a213
    v_accvgpr_read_b32 v75, a245
    v_accvgpr_read_b32 v76, a214
    v_accvgpr_read_b32 v77, a246
    v_accvgpr_read_b32 v78, a215
    v_accvgpr_read_b32 v79, a247
    v_pk_mul_f32 v[72:73], v[72:73], s[84:85]
    v_pk_mul_f32 v[74:75], v[74:75], s[84:85]
    v_pk_mul_f32 v[76:77], v[76:77], s[84:85]
    v_pk_mul_f32 v[78:79], v[78:79], s[84:85]
    v_cvt_pk_bf16_f32 v92, v72, v73
    v_cvt_pk_bf16_f32 v93, v74, v75
    v_cvt_pk_bf16_f32 v94, v76, v77
    v_cvt_pk_bf16_f32 v95, v78, v79
    buffer_store_dwordx4 v[92:95], v1, s[36:39], s83 offen offset:3072 sc1
    s_waitcnt vmcnt(2)
    s_add_u32 s83, s82, 0x30c0000
    v_accvgpr_read_b32 v64, a24
    v_accvgpr_read_b32 v65, a56
    v_accvgpr_read_b32 v66, a25
    v_accvgpr_read_b32 v67, a57
    v_accvgpr_read_b32 v68, a26
    v_accvgpr_read_b32 v69, a58
    v_accvgpr_read_b32 v70, a27
    v_accvgpr_read_b32 v71, a59
    v_pk_mul_f32 v[64:65], v[64:65], s[84:85]
    v_pk_mul_f32 v[66:67], v[66:67], s[84:85]
    v_pk_mul_f32 v[68:69], v[68:69], s[84:85]
    v_pk_mul_f32 v[70:71], v[70:71], s[84:85]
    v_cvt_pk_bf16_f32 v80, v64, v65
    v_cvt_pk_bf16_f32 v81, v66, v67
    v_cvt_pk_bf16_f32 v82, v68, v69
    v_cvt_pk_bf16_f32 v83, v70, v71
    buffer_store_dwordx4 v[80:83], v1, s[36:39], s83 offen offset:0 sc1
    s_waitcnt vmcnt(2)
    v_accvgpr_read_b32 v72, a88
    v_accvgpr_read_b32 v73, a120
    v_accvgpr_read_b32 v74, a89
    v_accvgpr_read_b32 v75, a121
    v_accvgpr_read_b32 v76, a90
    v_accvgpr_read_b32 v77, a122
    v_accvgpr_read_b32 v78, a91
    v_accvgpr_read_b32 v79, a123
    v_pk_mul_f32 v[72:73], v[72:73], s[84:85]
    v_pk_mul_f32 v[74:75], v[74:75], s[84:85]
    v_pk_mul_f32 v[76:77], v[76:77], s[84:85]
    v_pk_mul_f32 v[78:79], v[78:79], s[84:85]
    v_cvt_pk_bf16_f32 v84, v72, v73
    v_cvt_pk_bf16_f32 v85, v74, v75
    v_cvt_pk_bf16_f32 v86, v76, v77
    v_cvt_pk_bf16_f32 v87, v78, v79
    buffer_store_dwordx4 v[84:87], v1, s[36:39], s83 offen offset:1024 sc1
    s_waitcnt vmcnt(2)
    v_accvgpr_read_b32 v64, a152
    v_accvgpr_read_b32 v65, a184
    v_accvgpr_read_b32 v66, a153
    v_accvgpr_read_b32 v67, a185
    v_accvgpr_read_b32 v68, a154
    v_accvgpr_read_b32 v69, a186
    v_accvgpr_read_b32 v70, a155
    v_accvgpr_read_b32 v71, a187
    v_pk_mul_f32 v[64:65], v[64:65], s[84:85]
    v_pk_mul_f32 v[66:67], v[66:67], s[84:85]
    v_pk_mul_f32 v[68:69], v[68:69], s[84:85]
    v_pk_mul_f32 v[70:71], v[70:71], s[84:85]
    v_cvt_pk_bf16_f32 v88, v64, v65
    v_cvt_pk_bf16_f32 v89, v66, v67
    v_cvt_pk_bf16_f32 v90, v68, v69
    v_cvt_pk_bf16_f32 v91, v70, v71
    buffer_store_dwordx4 v[88:91], v1, s[36:39], s83 offen offset:2048 sc1
    s_waitcnt vmcnt(2)
    v_accvgpr_read_b32 v72, a216
    v_accvgpr_read_b32 v73, a248
    v_accvgpr_read_b32 v74, a217
    v_accvgpr_read_b32 v75, a249
    v_accvgpr_read_b32 v76, a218
    v_accvgpr_read_b32 v77, a250
    v_accvgpr_read_b32 v78, a219
    v_accvgpr_read_b32 v79, a251
    v_pk_mul_f32 v[72:73], v[72:73], s[84:85]
    v_pk_mul_f32 v[74:75], v[74:75], s[84:85]
    v_pk_mul_f32 v[76:77], v[76:77], s[84:85]
    v_pk_mul_f32 v[78:79], v[78:79], s[84:85]
    v_cvt_pk_bf16_f32 v92, v72, v73
    v_cvt_pk_bf16_f32 v93, v74, v75
    v_cvt_pk_bf16_f32 v94, v76, v77
    v_cvt_pk_bf16_f32 v95, v78, v79
    buffer_store_dwordx4 v[92:95], v1, s[36:39], s83 offen offset:3072 sc1
    s_waitcnt vmcnt(2)
    s_add_u32 s83, s82, 0x30c1000
    v_accvgpr_read_b32 v64, a28
    v_accvgpr_read_b32 v65, a60
    v_accvgpr_read_b32 v66, a29
    v_accvgpr_read_b32 v67, a61
    v_accvgpr_read_b32 v68, a30
    v_accvgpr_read_b32 v69, a62
    v_accvgpr_read_b32 v70, a31
    v_accvgpr_read_b32 v71, a63
    v_pk_mul_f32 v[64:65], v[64:65], s[84:85]
    v_pk_mul_f32 v[66:67], v[66:67], s[84:85]
    v_pk_mul_f32 v[68:69], v[68:69], s[84:85]
    v_pk_mul_f32 v[70:71], v[70:71], s[84:85]
    v_cvt_pk_bf16_f32 v80, v64, v65
    v_cvt_pk_bf16_f32 v81, v66, v67
    v_cvt_pk_bf16_f32 v82, v68, v69
    v_cvt_pk_bf16_f32 v83, v70, v71
    buffer_store_dwordx4 v[80:83], v1, s[36:39], s83 offen offset:0 sc1
    s_waitcnt vmcnt(2)
    v_accvgpr_read_b32 v72, a92
    v_accvgpr_read_b32 v73, a124
    v_accvgpr_read_b32 v74, a93
    v_accvgpr_read_b32 v75, a125
    v_accvgpr_read_b32 v76, a94
    v_accvgpr_read_b32 v77, a126
    v_accvgpr_read_b32 v78, a95
    v_accvgpr_read_b32 v79, a127
    v_pk_mul_f32 v[72:73], v[72:73], s[84:85]
    v_pk_mul_f32 v[74:75], v[74:75], s[84:85]
    v_pk_mul_f32 v[76:77], v[76:77], s[84:85]
    v_pk_mul_f32 v[78:79], v[78:79], s[84:85]
    v_cvt_pk_bf16_f32 v84, v72, v73
    v_cvt_pk_bf16_f32 v85, v74, v75
    v_cvt_pk_bf16_f32 v86, v76, v77
    v_cvt_pk_bf16_f32 v87, v78, v79
    buffer_store_dwordx4 v[84:87], v1, s[36:39], s83 offen offset:1024 sc1
    s_waitcnt vmcnt(2)
    v_accvgpr_read_b32 v64, a156
    v_accvgpr_read_b32 v65, a188
    v_accvgpr_read_b32 v66, a157
    v_accvgpr_read_b32 v67, a189
    v_accvgpr_read_b32 v68, a158
    v_accvgpr_read_b32 v69, a190
    v_accvgpr_read_b32 v70, a159
    v_accvgpr_read_b32 v71, a191
    v_pk_mul_f32 v[64:65], v[64:65], s[84:85]
    v_pk_mul_f32 v[66:67], v[66:67], s[84:85]
    v_pk_mul_f32 v[68:69], v[68:69], s[84:85]
    v_pk_mul_f32 v[70:71], v[70:71], s[84:85]
    v_cvt_pk_bf16_f32 v88, v64, v65
    v_cvt_pk_bf16_f32 v89, v66, v67
    v_cvt_pk_bf16_f32 v90, v68, v69
    v_cvt_pk_bf16_f32 v91, v70, v71
    buffer_store_dwordx4 v[88:91], v1, s[36:39], s83 offen offset:2048 sc1
    s_waitcnt vmcnt(2)
    v_accvgpr_read_b32 v72, a220
    v_accvgpr_read_b32 v73, a252
    v_accvgpr_read_b32 v74, a221
    v_accvgpr_read_b32 v75, a253
    v_accvgpr_read_b32 v76, a222
    v_accvgpr_read_b32 v77, a254
    v_accvgpr_read_b32 v78, a223
    v_accvgpr_read_b32 v79, a255
    v_pk_mul_f32 v[72:73], v[72:73], s[84:85]
    v_pk_mul_f32 v[74:75], v[74:75], s[84:85]
    v_pk_mul_f32 v[76:77], v[76:77], s[84:85]
    v_pk_mul_f32 v[78:79], v[78:79], s[84:85]
    v_cvt_pk_bf16_f32 v92, v72, v73
    v_cvt_pk_bf16_f32 v93, v74, v75
    v_cvt_pk_bf16_f32 v94, v76, v77
    v_cvt_pk_bf16_f32 v95, v78, v79
    buffer_store_dwordx4 v[92:95], v1, s[36:39], s83 offen offset:3072 sc1
    s_waitcnt vmcnt(2)
    s_mov_b32 s83, 0x40400
    s_branch L_done
L_epiV:
    s_add_u32 s83, s82, 0x1002000
    v_accvgpr_read_b32 v64, a0
    v_accvgpr_read_b32 v65, a1
    v_accvgpr_read_b32 v66, a2
    v_accvgpr_read_b32 v67, a3
    v_accvgpr_read_b32 v68, a4
    v_accvgpr_read_b32 v69, a5
    v_accvgpr_read_b32 v70, a6
    v_accvgpr_read_b32 v71, a7
    v_cvt_pk_bf16_f32 v80, v64, v65
    v_cvt_pk_bf16_f32 v81, v66, v67
    v_cvt_pk_bf16_f32 v82, v68, v69
    v_cvt_pk_bf16_f32 v83, v70, v71
    buffer_store_dwordx4 v[80:83], v1, s[36:39], s83 offen offset:0 sc1
    v_accvgpr_read_b32 v72, a32
    v_accvgpr_read_b32 v73, a33
    v_accvgpr_read_b32 v74, a34
    v_accvgpr_read_b32 v75, a35
    v_accvgpr_read_b32 v76, a36
    v_accvgpr_read_b32 v77, a37
    v_accvgpr_read_b32 v78, a38
    v_accvgpr_read_b32 v79, a39
    v_cvt_pk_bf16_f32 v84, v72, v73
    v_cvt_pk_bf16_f32 v85, v74, v75
    v_cvt_pk_bf16_f32 v86, v76, v77
    v_cvt_pk_bf16_f32 v87, v78, v79
    buffer_store_dwordx4 v[84:87], v1, s[36:39], s83 offen offset:1024 sc1
    v_accvgpr_read_b32 v64, a64
    v_accvgpr_read_b32 v65, a65
    v_accvgpr_read_b32 v66, a66
    v_accvgpr_read_b32 v67, a67
    v_accvgpr_read_b32 v68, a68
    v_accvgpr_read_b32 v69, a69
    v_accvgpr_read_b32 v70, a70
    v_accvgpr_read_b32 v71, a71
    v_cvt_pk_bf16_f32 v88, v64, v65
    v_cvt_pk_bf16_f32 v89, v66, v67
    v_cvt_pk_bf16_f32 v90, v68, v69
    v_cvt_pk_bf16_f32 v91, v70, v71
    buffer_store_dwordx4 v[88:91], v1, s[36:39], s83 offen offset:2048 sc1
    v_accvgpr_read_b32 v72, a96
    v_accvgpr_read_b32 v73, a97
    v_accvgpr_read_b32 v74, a98
    v_accvgpr_read_b32 v75, a99
    v_accvgpr_read_b32 v76, a100
    v_accvgpr_read_b32 v77, a101
    v_accvgpr_read_b32 v78, a102
    v_accvgpr_read_b32 v79, a103
    v_cvt_pk_bf16_f32 v92, v72, v73
    v_cvt_pk_bf16_f32 v93, v74, v75
    v_cvt_pk_bf16_f32 v94, v76, v77
    v_cvt_pk_bf16_f32 v95, v78, v79
    buffer_store_dwordx4 v[92:95], v1, s[36:39], s83 offen offset:3072 sc1
    s_add_u32 s83, s82, 0x1003000
    v_accvgpr_read_b32 v64, a128
    v_accvgpr_read_b32 v65, a129
    v_accvgpr_read_b32 v66, a130
    v_accvgpr_read_b32 v67, a131
    v_accvgpr_read_b32 v68, a132
    v_accvgpr_read_b32 v69, a133
    v_accvgpr_read_b32 v70, a134
    v_accvgpr_read_b32 v71, a135
    v_cvt_pk_bf16_f32 v80, v64, v65
    v_cvt_pk_bf16_f32 v81, v66, v67
    v_cvt_pk_bf16_f32 v82, v68, v69
    v_cvt_pk_bf16_f32 v83, v70, v71
    buffer_store_dwordx4 v[80:83], v1, s[36:39], s83 offen offset:0 sc1
    v_accvgpr_read_b32 v72, a160
    v_accvgpr_read_b32 v73, a161
    v_accvgpr_read_b32 v74, a162
    v_accvgpr_read_b32 v75, a163
    v_accvgpr_read_b32 v76, a164
    v_accvgpr_read_b32 v77, a165
    v_accvgpr_read_b32 v78, a166
    v_accvgpr_read_b32 v79, a167
    v_cvt_pk_bf16_f32 v84, v72, v73
    v_cvt_pk_bf16_f32 v85, v74, v75
    v_cvt_pk_bf16_f32 v86, v76, v77
    v_cvt_pk_bf16_f32 v87, v78, v79
    buffer_store_dwordx4 v[84:87], v1, s[36:39], s83 offen offset:1024 sc1
    v_accvgpr_read_b32 v64, a192
    v_accvgpr_read_b32 v65, a193
    v_accvgpr_read_b32 v66, a194
    v_accvgpr_read_b32 v67, a195
    v_accvgpr_read_b32 v68, a196
    v_accvgpr_read_b32 v69, a197
    v_accvgpr_read_b32 v70, a198
    v_accvgpr_read_b32 v71, a199
    v_cvt_pk_bf16_f32 v88, v64, v65
    v_cvt_pk_bf16_f32 v89, v66, v67
    v_cvt_pk_bf16_f32 v90, v68, v69
    v_cvt_pk_bf16_f32 v91, v70, v71
    buffer_store_dwordx4 v[88:91], v1, s[36:39], s83 offen offset:2048 sc1
    v_accvgpr_read_b32 v72, a224
    v_accvgpr_read_b32 v73, a225
    v_accvgpr_read_b32 v74, a226
    v_accvgpr_read_b32 v75, a227
    v_accvgpr_read_b32 v76, a228
    v_accvgpr_read_b32 v77, a229
    v_accvgpr_read_b32 v78, a230
    v_accvgpr_read_b32 v79, a231
    v_cvt_pk_bf16_f32 v92, v72, v73
    v_cvt_pk_bf16_f32 v93, v74, v75
    v_cvt_pk_bf16_f32 v94, v76, v77
    v_cvt_pk_bf16_f32 v95, v78, v79
    buffer_store_dwordx4 v[92:95], v1, s[36:39], s83 offen offset:3072 sc1
    s_add_u32 s83, s82, 0x1082000
    v_accvgpr_read_b32 v64, a8
    v_accvgpr_read_b32 v65, a9
    v_accvgpr_read_b32 v66, a10
    v_accvgpr_read_b32 v67, a11
    v_accvgpr_read_b32 v68, a12
    v_accvgpr_read_b32 v69, a13
    v_accvgpr_read_b32 v70, a14
    v_accvgpr_read_b32 v71, a15
    v_cvt_pk_bf16_f32 v80, v64, v65
    v_cvt_pk_bf16_f32 v81, v66, v67
    v_cvt_pk_bf16_f32 v82, v68, v69
    v_cvt_pk_bf16_f32 v83, v70, v71
    buffer_store_dwordx4 v[80:83], v1, s[36:39], s83 offen offset:0 sc1
    v_accvgpr_read_b32 v72, a40
    v_accvgpr_read_b32 v73, a41
    v_accvgpr_read_b32 v74, a42
    v_accvgpr_read_b32 v75, a43
    v_accvgpr_read_b32 v76, a44
    v_accvgpr_read_b32 v77, a45
    v_accvgpr_read_b32 v78, a46
    v_accvgpr_read_b32 v79, a47
    v_cvt_pk_bf16_f32 v84, v72, v73
    v_cvt_pk_bf16_f32 v85, v74, v75
    v_cvt_pk_bf16_f32 v86, v76, v77
    v_cvt_pk_bf16_f32 v87, v78, v79
    buffer_store_dwordx4 v[84:87], v1, s[36:39], s83 offen offset:1024 sc1
    v_accvgpr_read_b32 v64, a72
    v_accvgpr_read_b32 v65, a73
    v_accvgpr_read_b32 v66, a74
    v_accvgpr_read_b32 v67, a75
    v_accvgpr_read_b32 v68, a76
    v_accvgpr_read_b32 v69, a77
    v_accvgpr_read_b32 v70, a78
    v_accvgpr_read_b32 v71, a79
    v_cvt_pk_bf16_f32 v88, v64, v65
    v_cvt_pk_bf16_f32 v89, v66, v67
    v_cvt_pk_bf16_f32 v90, v68, v69
    v_cvt_pk_bf16_f32 v91, v70, v71
    buffer_store_dwordx4 v[88:91], v1, s[36:39], s83 offen offset:2048 sc1
    v_accvgpr_read_b32 v72, a104
    v_accvgpr_read_b32 v73, a105
    v_accvgpr_read_b32 v74, a106
    v_accvgpr_read_b32 v75, a107
    v_accvgpr_read_b32 v76, a108
    v_accvgpr_read_b32 v77, a109
    v_accvgpr_read_b32 v78, a110
    v_accvgpr_read_b32 v79, a111
    v_cvt_pk_bf16_f32 v92, v72, v73
    v_cvt_pk_bf16_f32 v93, v74, v75
    v_cvt_pk_bf16_f32 v94, v76, v77
    v_cvt_pk_bf16_f32 v95, v78, v79
    buffer_store_dwordx4 v[92:95], v1, s[36:39], s83 offen offset:3072 sc1
    s_add_u32 s83, s82, 0x1083000
    v_accvgpr_read_b32 v64, a136
    v_accvgpr_read_b32 v65, a137
    v_accvgpr_read_b32 v66, a138
    v_accvgpr_read_b32 v67, a139
    v_accvgpr_read_b32 v68, a140
    v_accvgpr_read_b32 v69, a141
    v_accvgpr_read_b32 v70, a142
    v_accvgpr_read_b32 v71, a143
    v_cvt_pk_bf16_f32 v80, v64, v65
    v_cvt_pk_bf16_f32 v81, v66, v67
    v_cvt_pk_bf16_f32 v82, v68, v69
    v_cvt_pk_bf16_f32 v83, v70, v71
    buffer_store_dwordx4 v[80:83], v1, s[36:39], s83 offen offset:0 sc1
    v_accvgpr_read_b32 v72, a168
    v_accvgpr_read_b32 v73, a169
    v_accvgpr_read_b32 v74, a170
    v_accvgpr_read_b32 v75, a171
    v_accvgpr_read_b32 v76, a172
    v_accvgpr_read_b32 v77, a173
    v_accvgpr_read_b32 v78, a174
    v_accvgpr_read_b32 v79, a175
    v_cvt_pk_bf16_f32 v84, v72, v73
    v_cvt_pk_bf16_f32 v85, v74, v75
    v_cvt_pk_bf16_f32 v86, v76, v77
    v_cvt_pk_bf16_f32 v87, v78, v79
    buffer_store_dwordx4 v[84:87], v1, s[36:39], s83 offen offset:1024 sc1
    v_accvgpr_read_b32 v64, a200
    v_accvgpr_read_b32 v65, a201
    v_accvgpr_read_b32 v66, a202
    v_accvgpr_read_b32 v67, a203
    v_accvgpr_read_b32 v68, a204
    v_accvgpr_read_b32 v69, a205
    v_accvgpr_read_b32 v70, a206
    v_accvgpr_read_b32 v71, a207
    v_cvt_pk_bf16_f32 v88, v64, v65
    v_cvt_pk_bf16_f32 v89, v66, v67
    v_cvt_pk_bf16_f32 v90, v68, v69
    v_cvt_pk_bf16_f32 v91, v70, v71
    buffer_store_dwordx4 v[88:91], v1, s[36:39], s83 offen offset:2048 sc1
    v_accvgpr_read_b32 v72, a232
    v_accvgpr_read_b32 v73, a233
    v_accvgpr_read_b32 v74, a234
    v_accvgpr_read_b32 v75, a235
    v_accvgpr_read_b32 v76, a236
    v_accvgpr_read_b32 v77, a237
    v_accvgpr_read_b32 v78, a238
    v_accvgpr_read_b32 v79, a239
    v_cvt_pk_bf16_f32 v92, v72, v73
    v_cvt_pk_bf16_f32 v93, v74, v75
    v_cvt_pk_bf16_f32 v94, v76, v77
    v_cvt_pk_bf16_f32 v95, v78, v79
    buffer_store_dwordx4 v[92:95], v1, s[36:39], s83 offen offset:3072 sc1
    s_cmp_eq_u32 s90, 0
    s_cbranch_scc0 L_kvdone
    s_add_u32 s83, s82, 0x1102000
    v_accvgpr_read_b32 v64, a16
    v_accvgpr_read_b32 v65, a17
    v_accvgpr_read_b32 v66, a18
    v_accvgpr_read_b32 v67, a19
    v_accvgpr_read_b32 v68, a20
    v_accvgpr_read_b32 v69, a21
    v_accvgpr_read_b32 v70, a22
    v_accvgpr_read_b32 v71, a23
    v_cvt_pk_bf16_f32 v80, v64, v65
    v_cvt_pk_bf16_f32 v81, v66, v67
    v_cvt_pk_bf16_f32 v82, v68, v69
    v_cvt_pk_bf16_f32 v83, v70, v71
    buffer_store_dwordx4 v[80:83], v1, s[36:39], s83 offen offset:0 sc1
    s_waitcnt vmcnt(2)
    v_accvgpr_read_b32 v72, a48
    v_accvgpr_read_b32 v73, a49
    v_accvgpr_read_b32 v74, a50
    v_accvgpr_read_b32 v75, a51
    v_accvgpr_read_b32 v76, a52
    v_accvgpr_read_b32 v77, a53
    v_accvgpr_read_b32 v78, a54
    v_accvgpr_read_b32 v79, a55
    v_cvt_pk_bf16_f32 v84, v72, v73
    v_cvt_pk_bf16_f32 v85, v74, v75
    v_cvt_pk_bf16_f32 v86, v76, v77
    v_cvt_pk_bf16_f32 v87, v78, v79
    buffer_store_dwordx4 v[84:87], v1, s[36:39], s83 offen offset:1024 sc1
    s_waitcnt vmcnt(2)
    v_accvgpr_read_b32 v64, a80
    v_accvgpr_read_b32 v65, a81
    v_accvgpr_read_b32 v66, a82
    v_accvgpr_read_b32 v67, a83
    v_accvgpr_read_b32 v68, a84
    v_accvgpr_read_b32 v69, a85
    v_accvgpr_read_b32 v70, a86
    v_accvgpr_read_b32 v71, a87
    v_cvt_pk_bf16_f32 v88, v64, v65
    v_cvt_pk_bf16_f32 v89, v66, v67
    v_cvt_pk_bf16_f32 v90, v68, v69
    v_cvt_pk_bf16_f32 v91, v70, v71
    buffer_store_dwordx4 v[88:91], v1, s[36:39], s83 offen offset:2048 sc1
    s_waitcnt vmcnt(2)
    v_accvgpr_read_b32 v72, a112
    v_accvgpr_read_b32 v73, a113
    v_accvgpr_read_b32 v74, a114
    v_accvgpr_read_b32 v75, a115
    v_accvgpr_read_b32 v76, a116
    v_accvgpr_read_b32 v77, a117
    v_accvgpr_read_b32 v78, a118
    v_accvgpr_read_b32 v79, a119
    v_cvt_pk_bf16_f32 v92, v72, v73
    v_cvt_pk_bf16_f32 v93, v74, v75
    v_cvt_pk_bf16_f32 v94, v76, v77
    v_cvt_pk_bf16_f32 v95, v78, v79
    buffer_store_dwordx4 v[92:95], v1, s[36:39], s83 offen offset:3072 sc1
    s_waitcnt vmcnt(2)
    s_add_u32 s83, s82, 0x1103000
    v_accvgpr_read_b32 v64, a144
    v_accvgpr_read_b32 v65, a145
    v_accvgpr_read_b32 v66, a146
    v_accvgpr_read_b32 v67, a147
    v_accvgpr_read_b32 v68, a148
    v_accvgpr_read_b32 v69, a149
    v_accvgpr_read_b32 v70, a150
    v_accvgpr_read_b32 v71, a151
    v_cvt_pk_bf16_f32 v80, v64, v65
    v_cvt_pk_bf16_f32 v81, v66, v67
    v_cvt_pk_bf16_f32 v82, v68, v69
    v_cvt_pk_bf16_f32 v83, v70, v71
    buffer_store_dwordx4 v[80:83], v1, s[36:39], s83 offen offset:0 sc1
    s_waitcnt vmcnt(2)
    v_accvgpr_read_b32 v72, a176
    v_accvgpr_read_b32 v73, a177
    v_accvgpr_read_b32 v74, a178
    v_accvgpr_read_b32 v75, a179
    v_accvgpr_read_b32 v76, a180
    v_accvgpr_read_b32 v77, a181
    v_accvgpr_read_b32 v78, a182
    v_accvgpr_read_b32 v79, a183
    v_cvt_pk_bf16_f32 v84, v72, v73
    v_cvt_pk_bf16_f32 v85, v74, v75
    v_cvt_pk_bf16_f32 v86, v76, v77
    v_cvt_pk_bf16_f32 v87, v78, v79
    buffer_store_dwordx4 v[84:87], v1, s[36:39], s83 offen offset:1024 sc1
    s_waitcnt vmcnt(2)
    v_accvgpr_read_b32 v64, a208
    v_accvgpr_read_b32 v65, a209
    v_accvgpr_read_b32 v66, a210
    v_accvgpr_read_b32 v67, a211
    v_accvgpr_read_b32 v68, a212
    v_accvgpr_read_b32 v69, a213
    v_accvgpr_read_b32 v70, a214
    v_accvgpr_read_b32 v71, a215
    v_cvt_pk_bf16_f32 v88, v64, v65
    v_cvt_pk_bf16_f32 v89, v66, v67
    v_cvt_pk_bf16_f32 v90, v68, v69
    v_cvt_pk_bf16_f32 v91, v70, v71
    buffer_store_dwordx4 v[88:91], v1, s[36:39], s83 offen offset:2048 sc1
    s_waitcnt vmcnt(2)
    v_accvgpr_read_b32 v72, a240
    v_accvgpr_read_b32 v73, a241
    v_accvgpr_read_b32 v74, a242
    v_accvgpr_read_b32 v75, a243
    v_accvgpr_read_b32 v76, a244
    v_accvgpr_read_b32 v77, a245
    v_accvgpr_read_b32 v78, a246
    v_accvgpr_read_b32 v79, a247
    v_cvt_pk_bf16_f32 v92, v72, v73
    v_cvt_pk_bf16_f32 v93, v74, v75
    v_cvt_pk_bf16_f32 v94, v76, v77
    v_cvt_pk_bf16_f32 v95, v78, v79
    buffer_store_dwordx4 v[92:95], v1, s[36:39], s83 offen offset:3072 sc1
    s_waitcnt vmcnt(2)
    s_add_u32 s83, s82, 0x1182000
    v_accvgpr_read_b32 v64, a24
    v_accvgpr_read_b32 v65, a25
    v_accvgpr_read_b32 v66, a26
    v_accvgpr_read_b32 v67, a27
    v_accvgpr_read_b32 v68, a28
    v_accvgpr_read_b32 v69, a29
    v_accvgpr_read_b32 v70, a30
    v_accvgpr_read_b32 v71, a31
    v_cvt_pk_bf16_f32 v80, v64, v65
    v_cvt_pk_bf16_f32 v81, v66, v67
    v_cvt_pk_bf16_f32 v82, v68, v69
    v_cvt_pk_bf16_f32 v83, v70, v71
    buffer_store_dwordx4 v[80:83], v1, s[36:39], s83 offen offset:0 sc1
    s_waitcnt vmcnt(2)
    v_accvgpr_read_b32 v72, a56
    v_accvgpr_read_b32 v73, a57
    v_accvgpr_read_b32 v74, a58
    v_accvgpr_read_b32 v75, a59
    v_accvgpr_read_b32 v76, a60
    v_accvgpr_read_b32 v77, a61
    v_accvgpr_read_b32 v78, a62
    v_accvgpr_read_b32 v79, a63
    v_cvt_pk_bf16_f32 v84, v72, v73
    v_cvt_pk_bf16_f32 v85, v74, v75
    v_cvt_pk_bf16_f32 v86, v76, v77
    v_cvt_pk_bf16_f32 v87, v78, v79
    buffer_store_dwordx4 v[84:87], v1, s[36:39], s83 offen offset:1024 sc1
    s_waitcnt vmcnt(2)
    v_accvgpr_read_b32 v64, a88
    v_accvgpr_read_b32 v65, a89
    v_accvgpr_read_b32 v66, a90
    v_accvgpr_read_b32 v67, a91
    v_accvgpr_read_b32 v68, a92
    v_accvgpr_read_b32 v69, a93
    v_accvgpr_read_b32 v70, a94
    v_accvgpr_read_b32 v71, a95
    v_cvt_pk_bf16_f32 v88, v64, v65
    v_cvt_pk_bf16_f32 v89, v66, v67
    v_cvt_pk_bf16_f32 v90, v68, v69
    v_cvt_pk_bf16_f32 v91, v70, v71
    buffer_store_dwordx4 v[88:91], v1, s[36:39], s83 offen offset:2048 sc1
    s_waitcnt vmcnt(2)
    v_accvgpr_read_b32 v72, a120
    v_accvgpr_read_b32 v73, a121
    v_accvgpr_read_b32 v74, a122
    v_accvgpr_read_b32 v75, a123
    v_accvgpr_read_b32 v76, a124
    v_accvgpr_read_b32 v77, a125
    v_accvgpr_read_b32 v78, a126
    v_accvgpr_read_b32 v79, a127
    v_cvt_pk_bf16_f32 v92, v72, v73
    v_cvt_pk_bf16_f32 v93, v74, v75
    v_cvt_pk_bf16_f32 v94, v76, v77
    v_cvt_pk_bf16_f32 v95, v78, v79
    buffer_store_dwordx4 v[92:95], v1, s[36:39], s83 offen offset:3072 sc1
    s_waitcnt vmcnt(2)
    s_add_u32 s83, s82, 0x1183000
    v_accvgpr_read_b32 v64, a152
    v_accvgpr_read_b32 v65, a153
    v_accvgpr_read_b32 v66, a154
    v_accvgpr_read_b32 v67, a155
    v_accvgpr_read_b32 v68, a156
    v_accvgpr_read_b32 v69, a157
    v_accvgpr_read_b32 v70, a158
    v_accvgpr_read_b32 v71, a159
    v_cvt_pk_bf16_f32 v80, v64, v65
    v_cvt_pk_bf16_f32 v81, v66, v67
    v_cvt_pk_bf16_f32 v82, v68, v69
    v_cvt_pk_bf16_f32 v83, v70, v71
    buffer_store_dwordx4 v[80:83], v1, s[36:39], s83 offen offset:0 sc1
    s_waitcnt vmcnt(2)
    v_accvgpr_read_b32 v72, a184
    v_accvgpr_read_b32 v73, a185
    v_accvgpr_read_b32 v74, a186
    v_accvgpr_read_b32 v75, a187
    v_accvgpr_read_b32 v76, a188
    v_accvgpr_read_b32 v77, a189
    v_accvgpr_read_b32 v78, a190
    v_accvgpr_read_b32 v79, a191
    v_cvt_pk_bf16_f32 v84, v72, v73
    v_cvt_pk_bf16_f32 v85, v74, v75
    v_cvt_pk_bf16_f32 v86, v76, v77
    v_cvt_pk_bf16_f32 v87, v78, v79
    buffer_store_dwordx4 v[84:87], v1, s[36:39], s83 offen offset:1024 sc1
    s_waitcnt vmcnt(2)
    v_accvgpr_read_b32 v64, a216
    v_accvgpr_read_b32 v65, a217
    v_accvgpr_read_b32 v66, a218
    v_accvgpr_read_b32 v67, a219
    v_accvgpr_read_b32 v68, a220
    v_accvgpr_read_b32 v69, a221
    v_accvgpr_read_b32 v70, a222
    v_accvgpr_read_b32 v71, a223
    v_cvt_pk_bf16_f32 v88, v64, v65
    v_cvt_pk_bf16_f32 v89, v66, v67
    v_cvt_pk_bf16_f32 v90, v68, v69
    v_cvt_pk_bf16_f32 v91, v70, v71
    buffer_store_dwordx4 v[88:91], v1, s[36:39], s83 offen offset:2048 sc1
    s_waitcnt vmcnt(2)
    v_accvgpr_read_b32 v72, a248
    v_accvgpr_read_b32 v73, a249
    v_accvgpr_read_b32 v74, a250
    v_accvgpr_read_b32 v75, a251
    v_accvgpr_read_b32 v76, a252
    v_accvgpr_read_b32 v77, a253
    v_accvgpr_read_b32 v78, a254
    v_accvgpr_read_b32 v79, a255
    v_cvt_pk_bf16_f32 v92, v72, v73
    v_cvt_pk_bf16_f32 v93, v74, v75
    v_cvt_pk_bf16_f32 v94, v76, v77
    v_cvt_pk_bf16_f32 v95, v78, v79
    buffer_store_dwordx4 v[92:95], v1, s[36:39], s83 offen offset:3072 sc1
    s_waitcnt vmcnt(2)
L_kvdone:
    s_mov_b32 s83, 0x40000
    s_branch L_done
L_epiF2:
    s_sub_u32 s83, s54, 24
    s_lshl_b32 s83, s83, 21
    s_lshl_b32 s84, s53, 17
    s_add_u32 s83, s83, s84
    s_lshl_b32 s84, s34, 12
    s_add_u32 s82, s83, s84
    s_add_u32 s83, s82, 0x5800000
    v_accvgpr_read_b32 v64, a0
    v_accvgpr_read_b32 v65, a32
    v_accvgpr_read_b32 v66, a64
    v_accvgpr_read_b32 v67, a96
    v_accvgpr_read_b32 v68, a128
    v_accvgpr_read_b32 v69, a160
    v_accvgpr_read_b32 v70, a192
    v_accvgpr_read_b32 v71, a224
    v_cvt_pk_bf16_f32 v80, v64, v65
    v_cvt_pk_bf16_f32 v81, v66, v67
    v_cvt_pk_bf16_f32 v82, v68, v69
    v_cvt_pk_bf16_f32 v83, v70, v71
    buffer_store_dwordx4 v[80:83], v1, s[36:39], s83 offen offset:0 sc1
    s_waitcnt vmcnt(2)
    v_accvgpr_read_b32 v72, a1
    v_accvgpr_read_b32 v73, a33
    v_accvgpr_read_b32 v74, a65
    v_accvgpr_read_b32 v75, a97
    v_accvgpr_read_b32 v76, a129
    v_accvgpr_read_b32 v77, a161
    v_accvgpr_read_b32 v78, a193
    v_accvgpr_read_b32 v79, a225
    v_cvt_pk_bf16_f32 v84, v72, v73
    v_cvt_pk_bf16_f32 v85, v74, v75
    v_cvt_pk_bf16_f32 v86, v76, v77
    v_cvt_pk_bf16_f32 v87, v78, v79
    buffer_store_dwordx4 v[84:87], v1, s[36:39], s83 offen offset:1024 sc1
    s_waitcnt vmcnt(2)
    v_accvgpr_read_b32 v64, a2
    v_accvgpr_read_b32 v65, a34
    v_accvgpr_read_b32 v66, a66
    v_accvgpr_read_b32 v67, a98
    v_accvgpr_read_b32 v68, a130
    v_accvgpr_read_b32 v69, a162
    v_accvgpr_read_b32 v70, a194
    v_accvgpr_read_b32 v71, a226
    v_cvt_pk_bf16_f32 v88, v64, v65
    v_cvt_pk_bf16_f32 v89, v66, v67
    v_cvt_pk_bf16_f32 v90, v68, v69
    v_cvt_pk_bf16_f32 v91, v70, v71
    buffer_store_dwordx4 v[88:91], v1, s[36:39], s83 offen offset:2048 sc1
    s_waitcnt vmcnt(2)
    v_accvgpr_read_b32 v72, a3
    v_accvgpr_read_b32 v73, a35
    v_accvgpr_read_b32 v74, a67
    v_accvgpr_read_b32 v75, a99
    v_accvgpr_read_b32 v76, a131
    v_accvgpr_read_b32 v77, a163
    v_accvgpr_read_b32 v78, a195
    v_accvgpr_read_b32 v79, a227
    v_cvt_pk_bf16_f32 v92, v72, v73
    v_cvt_pk_bf16_f32 v93, v74, v75
    v_cvt_pk_bf16_f32 v94, v76, v77
    v_cvt_pk_bf16_f32 v95, v78, v79
    buffer_store_dwordx4 v[92:95], v1, s[36:39], s83 offen offset:3072 sc1
    s_waitcnt vmcnt(2)
    s_add_u32 s83, s82, 0x5804000
    v_accvgpr_read_b32 v64, a4
    v_accvgpr_read_b32 v65, a36
    v_accvgpr_read_b32 v66, a68
    v_accvgpr_read_b32 v67, a100
    v_accvgpr_read_b32 v68, a132
    v_accvgpr_read_b32 v69, a164
    v_accvgpr_read_b32 v70, a196
    v_accvgpr_read_b32 v71, a228
    v_cvt_pk_bf16_f32 v80, v64, v65
    v_cvt_pk_bf16_f32 v81, v66, v67
    v_cvt_pk_bf16_f32 v82, v68, v69
    v_cvt_pk_bf16_f32 v83, v70, v71
    buffer_store_dwordx4 v[80:83], v1, s[36:39], s83 offen offset:0 sc1
    s_waitcnt vmcnt(2)
    v_accvgpr_read_b32 v72, a5
    v_accvgpr_read_b32 v73, a37
    v_accvgpr_read_b32 v74, a69
    v_accvgpr_read_b32 v75, a101
    v_accvgpr_read_b32 v76, a133
    v_accvgpr_read_b32 v77, a165
    v_accvgpr_read_b32 v78, a197
    v_accvgpr_read_b32 v79, a229
    v_cvt_pk_bf16_f32 v84, v72, v73
    v_cvt_pk_bf16_f32 v85, v74, v75
    v_cvt_pk_bf16_f32 v86, v76, v77
    v_cvt_pk_bf16_f32 v87, v78, v79
    buffer_store_dwordx4 v[84:87], v1, s[36:39], s83 offen offset:1024 sc1
    s_waitcnt vmcnt(2)
    v_accvgpr_read_b32 v64, a6
    v_accvgpr_read_b32 v65, a38
    v_accvgpr_read_b32 v66, a70
    v_accvgpr_read_b32 v67, a102
    v_accvgpr_read_b32 v68, a134
    v_accvgpr_read_b32 v69, a166
    v_accvgpr_read_b32 v70, a198
    v_accvgpr_read_b32 v71, a230
    v_cvt_pk_bf16_f32 v88, v64, v65
    v_cvt_pk_bf16_f32 v89, v66, v67
    v_cvt_pk_bf16_f32 v90, v68, v69
    v_cvt_pk_bf16_f32 v91, v70, v71
    buffer_store_dwordx4 v[88:91], v1, s[36:39], s83 offen offset:2048 sc1
    s_waitcnt vmcnt(2)
    v_accvgpr_read_b32 v72, a7
    v_accvgpr_read_b32 v73, a39
    v_accvgpr_read_b32 v74, a71
    v_accvgpr_read_b32 v75, a103
    v_accvgpr_read_b32 v76, a135
    v_accvgpr_read_b32 v77, a167
    v_accvgpr_read_b32 v78, a199
    v_accvgpr_read_b32 v79, a231
    v_cvt_pk_bf16_f32 v92, v72, v73
    v_cvt_pk_bf16_f32 v93, v74, v75
    v_cvt_pk_bf16_f32 v94, v76, v77
    v_cvt_pk_bf16_f32 v95, v78, v79
    buffer_store_dwordx4 v[92:95], v1, s[36:39], s83 offen offset:3072 sc1
    s_waitcnt vmcnt(2)
    s_add_u32 s83, s82, 0x5808000
    v_accvgpr_read_b32 v64, a8
    v_accvgpr_read_b32 v65, a40
    v_accvgpr_read_b32 v66, a72
    v_accvgpr_read_b32 v67, a104
    v_accvgpr_read_b32 v68, a136
    v_accvgpr_read_b32 v69, a168
    v_accvgpr_read_b32 v70, a200
    v_accvgpr_read_b32 v71, a232
    v_cvt_pk_bf16_f32 v80, v64, v65
    v_cvt_pk_bf16_f32 v81, v66, v67
    v_cvt_pk_bf16_f32 v82, v68, v69
    v_cvt_pk_bf16_f32 v83, v70, v71
    buffer_store_dwordx4 v[80:83], v1, s[36:39], s83 offen offset:0 sc1
    s_waitcnt vmcnt(2)
    v_accvgpr_read_b32 v72, a9
    v_accvgpr_read_b32 v73, a41
    v_accvgpr_read_b32 v74, a73
    v_accvgpr_read_b32 v75, a105
    v_accvgpr_read_b32 v76, a137
    v_accvgpr_read_b32 v77, a169
    v_accvgpr_read_b32 v78, a201
    v_accvgpr_read_b32 v79, a233
    v_cvt_pk_bf16_f32 v84, v72, v73
    v_cvt_pk_bf16_f32 v85, v74, v75
    v_cvt_pk_bf16_f32 v86, v76, v77
    v_cvt_pk_bf16_f32 v87, v78, v79
    buffer_store_dwordx4 v[84:87], v1, s[36:39], s83 offen offset:1024 sc1
    s_waitcnt vmcnt(2)
    v_accvgpr_read_b32 v64, a10
    v_accvgpr_read_b32 v65, a42
    v_accvgpr_read_b32 v66, a74
    v_accvgpr_read_b32 v67, a106
    v_accvgpr_read_b32 v68, a138
    v_accvgpr_read_b32 v69, a170
    v_accvgpr_read_b32 v70, a202
    v_accvgpr_read_b32 v71, a234
    v_cvt_pk_bf16_f32 v88, v64, v65
    v_cvt_pk_bf16_f32 v89, v66, v67
    v_cvt_pk_bf16_f32 v90, v68, v69
    v_cvt_pk_bf16_f32 v91, v70, v71
    buffer_store_dwordx4 v[88:91], v1, s[36:39], s83 offen offset:2048 sc1
    s_waitcnt vmcnt(2)
    v_accvgpr_read_b32 v72, a11
    v_accvgpr_read_b32 v73, a43
    v_accvgpr_read_b32 v74, a75
    v_accvgpr_read_b32 v75, a107
    v_accvgpr_read_b32 v76, a139
    v_accvgpr_read_b32 v77, a171
    v_accvgpr_read_b32 v78, a203
    v_accvgpr_read_b32 v79, a235
    v_cvt_pk_bf16_f32 v92, v72, v73
    v_cvt_pk_bf16_f32 v93, v74, v75
    v_cvt_pk_bf16_f32 v94, v76, v77
    v_cvt_pk_bf16_f32 v95, v78, v79
    buffer_store_dwordx4 v[92:95], v1, s[36:39], s83 offen offset:3072 sc1
    s_waitcnt vmcnt(2)
    s_add_u32 s83, s82, 0x580c000
    v_accvgpr_read_b32 v64, a12
    v_accvgpr_read_b32 v65, a44
    v_accvgpr_read_b32 v66, a76
    v_accvgpr_read_b32 v67, a108
    v_accvgpr_read_b32 v68, a140
    v_accvgpr_read_b32 v69, a172
    v_accvgpr_read_b32 v70, a204
    v_accvgpr_read_b32 v71, a236
    v_cvt_pk_bf16_f32 v80, v64, v65
    v_cvt_pk_bf16_f32 v81, v66, v67
    v_cvt_pk_bf16_f32 v82, v68, v69
    v_cvt_pk_bf16_f32 v83, v70, v71
    buffer_store_dwordx4 v[80:83], v1, s[36:39], s83 offen offset:0 sc1
    s_waitcnt vmcnt(2)
    v_accvgpr_read_b32 v72, a13
    v_accvgpr_read_b32 v73, a45
    v_accvgpr_read_b32 v74, a77
    v_accvgpr_read_b32 v75, a109
    v_accvgpr_read_b32 v76, a141
    v_accvgpr_read_b32 v77, a173
    v_accvgpr_read_b32 v78, a205
    v_accvgpr_read_b32 v79, a237
    v_cvt_pk_bf16_f32 v84, v72, v73
    v_cvt_pk_bf16_f32 v85, v74, v75
    v_cvt_pk_bf16_f32 v86, v76, v77
    v_cvt_pk_bf16_f32 v87, v78, v79
    buffer_store_dwordx4 v[84:87], v1, s[36:39], s83 offen offset:1024 sc1
    s_waitcnt vmcnt(2)
    v_accvgpr_read_b32 v64, a14
    v_accvgpr_read_b32 v65, a46
    v_accvgpr_read_b32 v66, a78
    v_accvgpr_read_b32 v67, a110
    v_accvgpr_read_b32 v68, a142
    v_accvgpr_read_b32 v69, a174
    v_accvgpr_read_b32 v70, a206
    v_accvgpr_read_b32 v71, a238
    v_cvt_pk_bf16_f32 v88, v64, v65
    v_cvt_pk_bf16_f32 v89, v66, v67
    v_cvt_pk_bf16_f32 v90, v68, v69
    v_cvt_pk_bf16_f32 v91, v70, v71
    buffer_store_dwordx4 v[88:91], v1, s[36:39], s83 offen offset:2048 sc1
    s_waitcnt vmcnt(2)
    v_accvgpr_read_b32 v72, a15
    v_accvgpr_read_b32 v73, a47
    v_accvgpr_read_b32 v74, a79
    v_accvgpr_read_b32 v75, a111
    v_accvgpr_read_b32 v76, a143
    v_accvgpr_read_b32 v77, a175
    v_accvgpr_read_b32 v78, a207
    v_accvgpr_read_b32 v79, a239
    v_cvt_pk_bf16_f32 v92, v72, v73
    v_cvt_pk_bf16_f32 v93, v74, v75
    v_cvt_pk_bf16_f32 v94, v76, v77
    v_cvt_pk_bf16_f32 v95, v78, v79
    buffer_store_dwordx4 v[92:95], v1, s[36:39], s83 offen offset:3072 sc1
    s_waitcnt vmcnt(2)
    s_add_u32 s83, s82, 0x5810000
    v_accvgpr_read_b32 v64, a16
    v_accvgpr_read_b32 v65, a48
    v_accvgpr_read_b32 v66, a80
    v_accvgpr_read_b32 v67, a112
    v_accvgpr_read_b32 v68, a144
    v_accvgpr_read_b32 v69, a176
    v_accvgpr_read_b32 v70, a208
    v_accvgpr_read_b32 v71, a240
    v_cvt_pk_bf16_f32 v80, v64, v65
    v_cvt_pk_bf16_f32 v81, v66, v67
    v_cvt_pk_bf16_f32 v82, v68, v69
    v_cvt_pk_bf16_f32 v83, v70, v71
    buffer_store_dwordx4 v[80:83], v1, s[36:39], s83 offen offset:0 sc1
    s_waitcnt vmcnt(2)
    v_accvgpr_read_b32 v72, a17
    v_accvgpr_read_b32 v73, a49
    v_accvgpr_read_b32 v74, a81
    v_accvgpr_read_b32 v75, a113
    v_accvgpr_read_b32 v76, a145
    v_accvgpr_read_b32 v77, a177
    v_accvgpr_read_b32 v78, a209
    v_accvgpr_read_b32 v79, a241
    v_cvt_pk_bf16_f32 v84, v72, v73
    v_cvt_pk_bf16_f32 v85, v74, v75
    v_cvt_pk_bf16_f32 v86, v76, v77
    v_cvt_pk_bf16_f32 v87, v78, v79
    buffer_store_dwordx4 v[84:87], v1, s[36:39], s83 offen offset:1024 sc1
    s_waitcnt vmcnt(2)
    v_accvgpr_read_b32 v64, a18
    v_accvgpr_read_b32 v65, a50
    v_accvgpr_read_b32 v66, a82
    v_accvgpr_read_b32 v67, a114
    v_accvgpr_read_b32 v68, a146
    v_accvgpr_read_b32 v69, a178
    v_accvgpr_read_b32 v70, a210
    v_accvgpr_read_b32 v71, a242
    v_cvt_pk_bf16_f32 v88, v64, v65
    v_cvt_pk_bf16_f32 v89, v66, v67
    v_cvt_pk_bf16_f32 v90, v68, v69
    v_cvt_pk_bf16_f32 v91, v70, v71
    buffer_store_dwordx4 v[88:91], v1, s[36:39], s83 offen offset:2048 sc1
    s_waitcnt vmcnt(2)
    v_accvgpr_read_b32 v72, a19
    v_accvgpr_read_b32 v73, a51
    v_accvgpr_read_b32 v74, a83
    v_accvgpr_read_b32 v75, a115
    v_accvgpr_read_b32 v76, a147
    v_accvgpr_read_b32 v77, a179
    v_accvgpr_read_b32 v78, a211
    v_accvgpr_read_b32 v79, a243
    v_cvt_pk_bf16_f32 v92, v72, v73
    v_cvt_pk_bf16_f32 v93, v74, v75
    v_cvt_pk_bf16_f32 v94, v76, v77
    v_cvt_pk_bf16_f32 v95, v78, v79
    buffer_store_dwordx4 v[92:95], v1, s[36:39], s83 offen offset:3072 sc1
    s_waitcnt vmcnt(2)
    s_add_u32 s83, s82, 0x5814000
    v_accvgpr_read_b32 v64, a20
    v_accvgpr_read_b32 v65, a52
    v_accvgpr_read_b32 v66, a84
    v_accvgpr_read_b32 v67, a116
    v_accvgpr_read_b32 v68, a148
    v_accvgpr_read_b32 v69, a180
    v_accvgpr_read_b32 v70, a212
    v_accvgpr_read_b32 v71, a244
    v_cvt_pk_bf16_f32 v80, v64, v65
    v_cvt_pk_bf16_f32 v81, v66, v67
    v_cvt_pk_bf16_f32 v82, v68, v69
    v_cvt_pk_bf16_f32 v83, v70, v71
    buffer_store_dwordx4 v[80:83], v1, s[36:39], s83 offen offset:0 sc1
    s_waitcnt vmcnt(2)
    v_accvgpr_read_b32 v72, a21
    v_accvgpr_read_b32 v73, a53
    v_accvgpr_read_b32 v74, a85
    v_accvgpr_read_b32 v75, a117
    v_accvgpr_read_b32 v76, a149
    v_accvgpr_read_b32 v77, a181
    v_accvgpr_read_b32 v78, a213
    v_accvgpr_read_b32 v79, a245
    v_cvt_pk_bf16_f32 v84, v72, v73
    v_cvt_pk_bf16_f32 v85, v74, v75
    v_cvt_pk_bf16_f32 v86, v76, v77
    v_cvt_pk_bf16_f32 v87, v78, v79
    buffer_store_dwordx4 v[84:87], v1, s[36:39], s83 offen offset:1024 sc1
    s_waitcnt vmcnt(2)
    v_accvgpr_read_b32 v64, a22
    v_accvgpr_read_b32 v65, a54
    v_accvgpr_read_b32 v66, a86
    v_accvgpr_read_b32 v67, a118
    v_accvgpr_read_b32 v68, a150
    v_accvgpr_read_b32 v69, a182
    v_accvgpr_read_b32 v70, a214
    v_accvgpr_read_b32 v71, a246
    v_cvt_pk_bf16_f32 v88, v64, v65
    v_cvt_pk_bf16_f32 v89, v66, v67
    v_cvt_pk_bf16_f32 v90, v68, v69
    v_cvt_pk_bf16_f32 v91, v70, v71
    buffer_store_dwordx4 v[88:91], v1, s[36:39], s83 offen offset:2048 sc1
    s_waitcnt vmcnt(2)
    v_accvgpr_read_b32 v72, a23
    v_accvgpr_read_b32 v73, a55
    v_accvgpr_read_b32 v74, a87
    v_accvgpr_read_b32 v75, a119
    v_accvgpr_read_b32 v76, a151
    v_accvgpr_read_b32 v77, a183
    v_accvgpr_read_b32 v78, a215
    v_accvgpr_read_b32 v79, a247
    v_cvt_pk_bf16_f32 v92, v72, v73
    v_cvt_pk_bf16_f32 v93, v74, v75
    v_cvt_pk_bf16_f32 v94, v76, v77
    v_cvt_pk_bf16_f32 v95, v78, v79
    buffer_store_dwordx4 v[92:95], v1, s[36:39], s83 offen offset:3072 sc1
    s_waitcnt vmcnt(2)
    s_add_u32 s83, s82, 0x5818000
    v_accvgpr_read_b32 v64, a24
    v_accvgpr_read_b32 v65, a56
    v_accvgpr_read_b32 v66, a88
    v_accvgpr_read_b32 v67, a120
    v_accvgpr_read_b32 v68, a152
    v_accvgpr_read_b32 v69, a184
    v_accvgpr_read_b32 v70, a216
    v_accvgpr_read_b32 v71, a248
    v_cvt_pk_bf16_f32 v80, v64, v65
    v_cvt_pk_bf16_f32 v81, v66, v67
    v_cvt_pk_bf16_f32 v82, v68, v69
    v_cvt_pk_bf16_f32 v83, v70, v71
    buffer_store_dwordx4 v[80:83], v1, s[36:39], s83 offen offset:0 sc1
    s_waitcnt vmcnt(2)
    v_accvgpr_read_b32 v72, a25
    v_accvgpr_read_b32 v73, a57
    v_accvgpr_read_b32 v74, a89
    v_accvgpr_read_b32 v75, a121
    v_accvgpr_read_b32 v76, a153
    v_accvgpr_read_b32 v77, a185
    v_accvgpr_read_b32 v78, a217
    v_accvgpr_read_b32 v79, a249
    v_cvt_pk_bf16_f32 v84, v72, v73
    v_cvt_pk_bf16_f32 v85, v74, v75
    v_cvt_pk_bf16_f32 v86, v76, v77
    v_cvt_pk_bf16_f32 v87, v78, v79
    buffer_store_dwordx4 v[84:87], v1, s[36:39], s83 offen offset:1024 sc1
    s_waitcnt vmcnt(2)
    v_accvgpr_read_b32 v64, a26
    v_accvgpr_read_b32 v65, a58
    v_accvgpr_read_b32 v66, a90
    v_accvgpr_read_b32 v67, a122
    v_accvgpr_read_b32 v68, a154
    v_accvgpr_read_b32 v69, a186
    v_accvgpr_read_b32 v70, a218
    v_accvgpr_read_b32 v71, a250
    v_cvt_pk_bf16_f32 v88, v64, v65
    v_cvt_pk_bf16_f32 v89, v66, v67
    v_cvt_pk_bf16_f32 v90, v68, v69
    v_cvt_pk_bf16_f32 v91, v70, v71
    buffer_store_dwordx4 v[88:91], v1, s[36:39], s83 offen offset:2048 sc1
    s_waitcnt vmcnt(2)
    v_accvgpr_read_b32 v72, a27
    v_accvgpr_read_b32 v73, a59
    v_accvgpr_read_b32 v74, a91
    v_accvgpr_read_b32 v75, a123
    v_accvgpr_read_b32 v76, a155
    v_accvgpr_read_b32 v77, a187
    v_accvgpr_read_b32 v78, a219
    v_accvgpr_read_b32 v79, a251
    v_cvt_pk_bf16_f32 v92, v72, v73
    v_cvt_pk_bf16_f32 v93, v74, v75
    v_cvt_pk_bf16_f32 v94, v76, v77
    v_cvt_pk_bf16_f32 v95, v78, v79
    buffer_store_dwordx4 v[92:95], v1, s[36:39], s83 offen offset:3072 sc1
    s_waitcnt vmcnt(2)
    s_add_u32 s83, s82, 0x581c000
    v_accvgpr_read_b32 v64, a28
    v_accvgpr_read_b32 v65, a60
    v_accvgpr_read_b32 v66, a92
    v_accvgpr_read_b32 v67, a124
    v_accvgpr_read_b32 v68, a156
    v_accvgpr_read_b32 v69, a188
    v_accvgpr_read_b32 v70, a220
    v_accvgpr_read_b32 v71, a252
    v_cvt_pk_bf16_f32 v80, v64, v65
    v_cvt_pk_bf16_f32 v81, v66, v67
    v_cvt_pk_bf16_f32 v82, v68, v69
    v_cvt_pk_bf16_f32 v83, v70, v71
    buffer_store_dwordx4 v[80:83], v1, s[36:39], s83 offen offset:0 sc1
    s_waitcnt vmcnt(2)
    v_accvgpr_read_b32 v72, a29
    v_accvgpr_read_b32 v73, a61
    v_accvgpr_read_b32 v74, a93
    v_accvgpr_read_b32 v75, a125
    v_accvgpr_read_b32 v76, a157
    v_accvgpr_read_b32 v77, a189
    v_accvgpr_read_b32 v78, a221
    v_accvgpr_read_b32 v79, a253
    v_cvt_pk_bf16_f32 v84, v72, v73
    v_cvt_pk_bf16_f32 v85, v74, v75
    v_cvt_pk_bf16_f32 v86, v76, v77
    v_cvt_pk_bf16_f32 v87, v78, v79
    buffer_store_dwordx4 v[84:87], v1, s[36:39], s83 offen offset:1024 sc1
    s_waitcnt vmcnt(2)
    v_accvgpr_read_b32 v64, a30
    v_accvgpr_read_b32 v65, a62
    v_accvgpr_read_b32 v66, a94
    v_accvgpr_read_b32 v67, a126
    v_accvgpr_read_b32 v68, a158
    v_accvgpr_read_b32 v69, a190
    v_accvgpr_read_b32 v70, a222
    v_accvgpr_read_b32 v71, a254
    v_cvt_pk_bf16_f32 v88, v64, v65
    v_cvt_pk_bf16_f32 v89, v66, v67
    v_cvt_pk_bf16_f32 v90, v68, v69
    v_cvt_pk_bf16_f32 v91, v70, v71
    buffer_store_dwordx4 v[88:91], v1, s[36:39], s83 offen offset:2048 sc1
    s_waitcnt vmcnt(2)
    v_accvgpr_read_b32 v72, a31
    v_accvgpr_read_b32 v73, a63
    v_accvgpr_read_b32 v74, a95
    v_accvgpr_read_b32 v75, a127
    v_accvgpr_read_b32 v76, a159
    v_accvgpr_read_b32 v77, a191
    v_accvgpr_read_b32 v78, a223
    v_accvgpr_read_b32 v79, a255
    v_cvt_pk_bf16_f32 v92, v72, v73
    v_cvt_pk_bf16_f32 v93, v74, v75
    v_cvt_pk_bf16_f32 v94, v76, v77
    v_cvt_pk_bf16_f32 v95, v78, v79
    buffer_store_dwordx4 v[92:95], v1, s[36:39], s83 offen offset:3072 sc1
    s_waitcnt vmcnt(2)
    s_mov_b32 s83, 0x40400
    s_branch L_done
L_epiF1:
    s_mov_b32 s48, s22
    s_mov_b32 s49, s23
    s_mov_b32 s50, 0xe00
    s_mov_b32 s51, 0x20000
    v_lshlrev_b32 v8, 6, v6
    buffer_load_dwordx4 v[16:19], v8, s[48:51], s79 offen offset:0
    buffer_load_dwordx4 v[20:23], v8, s[48:51], s79 offen offset:16
    buffer_load_dwordx4 v[24:27], v8, s[48:51], s79 offen offset:32
    buffer_load_dwordx4 v[28:31], v8, s[48:51], s79 offen offset:48
    s_sub_u32 s83, s54, 24
    s_lshl_b32 s83, s83, 19
    s_lshl_b32 s79, s34, 8
    s_add_u32 s79, s79, s83
    s_mov_b32 s55, 3
    s_mov_b32 s44, s24
    s_mov_b32 s45, s25
    s_mov_b32 s46, 1835008
    s_mov_b32 s47, 0x20000
    s_mov_b32 s56, 1024
    s_cmp_eq_u32 s54, 27
    s_cselect_b32 s57, 2, 4
    v_lshlrev_b32 v8, 4, v7
    s_lshl_b32 s80, s56, 5
    v_mul_lo_u32 v9, s80, v6
    v_add3_u32 v4, v8, v9, s79
    s_mul_i32 s64, s56, 0
    s_mul_i32 s65, s56, 1
    s_mul_i32 s66, s56, 8
    s_mul_i32 s67, s56, 9
    s_mul_i32 s68, s56, 16
    s_mul_i32 s69, s56, 17
    s_mul_i32 s70, s56, 24
    s_mul_i32 s71, s56, 25
    s_mul_i32 s61, s56, 2
    s_mul_i32 s62, s56, 4
    s_mul_i32 s63, s56, 6
    s_lshl_b32 s75, s56, 7
    buffer_load_dwordx4 v[160:163], v4, s[44:47], s64 offen
    buffer_load_dwordx4 v[164:167], v4, s[44:47], s65 offen
    buffer_load_dwordx4 v[168:171], v4, s[44:47], s66 offen
    buffer_load_dwordx4 v[172:175], v4, s[44:47], s67 offen
    buffer_load_dwordx4 v[176:179], v4, s[44:47], s68 offen
    buffer_load_dwordx4 v[180:183], v4, s[44:47], s69 offen
    buffer_load_dwordx4 v[184:187], v4, s[44:47], s70 offen
    buffer_load_dwordx4 v[188:191], v4, s[44:47], s71 offen
    s_add_u32 s73, s61, s64
    buffer_load_dwordx4 v[192:195], v4, s[44:47], s73 offen
    s_add_u32 s73, s61, s65
    buffer_load_dwordx4 v[196:199], v4, s[44:47], s73 offen
    s_add_u32 s73, s61, s66
    buffer_load_dwordx4 v[200:203], v4, s[44:47], s73 offen
    s_add_u32 s73, s61, s67
    buffer_load_dwordx4 v[204:207], v4, s[44:47], s73 offen
    s_add_u32 s73, s61, s68
    buffer_load_dwordx4 v[208:211], v4, s[44:47], s73 offen
    s_add_u32 s73, s61, s69
    buffer_load_dwordx4 v[212:215], v4, s[44:47], s73 offen
    s_add_u32 s73, s61, s70
    buffer_load_dwordx4 v[216:219], v4, s[44:47], s73 offen
    s_add_u32 s73, s61, s71
    buffer_load_dwordx4 v[220:223], v4, s[44:47], s73 offen
    s_add_u32 s73, s62, s64
    buffer_load_dwordx4 v[224:227], v4, s[44:47], s73 offen
    s_add_u32 s73, s62, s65
    buffer_load_dwordx4 v[228:231], v4, s[44:47], s73 offen
    s_add_u32 s73, s62, s66
    buffer_load_dwordx4 v[232:235], v4, s[44:47], s73 offen
    s_add_u32 s73, s62, s67
    buffer_load_dwordx4 v[236:239], v4, s[44:47], s73 offen
    s_add_u32 s73, s62, s68
    buffer_load_dwordx4 v[240:243], v4, s[44:47], s73 offen
    s_add_u32 s73, s62, s69
    buffer_load_dwordx4 v[244:247], v4, s[44:47], s73 offen
    s_add_u32 s73, s62, s70
    buffer_load_dwordx4 v[248:251], v4, s[44:47], s73 offen
    s_add_u32 s73, s62, s71
    buffer_load_dwordx4 v[252:255], v4, s[44:47], s73 offen
    s_waitcnt vmcnt(24)
    v_lshlrev_b32 v32, 16, v16
    v_and_b32 v33, 0xffff0000, v16
    v_lshlrev_b32 v34, 16, v17
    v_and_b32 v35, 0xffff0000, v17
    v_lshlrev_b32 v36, 16, v18
    v_and_b32 v37, 0xffff0000, v18
    v_lshlrev_b32 v38, 16, v19
    v_and_b32 v39, 0xffff0000, v19
    v_lshlrev_b32 v40, 16, v20
    v_and_b32 v41, 0xffff0000, v20
    v_lshlrev_b32 v42, 16, v21
    v_and_b32 v43, 0xffff0000, v21
    v_lshlrev_b32 v44, 16, v22
    v_and_b32 v45, 0xffff0000, v22
    v_lshlrev_b32 v46, 16, v23
    v_and_b32 v47, 0xffff0000, v23
    v_lshlrev_b32 v48, 16, v24
    v_and_b32 v49, 0xffff0000, v24
    v_lshlrev_b32 v50, 16, v25
    v_and_b32 v51, 0xffff0000, v25
    v_lshlrev_b32 v52, 16, v26
    v_and_b32 v53, 0xffff0000, v26
    v_lshlrev_b32 v54, 16, v27
    v_and_b32 v55, 0xffff0000, v27
    v_lshlrev_b32 v56, 16, v28
    v_and_b32 v57, 0xffff0000, v28
    v_lshlrev_b32 v58, 16, v29
    v_and_b32 v59, 0xffff0000, v29
    v_lshlrev_b32 v60, 16, v30
    v_and_b32 v61, 0xffff0000, v30
    v_lshlrev_b32 v62, 16, v31
    v_and_b32 v63, 0xffff0000, v31
    s_lshl_b32 s80, s34, 12
    v_add_u32 v2, s80, v1
    v_add_u32 v3, 0x10000, v2
    s_barrier
    v_accvgpr_read_b32 v64, a0
    v_accvgpr_read_b32 v65, a32
    v_accvgpr_read_b32 v66, a1
    v_accvgpr_read_b32 v67, a33
    v_accvgpr_read_b32 v68, a2
    v_accvgpr_read_b32 v69, a34
    v_accvgpr_read_b32 v70, a3
    v_accvgpr_read_b32 v71, a35
    v_pk_add_f32 v[64:65], v[64:65], v[32:33]
    v_pk_add_f32 v[66:67], v[66:67], v[40:41]
    v_pk_add_f32 v[68:69], v[68:69], v[48:49]
    v_pk_add_f32 v[70:71], v[70:71], v[56:57]
    v_max_f32 v64, 0, v64
    v_max_f32 v65, 0, v65
    v_max_f32 v66, 0, v66
    v_max_f32 v67, 0, v67
    v_max_f32 v68, 0, v68
    v_max_f32 v69, 0, v69
    v_max_f32 v70, 0, v70
    v_max_f32 v71, 0, v71
    v_pk_mul_f32 v[64:65], v[64:65], v[64:65]
    v_pk_mul_f32 v[66:67], v[66:67], v[66:67]
    v_pk_mul_f32 v[68:69], v[68:69], v[68:69]
    v_pk_mul_f32 v[70:71], v[70:71], v[70:71]
    v_cvt_pk_bf16_f32 v96, v64, v65
    v_cvt_pk_bf16_f32 v97, v66, v67
    v_cvt_pk_bf16_f32 v98, v68, v69
    v_cvt_pk_bf16_f32 v99, v70, v71
    ds_write_b128 v2, v[96:99] offset:0
    v_accvgpr_read_b32 v80, a64
    v_accvgpr_read_b32 v81, a96
    v_accvgpr_read_b32 v82, a65
    v_accvgpr_read_b32 v83, a97
    v_accvgpr_read_b32 v84, a66
    v_accvgpr_read_b32 v85, a98
    v_accvgpr_read_b32 v86, a67
    v_accvgpr_read_b32 v87, a99
    v_pk_add_f32 v[80:81], v[80:81], v[34:35]
    v_pk_add_f32 v[82:83], v[82:83], v[42:43]
    v_pk_add_f32 v[84:85], v[84:85], v[50:51]
    v_pk_add_f32 v[86:87], v[86:87], v[58:59]
    v_max_f32 v80, 0, v80
    v_max_f32 v81, 0, v81
    v_max_f32 v82, 0, v82
    v_max_f32 v83, 0, v83
    v_max_f32 v84, 0, v84
    v_max_f32 v85, 0, v85
    v_max_f32 v86, 0, v86
    v_max_f32 v87, 0, v87
    v_pk_mul_f32 v[80:81], v[80:81], v[80:81]
    v_pk_mul_f32 v[82:83], v[82:83], v[82:83]
    v_pk_mul_f32 v[84:85], v[84:85], v[84:85]
    v_pk_mul_f32 v[86:87], v[86:87], v[86:87]
    v_cvt_pk_bf16_f32 v100, v80, v81
    v_cvt_pk_bf16_f32 v101, v82, v83
    v_cvt_pk_bf16_f32 v102, v84, v85
    v_cvt_pk_bf16_f32 v103, v86, v87
    ds_write_b128 v2, v[100:103] offset:1024
    v_accvgpr_read_b32 v64, a128
    v_accvgpr_read_b32 v65, a160
    v_accvgpr_read_b32 v66, a129
    v_accvgpr_read_b32 v67, a161
    v_accvgpr_read_b32 v68, a130
    v_accvgpr_read_b32 v69, a162
    v_accvgpr_read_b32 v70, a131
    v_accvgpr_read_b32 v71, a163
    v_pk_add_f32 v[64:65], v[64:65], v[36:37]
    v_pk_add_f32 v[66:67], v[66:67], v[44:45]
    v_pk_add_f32 v[68:69], v[68:69], v[52:53]
    v_pk_add_f32 v[70:71], v[70:71], v[60:61]
    v_max_f32 v64, 0, v64
    v_max_f32 v65, 0, v65
    v_max_f32 v66, 0, v66
    v_max_f32 v67, 0, v67
    v_max_f32 v68, 0, v68
    v_max_f32 v69, 0, v69
    v_max_f32 v70, 0, v70
    v_max_f32 v71, 0, v71
    v_pk_mul_f32 v[64:65], v[64:65], v[64:65]
    v_pk_mul_f32 v[66:67], v[66:67], v[66:67]
    v_pk_mul_f32 v[68:69], v[68:69], v[68:69]
    v_pk_mul_f32 v[70:71], v[70:71], v[70:71]
    v_cvt_pk_bf16_f32 v96, v64, v65
    v_cvt_pk_bf16_f32 v97, v66, v67
    v_cvt_pk_bf16_f32 v98, v68, v69
    v_cvt_pk_bf16_f32 v99, v70, v71
    ds_write_b128 v2, v[96:99] offset:2048
    v_accvgpr_read_b32 v80, a192
    v_accvgpr_read_b32 v81, a224
    v_accvgpr_read_b32 v82, a193
    v_accvgpr_read_b32 v83, a225
    v_accvgpr_read_b32 v84, a194
    v_accvgpr_read_b32 v85, a226
    v_accvgpr_read_b32 v86, a195
    v_accvgpr_read_b32 v87, a227
    v_pk_add_f32 v[80:81], v[80:81], v[38:39]
    v_pk_add_f32 v[82:83], v[82:83], v[46:47]
    v_pk_add_f32 v[84:85], v[84:85], v[54:55]
    v_pk_add_f32 v[86:87], v[86:87], v[62:63]
    v_max_f32 v80, 0, v80
    v_max_f32 v81, 0, v81
    v_max_f32 v82, 0, v82
    v_max_f32 v83, 0, v83
    v_max_f32 v84, 0, v84
    v_max_f32 v85, 0, v85
    v_max_f32 v86, 0, v86
    v_max_f32 v87, 0, v87
    v_pk_mul_f32 v[80:81], v[80:81], v[80:81]
    v_pk_mul_f32 v[82:83], v[82:83], v[82:83]
    v_pk_mul_f32 v[84:85], v[84:85], v[84:85]
    v_pk_mul_f32 v[86:87], v[86:87], v[86:87]
    v_cvt_pk_bf16_f32 v100, v80, v81
    v_cvt_pk_bf16_f32 v101, v82, v83
    v_cvt_pk_bf16_f32 v102, v84, v85
    v_cvt_pk_bf16_f32 v103, v86, v87
    ds_write_b128 v2, v[100:103] offset:3072
    v_accvgpr_read_b32 v64, a4
    v_accvgpr_read_b32 v65, a36
    v_accvgpr_read_b32 v66, a5
    v_accvgpr_read_b32 v67, a37
    v_accvgpr_read_b32 v68, a6
    v_accvgpr_read_b32 v69, a38
    v_accvgpr_read_b32 v70, a7
    v_accvgpr_read_b32 v71, a39
    v_pk_add_f32 v[64:65], v[64:65], v[32:33]
    v_pk_add_f32 v[66:67], v[66:67], v[40:41]
    v_pk_add_f32 v[68:69], v[68:69], v[48:49]
    v_pk_add_f32 v[70:71], v[70:71], v[56:57]
    v_max_f32 v64, 0, v64
    v_max_f32 v65, 0, v65
    v_max_f32 v66, 0, v66
    v_max_f32 v67, 0, v67
    v_max_f32 v68, 0, v68
    v_max_f32 v69, 0, v69
    v_max_f32 v70, 0, v70
    v_max_f32 v71, 0, v71
    v_pk_mul_f32 v[64:65], v[64:65], v[64:65]
    v_pk_mul_f32 v[66:67], v[66:67], v[66:67]
    v_pk_mul_f32 v[68:69], v[68:69], v[68:69]
    v_pk_mul_f32 v[70:71], v[70:71], v[70:71]
    v_cvt_pk_bf16_f32 v96, v64, v65
    v_cvt_pk_bf16_f32 v97, v66, v67
    v_cvt_pk_bf16_f32 v98, v68, v69
    v_cvt_pk_bf16_f32 v99, v70, v71
    ds_write_b128 v2, v[96:99] offset:16384
    v_accvgpr_read_b32 v80, a68
    v_accvgpr_read_b32 v81, a100
    v_accvgpr_read_b32 v82, a69
    v_accvgpr_read_b32 v83, a101
    v_accvgpr_read_b32 v84, a70
    v_accvgpr_read_b32 v85, a102
    v_accvgpr_read_b32 v86, a71
    v_accvgpr_read_b32 v87, a103
    v_pk_add_f32 v[80:81], v[80:81], v[34:35]
    v_pk_add_f32 v[82:83], v[82:83], v[42:43]
    v_pk_add_f32 v[84:85], v[84:85], v[50:51]
    v_pk_add_f32 v[86:87], v[86:87], v[58:59]
    v_max_f32 v80, 0, v80
    v_max_f32 v81, 0, v81
    v_max_f32 v82, 0, v82
    v_max_f32 v83, 0, v83
    v_max_f32 v84, 0, v84
    v_max_f32 v85, 0, v85
    v_max_f32 v86, 0, v86
    v_max_f32 v87, 0, v87
    v_pk_mul_f32 v[80:81], v[80:81], v[80:81]
    v_pk_mul_f32 v[82:83], v[82:83], v[82:83]
    v_pk_mul_f32 v[84:85], v[84:85], v[84:85]
    v_pk_mul_f32 v[86:87], v[86:87], v[86:87]
    v_cvt_pk_bf16_f32 v100, v80, v81
    v_cvt_pk_bf16_f32 v101, v82, v83
    v_cvt_pk_bf16_f32 v102, v84, v85
    v_cvt_pk_bf16_f32 v103, v86, v87
    ds_write_b128 v2, v[100:103] offset:17408
    v_accvgpr_read_b32 v64, a132
    v_accvgpr_read_b32 v65, a164
    v_accvgpr_read_b32 v66, a133
    v_accvgpr_read_b32 v67, a165
    v_accvgpr_read_b32 v68, a134
    v_accvgpr_read_b32 v69, a166
    v_accvgpr_read_b32 v70, a135
    v_accvgpr_read_b32 v71, a167
    v_pk_add_f32 v[64:65], v[64:65], v[36:37]
    v_pk_add_f32 v[66:67], v[66:67], v[44:45]
    v_pk_add_f32 v[68:69], v[68:69], v[52:53]
    v_pk_add_f32 v[70:71], v[70:71], v[60:61]
    v_max_f32 v64, 0, v64
    v_max_f32 v65, 0, v65
    v_max_f32 v66, 0, v66
    v_max_f32 v67, 0, v67
    v_max_f32 v68, 0, v68
    v_max_f32 v69, 0, v69
    v_max_f32 v70, 0, v70
    v_max_f32 v71, 0, v71
    v_pk_mul_f32 v[64:65], v[64:65], v[64:65]
    v_pk_mul_f32 v[66:67], v[66:67], v[66:67]
    v_pk_mul_f32 v[68:69], v[68:69], v[68:69]
    v_pk_mul_f32 v[70:71], v[70:71], v[70:71]
    v_cvt_pk_bf16_f32 v96, v64, v65
    v_cvt_pk_bf16_f32 v97, v66, v67
    v_cvt_pk_bf16_f32 v98, v68, v69
    v_cvt_pk_bf16_f32 v99, v70, v71
    ds_write_b128 v2, v[96:99] offset:18432
    v_accvgpr_read_b32 v80, a196
    v_accvgpr_read_b32 v81, a228
    v_accvgpr_read_b32 v82, a197
    v_accvgpr_read_b32 v83, a229
    v_accvgpr_read_b32 v84, a198
    v_accvgpr_read_b32 v85, a230
    v_accvgpr_read_b32 v86, a199
    v_accvgpr_read_b32 v87, a231
    v_pk_add_f32 v[80:81], v[80:81], v[38:39]
    v_pk_add_f32 v[82:83], v[82:83], v[46:47]
    v_pk_add_f32 v[84:85], v[84:85], v[54:55]
    v_pk_add_f32 v[86:87], v[86:87], v[62:63]
    v_max_f32 v80, 0, v80
    v_max_f32 v81, 0, v81
    v_max_f32 v82, 0, v82
    v_max_f32 v83, 0, v83
    v_max_f32 v84, 0, v84
    v_max_f32 v85, 0, v85
    v_max_f32 v86, 0, v86
    v_max_f32 v87, 0, v87
    v_pk_mul_f32 v[80:81], v[80:81], v[80:81]
    v_pk_mul_f32 v[82:83], v[82:83], v[82:83]
    v_pk_mul_f32 v[84:85], v[84:85], v[84:85]
    v_pk_mul_f32 v[86:87], v[86:87], v[86:87]
    v_cvt_pk_bf16_f32 v100, v80, v81
    v_cvt_pk_bf16_f32 v101, v82, v83
    v_cvt_pk_bf16_f32 v102, v84, v85
    v_cvt_pk_bf16_f32 v103, v86, v87
    ds_write_b128 v2, v[100:103] offset:19456
    v_accvgpr_read_b32 v64, a8
    v_accvgpr_read_b32 v65, a40
    v_accvgpr_read_b32 v66, a9
    v_accvgpr_read_b32 v67, a41
    v_accvgpr_read_b32 v68, a10
    v_accvgpr_read_b32 v69, a42
    v_accvgpr_read_b32 v70, a11
    v_accvgpr_read_b32 v71, a43
    v_pk_add_f32 v[64:65], v[64:65], v[32:33]
    v_pk_add_f32 v[66:67], v[66:67], v[40:41]
    v_pk_add_f32 v[68:69], v[68:69], v[48:49]
    v_pk_add_f32 v[70:71], v[70:71], v[56:57]
    v_max_f32 v64, 0, v64
    v_max_f32 v65, 0, v65
    v_max_f32 v66, 0, v66
    v_max_f32 v67, 0, v67
    v_max_f32 v68, 0, v68
    v_max_f32 v69, 0, v69
    v_max_f32 v70, 0, v70
    v_max_f32 v71, 0, v71
    v_pk_mul_f32 v[64:65], v[64:65], v[64:65]
    v_pk_mul_f32 v[66:67], v[66:67], v[66:67]
    v_pk_mul_f32 v[68:69], v[68:69], v[68:69]
    v_pk_mul_f32 v[70:71], v[70:71], v[70:71]
    v_cvt_pk_bf16_f32 v96, v64, v65
    v_cvt_pk_bf16_f32 v97, v66, v67
    v_cvt_pk_bf16_f32 v98, v68, v69
    v_cvt_pk_bf16_f32 v99, v70, v71
    ds_write_b128 v2, v[96:99] offset:32768
    v_accvgpr_read_b32 v80, a72
    v_accvgpr_read_b32 v81, a104
    v_accvgpr_read_b32 v82, a73
    v_accvgpr_read_b32 v83, a105
    v_accvgpr_read_b32 v84, a74
    v_accvgpr_read_b32 v85, a106
    v_accvgpr_read_b32 v86, a75
    v_accvgpr_read_b32 v87, a107
    v_pk_add_f32 v[80:81], v[80:81], v[34:35]
    v_pk_add_f32 v[82:83], v[82:83], v[42:43]
    v_pk_add_f32 v[84:85], v[84:85], v[50:51]
    v_pk_add_f32 v[86:87], v[86:87], v[58:59]
    v_max_f32 v80, 0, v80
    v_max_f32 v81, 0, v81
    v_max_f32 v82, 0, v82
    v_max_f32 v83, 0, v83
    v_max_f32 v84, 0, v84
    v_max_f32 v85, 0, v85
    v_max_f32 v86, 0, v86
    v_max_f32 v87, 0, v87
    v_pk_mul_f32 v[80:81], v[80:81], v[80:81]
    v_pk_mul_f32 v[82:83], v[82:83], v[82:83]
    v_pk_mul_f32 v[84:85], v[84:85], v[84:85]
    v_pk_mul_f32 v[86:87], v[86:87], v[86:87]
    v_cvt_pk_bf16_f32 v100, v80, v81
    v_cvt_pk_bf16_f32 v101, v82, v83
    v_cvt_pk_bf16_f32 v102, v84, v85
    v_cvt_pk_bf16_f32 v103, v86, v87
    ds_write_b128 v2, v[100:103] offset:33792
    v_accvgpr_read_b32 v64, a136
    v_accvgpr_read_b32 v65, a168
    v_accvgpr_read_b32 v66, a137
    v_accvgpr_read_b32 v67, a169
    v_accvgpr_read_b32 v68, a138
    v_accvgpr_read_b32 v69, a170
    v_accvgpr_read_b32 v70, a139
    v_accvgpr_read_b32 v71, a171
    v_pk_add_f32 v[64:65], v[64:65], v[36:37]
    v_pk_add_f32 v[66:67], v[66:67], v[44:45]
    v_pk_add_f32 v[68:69], v[68:69], v[52:53]
    v_pk_add_f32 v[70:71], v[70:71], v[60:61]
    v_max_f32 v64, 0, v64
    v_max_f32 v65, 0, v65
    v_max_f32 v66, 0, v66
    v_max_f32 v67, 0, v67
    v_max_f32 v68, 0, v68
    v_max_f32 v69, 0, v69
    v_max_f32 v70, 0, v70
    v_max_f32 v71, 0, v71
    v_pk_mul_f32 v[64:65], v[64:65], v[64:65]
    v_pk_mul_f32 v[66:67], v[66:67], v[66:67]
    v_pk_mul_f32 v[68:69], v[68:69], v[68:69]
    v_pk_mul_f32 v[70:71], v[70:71], v[70:71]
    v_cvt_pk_bf16_f32 v96, v64, v65
    v_cvt_pk_bf16_f32 v97, v66, v67
    v_cvt_pk_bf16_f32 v98, v68, v69
    v_cvt_pk_bf16_f32 v99, v70, v71
    ds_write_b128 v2, v[96:99] offset:34816
    v_accvgpr_read_b32 v80, a200
    v_accvgpr_read_b32 v81, a232
    v_accvgpr_read_b32 v82, a201
    v_accvgpr_read_b32 v83, a233
    v_accvgpr_read_b32 v84, a202
    v_accvgpr_read_b32 v85, a234
    v_accvgpr_read_b32 v86, a203
    v_accvgpr_read_b32 v87, a235
    v_pk_add_f32 v[80:81], v[80:81], v[38:39]
    v_pk_add_f32 v[82:83], v[82:83], v[46:47]
    v_pk_add_f32 v[84:85], v[84:85], v[54:55]
    v_pk_add_f32 v[86:87], v[86:87], v[62:63]
    v_max_f32 v80, 0, v80
    v_max_f32 v81, 0, v81
    v_max_f32 v82, 0, v82
    v_max_f32 v83, 0, v83
    v_max_f32 v84, 0, v84
    v_max_f32 v85, 0, v85
    v_max_f32 v86, 0, v86
    v_max_f32 v87, 0, v87
    v_pk_mul_f32 v[80:81], v[80:81], v[80:81]
    v_pk_mul_f32 v[82:83], v[82:83], v[82:83]
    v_pk_mul_f32 v[84:85], v[84:85], v[84:85]
    v_pk_mul_f32 v[86:87], v[86:87], v[86:87]
    v_cvt_pk_bf16_f32 v100, v80, v81
    v_cvt_pk_bf16_f32 v101, v82, v83
    v_cvt_pk_bf16_f32 v102, v84, v85
    v_cvt_pk_bf16_f32 v103, v86, v87
    ds_write_b128 v2, v[100:103] offset:35840
    v_accvgpr_read_b32 v64, a12
    v_accvgpr_read_b32 v65, a44
    v_accvgpr_read_b32 v66, a13
    v_accvgpr_read_b32 v67, a45
    v_accvgpr_read_b32 v68, a14
    v_accvgpr_read_b32 v69, a46
    v_accvgpr_read_b32 v70, a15
    v_accvgpr_read_b32 v71, a47
    v_pk_add_f32 v[64:65], v[64:65], v[32:33]
    v_pk_add_f32 v[66:67], v[66:67], v[40:41]
    v_pk_add_f32 v[68:69], v[68:69], v[48:49]
    v_pk_add_f32 v[70:71], v[70:71], v[56:57]
    v_max_f32 v64, 0, v64
    v_max_f32 v65, 0, v65
    v_max_f32 v66, 0, v66
    v_max_f32 v67, 0, v67
    v_max_f32 v68, 0, v68
    v_max_f32 v69, 0, v69
    v_max_f32 v70, 0, v70
    v_max_f32 v71, 0, v71
    v_pk_mul_f32 v[64:65], v[64:65], v[64:65]
    v_pk_mul_f32 v[66:67], v[66:67], v[66:67]
    v_pk_mul_f32 v[68:69], v[68:69], v[68:69]
    v_pk_mul_f32 v[70:71], v[70:71], v[70:71]
    v_cvt_pk_bf16_f32 v96, v64, v65
    v_cvt_pk_bf16_f32 v97, v66, v67
    v_cvt_pk_bf16_f32 v98, v68, v69
    v_cvt_pk_bf16_f32 v99, v70, v71
    ds_write_b128 v2, v[96:99] offset:49152
    v_accvgpr_read_b32 v80, a76
    v_accvgpr_read_b32 v81, a108
    v_accvgpr_read_b32 v82, a77
    v_accvgpr_read_b32 v83, a109
    v_accvgpr_read_b32 v84, a78
    v_accvgpr_read_b32 v85, a110
    v_accvgpr_read_b32 v86, a79
    v_accvgpr_read_b32 v87, a111
    v_pk_add_f32 v[80:81], v[80:81], v[34:35]
    v_pk_add_f32 v[82:83], v[82:83], v[42:43]
    v_pk_add_f32 v[84:85], v[84:85], v[50:51]
    v_pk_add_f32 v[86:87], v[86:87], v[58:59]
    v_max_f32 v80, 0, v80
    v_max_f32 v81, 0, v81
    v_max_f32 v82, 0, v82
    v_max_f32 v83, 0, v83
    v_max_f32 v84, 0, v84
    v_max_f32 v85, 0, v85
    v_max_f32 v86, 0, v86
    v_max_f32 v87, 0, v87
    v_pk_mul_f32 v[80:81], v[80:81], v[80:81]
    v_pk_mul_f32 v[82:83], v[82:83], v[82:83]
    v_pk_mul_f32 v[84:85], v[84:85], v[84:85]
    v_pk_mul_f32 v[86:87], v[86:87], v[86:87]
    v_cvt_pk_bf16_f32 v100, v80, v81
    v_cvt_pk_bf16_f32 v101, v82, v83
    v_cvt_pk_bf16_f32 v102, v84, v85
    v_cvt_pk_bf16_f32 v103, v86, v87
    ds_write_b128 v2, v[100:103] offset:50176
    v_accvgpr_read_b32 v64, a140
    v_accvgpr_read_b32 v65, a172
    v_accvgpr_read_b32 v66, a141
    v_accvgpr_read_b32 v67, a173
    v_accvgpr_read_b32 v68, a142
    v_accvgpr_read_b32 v69, a174
    v_accvgpr_read_b32 v70, a143
    v_accvgpr_read_b32 v71, a175
    v_pk_add_f32 v[64:65], v[64:65], v[36:37]
    v_pk_add_f32 v[66:67], v[66:67], v[44:45]
    v_pk_add_f32 v[68:69], v[68:69], v[52:53]
    v_pk_add_f32 v[70:71], v[70:71], v[60:61]
    v_max_f32 v64, 0, v64
    v_max_f32 v65, 0, v65
    v_max_f32 v66, 0, v66
    v_max_f32 v67, 0, v67
    v_max_f32 v68, 0, v68
    v_max_f32 v69, 0, v69
    v_max_f32 v70, 0, v70
    v_max_f32 v71, 0, v71
    v_pk_mul_f32 v[64:65], v[64:65], v[64:65]
    v_pk_mul_f32 v[66:67], v[66:67], v[66:67]
    v_pk_mul_f32 v[68:69], v[68:69], v[68:69]
    v_pk_mul_f32 v[70:71], v[70:71], v[70:71]
    v_cvt_pk_bf16_f32 v96, v64, v65
    v_cvt_pk_bf16_f32 v97, v66, v67
    v_cvt_pk_bf16_f32 v98, v68, v69
    v_cvt_pk_bf16_f32 v99, v70, v71
    ds_write_b128 v2, v[96:99] offset:51200
    v_accvgpr_read_b32 v80, a204
    v_accvgpr_read_b32 v81, a236
    v_accvgpr_read_b32 v82, a205
    v_accvgpr_read_b32 v83, a237
    v_accvgpr_read_b32 v84, a206
    v_accvgpr_read_b32 v85, a238
    v_accvgpr_read_b32 v86, a207
    v_accvgpr_read_b32 v87, a239
    v_pk_add_f32 v[80:81], v[80:81], v[38:39]
    v_pk_add_f32 v[82:83], v[82:83], v[46:47]
    v_pk_add_f32 v[84:85], v[84:85], v[54:55]
    v_pk_add_f32 v[86:87], v[86:87], v[62:63]
    v_max_f32 v80, 0, v80
    v_max_f32 v81, 0, v81
    v_max_f32 v82, 0, v82
    v_max_f32 v83, 0, v83
    v_max_f32 v84, 0, v84
    v_max_f32 v85, 0, v85
    v_max_f32 v86, 0, v86
    v_max_f32 v87, 0, v87
    v_pk_mul_f32 v[80:81], v[80:81], v[80:81]
    v_pk_mul_f32 v[82:83], v[82:83], v[82:83]
    v_pk_mul_f32 v[84:85], v[84:85], v[84:85]
    v_pk_mul_f32 v[86:87], v[86:87], v[86:87]
    v_cvt_pk_bf16_f32 v100, v80, v81
    v_cvt_pk_bf16_f32 v101, v82, v83
    v_cvt_pk_bf16_f32 v102, v84, v85
    v_cvt_pk_bf16_f32 v103, v86, v87
    ds_write_b128 v2, v[100:103] offset:52224
    v_accvgpr_read_b32 v64, a16
    v_accvgpr_read_b32 v65, a48
    v_accvgpr_read_b32 v66, a17
    v_accvgpr_read_b32 v67, a49
    v_accvgpr_read_b32 v68, a18
    v_accvgpr_read_b32 v69, a50
    v_accvgpr_read_b32 v70, a19
    v_accvgpr_read_b32 v71, a51
    v_pk_add_f32 v[64:65], v[64:65], v[32:33]
    v_pk_add_f32 v[66:67], v[66:67], v[40:41]
    v_pk_add_f32 v[68:69], v[68:69], v[48:49]
    v_pk_add_f32 v[70:71], v[70:71], v[56:57]
    v_max_f32 v64, 0, v64
    v_max_f32 v65, 0, v65
    v_max_f32 v66, 0, v66
    v_max_f32 v67, 0, v67
    v_max_f32 v68, 0, v68
    v_max_f32 v69, 0, v69
    v_max_f32 v70, 0, v70
    v_max_f32 v71, 0, v71
    v_pk_mul_f32 v[64:65], v[64:65], v[64:65]
    v_pk_mul_f32 v[66:67], v[66:67], v[66:67]
    v_pk_mul_f32 v[68:69], v[68:69], v[68:69]
    v_pk_mul_f32 v[70:71], v[70:71], v[70:71]
    v_cvt_pk_bf16_f32 v96, v64, v65
    v_cvt_pk_bf16_f32 v97, v66, v67
    v_cvt_pk_bf16_f32 v98, v68, v69
    v_cvt_pk_bf16_f32 v99, v70, v71
    ds_write_b128 v3, v[96:99] offset:0
    v_accvgpr_read_b32 v80, a80
    v_accvgpr_read_b32 v81, a112
    v_accvgpr_read_b32 v82, a81
    v_accvgpr_read_b32 v83, a113
    v_accvgpr_read_b32 v84, a82
    v_accvgpr_read_b32 v85, a114
    v_accvgpr_read_b32 v86, a83
    v_accvgpr_read_b32 v87, a115
    v_pk_add_f32 v[80:81], v[80:81], v[34:35]
    v_pk_add_f32 v[82:83], v[82:83], v[42:43]
    v_pk_add_f32 v[84:85], v[84:85], v[50:51]
    v_pk_add_f32 v[86:87], v[86:87], v[58:59]
    v_max_f32 v80, 0, v80
    v_max_f32 v81, 0, v81
    v_max_f32 v82, 0, v82
    v_max_f32 v83, 0, v83
    v_max_f32 v84, 0, v84
    v_max_f32 v85, 0, v85
    v_max_f32 v86, 0, v86
    v_max_f32 v87, 0, v87
    v_pk_mul_f32 v[80:81], v[80:81], v[80:81]
    v_pk_mul_f32 v[82:83], v[82:83], v[82:83]
    v_pk_mul_f32 v[84:85], v[84:85], v[84:85]
    v_pk_mul_f32 v[86:87], v[86:87], v[86:87]
    v_cvt_pk_bf16_f32 v100, v80, v81
    v_cvt_pk_bf16_f32 v101, v82, v83
    v_cvt_pk_bf16_f32 v102, v84, v85
    v_cvt_pk_bf16_f32 v103, v86, v87
    ds_write_b128 v3, v[100:103] offset:1024
    v_accvgpr_read_b32 v64, a144
    v_accvgpr_read_b32 v65, a176
    v_accvgpr_read_b32 v66, a145
    v_accvgpr_read_b32 v67, a177
    v_accvgpr_read_b32 v68, a146
    v_accvgpr_read_b32 v69, a178
    v_accvgpr_read_b32 v70, a147
    v_accvgpr_read_b32 v71, a179
    v_pk_add_f32 v[64:65], v[64:65], v[36:37]
    v_pk_add_f32 v[66:67], v[66:67], v[44:45]
    v_pk_add_f32 v[68:69], v[68:69], v[52:53]
    v_pk_add_f32 v[70:71], v[70:71], v[60:61]
    v_max_f32 v64, 0, v64
    v_max_f32 v65, 0, v65
    v_max_f32 v66, 0, v66
    v_max_f32 v67, 0, v67
    v_max_f32 v68, 0, v68
    v_max_f32 v69, 0, v69
    v_max_f32 v70, 0, v70
    v_max_f32 v71, 0, v71
    v_pk_mul_f32 v[64:65], v[64:65], v[64:65]
    v_pk_mul_f32 v[66:67], v[66:67], v[66:67]
    v_pk_mul_f32 v[68:69], v[68:69], v[68:69]
    v_pk_mul_f32 v[70:71], v[70:71], v[70:71]
    v_cvt_pk_bf16_f32 v96, v64, v65
    v_cvt_pk_bf16_f32 v97, v66, v67
    v_cvt_pk_bf16_f32 v98, v68, v69
    v_cvt_pk_bf16_f32 v99, v70, v71
    ds_write_b128 v3, v[96:99] offset:2048
    v_accvgpr_read_b32 v80, a208
    v_accvgpr_read_b32 v81, a240
    v_accvgpr_read_b32 v82, a209
    v_accvgpr_read_b32 v83, a241
    v_accvgpr_read_b32 v84, a210
    v_accvgpr_read_b32 v85, a242
    v_accvgpr_read_b32 v86, a211
    v_accvgpr_read_b32 v87, a243
    v_pk_add_f32 v[80:81], v[80:81], v[38:39]
    v_pk_add_f32 v[82:83], v[82:83], v[46:47]
    v_pk_add_f32 v[84:85], v[84:85], v[54:55]
    v_pk_add_f32 v[86:87], v[86:87], v[62:63]
    v_max_f32 v80, 0, v80
    v_max_f32 v81, 0, v81
    v_max_f32 v82, 0, v82
    v_max_f32 v83, 0, v83
    v_max_f32 v84, 0, v84
    v_max_f32 v85, 0, v85
    v_max_f32 v86, 0, v86
    v_max_f32 v87, 0, v87
    v_pk_mul_f32 v[80:81], v[80:81], v[80:81]
    v_pk_mul_f32 v[82:83], v[82:83], v[82:83]
    v_pk_mul_f32 v[84:85], v[84:85], v[84:85]
    v_pk_mul_f32 v[86:87], v[86:87], v[86:87]
    v_cvt_pk_bf16_f32 v100, v80, v81
    v_cvt_pk_bf16_f32 v101, v82, v83
    v_cvt_pk_bf16_f32 v102, v84, v85
    v_cvt_pk_bf16_f32 v103, v86, v87
    ds_write_b128 v3, v[100:103] offset:3072
    v_accvgpr_read_b32 v64, a20
    v_accvgpr_read_b32 v65, a52
    v_accvgpr_read_b32 v66, a21
    v_accvgpr_read_b32 v67, a53
    v_accvgpr_read_b32 v68, a22
    v_accvgpr_read_b32 v69, a54
    v_accvgpr_read_b32 v70, a23
    v_accvgpr_read_b32 v71, a55
    v_pk_add_f32 v[64:65], v[64:65], v[32:33]
    v_pk_add_f32 v[66:67], v[66:67], v[40:41]
    v_pk_add_f32 v[68:69], v[68:69], v[48:49]
    v_pk_add_f32 v[70:71], v[70:71], v[56:57]
    v_max_f32 v64, 0, v64
    v_max_f32 v65, 0, v65
    v_max_f32 v66, 0, v66
    v_max_f32 v67, 0, v67
    v_max_f32 v68, 0, v68
    v_max_f32 v69, 0, v69
    v_max_f32 v70, 0, v70
    v_max_f32 v71, 0, v71
    v_pk_mul_f32 v[64:65], v[64:65], v[64:65]
    v_pk_mul_f32 v[66:67], v[66:67], v[66:67]
    v_pk_mul_f32 v[68:69], v[68:69], v[68:69]
    v_pk_mul_f32 v[70:71], v[70:71], v[70:71]
    v_cvt_pk_bf16_f32 v96, v64, v65
    v_cvt_pk_bf16_f32 v97, v66, v67
    v_cvt_pk_bf16_f32 v98, v68, v69
    v_cvt_pk_bf16_f32 v99, v70, v71
    ds_write_b128 v3, v[96:99] offset:16384
    v_accvgpr_read_b32 v80, a84
    v_accvgpr_read_b32 v81, a116
    v_accvgpr_read_b32 v82, a85
    v_accvgpr_read_b32 v83, a117
    v_accvgpr_read_b32 v84, a86
    v_accvgpr_read_b32 v85, a118
    v_accvgpr_read_b32 v86, a87
    v_accvgpr_read_b32 v87, a119
    v_pk_add_f32 v[80:81], v[80:81], v[34:35]
    v_pk_add_f32 v[82:83], v[82:83], v[42:43]
    v_pk_add_f32 v[84:85], v[84:85], v[50:51]
    v_pk_add_f32 v[86:87], v[86:87], v[58:59]
    v_max_f32 v80, 0, v80
    v_max_f32 v81, 0, v81
    v_max_f32 v82, 0, v82
    v_max_f32 v83, 0, v83
    v_max_f32 v84, 0, v84
    v_max_f32 v85, 0, v85
    v_max_f32 v86, 0, v86
    v_max_f32 v87, 0, v87
    v_pk_mul_f32 v[80:81], v[80:81], v[80:81]
    v_pk_mul_f32 v[82:83], v[82:83], v[82:83]
    v_pk_mul_f32 v[84:85], v[84:85], v[84:85]
    v_pk_mul_f32 v[86:87], v[86:87], v[86:87]
    v_cvt_pk_bf16_f32 v100, v80, v81
    v_cvt_pk_bf16_f32 v101, v82, v83
    v_cvt_pk_bf16_f32 v102, v84, v85
    v_cvt_pk_bf16_f32 v103, v86, v87
    ds_write_b128 v3, v[100:103] offset:17408
    v_accvgpr_read_b32 v64, a148
    v_accvgpr_read_b32 v65, a180
    v_accvgpr_read_b32 v66, a149
    v_accvgpr_read_b32 v67, a181
    v_accvgpr_read_b32 v68, a150
    v_accvgpr_read_b32 v69, a182
    v_accvgpr_read_b32 v70, a151
    v_accvgpr_read_b32 v71, a183
    v_pk_add_f32 v[64:65], v[64:65], v[36:37]
    v_pk_add_f32 v[66:67], v[66:67], v[44:45]
    v_pk_add_f32 v[68:69], v[68:69], v[52:53]
    v_pk_add_f32 v[70:71], v[70:71], v[60:61]
    v_max_f32 v64, 0, v64
    v_max_f32 v65, 0, v65
    v_max_f32 v66, 0, v66
    v_max_f32 v67, 0, v67
    v_max_f32 v68, 0, v68
    v_max_f32 v69, 0, v69
    v_max_f32 v70, 0, v70
    v_max_f32 v71, 0, v71
    v_pk_mul_f32 v[64:65], v[64:65], v[64:65]
    v_pk_mul_f32 v[66:67], v[66:67], v[66:67]
    v_pk_mul_f32 v[68:69], v[68:69], v[68:69]
    v_pk_mul_f32 v[70:71], v[70:71], v[70:71]
    v_cvt_pk_bf16_f32 v96, v64, v65
    v_cvt_pk_bf16_f32 v97, v66, v67
    v_cvt_pk_bf16_f32 v98, v68, v69
    v_cvt_pk_bf16_f32 v99, v70, v71
    ds_write_b128 v3, v[96:99] offset:18432
    v_accvgpr_read_b32 v80, a212
    v_accvgpr_read_b32 v81, a244
    v_accvgpr_read_b32 v82, a213
    v_accvgpr_read_b32 v83, a245
    v_accvgpr_read_b32 v84, a214
    v_accvgpr_read_b32 v85, a246
    v_accvgpr_read_b32 v86, a215
    v_accvgpr_read_b32 v87, a247
    v_pk_add_f32 v[80:81], v[80:81], v[38:39]
    v_pk_add_f32 v[82:83], v[82:83], v[46:47]
    v_pk_add_f32 v[84:85], v[84:85], v[54:55]
    v_pk_add_f32 v[86:87], v[86:87], v[62:63]
    v_max_f32 v80, 0, v80
    v_max_f32 v81, 0, v81
    v_max_f32 v82, 0, v82
    v_max_f32 v83, 0, v83
    v_max_f32 v84, 0, v84
    v_max_f32 v85, 0, v85
    v_max_f32 v86, 0, v86
    v_max_f32 v87, 0, v87
    v_pk_mul_f32 v[80:81], v[80:81], v[80:81]
    v_pk_mul_f32 v[82:83], v[82:83], v[82:83]
    v_pk_mul_f32 v[84:85], v[84:85], v[84:85]
    v_pk_mul_f32 v[86:87], v[86:87], v[86:87]
    v_cvt_pk_bf16_f32 v100, v80, v81
    v_cvt_pk_bf16_f32 v101, v82, v83
    v_cvt_pk_bf16_f32 v102, v84, v85
    v_cvt_pk_bf16_f32 v103, v86, v87
    ds_write_b128 v3, v[100:103] offset:19456
    v_accvgpr_read_b32 v64, a24
    v_accvgpr_read_b32 v65, a56
    v_accvgpr_read_b32 v66, a25
    v_accvgpr_read_b32 v67, a57
    v_accvgpr_read_b32 v68, a26
    v_accvgpr_read_b32 v69, a58
    v_accvgpr_read_b32 v70, a27
    v_accvgpr_read_b32 v71, a59
    v_pk_add_f32 v[64:65], v[64:65], v[32:33]
    v_pk_add_f32 v[66:67], v[66:67], v[40:41]
    v_pk_add_f32 v[68:69], v[68:69], v[48:49]
    v_pk_add_f32 v[70:71], v[70:71], v[56:57]
    v_max_f32 v64, 0, v64
    v_max_f32 v65, 0, v65
    v_max_f32 v66, 0, v66
    v_max_f32 v67, 0, v67
    v_max_f32 v68, 0, v68
    v_max_f32 v69, 0, v69
    v_max_f32 v70, 0, v70
    v_max_f32 v71, 0, v71
    v_pk_mul_f32 v[64:65], v[64:65], v[64:65]
    v_pk_mul_f32 v[66:67], v[66:67], v[66:67]
    v_pk_mul_f32 v[68:69], v[68:69], v[68:69]
    v_pk_mul_f32 v[70:71], v[70:71], v[70:71]
    v_cvt_pk_bf16_f32 v96, v64, v65
    v_cvt_pk_bf16_f32 v97, v66, v67
    v_cvt_pk_bf16_f32 v98, v68, v69
    v_cvt_pk_bf16_f32 v99, v70, v71
    ds_write_b128 v3, v[96:99] offset:32768
    v_accvgpr_read_b32 v80, a88
    v_accvgpr_read_b32 v81, a120
    v_accvgpr_read_b32 v82, a89
    v_accvgpr_read_b32 v83, a121
    v_accvgpr_read_b32 v84, a90
    v_accvgpr_read_b32 v85, a122
    v_accvgpr_read_b32 v86, a91
    v_accvgpr_read_b32 v87, a123
    v_pk_add_f32 v[80:81], v[80:81], v[34:35]
    v_pk_add_f32 v[82:83], v[82:83], v[42:43]
    v_pk_add_f32 v[84:85], v[84:85], v[50:51]
    v_pk_add_f32 v[86:87], v[86:87], v[58:59]
    v_max_f32 v80, 0, v80
    v_max_f32 v81, 0, v81
    v_max_f32 v82, 0, v82
    v_max_f32 v83, 0, v83
    v_max_f32 v84, 0, v84
    v_max_f32 v85, 0, v85
    v_max_f32 v86, 0, v86
    v_max_f32 v87, 0, v87
    v_pk_mul_f32 v[80:81], v[80:81], v[80:81]
    v_pk_mul_f32 v[82:83], v[82:83], v[82:83]
    v_pk_mul_f32 v[84:85], v[84:85], v[84:85]
    v_pk_mul_f32 v[86:87], v[86:87], v[86:87]
    v_cvt_pk_bf16_f32 v100, v80, v81
    v_cvt_pk_bf16_f32 v101, v82, v83
    v_cvt_pk_bf16_f32 v102, v84, v85
    v_cvt_pk_bf16_f32 v103, v86, v87
    ds_write_b128 v3, v[100:103] offset:33792
    v_accvgpr_read_b32 v64, a152
    v_accvgpr_read_b32 v65, a184
    v_accvgpr_read_b32 v66, a153
    v_accvgpr_read_b32 v67, a185
    v_accvgpr_read_b32 v68, a154
    v_accvgpr_read_b32 v69, a186
    v_accvgpr_read_b32 v70, a155
    v_accvgpr_read_b32 v71, a187
    v_pk_add_f32 v[64:65], v[64:65], v[36:37]
    v_pk_add_f32 v[66:67], v[66:67], v[44:45]
    v_pk_add_f32 v[68:69], v[68:69], v[52:53]
    v_pk_add_f32 v[70:71], v[70:71], v[60:61]
    v_max_f32 v64, 0, v64
    v_max_f32 v65, 0, v65
    v_max_f32 v66, 0, v66
    v_max_f32 v67, 0, v67
    v_max_f32 v68, 0, v68
    v_max_f32 v69, 0, v69
    v_max_f32 v70, 0, v70
    v_max_f32 v71, 0, v71
    v_pk_mul_f32 v[64:65], v[64:65], v[64:65]
    v_pk_mul_f32 v[66:67], v[66:67], v[66:67]
    v_pk_mul_f32 v[68:69], v[68:69], v[68:69]
    v_pk_mul_f32 v[70:71], v[70:71], v[70:71]
    v_cvt_pk_bf16_f32 v96, v64, v65
    v_cvt_pk_bf16_f32 v97, v66, v67
    v_cvt_pk_bf16_f32 v98, v68, v69
    v_cvt_pk_bf16_f32 v99, v70, v71
    ds_write_b128 v3, v[96:99] offset:34816
    v_accvgpr_read_b32 v80, a216
    v_accvgpr_read_b32 v81, a248
    v_accvgpr_read_b32 v82, a217
    v_accvgpr_read_b32 v83, a249
    v_accvgpr_read_b32 v84, a218
    v_accvgpr_read_b32 v85, a250
    v_accvgpr_read_b32 v86, a219
    v_accvgpr_read_b32 v87, a251
    v_pk_add_f32 v[80:81], v[80:81], v[38:39]
    v_pk_add_f32 v[82:83], v[82:83], v[46:47]
    v_pk_add_f32 v[84:85], v[84:85], v[54:55]
    v_pk_add_f32 v[86:87], v[86:87], v[62:63]
    v_max_f32 v80, 0, v80
    v_max_f32 v81, 0, v81
    v_max_f32 v82, 0, v82
    v_max_f32 v83, 0, v83
    v_max_f32 v84, 0, v84
    v_max_f32 v85, 0, v85
    v_max_f32 v86, 0, v86
    v_max_f32 v87, 0, v87
    v_pk_mul_f32 v[80:81], v[80:81], v[80:81]
    v_pk_mul_f32 v[82:83], v[82:83], v[82:83]
    v_pk_mul_f32 v[84:85], v[84:85], v[84:85]
    v_pk_mul_f32 v[86:87], v[86:87], v[86:87]
    v_cvt_pk_bf16_f32 v100, v80, v81
    v_cvt_pk_bf16_f32 v101, v82, v83
    v_cvt_pk_bf16_f32 v102, v84, v85
    v_cvt_pk_bf16_f32 v103, v86, v87
    ds_write_b128 v3, v[100:103] offset:35840
    v_accvgpr_read_b32 v64, a28
    v_accvgpr_read_b32 v65, a60
    v_accvgpr_read_b32 v66, a29
    v_accvgpr_read_b32 v67, a61
    v_accvgpr_read_b32 v68, a30
    v_accvgpr_read_b32 v69, a62
    v_accvgpr_read_b32 v70, a31
    v_accvgpr_read_b32 v71, a63
    v_pk_add_f32 v[64:65], v[64:65], v[32:33]
    v_pk_add_f32 v[66:67], v[66:67], v[40:41]
    v_pk_add_f32 v[68:69], v[68:69], v[48:49]
    v_pk_add_f32 v[70:71], v[70:71], v[56:57]
    v_max_f32 v64, 0, v64
    v_max_f32 v65, 0, v65
    v_max_f32 v66, 0, v66
    v_max_f32 v67, 0, v67
    v_max_f32 v68, 0, v68
    v_max_f32 v69, 0, v69
    v_max_f32 v70, 0, v70
    v_max_f32 v71, 0, v71
    v_pk_mul_f32 v[64:65], v[64:65], v[64:65]
    v_pk_mul_f32 v[66:67], v[66:67], v[66:67]
    v_pk_mul_f32 v[68:69], v[68:69], v[68:69]
    v_pk_mul_f32 v[70:71], v[70:71], v[70:71]
    v_cvt_pk_bf16_f32 v96, v64, v65
    v_cvt_pk_bf16_f32 v97, v66, v67
    v_cvt_pk_bf16_f32 v98, v68, v69
    v_cvt_pk_bf16_f32 v99, v70, v71
    ds_write_b128 v3, v[96:99] offset:49152
    v_accvgpr_read_b32 v80, a92
    v_accvgpr_read_b32 v81, a124
    v_accvgpr_read_b32 v82, a93
    v_accvgpr_read_b32 v83, a125
    v_accvgpr_read_b32 v84, a94
    v_accvgpr_read_b32 v85, a126
    v_accvgpr_read_b32 v86, a95
    v_accvgpr_read_b32 v87, a127
    v_pk_add_f32 v[80:81], v[80:81], v[34:35]
    v_pk_add_f32 v[82:83], v[82:83], v[42:43]
    v_pk_add_f32 v[84:85], v[84:85], v[50:51]
    v_pk_add_f32 v[86:87], v[86:87], v[58:59]
    v_max_f32 v80, 0, v80
    v_max_f32 v81, 0, v81
    v_max_f32 v82, 0, v82
    v_max_f32 v83, 0, v83
    v_max_f32 v84, 0, v84
    v_max_f32 v85, 0, v85
    v_max_f32 v86, 0, v86
    v_max_f32 v87, 0, v87
    v_pk_mul_f32 v[80:81], v[80:81], v[80:81]
    v_pk_mul_f32 v[82:83], v[82:83], v[82:83]
    v_pk_mul_f32 v[84:85], v[84:85], v[84:85]
    v_pk_mul_f32 v[86:87], v[86:87], v[86:87]
    v_cvt_pk_bf16_f32 v100, v80, v81
    v_cvt_pk_bf16_f32 v101, v82, v83
    v_cvt_pk_bf16_f32 v102, v84, v85
    v_cvt_pk_bf16_f32 v103, v86, v87
    ds_write_b128 v3, v[100:103] offset:50176
    v_accvgpr_read_b32 v64, a156
    v_accvgpr_read_b32 v65, a188
    v_accvgpr_read_b32 v66, a157
    v_accvgpr_read_b32 v67, a189
    v_accvgpr_read_b32 v68, a158
    v_accvgpr_read_b32 v69, a190
    v_accvgpr_read_b32 v70, a159
    v_accvgpr_read_b32 v71, a191
    v_pk_add_f32 v[64:65], v[64:65], v[36:37]
    v_pk_add_f32 v[66:67], v[66:67], v[44:45]
    v_pk_add_f32 v[68:69], v[68:69], v[52:53]
    v_pk_add_f32 v[70:71], v[70:71], v[60:61]
    v_max_f32 v64, 0, v64
    v_max_f32 v65, 0, v65
    v_max_f32 v66, 0, v66
    v_max_f32 v67, 0, v67
    v_max_f32 v68, 0, v68
    v_max_f32 v69, 0, v69
    v_max_f32 v70, 0, v70
    v_max_f32 v71, 0, v71
    v_pk_mul_f32 v[64:65], v[64:65], v[64:65]
    v_pk_mul_f32 v[66:67], v[66:67], v[66:67]
    v_pk_mul_f32 v[68:69], v[68:69], v[68:69]
    v_pk_mul_f32 v[70:71], v[70:71], v[70:71]
    v_cvt_pk_bf16_f32 v96, v64, v65
    v_cvt_pk_bf16_f32 v97, v66, v67
    v_cvt_pk_bf16_f32 v98, v68, v69
    v_cvt_pk_bf16_f32 v99, v70, v71
    ds_write_b128 v3, v[96:99] offset:51200
    v_accvgpr_read_b32 v80, a220
    v_accvgpr_read_b32 v81, a252
    v_accvgpr_read_b32 v82, a221
    v_accvgpr_read_b32 v83, a253
    v_accvgpr_read_b32 v84, a222
    v_accvgpr_read_b32 v85, a254
    v_accvgpr_read_b32 v86, a223
    v_accvgpr_read_b32 v87, a255
    v_pk_add_f32 v[80:81], v[80:81], v[38:39]
    v_pk_add_f32 v[82:83], v[82:83], v[46:47]
    v_pk_add_f32 v[84:85], v[84:85], v[54:55]
    v_pk_add_f32 v[86:87], v[86:87], v[62:63]
    v_max_f32 v80, 0, v80
    v_max_f32 v81, 0, v81
    v_max_f32 v82, 0, v82
    v_max_f32 v83, 0, v83
    v_max_f32 v84, 0, v84
    v_max_f32 v85, 0, v85
    v_max_f32 v86, 0, v86
    v_max_f32 v87, 0, v87
    v_pk_mul_f32 v[80:81], v[80:81], v[80:81]
    v_pk_mul_f32 v[82:83], v[82:83], v[82:83]
    v_pk_mul_f32 v[84:85], v[84:85], v[84:85]
    v_pk_mul_f32 v[86:87], v[86:87], v[86:87]
    v_cvt_pk_bf16_f32 v100, v80, v81
    v_cvt_pk_bf16_f32 v101, v82, v83
    v_cvt_pk_bf16_f32 v102, v84, v85
    v_cvt_pk_bf16_f32 v103, v86, v87
    ds_write_b128 v3, v[100:103] offset:52224
    s_branch L_gemm
L_done:
    s_lshl_b32 s84, s53, 6
    s_add_u32 s83, s83, s84
    s_waitcnt vmcnt(0)
    s_barrier
    s_cmp_eq_u32 s34, 0
    s_cbranch_scc0 L_done2
    s_cmp_eq_u32 s90, 0
    s_cselect_b32 s84, 2, 1
    s_mov_b64 exec, 1
    v_mov_b32 v8, s84
    buffer_atomic_add v8, off, s[36:39], s83
    s_mov_b64 exec, -1
L_done2:
    s_add_u32 s52, s52, 1
    s_cmp_lt_u32 s52, 3
    s_cbranch_scc1 L_task
L_g1_end:
    s_and_b32 s52, s35, 31
    s_lshr_b32 s53, s35, 5
    s_and_b32 s55, s34, 1
    s_lshr_b32 s56, s34, 1
    v_lshlrev_b32 v8, 4, v7
    v_lshrrev_b32 v9, 1, v6
    v_lshl_add_u32 v8, v9, 19, v8
    v_and_b32 v9, 1, v6
    v_lshl_add_u32 v8, v9, 17, v8
    s_lshl_b32 s78, s34, 14
    s_lshl_b32 s79, s52, 8
    s_add_u32 s78, s78, s79
    v_add_u32 v8, s78, v8
    s_lshl_b32 s78, s34, 12
    v_add_u32 v9, s78, v1
    v_add_u32 v10, 0x10000, v9
    s_lshl_b32 s78, s34, 15
    v_add_u32 v11, s78, v1
    s_mov_b32 s44, s10
    s_mov_b32 s45, s11
    s_mov_b32 s46, 0x400000
    s_mov_b32 s47, 0x20000
    s_mov_b32 s78, 0x0
    buffer_load_dwordx4 v[24:27], v8, s[44:47], s78 offen
    s_mov_b32 s78, 0x2000
    buffer_load_dwordx4 v[28:31], v8, s[44:47], s78 offen
    s_mov_b32 s78, 0x40000
    buffer_load_dwordx4 v[32:35], v8, s[44:47], s78 offen
    s_mov_b32 s78, 0x42000
    buffer_load_dwordx4 v[36:39], v8, s[44:47], s78 offen
    s_mov_b32 s78, 0x10000
    buffer_load_dwordx4 v[40:43], v8, s[44:47], s78 offen
    s_mov_b32 s78, 0x12000
    buffer_load_dwordx4 v[44:47], v8, s[44:47], s78 offen
    s_mov_b32 s78, 0x50000
    buffer_load_dwordx4 v[48:51], v8, s[44:47], s78 offen
    s_mov_b32 s78, 0x52000
    buffer_load_dwordx4 v[52:55], v8, s[44:47], s78 offen
    s_mov_b32 s78, 0x100000
    buffer_load_dwordx4 v[56:59], v8, s[44:47], s78 offen
    s_mov_b32 s78, 0x102000
    buffer_load_dwordx4 v[60:63], v8, s[44:47], s78 offen
    s_mov_b32 s78, 0x140000
    buffer_load_dwordx4 v[64:67], v8, s[44:47], s78 offen
    s_mov_b32 s78, 0x142000
    buffer_load_dwordx4 v[68:71], v8, s[44:47], s78 offen
    s_mov_b32 s78, 0x110000
    buffer_load_dwordx4 v[72:75], v8, s[44:47], s78 offen
    s_mov_b32 s78, 0x112000
    buffer_load_dwordx4 v[76:79], v8, s[44:47], s78 offen
    s_mov_b32 s78, 0x150000
    buffer_load_dwordx4 v[80:83], v8, s[44:47], s78 offen
    s_mov_b32 s78, 0x152000
    buffer_load_dwordx4 v[84:87], v8, s[44:47], s78 offen
    s_mov_b32 s78, 0x200000
    buffer_load_dwordx4 v[88:91], v8, s[44:47], s78 offen
    s_mov_b32 s78, 0x202000
    buffer_load_dwordx4 v[92:95], v8, s[44:47], s78 offen
    s_mov_b32 s78, 0x240000
    buffer_load_dwordx4 v[96:99], v8, s[44:47], s78 offen
    s_mov_b32 s78, 0x242000
    buffer_load_dwordx4 v[100:103], v8, s[44:47], s78 offen
    s_mov_b32 s78, 0x210000
    buffer_load_dwordx4 v[104:107], v8, s[44:47], s78 offen
    s_mov_b32 s78, 0x212000
    buffer_load_dwordx4 v[108:111], v8, s[44:47], s78 offen
    s_mov_b32 s78, 0x250000
    buffer_load_dwordx4 v[112:115], v8, s[44:47], s78 offen
    s_mov_b32 s78, 0x252000
    buffer_load_dwordx4 v[116:119], v8, s[44:47], s78 offen
    s_mov_b32 s78, 0x300000
    buffer_load_dwordx4 v[120:123], v8, s[44:47], s78 offen
    s_mov_b32 s78, 0x302000
    buffer_load_dwordx4 v[124:127], v8, s[44:47], s78 offen
    s_mov_b32 s78, 0x340000
    buffer_load_dwordx4 v[128:131], v8, s[44:47], s78 offen
    s_mov_b32 s78, 0x342000
    buffer_load_dwordx4 v[132:135], v8, s[44:47], s78 offen
    s_mov_b32 s78, 0x310000
    buffer_load_dwordx4 v[136:139], v8, s[44:47], s78 offen
    s_mov_b32 s78, 0x312000
    buffer_load_dwordx4 v[140:143], v8, s[44:47], s78 offen
    s_mov_b32 s78, 0x350000
    buffer_load_dwordx4 v[144:147], v8, s[44:47], s78 offen
    s_mov_b32 s78, 0x352000
    buffer_load_dwordx4 v[148:151], v8, s[44:47], s78 offen
    s_waitcnt lgkmcnt(0)
    s_barrier
    s_waitcnt vmcnt(16)
    v_perm_b32 v160, v28, v24, s76
    v_perm_b32 v161, v36, v32, s76
    v_perm_b32 v162, v44, v40, s76
    v_perm_b32 v163, v52, v48, s76
    ds_write_b128 v9, v[160:163] offset:0
    v_perm_b32 v164, v60, v56, s76
    v_perm_b32 v165, v68, v64, s76
    v_perm_b32 v166, v76, v72, s76
    v_perm_b32 v167, v84, v80, s76
    ds_write_b128 v9, v[164:167] offset:1024
    v_perm_b32 v168, v28, v24, s77
    v_perm_b32 v169, v36, v32, s77
    v_perm_b32 v170, v44, v40, s77
    v_perm_b32 v171, v52, v48, s77
    ds_write_b128 v9, v[168:171] offset:16384
    v_perm_b32 v160, v60, v56, s77
    v_perm_b32 v161, v68, v64, s77
    v_perm_b32 v162, v76, v72, s77
    v_perm_b32 v163, v84, v80, s77
    ds_write_b128 v9, v[160:163] offset:17408
    v_perm_b32 v164, v29, v25, s76
    v_perm_b32 v165, v37, v33, s76
    v_perm_b32 v166, v45, v41, s76
    v_perm_b32 v167, v53, v49, s76
    ds_write_b128 v9, v[164:167] offset:32768
    v_perm_b32 v168, v61, v57, s76
    v_perm_b32 v169, v69, v65, s76
    v_perm_b32 v170, v77, v73, s76
    v_perm_b32 v171, v85, v81, s76
    ds_write_b128 v9, v[168:171] offset:33792
    v_perm_b32 v160, v29, v25, s77
    v_perm_b32 v161, v37, v33, s77
    v_perm_b32 v162, v45, v41, s77
    v_perm_b32 v163, v53, v49, s77
    ds_write_b128 v9, v[160:163] offset:49152
    v_perm_b32 v164, v61, v57, s77
    v_perm_b32 v165, v69, v65, s77
    v_perm_b32 v166, v77, v73, s77
    v_perm_b32 v167, v85, v81, s77
    ds_write_b128 v9, v[164:167] offset:50176
    v_perm_b32 v168, v30, v26, s76
    v_perm_b32 v169, v38, v34, s76
    v_perm_b32 v170, v46, v42, s76
    v_perm_b32 v171, v54, v50, s76
    ds_write_b128 v10, v[168:171] offset:0
    v_perm_b32 v160, v62, v58, s76
    v_perm_b32 v161, v70, v66, s76
    v_perm_b32 v162, v78, v74, s76
    v_perm_b32 v163, v86, v82, s76
    ds_write_b128 v10, v[160:163] offset:1024
    v_perm_b32 v164, v30, v26, s77
    v_perm_b32 v165, v38, v34, s77
    v_perm_b32 v166, v46, v42, s77
    v_perm_b32 v167, v54, v50, s77
    ds_write_b128 v10, v[164:167] offset:16384
    v_perm_b32 v168, v62, v58, s77
    v_perm_b32 v169, v70, v66, s77
    v_perm_b32 v170, v78, v74, s77
    v_perm_b32 v171, v86, v82, s77
    ds_write_b128 v10, v[168:171] offset:17408
    v_perm_b32 v160, v31, v27, s76
    v_perm_b32 v161, v39, v35, s76
    v_perm_b32 v162, v47, v43, s76
    v_perm_b32 v163, v55, v51, s76
    ds_write_b128 v10, v[160:163] offset:32768
    v_perm_b32 v164, v63, v59, s76
    v_perm_b32 v165, v71, v67, s76
    v_perm_b32 v166, v79, v75, s76
    v_perm_b32 v167, v87, v83, s76
    ds_write_b128 v10, v[164:167] offset:33792
    v_perm_b32 v168, v31, v27, s77
    v_perm_b32 v169, v39, v35, s77
    v_perm_b32 v170, v47, v43, s77
    v_perm_b32 v171, v55, v51, s77
    ds_write_b128 v10, v[168:171] offset:49152
    v_perm_b32 v160, v63, v59, s77
    v_perm_b32 v161, v71, v67, s77
    v_perm_b32 v162, v79, v75, s77
    v_perm_b32 v163, v87, v83, s77
    ds_write_b128 v10, v[160:163] offset:50176
    s_waitcnt vmcnt(0)
    v_perm_b32 v164, v92, v88, s76
    v_perm_b32 v165, v100, v96, s76
    v_perm_b32 v166, v108, v104, s76
    v_perm_b32 v167, v116, v112, s76
    ds_write_b128 v9, v[164:167] offset:2048
    v_perm_b32 v168, v124, v120, s76
    v_perm_b32 v169, v132, v128, s76
    v_perm_b32 v170, v140, v136, s76
    v_perm_b32 v171, v148, v144, s76
    ds_write_b128 v9, v[168:171] offset:3072
    v_perm_b32 v160, v92, v88, s77
    v_perm_b32 v161, v100, v96, s77
    v_perm_b32 v162, v108, v104, s77
    v_perm_b32 v163, v116, v112, s77
    ds_write_b128 v9, v[160:163] offset:18432
    v_perm_b32 v164, v124, v120, s77
    v_perm_b32 v165, v132, v128, s77
    v_perm_b32 v166, v140, v136, s77
    v_perm_b32 v167, v148, v144, s77
    ds_write_b128 v9, v[164:167] offset:19456
    v_perm_b32 v168, v93, v89, s76
    v_perm_b32 v169, v101, v97, s76
    v_perm_b32 v170, v109, v105, s76
    v_perm_b32 v171, v117, v113, s76
    ds_write_b128 v9, v[168:171] offset:34816
    v_perm_b32 v160, v125, v121, s76
    v_perm_b32 v161, v133, v129, s76
    v_perm_b32 v162, v141, v137, s76
    v_perm_b32 v163, v149, v145, s76
    ds_write_b128 v9, v[160:163] offset:35840
    v_perm_b32 v164, v93, v89, s77
    v_perm_b32 v165, v101, v97, s77
    v_perm_b32 v166, v109, v105, s77
    v_perm_b32 v167, v117, v113, s77
    ds_write_b128 v9, v[164:167] offset:51200
    v_perm_b32 v168, v125, v121, s77
    v_perm_b32 v169, v133, v129, s77
    v_perm_b32 v170, v141, v137, s77
    v_perm_b32 v171, v149, v145, s77
    ds_write_b128 v9, v[168:171] offset:52224
    v_perm_b32 v160, v94, v90, s76
    v_perm_b32 v161, v102, v98, s76
    v_perm_b32 v162, v110, v106, s76
    v_perm_b32 v163, v118, v114, s76
    ds_write_b128 v10, v[160:163] offset:2048
    v_perm_b32 v164, v126, v122, s76
    v_perm_b32 v165, v134, v130, s76
    v_perm_b32 v166, v142, v138, s76
    v_perm_b32 v167, v150, v146, s76
    ds_write_b128 v10, v[164:167] offset:3072
    v_perm_b32 v168, v94, v90, s77
    v_perm_b32 v169, v102, v98, s77
    v_perm_b32 v170, v110, v106, s77
    v_perm_b32 v171, v118, v114, s77
    ds_write_b128 v10, v[168:171] offset:18432
    v_perm_b32 v160, v126, v122, s77
    v_perm_b32 v161, v134, v130, s77
    v_perm_b32 v162, v142, v138, s77
    v_perm_b32 v163, v150, v146, s77
    ds_write_b128 v10, v[160:163] offset:19456
    v_perm_b32 v164, v95, v91, s76
    v_perm_b32 v165, v103, v99, s76
    v_perm_b32 v166, v111, v107, s76
    v_perm_b32 v167, v119, v115, s76
    ds_write_b128 v10, v[164:167] offset:34816
    v_perm_b32 v168, v127, v123, s76
    v_perm_b32 v169, v135, v131, s76
    v_perm_b32 v170, v143, v139, s76
    v_perm_b32 v171, v151, v147, s76
    ds_write_b128 v10, v[168:171] offset:35840
    v_perm_b32 v160, v95, v91, s77
    v_perm_b32 v161, v103, v99, s77
    v_perm_b32 v162, v111, v107, s77
    v_perm_b32 v163, v119, v115, s77
    ds_write_b128 v10, v[160:163] offset:51200
    v_perm_b32 v164, v127, v123, s77
    v_perm_b32 v165, v135, v131, s77
    v_perm_b32 v166, v143, v139, s77
    v_perm_b32 v167, v151, v147, s77
    ds_write_b128 v10, v[164:167] offset:52224
    s_waitcnt lgkmcnt(0)
    s_barrier
    ds_read_b128 a[0:3], v11 offset:0
    ds_read_b128 a[4:7], v11 offset:1024
    ds_read_b128 a[8:11], v11 offset:2048
    ds_read_b128 a[12:15], v11 offset:3072
    ds_read_b128 a[16:19], v11 offset:4096
    ds_read_b128 a[20:23], v11 offset:5120
    ds_read_b128 a[24:27], v11 offset:6144
    ds_read_b128 a[28:31], v11 offset:7168
    ds_read_b128 a[32:35], v11 offset:8192
    ds_read_b128 a[36:39], v11 offset:9216
    ds_read_b128 a[40:43], v11 offset:10240
    ds_read_b128 a[44:47], v11 offset:11264
    ds_read_b128 a[48:51], v11 offset:12288
    ds_read_b128 a[52:55], v11 offset:13312
    ds_read_b128 a[56:59], v11 offset:14336
    ds_read_b128 a[60:63], v11 offset:15360
    ds_read_b128 a[64:67], v11 offset:16384
    ds_read_b128 a[68:71], v11 offset:17408
    ds_read_b128 a[72:75], v11 offset:18432
    ds_read_b128 a[76:79], v11 offset:19456
    ds_read_b128 a[80:83], v11 offset:20480
    ds_read_b128 a[84:87], v11 offset:21504
    ds_read_b128 a[88:91], v11 offset:22528
    ds_read_b128 a[92:95], v11 offset:23552
    ds_read_b128 a[96:99], v11 offset:24576
    ds_read_b128 a[100:103], v11 offset:25600
    ds_read_b128 a[104:107], v11 offset:26624
    ds_read_b128 a[108:111], v11 offset:27648
    ds_read_b128 a[112:115], v11 offset:28672
    ds_read_b128 a[116:119], v11 offset:29696
    ds_read_b128 a[120:123], v11 offset:30720
    ds_read_b128 a[124:127], v11 offset:31744
    s_mov_b32 s44, s12
    s_mov_b32 s45, s13
    s_mov_b32 s46, 0x400000
    s_mov_b32 s47, 0x20000
    s_mov_b32 s78, 0x0
    buffer_load_dwordx4 v[24:27], v8, s[44:47], s78 offen
    s_mov_b32 s78, 0x2000
    buffer_load_dwordx4 v[28:31], v8, s[44:47], s78 offen
    s_mov_b32 s78, 0x40000
    buffer_load_dwordx4 v[32:35], v8, s[44:47], s78 offen
    s_mov_b32 s78, 0x42000
    buffer_load_dwordx4 v[36:39], v8, s[44:47], s78 offen
    s_mov_b32 s78, 0x10000
    buffer_load_dwordx4 v[40:43], v8, s[44:47], s78 offen
    s_mov_b32 s78, 0x12000
    buffer_load_dwordx4 v[44:47], v8, s[44:47], s78 offen
    s_mov_b32 s78, 0x50000
    buffer_load_dwordx4 v[48:51], v8, s[44:47], s78 offen
    s_mov_b32 s78, 0x52000
    buffer_load_dwordx4 v[52:55], v8, s[44:47], s78 offen
    s_mov_b32 s78, 0x100000
    buffer_load_dwordx4 v[56:59], v8, s[44:47], s78 offen
    s_mov_b32 s78, 0x102000
    buffer_load_dwordx4 v[60:63], v8, s[44:47], s78 offen
    s_mov_b32 s78, 0x140000
    buffer_load_dwordx4 v[64:67], v8, s[44:47], s78 offen
    s_mov_b32 s78, 0x142000
    buffer_load_dwordx4 v[68:71], v8, s[44:47], s78 offen
    s_mov_b32 s78, 0x110000
    buffer_load_dwordx4 v[72:75], v8, s[44:47], s78 offen
    s_mov_b32 s78, 0x112000
    buffer_load_dwordx4 v[76:79], v8, s[44:47], s78 offen
    s_mov_b32 s78, 0x150000
    buffer_load_dwordx4 v[80:83], v8, s[44:47], s78 offen
    s_mov_b32 s78, 0x152000
    buffer_load_dwordx4 v[84:87], v8, s[44:47], s78 offen
    s_mov_b32 s78, 0x200000
    buffer_load_dwordx4 v[88:91], v8, s[44:47], s78 offen
    s_mov_b32 s78, 0x202000
    buffer_load_dwordx4 v[92:95], v8, s[44:47], s78 offen
    s_mov_b32 s78, 0x240000
    buffer_load_dwordx4 v[96:99], v8, s[44:47], s78 offen
    s_mov_b32 s78, 0x242000
    buffer_load_dwordx4 v[100:103], v8, s[44:47], s78 offen
    s_mov_b32 s78, 0x210000
    buffer_load_dwordx4 v[104:107], v8, s[44:47], s78 offen
    s_mov_b32 s78, 0x212000
    buffer_load_dwordx4 v[108:111], v8, s[44:47], s78 offen
    s_mov_b32 s78, 0x250000
    buffer_load_dwordx4 v[112:115], v8, s[44:47], s78 offen
    s_mov_b32 s78, 0x252000
    buffer_load_dwordx4 v[116:119], v8, s[44:47], s78 offen
    s_mov_b32 s78, 0x300000
    buffer_load_dwordx4 v[120:123], v8, s[44:47], s78 offen
    s_mov_b32 s78, 0x302000
    buffer_load_dwordx4 v[124:127], v8, s[44:47], s78 offen
    s_mov_b32 s78, 0x340000
    buffer_load_dwordx4 v[128:131], v8, s[44:47], s78 offen
    s_mov_b32 s78, 0x342000
    buffer_load_dwordx4 v[132:135], v8, s[44:47], s78 offen
    s_mov_b32 s78, 0x310000
    buffer_load_dwordx4 v[136:139], v8, s[44:47], s78 offen
    s_mov_b32 s78, 0x312000
    buffer_load_dwordx4 v[140:143], v8, s[44:47], s78 offen
    s_mov_b32 s78, 0x350000
    buffer_load_dwordx4 v[144:147], v8, s[44:47], s78 offen
    s_mov_b32 s78, 0x352000
    buffer_load_dwordx4 v[148:151], v8, s[44:47], s78 offen
    s_waitcnt lgkmcnt(0)
    s_barrier
    s_waitcnt vmcnt(16)
    v_perm_b32 v160, v28, v24, s76
    v_perm_b32 v161, v36, v32, s76
    v_perm_b32 v162, v44, v40, s76
    v_perm_b32 v163, v52, v48, s76
    ds_write_b128 v9, v[160:163] offset:0
    v_perm_b32 v164, v60, v56, s76
    v_perm_b32 v165, v68, v64, s76
    v_perm_b32 v166, v76, v72, s76
    v_perm_b32 v167, v84, v80, s76
    ds_write_b128 v9, v[164:167] offset:1024
    v_perm_b32 v168, v28, v24, s77
    v_perm_b32 v169, v36, v32, s77
    v_perm_b32 v170, v44, v40, s77
    v_perm_b32 v171, v52, v48, s77
    ds_write_b128 v9, v[168:171] offset:16384
    v_perm_b32 v160, v60, v56, s77
    v_perm_b32 v161, v68, v64, s77
    v_perm_b32 v162, v76, v72, s77
    v_perm_b32 v163, v84, v80, s77
    ds_write_b128 v9, v[160:163] offset:17408
    v_perm_b32 v164, v29, v25, s76
    v_perm_b32 v165, v37, v33, s76
    v_perm_b32 v166, v45, v41, s76
    v_perm_b32 v167, v53, v49, s76
    ds_write_b128 v9, v[164:167] offset:32768
    v_perm_b32 v168, v61, v57, s76
    v_perm_b32 v169, v69, v65, s76
    v_perm_b32 v170, v77, v73, s76
    v_perm_b32 v171, v85, v81, s76
    ds_write_b128 v9, v[168:171] offset:33792
    v_perm_b32 v160, v29, v25, s77
    v_perm_b32 v161, v37, v33, s77
    v_perm_b32 v162, v45, v41, s77
    v_perm_b32 v163, v53, v49, s77
    ds_write_b128 v9, v[160:163] offset:49152
    v_perm_b32 v164, v61, v57, s77
    v_perm_b32 v165, v69, v65, s77
    v_perm_b32 v166, v77, v73, s77
    v_perm_b32 v167, v85, v81, s77
    ds_write_b128 v9, v[164:167] offset:50176
    v_perm_b32 v168, v30, v26, s76
    v_perm_b32 v169, v38, v34, s76
    v_perm_b32 v170, v46, v42, s76
    v_perm_b32 v171, v54, v50, s76
    ds_write_b128 v10, v[168:171] offset:0
    v_perm_b32 v160, v62, v58, s76
    v_perm_b32 v161, v70, v66, s76
    v_perm_b32 v162, v78, v74, s76
    v_perm_b32 v163, v86, v82, s76
    ds_write_b128 v10, v[160:163] offset:1024
    v_perm_b32 v164, v30, v26, s77
    v_perm_b32 v165, v38, v34, s77
    v_perm_b32 v166, v46, v42, s77
    v_perm_b32 v167, v54, v50, s77
    ds_write_b128 v10, v[164:167] offset:16384
    v_perm_b32 v168, v62, v58, s77
    v_perm_b32 v169, v70, v66, s77
    v_perm_b32 v170, v78, v74, s77
    v_perm_b32 v171, v86, v82, s77
    ds_write_b128 v10, v[168:171] offset:17408
    v_perm_b32 v160, v31, v27, s76
    v_perm_b32 v161, v39, v35, s76
    v_perm_b32 v162, v47, v43, s76
    v_perm_b32 v163, v55, v51, s76
    ds_write_b128 v10, v[160:163] offset:32768
    v_perm_b32 v164, v63, v59, s76
    v_perm_b32 v165, v71, v67, s76
    v_perm_b32 v166, v79, v75, s76
    v_perm_b32 v167, v87, v83, s76
    ds_write_b128 v10, v[164:167] offset:33792
    v_perm_b32 v168, v31, v27, s77
    v_perm_b32 v169, v39, v35, s77
    v_perm_b32 v170, v47, v43, s77
    v_perm_b32 v171, v55, v51, s77
    ds_write_b128 v10, v[168:171] offset:49152
    v_perm_b32 v160, v63, v59, s77
    v_perm_b32 v161, v71, v67, s77
    v_perm_b32 v162, v79, v75, s77
    v_perm_b32 v163, v87, v83, s77
    ds_write_b128 v10, v[160:163] offset:50176
    s_waitcnt vmcnt(0)
    v_perm_b32 v164, v92, v88, s76
    v_perm_b32 v165, v100, v96, s76
    v_perm_b32 v166, v108, v104, s76
    v_perm_b32 v167, v116, v112, s76
    ds_write_b128 v9, v[164:167] offset:2048
    v_perm_b32 v168, v124, v120, s76
    v_perm_b32 v169, v132, v128, s76
    v_perm_b32 v170, v140, v136, s76
    v_perm_b32 v171, v148, v144, s76
    ds_write_b128 v9, v[168:171] offset:3072
    v_perm_b32 v160, v92, v88, s77
    v_perm_b32 v161, v100, v96, s77
    v_perm_b32 v162, v108, v104, s77
    v_perm_b32 v163, v116, v112, s77
    ds_write_b128 v9, v[160:163] offset:18432
    v_perm_b32 v164, v124, v120, s77
    v_perm_b32 v165, v132, v128, s77
    v_perm_b32 v166, v140, v136, s77
    v_perm_b32 v167, v148, v144, s77
    ds_write_b128 v9, v[164:167] offset:19456
    v_perm_b32 v168, v93, v89, s76
    v_perm_b32 v169, v101, v97, s76
    v_perm_b32 v170, v109, v105, s76
    v_perm_b32 v171, v117, v113, s76
    ds_write_b128 v9, v[168:171] offset:34816
    v_perm_b32 v160, v125, v121, s76
    v_perm_b32 v161, v133, v129, s76
    v_perm_b32 v162, v141, v137, s76
    v_perm_b32 v163, v149, v145, s76
    ds_write_b128 v9, v[160:163] offset:35840
    v_perm_b32 v164, v93, v89, s77
    v_perm_b32 v165, v101, v97, s77
    v_perm_b32 v166, v109, v105, s77
    v_perm_b32 v167, v117, v113, s77
    ds_write_b128 v9, v[164:167] offset:51200
    v_perm_b32 v168, v125, v121, s77
    v_perm_b32 v169, v133, v129, s77
    v_perm_b32 v170, v141, v137, s77
    v_perm_b32 v171, v149, v145, s77
    ds_write_b128 v9, v[168:171] offset:52224
    v_perm_b32 v160, v94, v90, s76
    v_perm_b32 v161, v102, v98, s76
    v_perm_b32 v162, v110, v106, s76
    v_perm_b32 v163, v118, v114, s76
    ds_write_b128 v10, v[160:163] offset:2048
    v_perm_b32 v164, v126, v122, s76
    v_perm_b32 v165, v134, v130, s76
    v_perm_b32 v166, v142, v138, s76
    v_perm_b32 v167, v150, v146, s76
    ds_write_b128 v10, v[164:167] offset:3072
    v_perm_b32 v168, v94, v90, s77
    v_perm_b32 v169, v102, v98, s77
    v_perm_b32 v170, v110, v106, s77
    v_perm_b32 v171, v118, v114, s77
    ds_write_b128 v10, v[168:171] offset:18432
    v_perm_b32 v160, v126, v122, s77
    v_perm_b32 v161, v134, v130, s77
    v_perm_b32 v162, v142, v138, s77
    v_perm_b32 v163, v150, v146, s77
    ds_write_b128 v10, v[160:163] offset:19456
    v_perm_b32 v164, v95, v91, s76
    v_perm_b32 v165, v103, v99, s76
    v_perm_b32 v166, v111, v107, s76
    v_perm_b32 v167, v119, v115, s76
    ds_write_b128 v10, v[164:167] offset:34816
    v_perm_b32 v168, v127, v123, s76
    v_perm_b32 v169, v135, v131, s76
    v_perm_b32 v170, v143, v139, s76
    v_perm_b32 v171, v151, v147, s76
    ds_write_b128 v10, v[168:171] offset:35840
    v_perm_b32 v160, v95, v91, s77
    v_perm_b32 v161, v103, v99, s77
    v_perm_b32 v162, v111, v107, s77
    v_perm_b32 v163, v119, v115, s77
    ds_write_b128 v10, v[160:163] offset:51200
    v_perm_b32 v164, v127, v123, s77
    v_perm_b32 v165, v135, v131, s77
    v_perm_b32 v166, v143, v139, s77
    v_perm_b32 v167, v151, v147, s77
    ds_write_b128 v10, v[164:167] offset:52224
    s_waitcnt lgkmcnt(0)
    s_barrier
    ds_read_b128 a[128:131], v11 offset:0
    ds_read_b128 a[132:135], v11 offset:1024
    ds_read_b128 a[136:139], v11 offset:2048
    ds_read_b128 a[140:143], v11 offset:3072
    ds_read_b128 a[144:147], v11 offset:4096
    ds_read_b128 a[148:151], v11 offset:5120
    ds_read_b128 a[152:155], v11 offset:6144
    ds_read_b128 a[156:159], v11 offset:7168
    ds_read_b128 a[160:163], v11 offset:8192
    ds_read_b128 a[164:167], v11 offset:9216
    ds_read_b128 a[168:171], v11 offset:10240
    ds_read_b128 a[172:175], v11 offset:11264
    ds_read_b128 a[176:179], v11 offset:12288
    ds_read_b128 a[180:183], v11 offset:13312
    ds_read_b128 a[184:187], v11 offset:14336
    ds_read_b128 a[188:191], v11 offset:15360
    ds_read_b128 a[192:195], v11 offset:16384
    ds_read_b128 a[196:199], v11 offset:17408
    ds_read_b128 a[200:203], v11 offset:18432
    ds_read_b128 a[204:207], v11 offset:19456
    ds_read_b128 a[208:211], v11 offset:20480
    ds_read_b128 a[212:215], v11 offset:21504
    ds_read_b128 a[216:219], v11 offset:22528
    ds_read_b128 a[220:223], v11 offset:23552
    ds_read_b128 a[224:227], v11 offset:24576
    ds_read_b128 a[228:231], v11 offset:25600
    ds_read_b128 a[232:235], v11 offset:26624
    ds_read_b128 a[236:239], v11 offset:27648
    ds_read_b128 a[240:243], v11 offset:28672
    ds_read_b128 a[244:247], v11 offset:29696
    ds_read_b128 a[248:251], v11 offset:30720
    ds_read_b128 a[252:255], v11 offset:31744
    s_mov_b32 s44, s14
    s_mov_b32 s45, s15
    s_mov_b32 s46, 0x400000
    s_mov_b32 s47, 0x20000
    v_lshlrev_b32 v8, 4, v7
    v_lshl_add_u32 v8, v6, 15, v8
    s_lshl_b32 s78, s52, 17
    s_lshl_b32 s79, s34, 8
    s_add_u32 s78, s78, s79
    s_add_u32 s79, s78, 0
    buffer_load_dwordx4 v[24:27], v8, s[44:47], s79 offen
    s_add_u32 s79, s78, 1024
    buffer_load_dwordx4 v[28:31], v8, s[44:47], s79 offen
    s_add_u32 s79, s78, 8192
    buffer_load_dwordx4 v[32:35], v8, s[44:47], s79 offen
    s_add_u32 s79, s78, 9216
    buffer_load_dwordx4 v[36:39], v8, s[44:47], s79 offen
    s_add_u32 s79, s78, 16384
    buffer_load_dwordx4 v[40:43], v8, s[44:47], s79 offen
    s_add_u32 s79, s78, 17408
    buffer_load_dwordx4 v[44:47], v8, s[44:47], s79 offen
    s_add_u32 s79, s78, 24576
    buffer_load_dwordx4 v[48:51], v8, s[44:47], s79 offen
    s_add_u32 s79, s78, 25600
    buffer_load_dwordx4 v[52:55], v8, s[44:47], s79 offen
    s_add_u32 s79, s78, 2048
    buffer_load_dwordx4 v[56:59], v8, s[44:47], s79 offen
    s_add_u32 s79, s78, 3072
    buffer_load_dwordx4 v[60:63], v8, s[44:47], s79 offen
    s_add_u32 s79, s78, 10240
    buffer_load_dwordx4 v[64:67], v8, s[44:47], s79 offen
    s_add_u32 s79, s78, 11264
    buffer_load_dwordx4 v[68:71], v8, s[44:47], s79 offen
    s_add_u32 s79, s78, 18432
    buffer_load_dwordx4 v[72:75], v8, s[44:47], s79 offen
    s_add_u32 s79, s78, 19456
    buffer_load_dwordx4 v[76:79], v8, s[44:47], s79 offen
    s_add_u32 s79, s78, 26624
    buffer_load_dwordx4 v[80:83], v8, s[44:47], s79 offen
    s_add_u32 s79, s78, 27648
    buffer_load_dwordx4 v[84:87], v8, s[44:47], s79 offen
    s_waitcnt vmcnt(8)
    v_perm_b32 v128, v28, v24, s76
    v_perm_b32 v129, v36, v32, s76
    v_perm_b32 v130, v44, v40, s76
    v_perm_b32 v131, v52, v48, s76
    v_perm_b32 v132, v28, v24, s77
    v_perm_b32 v133, v36, v32, s77
    v_perm_b32 v134, v44, v40, s77
    v_perm_b32 v135, v52, v48, s77
    v_perm_b32 v136, v29, v25, s76
    v_perm_b32 v137, v37, v33, s76
    v_perm_b32 v138, v45, v41, s76
    v_perm_b32 v139, v53, v49, s76
    v_perm_b32 v140, v29, v25, s77
    v_perm_b32 v141, v37, v33, s77
    v_perm_b32 v142, v45, v41, s77
    v_perm_b32 v143, v53, v49, s77
    v_perm_b32 v144, v30, v26, s76
    v_perm_b32 v145, v38, v34, s76
    v_perm_b32 v146, v46, v42, s76
    v_perm_b32 v147, v54, v50, s76
    v_perm_b32 v148, v30, v26, s77
    v_perm_b32 v149, v38, v34, s77
    v_perm_b32 v150, v46, v42, s77
    v_perm_b32 v151, v54, v50, s77
    v_perm_b32 v152, v31, v27, s76
    v_perm_b32 v153, v39, v35, s76
    v_perm_b32 v154, v47, v43, s76
    v_perm_b32 v155, v55, v51, s76
    v_perm_b32 v156, v31, v27, s77
    v_perm_b32 v157, v39, v35, s77
    v_perm_b32 v158, v47, v43, s77
    v_perm_b32 v159, v55, v51, s77
    s_waitcnt vmcnt(0)
    v_perm_b32 v160, v60, v56, s76
    v_perm_b32 v161, v68, v64, s76
    v_perm_b32 v162, v76, v72, s76
    v_perm_b32 v163, v84, v80, s76
    v_perm_b32 v164, v60, v56, s77
    v_perm_b32 v165, v68, v64, s77
    v_perm_b32 v166, v76, v72, s77
    v_perm_b32 v167, v84, v80, s77
    v_perm_b32 v168, v61, v57, s76
    v_perm_b32 v169, v69, v65, s76
    v_perm_b32 v170, v77, v73, s76
    v_perm_b32 v171, v85, v81, s76
    v_perm_b32 v172, v61, v57, s77
    v_perm_b32 v173, v69, v65, s77
    v_perm_b32 v174, v77, v73, s77
    v_perm_b32 v175, v85, v81, s77
    v_perm_b32 v176, v62, v58, s76
    v_perm_b32 v177, v70, v66, s76
    v_perm_b32 v178, v78, v74, s76
    v_perm_b32 v179, v86, v82, s76
    v_perm_b32 v180, v62, v58, s77
    v_perm_b32 v181, v70, v66, s77
    v_perm_b32 v182, v78, v74, s77
    v_perm_b32 v183, v86, v82, s77
    v_perm_b32 v184, v63, v59, s76
    v_perm_b32 v185, v71, v67, s76
    v_perm_b32 v186, v79, v75, s76
    v_perm_b32 v187, v87, v83, s76
    v_perm_b32 v188, v63, v59, s77
    v_perm_b32 v189, v71, v67, s77
    v_perm_b32 v190, v79, v75, s77
    v_perm_b32 v191, v87, v83, s77
    s_add_u32 s79, s78, 4096
    buffer_load_dwordx4 v[24:27], v8, s[44:47], s79 offen
    s_add_u32 s79, s78, 5120
    buffer_load_dwordx4 v[28:31], v8, s[44:47], s79 offen
    s_add_u32 s79, s78, 12288
    buffer_load_dwordx4 v[32:35], v8, s[44:47], s79 offen
    s_add_u32 s79, s78, 13312
    buffer_load_dwordx4 v[36:39], v8, s[44:47], s79 offen
    s_add_u32 s79, s78, 20480
    buffer_load_dwordx4 v[40:43], v8, s[44:47], s79 offen
    s_add_u32 s79, s78, 21504
    buffer_load_dwordx4 v[44:47], v8, s[44:47], s79 offen
    s_add_u32 s79, s78, 28672
    buffer_load_dwordx4 v[48:51], v8, s[44:47], s79 offen
    s_add_u32 s79, s78, 29696
    buffer_load_dwordx4 v[52:55], v8, s[44:47], s79 offen
    s_add_u32 s79, s78, 6144
    buffer_load_dwordx4 v[56:59], v8, s[44:47], s79 offen
    s_add_u32 s79, s78, 7168
    buffer_load_dwordx4 v[60:63], v8, s[44:47], s79 offen
    s_add_u32 s79, s78, 14336
    buffer_load_dwordx4 v[64:67], v8, s[44:47], s79 offen
    s_add_u32 s79, s78, 15360
    buffer_load_dwordx4 v[68:71], v8, s[44:47], s79 offen
    s_add_u32 s79, s78, 22528
    buffer_load_dwordx4 v[72:75], v8, s[44:47], s79 offen
    s_add_u32 s79, s78, 23552
    buffer_load_dwordx4 v[76:79], v8, s[44:47], s79 offen
    s_add_u32 s79, s78, 30720
    buffer_load_dwordx4 v[80:83], v8, s[44:47], s79 offen
    s_add_u32 s79, s78, 31744
    buffer_load_dwordx4 v[84:87], v8, s[44:47], s79 offen
    s_waitcnt vmcnt(8)
    v_perm_b32 v192, v28, v24, s76
    v_perm_b32 v193, v36, v32, s76
    v_perm_b32 v194, v44, v40, s76
    v_perm_b32 v195, v52, v48, s76
    v_perm_b32 v196, v28, v24, s77
    v_perm_b32 v197, v36, v32, s77
    v_perm_b32 v198, v44, v40, s77
    v_perm_b32 v199, v52, v48, s77
    v_perm_b32 v200, v29, v25, s76
    v_perm_b32 v201, v37, v33, s76
    v_perm_b32 v202, v45, v41, s76
    v_perm_b32 v203, v53, v49, s76
    v_perm_b32 v204, v29, v25, s77
    v_perm_b32 v205, v37, v33, s77
    v_perm_b32 v206, v45, v41, s77
    v_perm_b32 v207, v53, v49, s77
    v_perm_b32 v208, v30, v26, s76
    v_perm_b32 v209, v38, v34, s76
    v_perm_b32 v210, v46, v42, s76
    v_perm_b32 v211, v54, v50, s76
    v_perm_b32 v212, v30, v26, s77
    v_perm_b32 v213, v38, v34, s77
    v_perm_b32 v214, v46, v42, s77
    v_perm_b32 v215, v54, v50, s77
    v_perm_b32 v216, v31, v27, s76
    v_perm_b32 v217, v39, v35, s76
    v_perm_b32 v218, v47, v43, s76
    v_perm_b32 v219, v55, v51, s76
    v_perm_b32 v220, v31, v27, s77
    v_perm_b32 v221, v39, v35, s77
    v_perm_b32 v222, v47, v43, s77
    v_perm_b32 v223, v55, v51, s77
    s_waitcnt vmcnt(0)
    v_perm_b32 v224, v60, v56, s76
    v_perm_b32 v225, v68, v64, s76
    v_perm_b32 v226, v76, v72, s76
    v_perm_b32 v227, v84, v80, s76
    v_perm_b32 v228, v60, v56, s77
    v_perm_b32 v229, v68, v64, s77
    v_perm_b32 v230, v76, v72, s77
    v_perm_b32 v231, v84, v80, s77
    v_perm_b32 v232, v61, v57, s76
    v_perm_b32 v233, v69, v65, s76
    v_perm_b32 v234, v77, v73, s76
    v_perm_b32 v235, v85, v81, s76
    v_perm_b32 v236, v61, v57, s77
    v_perm_b32 v237, v69, v65, s77
    v_perm_b32 v238, v77, v73, s77
    v_perm_b32 v239, v85, v81, s77
    v_perm_b32 v240, v62, v58, s76
    v_perm_b32 v241, v70, v66, s76
    v_perm_b32 v242, v78, v74, s76
    v_perm_b32 v243, v86, v82, s76
    v_perm_b32 v244, v62, v58, s77
    v_perm_b32 v245, v70, v66, s77
    v_perm_b32 v246, v78, v74, s77
    v_perm_b32 v247, v86, v82, s77
    v_perm_b32 v248, v63, v59, s76
    v_perm_b32 v249, v71, v67, s76
    v_perm_b32 v250, v79, v75, s76
    v_perm_b32 v251, v87, v83, s76
    v_perm_b32 v252, v63, v59, s77
    v_perm_b32 v253, v71, v67, s77
    v_perm_b32 v254, v79, v75, s77
    v_perm_b32 v255, v87, v83, s77
    s_mov_b32 s44, s28
    s_mov_b32 s45, s29
    s_mov_b32 s46, 0x200000
    s_mov_b32 s47, 0x20000
    s_mov_b32 s48, s26
    s_mov_b32 s49, s27
    s_mov_b32 s50, 0x400
    s_mov_b32 s51, 0x20000
    s_lshr_b32 s78, s52, 2
    s_lshl_b32 s78, s78, 2
    s_add_u32 s78, s78, s34
    s_lshl_b32 s78, s78, 10
    s_and_b32 s79, s52, 3
    s_lshl_b32 s57, s79, 8
    s_add_u32 s57, s57, s78
    s_lshr_b32 s78, s52, 3
    s_lshl_b32 s58, s78, 8
    s_lshl_b32 s79, s79, 6
    s_add_u32 s58, s58, s79
    s_lshl_b32 s79, s34, 4
    s_add_u32 s58, s58, s79
    v_lshlrev_b32 v11, 4, v7
    v_lshl_add_u32 v9, v6, 15, v11
    v_lshl_add_u32 v10, v6, 21, v11
    v_lshlrev_b32 v11, 10, v7
    v_lshl_add_u32 v12, v6, 3, v11
    v_mov_b32 v13, 0x80000000
    v_cmp_eq_u32 vcc, 0, v6
    s_nop 1
    v_cndmask_b32 v11, v13, v11, vcc
    v_cndmask_b32 v8, v13, 0, vcc
    v_cmp_gt_u32 vcc, 2, v6
    s_nop 1
    v_cndmask_b32 v12, v13, v12, vcc
    s_lshl_b32 s78, s55, 4
    v_lshlrev_b32 v13, 2, v6
    v_sub_u32 v13, v7, v13
    v_add_u32 v13, s78, v13
    v_mov_b32 v16, 0
    v_mov_b32 v14, 0x3f80
    v_cmp_eq_u32 vcc, 0, v7
    s_nop 1
    v_cndmask_b32 v16, v16, v14, vcc
    v_mov_b32 v14, 0x3f800000
    v_cmp_eq_u32 vcc, 1, v7
    s_nop 1
    v_cndmask_b32 v16, v16, v14, vcc
    v_mov_b32 v20, 0x3f803f80
    v_mov_b32 v17, 0
    v_mov_b32 v14, 0x3f80
    v_cmp_eq_u32 vcc, 2, v7
    s_nop 1
    v_cndmask_b32 v17, v17, v14, vcc
    v_mov_b32 v14, 0x3f800000
    v_cmp_eq_u32 vcc, 3, v7
    s_nop 1
    v_cndmask_b32 v17, v17, v14, vcc
    v_mov_b32 v21, 0x3f803f80
    v_mov_b32 v18, 0
    v_mov_b32 v14, 0x3f80
    v_cmp_eq_u32 vcc, 4, v7
    s_nop 1
    v_cndmask_b32 v18, v18, v14, vcc
    v_mov_b32 v14, 0x3f800000
    v_cmp_eq_u32 vcc, 5, v7
    s_nop 1
    v_cndmask_b32 v18, v18, v14, vcc
    v_mov_b32 v22, 0x3f803f80
    v_mov_b32 v19, 0
    v_mov_b32 v14, 0x3f80
    v_cmp_eq_u32 vcc, 6, v7
    s_nop 1
    v_cndmask_b32 v19, v19, v14, vcc
    v_mov_b32 v14, 0x3f800000
    v_cmp_eq_u32 vcc, 7, v7
    s_nop 1
    v_cndmask_b32 v19, v19, v14, vcc
    v_mov_b32 v23, 0x3f803f80
    v_lshrrev_b32 v14, 2, v7
    v_lshlrev_b32 v14, 7, v14
    v_lshl_add_u32 v14, v6, 5, v14
    v_and_b32 v15, 3, v7
    v_lshl_add_u32 v14, v15, 2, v14
    v_bfe_u32 v15, v7, 2, 1
    v_lshlrev_b32 v15, 6, v15
    v_xor_b32 v14, v14, v15
    v_and_b32 v15, 2, v7
    v_mov_b32 v6, 0x4444
    v_mov_b32 v7, 0xeeee
    v_cmp_eq_u32 vcc, 0, v15
    s_nop 1
    v_cndmask_b32 v6, v7, v6, vcc
    s_lshl_b32 s78, s34, 9
    s_add_u32 s78, s78, 16384
    v_add_u32 v7, s78, v14
    s_lshl_b32 s78, s34, 11
    s_add_u32 m0, s78, 8192
    s_mov_b32 s59, 0x7f817f81
    s_mov_b32 s60, 0x7f800000
    s_mov_b32 s61, 0
    s_mov_b32 s62, 0x80000000
    s_lshl_b32 s65, s53, 21
    s_add_u32 s65, s65, 0x6000000
    s_waitcnt lgkmcnt(0)
    s_barrier
L_g3:
    s_lshl_b32 s54, s53, 5
    s_add_u32 s54, s54, s52
    s_lshr_b32 s78, s53, 2
L_g3_rdy:
    s_bitcmp1_b32 s61, s78
    s_cbranch_scc1 L_g3_rdyok
    s_mov_b32 s79, 0x40000
    v_lshlrev_b32 v14, 2, v1
    buffer_load_dword v14, v14, s[36:39], s79 offen sc1
    s_waitcnt vmcnt(0)
    v_cmp_le_u32 vcc, 24, v14
    s_lshr_b32 s61, vcc_lo, 16
    v_cmp_le_u32 vcc, 32, v14
    s_and_b32 s61, s61, vcc_lo
    s_sub_u32 s100, s100, 1
    s_mov_b32 s101, 4
    s_cbranch_scc1 L_fail
    s_sleep 16
    s_branch L_g3_rdy
L_g3_rdyok:
    s_mul_i32 s86, s52, 0x4000
    s_lshl_b32 s80, s53, 19
    s_add_u32 s86, s86, s80
    s_mov_b32 s80, s86
    s_lshl_b32 s81, s55, 12
    s_lshr_b32 s82, s80, 1
    s_add_u32 s81, s81, s82
    s_add_u32 s81, s81, 0x3000000
    buffer_load_dwordx4 v[24:27], v1, s[36:39], s81 offen offset:0 sc1
    buffer_load_dwordx4 v[28:31], v1, s[36:39], s81 offen offset:1024 sc1
    buffer_load_dwordx4 v[32:35], v1, s[36:39], s81 offen offset:2048 sc1
    buffer_load_dwordx4 v[36:39], v1, s[36:39], s81 offen offset:3072 sc1
    s_add_u32 s81, s80, 0x1000000
    s_add_u32 s82, s80, 0x1001000
    buffer_load_dwordx4 v[40:43], v0, s[36:39], s81 offen offset:0 sc1
    buffer_load_dwordx4 v[44:47], v0, s[36:39], s81 offen offset:1024 sc1
    buffer_load_dwordx4 v[48:51], v0, s[36:39], s81 offen offset:2048 sc1
    buffer_load_dwordx4 v[52:55], v0, s[36:39], s81 offen offset:3072 sc1
    buffer_load_dwordx4 v[56:59], v0, s[36:39], s82 offen offset:0 sc1
    buffer_load_dwordx4 v[60:63], v0, s[36:39], s82 offen offset:1024 sc1
    buffer_load_dwordx4 v[64:67], v0, s[36:39], s82 offen offset:2048 sc1
    buffer_load_dwordx4 v[68:71], v0, s[36:39], s82 offen offset:3072 sc1
    s_lshl_b32 s81, s56, 12
    s_add_u32 s81, s81, s80
    s_add_u32 s81, s81, 0x1002000
    buffer_load_dwordx4 v[72:75], v1, s[36:39], s81 offen offset:0 sc1
    buffer_load_dwordx4 v[76:79], v1, s[36:39], s81 offen offset:1024 sc1
    buffer_load_dwordx4 v[80:83], v1, s[36:39], s81 offen offset:2048 sc1
    buffer_load_dwordx4 v[84:87], v1, s[36:39], s81 offen offset:3072 sc1
    s_bfe_u32 s84, s52, 0x10002
    s_lshl_b32 s83, s53, 1
    s_add_u32 s83, s83, s84
    s_lshl_b32 s83, s83, 14
    s_lshr_b32 s84, s52, 3
    s_lshl_b32 s84, s84, 2
    s_add_u32 s84, s84, s34
    s_lshl_b32 s84, s84, 10
    s_and_b32 s85, s52, 3
    s_lshl_b32 s85, s85, 8
    s_add_u32 s85, s85, s84
    s_add_u32 s85, s85, s83
    s_add_u32 s85, s85, 0x5800000
    s_add_u32 s83, s83, s58
    buffer_load_dwordx4 v[88:91], v11, s[40:43], s83 offen
    buffer_load_dwordx4 v[92:95], v8, s[48:51], s58 offen
    buffer_load_dwordx4 v[96:99], v10, s[36:39], s85 offen sc1
    s_cmp_eq_u32 s62, 0x80000000
    s_cbranch_scc1 L_g3_first
L_rp7:
    v_lshrrev_b32 v14, 2, v1
    buffer_load_dword v14, v14, s[36:39], s62 offen sc1
    s_waitcnt vmcnt(0)
    v_cmp_eq_u32 vcc, 1, v14
    s_cmp_eq_u32 vcc_lo, -1
    s_cbranch_scc1 L_rp7_ok
    s_sub_u32 s100, s100, 1
    s_mov_b32 s101, 7
    s_cbranch_scc1 L_fail
    s_branch L_rp7
L_rp7_ok:
    buffer_load_dwordx4 v[100:103], v9, s[36:39], s64 offen sc1
    s_add_u32 s64, s64, 0x20000
    buffer_load_dwordx4 v[104:107], v9, s[36:39], s64 offen sc1
    s_add_u32 s64, s64, 0x20000
    buffer_load_dwordx4 v[108:111], v9, s[36:39], s64 offen sc1
    s_add_u32 s64, s64, 0x20000
    buffer_load_dwordx4 v[112:115], v9, s[36:39], s64 offen sc1
    s_add_u32 s64, s64, 0x20000
    s_waitcnt vmcnt(3)
    v_mfma_f32_16x16x32_bf16 v[2:5], v[16:19], v[100:103], v[2:5]
    s_waitcnt vmcnt(2)
    v_mfma_f32_16x16x32_bf16 v[2:5], v[16:19], v[104:107], v[2:5]
    s_waitcnt vmcnt(1)
    v_mfma_f32_16x16x32_bf16 v[2:5], v[16:19], v[108:111], v[2:5]
    s_waitcnt vmcnt(0)
    v_mfma_f32_16x16x32_bf16 v[2:5], v[16:19], v[112:115], v[2:5]
    buffer_load_dwordx4 v[100:103], v9, s[36:39], s64 offen sc1
    s_add_u32 s64, s64, 0x20000
    buffer_load_dwordx4 v[104:107], v9, s[36:39], s64 offen sc1
    s_add_u32 s64, s64, 0x20000
    buffer_load_dwordx4 v[108:111], v9, s[36:39], s64 offen sc1
    s_add_u32 s64, s64, 0x20000
    buffer_load_dwordx4 v[112:115], v9, s[36:39], s64 offen sc1
    s_add_u32 s64, s64, 0x20000
    s_waitcnt vmcnt(3)
    v_mfma_f32_16x16x32_bf16 v[2:5], v[16:19], v[100:103], v[2:5]
    s_waitcnt vmcnt(2)
    v_mfma_f32_16x16x32_bf16 v[2:5], v[16:19], v[104:107], v[2:5]
    s_waitcnt vmcnt(1)
    v_mfma_f32_16x16x32_bf16 v[2:5], v[16:19], v[108:111], v[2:5]
    s_waitcnt vmcnt(0)
    v_mfma_f32_16x16x32_bf16 v[2:5], v[16:19], v[112:115], v[2:5]
    s_nop 7
    v_cvt_pk_bf16_f32 v14, v2, v3
    v_cvt_pk_bf16_f32 v15, v4, v5
    buffer_store_dwordx2 v[14:15], v12, s[44:47], s63 offen
L_g3_first:
    s_waitcnt vmcnt(7)
    v_mfma_f32_16x16x32_bf16 v[108:111], v[40:43], v[24:27], 0
    v_mfma_f32_16x16x32_bf16 v[108:111], v[44:47], v[28:31], v[108:111]
    v_mfma_f32_16x16x32_bf16 v[108:111], v[48:51], v[32:35], v[108:111]
    v_mfma_f32_16x16x32_bf16 v[108:111], v[52:55], v[36:39], v[108:111]
    v_mfma_f32_16x16x32_bf16 v[112:115], v[56:59], v[24:27], 0
    v_mfma_f32_16x16x32_bf16 v[112:115], v[60:63], v[28:31], v[112:115]
    v_mfma_f32_16x16x32_bf16 v[112:115], v[64:67], v[32:35], v[112:115]
    v_mfma_f32_16x16x32_bf16 v[112:115], v[68:71], v[36:39], v[112:115]
    s_waitcnt vmcnt(0)
    v_mfma_f32_16x16x32_bf16 v[2:5], v[16:19], v[88:91], 0
    v_mfma_f32_16x16x32_bf16 v[2:5], v[16:19], v[92:95], v[2:5]
    v_mfma_f32_16x16x32_bf16 v[2:5], v[16:19], v[96:99], v[2:5]
    v_mov_b32 v15, 0xff61b1e6
    v_cmp_le_i32 vcc, 0, v13
    s_nop 1
    v_cndmask_b32 v108, v15, v108, vcc
    v_cmp_le_i32 vcc, 1, v13
    s_nop 1
    v_cndmask_b32 v109, v15, v109, vcc
    v_cmp_le_i32 vcc, 2, v13
    s_nop 1
    v_cndmask_b32 v110, v15, v110, vcc
    v_cmp_le_i32 vcc, 3, v13
    s_nop 1
    v_cndmask_b32 v111, v15, v111, vcc
    v_cmp_le_i32 vcc, 16, v13
    s_nop 1
    v_cndmask_b32 v112, v15, v112, vcc
    v_cmp_le_i32 vcc, 17, v13
    s_nop 1
    v_cndmask_b32 v113, v15, v113, vcc
    v_cmp_le_i32 vcc, 18, v13
    s_nop 1
    v_cndmask_b32 v114, v15, v114, vcc
    v_cmp_le_i32 vcc, 19, v13
    s_nop 1
    v_cndmask_b32 v115, v15, v115, vcc
    v_max3_f32 v124, v108, v109, v110
    v_max3_f32 v125, v111, v112, v113
    v_max3_f32 v124, v124, v114, v115
    v_max_f32 v124, v124, v125
    v_mov_b64 v[88:89], 0
    v_mov_b64 v[90:91], 0
    v_mov_b64 v[92:93], 0
    v_mov_b64 v[94:95], 0
    v_mov_b64 v[96:97], 0
    v_mov_b64 v[98:99], 0
    v_mov_b64 v[100:101], 0
    v_mov_b64 v[102:103], 0
    s_lshl_b32 s80, s53, 13
    s_add_u32 s80, s80, 0x400000
    s_sub_u32 s79, s80, 8192
    s_cmp_eq_u32 s53, 0
    s_cbranch_scc1 L_g3_m
    s_cmp_eq_u32 s34, 0
    s_cbranch_scc0 L_g3_prb
L_g3_pre:
    buffer_load_dword v14, off, s[36:39], s79 sc1
    s_waitcnt vmcnt(0)
    v_cmp_eq_u32 vcc, s59, v14
    s_cbranch_vccz L_g3_prb
    s_sub_u32 s100, s100, 1
    s_mov_b32 s101, 6
    s_cbranch_scc1 L_fail
    s_sleep 12
    s_branch L_g3_pre
L_g3_prb:
    s_barrier
L_g3_m:
    s_lshl_b32 s79, s34, 11
    s_add_u32 s79, s79, s80
L_g3_mp:
    buffer_load_dwordx4 v1, s[36:39], s79 offen sc1 lds
    buffer_load_dwordx4 v1, s[36:39], s79 offen offset:1024 sc1 lds
    s_waitcnt vmcnt(0)
    s_barrier
    ds_read_b128 v[40:43], v1 offset:8192
    ds_read_b128 v[44:47], v1 offset:9216
    ds_read_b128 v[48:51], v1 offset:10240
    ds_read_b128 v[52:55], v1 offset:11264
    ds_read_b128 v[56:59], v1 offset:12288
    ds_read_b128 v[60:63], v1 offset:13312
    ds_read_b128 v[64:67], v1 offset:14336
    ds_read_b128 v[68:71], v1 offset:15360
    s_waitcnt lgkmcnt(0)
    v_max3_i32 v14, v40, v41, v42
    v_max3_i32 v14, v14, v43, v44
    v_max3_i32 v14, v14, v45, v46
    v_max3_i32 v14, v14, v47, v48
    v_max3_i32 v14, v14, v49, v50
    v_max3_i32 v14, v14, v51, v52
    v_max3_i32 v14, v14, v53, v54
    v_max3_i32 v14, v14, v55, v56
    v_max3_i32 v14, v14, v57, v58
    v_max3_i32 v14, v14, v59, v60
    v_max3_i32 v14, v14, v61, v62
    v_max3_i32 v14, v14, v63, v64
    v_max3_i32 v14, v14, v65, v66
    v_max3_i32 v14, v14, v67, v68
    v_max3_i32 v14, v14, v69, v70
    v_max_i32 v14, v14, v71
    v_cmp_le_i32 vcc, s60, v14
    s_cbranch_vccnz L_g3_mslow
L_g3_mok:
    v_smfmac_f32_16x16x64_bf16 v[88:91], v[40:43], a[0:7], v6
    v_smfmac_f32_16x16x64_bf16 v[88:91], v[44:47], a[8:15], v6
    v_smfmac_f32_16x16x64_bf16 v[88:91], v[48:51], a[16:23], v6
    v_smfmac_f32_16x16x64_bf16 v[88:91], v[52:55], a[24:31], v6
    v_smfmac_f32_16x16x64_bf16 v[88:91], v[56:59], a[32:39], v6
    v_smfmac_f32_16x16x64_bf16 v[88:91], v[60:63], a[40:47], v6
    v_smfmac_f32_16x16x64_bf16 v[88:91], v[64:67], a[48:55], v6
    v_smfmac_f32_16x16x64_bf16 v[88:91], v[68:71], a[56:63], v6
    v_smfmac_f32_16x16x64_bf16 v[92:95], v[40:43], a[64:71], v6
    v_smfmac_f32_16x16x64_bf16 v[92:95], v[44:47], a[72:79], v6
    v_smfmac_f32_16x16x64_bf16 v[92:95], v[48:51], a[80:87], v6
    v_smfmac_f32_16x16x64_bf16 v[92:95], v[52:55], a[88:95], v6
    v_smfmac_f32_16x16x64_bf16 v[92:95], v[56:59], a[96:103], v6
    v_smfmac_f32_16x16x64_bf16 v[92:95], v[60:63], a[104:111], v6
    v_smfmac_f32_16x16x64_bf16 v[92:95], v[64:67], a[112:119], v6
    v_smfmac_f32_16x16x64_bf16 v[92:95], v[68:71], a[120:127], v6
    v_smfmac_f32_16x16x64_bf16 v[96:99], v[40:43], a[128:135], v6
    v_smfmac_f32_16x16x64_bf16 v[96:99], v[44:47], a[136:143], v6
    v_smfmac_f32_16x16x64_bf16 v[96:99], v[48:51], a[144:151], v6
    v_smfmac_f32_16x16x64_bf16 v[96:99], v[52:55], a[152:159], v6
    v_add_f32 v88, v88, v90
    v_add_f32 v89, v89, v91
    v_add_f32 v92, v92, v94
    v_add_f32 v93, v93, v95
    v_cvt_pk_bf16_f32 v88, v88, v92
    v_cvt_pk_bf16_f32 v89, v89, v93
    ds_write2_b32 v7, v88, v89 offset0:0 offset1:4
    v_smfmac_f32_16x16x64_bf16 v[96:99], v[56:59], a[160:167], v6
    v_smfmac_f32_16x16x64_bf16 v[96:99], v[60:63], a[168:175], v6
    v_smfmac_f32_16x16x64_bf16 v[96:99], v[64:67], a[176:183], v6
    v_smfmac_f32_16x16x64_bf16 v[96:99], v[68:71], a[184:191], v6
    v_smfmac_f32_16x16x64_bf16 v[100:103], v[40:43], a[192:199], v6
    v_smfmac_f32_16x16x64_bf16 v[100:103], v[44:47], a[200:207], v6
    v_smfmac_f32_16x16x64_bf16 v[100:103], v[48:51], a[208:215], v6
    v_smfmac_f32_16x16x64_bf16 v[100:103], v[52:55], a[216:223], v6
    v_smfmac_f32_16x16x64_bf16 v[100:103], v[56:59], a[224:231], v6
    v_smfmac_f32_16x16x64_bf16 v[100:103], v[60:63], a[232:239], v6
    v_smfmac_f32_16x16x64_bf16 v[100:103], v[64:67], a[240:247], v6
    v_smfmac_f32_16x16x64_bf16 v[100:103], v[68:71], a[248:255], v6
    s_lshl_b32 s78, s34, 9
    v_lshrrev_b32 v15, 1, v1
    v_add_u32 v14, s78, v15
    v_add_f32 v96, v96, v98
    v_add_f32 v97, v97, v99
    s_nop 2
    v_add_f32 v100, v100, v102
    v_add_f32 v101, v101, v103
    v_cvt_pk_bf16_f32 v96, v96, v97
    v_cvt_pk_bf16_f32 v97, v100, v101
    ds_write_b64 v14, v[96:97] offset:18432
    s_lshl_b32 s78, s56, 10
    v_add_u32 v15, s78, v15
    v_and_b32 v14, 0x1ff, v0
    s_waitcnt lgkmcnt(0)
    s_barrier
    ds_read_b128 v[88:91], v14 offset:16384
    ds_read_b128 v[92:95], v14 offset:16896
    ds_read_b128 v[96:99], v14 offset:17408
    ds_read_b128 v[100:103], v14 offset:17920
    ds_read_b64 v[104:105], v15 offset:18432
    ds_read_b64 v[106:107], v15 offset:18944
    s_waitcnt lgkmcnt(5)
    v_mfma_f32_16x16x32_bf16 v[116:119], v[88:91], v[24:27], 0
    s_waitcnt lgkmcnt(4)
    v_mfma_f32_16x16x32_bf16 v[116:119], v[92:95], v[28:31], v[116:119]
    s_waitcnt lgkmcnt(3)
    v_mfma_f32_16x16x32_bf16 v[116:119], v[96:99], v[32:35], v[116:119]
    s_waitcnt lgkmcnt(2)
    v_mfma_f32_16x16x32_bf16 v[116:119], v[100:103], v[36:39], v[116:119]
    v_mov_b32 v45, 0
    v_mov_b32 v46, 0
    s_nop 4
    v_max3_f32 v124, v124, v116, v117
    v_mov_b32 v125, v124
    s_nop 1
    v_permlane32_swap_b32 v124, v125
    v_max_f32 v124, v124, v125
    v_mov_b32 v125, v124
    s_nop 1
    v_permlane16_swap_b32 v124, v125
    v_max_f32 v124, v124, v125
    v_sub_f32 v108, v108, v124
    v_sub_f32 v109, v109, v124
    v_sub_f32 v110, v110, v124
    v_sub_f32 v111, v111, v124
    v_sub_f32 v112, v112, v124
    v_sub_f32 v113, v113, v124
    v_sub_f32 v114, v114, v124
    v_sub_f32 v115, v115, v124
    v_sub_f32 v116, v116, v124
    v_sub_f32 v117, v117, v124
    v_exp_f32 v108, v108
    v_exp_f32 v109, v109
    v_exp_f32 v110, v110
    v_exp_f32 v111, v111
    v_exp_f32 v112, v112
    v_exp_f32 v113, v113
    v_exp_f32 v114, v114
    v_exp_f32 v115, v115
    v_exp_f32 v116, v116
    v_exp_f32 v117, v117
    v_cvt_pk_bf16_f32 v40, v108, v109
    v_cvt_pk_bf16_f32 v41, v110, v111
    v_cvt_pk_bf16_f32 v42, v112, v113
    v_cvt_pk_bf16_f32 v43, v114, v115
    v_cvt_pk_bf16_f32 v44, v116, v117
    v_cvt_pk_bf16_f32 v47, v116, v117
    s_waitcnt lgkmcnt(0)
    v_mfma_f32_16x16x32_bf16 v[120:123], v[20:23], v[40:43], 0
    v_mfma_f32_16x16x32_bf16 v[48:51], v[72:75], v[40:43], 0
    v_mfma_f32_16x16x32_bf16 v[52:55], v[76:79], v[40:43], 0
    v_mfma_f32_16x16x32_bf16 v[56:59], v[80:83], v[40:43], 0
    v_mfma_f32_16x16x32_bf16 v[60:63], v[84:87], v[40:43], 0
    v_mfma_f32_16x16x16_bf16 v[120:123], v[20:21], v[44:45], v[120:123]
    v_mfma_f32_16x16x16_bf16 v[48:51], v[104:105], v[44:45], v[48:51]
    v_mfma_f32_16x16x16_bf16 v[52:55], v[104:105], v[46:47], v[52:55]
    v_mfma_f32_16x16x16_bf16 v[56:59], v[106:107], v[44:45], v[56:59]
    v_mfma_f32_16x16x16_bf16 v[60:63], v[106:107], v[46:47], v[60:63]
    v_rcp_f32 v124, v120
    s_nop 0
    v_mul_f32 v48, v48, v124
    v_mul_f32 v49, v49, v124
    v_mul_f32 v50, v50, v124
    v_mul_f32 v51, v51, v124
    v_mul_f32 v52, v52, v124
    v_mul_f32 v53, v53, v124
    v_mul_f32 v54, v54, v124
    v_mul_f32 v55, v55, v124
    v_mul_f32 v56, v56, v124
    v_mul_f32 v57, v57, v124
    v_mul_f32 v58, v58, v124
    v_mul_f32 v59, v59, v124
    v_mul_f32 v60, v60, v124
    v_mul_f32 v61, v61, v124
    v_mul_f32 v62, v62, v124
    v_mul_f32 v63, v63, v124
    s_lshl_b32 s78, s55, 12
    s_lshl_b32 s79, s56, 11
    s_add_u32 s78, s78, s79
    v_add_u32 v14, s78, v1
    v_cvt_pk_bf16_f32 v64, v48, v52
    v_cvt_pk_bf16_f32 v65, v49, v53
    v_cvt_pk_bf16_f32 v66, v50, v54
    v_cvt_pk_bf16_f32 v67, v51, v55
    ds_write_b128 v14, v[64:67] offset:0
    v_cvt_pk_bf16_f32 v68, v56, v60
    v_cvt_pk_bf16_f32 v69, v57, v61
    v_cvt_pk_bf16_f32 v70, v58, v62
    v_cvt_pk_bf16_f32 v71, v59, v63
    ds_write_b128 v14, v[68:71] offset:1024
    s_waitcnt lgkmcnt(0)
    s_barrier
    ds_read_b128 v[24:27], v1 offset:0
    ds_read_b128 v[28:31], v1 offset:1024
    ds_read_b128 v[32:35], v1 offset:2048
    ds_read_b128 v[36:39], v1 offset:3072
    ds_read_b128 v[40:43], v1 offset:4096
    ds_read_b128 v[44:47], v1 offset:5120
    ds_read_b128 v[48:51], v1 offset:6144
    ds_read_b128 v[52:55], v1 offset:7168
    s_lshl_b32 s80, s52, 15
    s_lshl_b32 s81, s34, 13
    s_add_u32 s80, s80, s81
    s_add_u32 s80, s80, s65
    s_add_u32 s81, s80, 4096
    s_waitcnt lgkmcnt(7)
    v_mfma_f32_16x16x32_bf16 v[56:59], v[128:131], v[24:27], 0
    v_mfma_f32_16x16x32_bf16 v[60:63], v[132:135], v[24:27], 0
    v_mfma_f32_16x16x32_bf16 v[64:67], v[136:139], v[24:27], 0
    v_mfma_f32_16x16x32_bf16 v[68:71], v[140:143], v[24:27], 0
    v_mfma_f32_16x16x32_bf16 v[72:75], v[144:147], v[24:27], 0
    v_mfma_f32_16x16x32_bf16 v[76:79], v[148:151], v[24:27], 0
    v_mfma_f32_16x16x32_bf16 v[80:83], v[152:155], v[24:27], 0
    v_mfma_f32_16x16x32_bf16 v[84:87], v[156:159], v[24:27], 0
    s_waitcnt lgkmcnt(6)
    v_mfma_f32_16x16x32_bf16 v[56:59], v[160:163], v[28:31], v[56:59]
    v_mfma_f32_16x16x32_bf16 v[60:63], v[164:167], v[28:31], v[60:63]
    v_mfma_f32_16x16x32_bf16 v[64:67], v[168:171], v[28:31], v[64:67]
    v_mfma_f32_16x16x32_bf16 v[68:71], v[172:175], v[28:31], v[68:71]
    v_mfma_f32_16x16x32_bf16 v[72:75], v[176:179], v[28:31], v[72:75]
    v_mfma_f32_16x16x32_bf16 v[76:79], v[180:183], v[28:31], v[76:79]
    v_mfma_f32_16x16x32_bf16 v[80:83], v[184:187], v[28:31], v[80:83]
    v_mfma_f32_16x16x32_bf16 v[84:87], v[188:191], v[28:31], v[84:87]
    s_waitcnt lgkmcnt(5)
    v_mfma_f32_16x16x32_bf16 v[56:59], v[192:195], v[32:35], v[56:59]
    v_mfma_f32_16x16x32_bf16 v[60:63], v[196:199], v[32:35], v[60:63]
    v_mfma_f32_16x16x32_bf16 v[64:67], v[200:203], v[32:35], v[64:67]
    v_mfma_f32_16x16x32_bf16 v[68:71], v[204:207], v[32:35], v[68:71]
    v_mfma_f32_16x16x32_bf16 v[72:75], v[208:211], v[32:35], v[72:75]
    v_mfma_f32_16x16x32_bf16 v[76:79], v[212:215], v[32:35], v[76:79]
    v_mfma_f32_16x16x32_bf16 v[80:83], v[216:219], v[32:35], v[80:83]
    v_mfma_f32_16x16x32_bf16 v[84:87], v[220:223], v[32:35], v[84:87]
    s_waitcnt lgkmcnt(4)
    v_mfma_f32_16x16x32_bf16 v[56:59], v[224:227], v[36:39], v[56:59]
    v_mfma_f32_16x16x32_bf16 v[60:63], v[228:231], v[36:39], v[60:63]
    v_mfma_f32_16x16x32_bf16 v[64:67], v[232:235], v[36:39], v[64:67]
    v_mfma_f32_16x16x32_bf16 v[68:71], v[236:239], v[36:39], v[68:71]
    v_mfma_f32_16x16x32_bf16 v[72:75], v[240:243], v[36:39], v[72:75]
    v_mfma_f32_16x16x32_bf16 v[76:79], v[244:247], v[36:39], v[76:79]
    v_mfma_f32_16x16x32_bf16 v[80:83], v[248:251], v[36:39], v[80:83]
    v_mfma_f32_16x16x32_bf16 v[84:87], v[252:255], v[36:39], v[84:87]
    s_waitcnt lgkmcnt(3)
    v_mfma_f32_16x16x32_bf16 v[88:91], v[128:131], v[40:43], 0
    v_mfma_f32_16x16x32_bf16 v[92:95], v[132:135], v[40:43], 0
    v_mfma_f32_16x16x32_bf16 v[96:99], v[136:139], v[40:43], 0
    v_mfma_f32_16x16x32_bf16 v[100:103], v[140:143], v[40:43], 0
    v_mfma_f32_16x16x32_bf16 v[104:107], v[144:147], v[40:43], 0
    v_mfma_f32_16x16x32_bf16 v[108:111], v[148:151], v[40:43], 0
    v_mfma_f32_16x16x32_bf16 v[112:115], v[152:155], v[40:43], 0
    v_mfma_f32_16x16x32_bf16 v[116:119], v[156:159], v[40:43], 0
    s_waitcnt lgkmcnt(2)
    v_mfma_f32_16x16x32_bf16 v[88:91], v[160:163], v[44:47], v[88:91]
    v_mfma_f32_16x16x32_bf16 v[92:95], v[164:167], v[44:47], v[92:95]
    v_mfma_f32_16x16x32_bf16 v[96:99], v[168:171], v[44:47], v[96:99]
    v_mfma_f32_16x16x32_bf16 v[100:103], v[172:175], v[44:47], v[100:103]
    v_mfma_f32_16x16x32_bf16 v[104:107], v[176:179], v[44:47], v[104:107]
    v_mfma_f32_16x16x32_bf16 v[108:111], v[180:183], v[44:47], v[108:111]
    v_mfma_f32_16x16x32_bf16 v[112:115], v[184:187], v[44:47], v[112:115]
    v_mfma_f32_16x16x32_bf16 v[116:119], v[188:191], v[44:47], v[116:119]
    s_waitcnt lgkmcnt(1)
    v_mfma_f32_16x16x32_bf16 v[88:91], v[192:195], v[48:51], v[88:91]
    v_mfma_f32_16x16x32_bf16 v[92:95], v[196:199], v[48:51], v[92:95]
    v_mfma_f32_16x16x32_bf16 v[96:99], v[200:203], v[48:51], v[96:99]
    v_mfma_f32_16x16x32_bf16 v[100:103], v[204:207], v[48:51], v[100:103]
    v_mfma_f32_16x16x32_bf16 v[104:107], v[208:211], v[48:51], v[104:107]
    v_mfma_f32_16x16x32_bf16 v[108:111], v[212:215], v[48:51], v[108:111]
    v_mfma_f32_16x16x32_bf16 v[112:115], v[216:219], v[48:51], v[112:115]
    v_mfma_f32_16x16x32_bf16 v[116:119], v[220:223], v[48:51], v[116:119]
    s_waitcnt lgkmcnt(0)
    v_mfma_f32_16x16x32_bf16 v[88:91], v[224:227], v[52:55], v[88:91]
    v_mfma_f32_16x16x32_bf16 v[92:95], v[228:231], v[52:55], v[92:95]
    v_mfma_f32_16x16x32_bf16 v[96:99], v[232:235], v[52:55], v[96:99]
    v_mfma_f32_16x16x32_bf16 v[100:103], v[236:239], v[52:55], v[100:103]
    v_mfma_f32_16x16x32_bf16 v[104:107], v[240:243], v[52:55], v[104:107]
    v_mfma_f32_16x16x32_bf16 v[108:111], v[244:247], v[52:55], v[108:111]
    v_mfma_f32_16x16x32_bf16 v[112:115], v[248:251], v[52:55], v[112:115]
    v_mfma_f32_16x16x32_bf16 v[116:119], v[252:255], v[52:55], v[116:119]
    s_lshl_b32 s62, s53, 7
    s_add_u32 s62, s62, 0x42000
    s_lshl_b32 s78, s52, 2
    s_add_u32 s78, s78, s62
    s_cmp_eq_u32 s34, 0
    s_cselect_b32 s78, s78, 0x80000000
    s_mov_b32 s63, s83
    s_add_u32 s64, s65, s57
    s_xor_b32 s65, s65, 0x100000
    s_cmp_eq_u32 s18, 0
    s_cbranch_scc0 L_g3_stx
    v_cvt_pk_bf16_f32 v120, v56, v60
    v_cvt_pk_bf16_f32 v121, v64, v68
    v_cvt_pk_bf16_f32 v122, v72, v76
    v_cvt_pk_bf16_f32 v123, v80, v84
    buffer_store_dwordx4 v[120:123], v1, s[36:39], s80 offen offset:0
    v_cvt_pk_bf16_f32 v124, v57, v61
    v_cvt_pk_bf16_f32 v125, v65, v69
    v_cvt_pk_bf16_f32 v126, v73, v77
    v_cvt_pk_bf16_f32 v127, v81, v85
    buffer_store_dwordx4 v[124:127], v1, s[36:39], s80 offen offset:1024
    v_cvt_pk_bf16_f32 v120, v58, v62
    v_cvt_pk_bf16_f32 v121, v66, v70
    v_cvt_pk_bf16_f32 v122, v74, v78
    v_cvt_pk_bf16_f32 v123, v82, v86
    buffer_store_dwordx4 v[120:123], v1, s[36:39], s80 offen offset:2048
    v_cvt_pk_bf16_f32 v124, v59, v63
    v_cvt_pk_bf16_f32 v125, v67, v71
    v_cvt_pk_bf16_f32 v126, v75, v79
    v_cvt_pk_bf16_f32 v127, v83, v87
    buffer_store_dwordx4 v[124:127], v1, s[36:39], s80 offen offset:3072
    v_cvt_pk_bf16_f32 v120, v88, v92
    v_cvt_pk_bf16_f32 v121, v96, v100
    v_cvt_pk_bf16_f32 v122, v104, v108
    v_cvt_pk_bf16_f32 v123, v112, v116
    buffer_store_dwordx4 v[120:123], v1, s[36:39], s81 offen offset:0
    v_cvt_pk_bf16_f32 v124, v89, v93
    v_cvt_pk_bf16_f32 v125, v97, v101
    v_cvt_pk_bf16_f32 v126, v105, v109
    v_cvt_pk_bf16_f32 v127, v113, v117
    buffer_store_dwordx4 v[124:127], v1, s[36:39], s81 offen offset:1024
    v_cvt_pk_bf16_f32 v120, v90, v94
    v_cvt_pk_bf16_f32 v121, v98, v102
    v_cvt_pk_bf16_f32 v122, v106, v110
    v_cvt_pk_bf16_f32 v123, v114, v118
    buffer_store_dwordx4 v[120:123], v1, s[36:39], s81 offen offset:2048
    v_cvt_pk_bf16_f32 v124, v91, v95
    v_cvt_pk_bf16_f32 v125, v99, v103
    v_cvt_pk_bf16_f32 v126, v107, v111
    v_cvt_pk_bf16_f32 v127, v115, v119
    buffer_store_dwordx4 v[124:127], v1, s[36:39], s81 offen offset:3072
    v_mov_b32 v14, 1
    s_waitcnt vmcnt(0)
    s_barrier
    buffer_store_dword v14, off, s[36:39], s78
    s_branch L_g3_ste
L_g3_stx:
    v_cvt_pk_bf16_f32 v120, v56, v60
    v_cvt_pk_bf16_f32 v121, v64, v68
    v_cvt_pk_bf16_f32 v122, v72, v76
    v_cvt_pk_bf16_f32 v123, v80, v84
    buffer_store_dwordx4 v[120:123], v1, s[36:39], s80 offen offset:0 sc1
    v_cvt_pk_bf16_f32 v124, v57, v61
    v_cvt_pk_bf16_f32 v125, v65, v69
    v_cvt_pk_bf16_f32 v126, v73, v77
    v_cvt_pk_bf16_f32 v127, v81, v85
    buffer_store_dwordx4 v[124:127], v1, s[36:39], s80 offen offset:1024 sc1
    v_cvt_pk_bf16_f32 v120, v58, v62
    v_cvt_pk_bf16_f32 v121, v66, v70
    v_cvt_pk_bf16_f32 v122, v74, v78
    v_cvt_pk_bf16_f32 v123, v82, v86
    buffer_store_dwordx4 v[120:123], v1, s[36:39], s80 offen offset:2048 sc1
    v_cvt_pk_bf16_f32 v124, v59, v63
    v_cvt_pk_bf16_f32 v125, v67, v71
    v_cvt_pk_bf16_f32 v126, v75, v79
    v_cvt_pk_bf16_f32 v127, v83, v87
    buffer_store_dwordx4 v[124:127], v1, s[36:39], s80 offen offset:3072 sc1
    v_cvt_pk_bf16_f32 v120, v88, v92
    v_cvt_pk_bf16_f32 v121, v96, v100
    v_cvt_pk_bf16_f32 v122, v104, v108
    v_cvt_pk_bf16_f32 v123, v112, v116
    buffer_store_dwordx4 v[120:123], v1, s[36:39], s81 offen offset:0 sc1
    v_cvt_pk_bf16_f32 v124, v89, v93
    v_cvt_pk_bf16_f32 v125, v97, v101
    v_cvt_pk_bf16_f32 v126, v105, v109
    v_cvt_pk_bf16_f32 v127, v113, v117
    buffer_store_dwordx4 v[124:127], v1, s[36:39], s81 offen offset:1024 sc1
    v_cvt_pk_bf16_f32 v120, v90, v94
    v_cvt_pk_bf16_f32 v121, v98, v102
    v_cvt_pk_bf16_f32 v122, v106, v110
    v_cvt_pk_bf16_f32 v123, v114, v118
    buffer_store_dwordx4 v[120:123], v1, s[36:39], s81 offen offset:2048 sc1
    v_cvt_pk_bf16_f32 v124, v91, v95
    v_cvt_pk_bf16_f32 v125, v99, v103
    v_cvt_pk_bf16_f32 v126, v107, v111
    v_cvt_pk_bf16_f32 v127, v115, v119
    buffer_store_dwordx4 v[124:127], v1, s[36:39], s81 offen offset:3072 sc1
    v_mov_b32 v14, 1
    s_waitcnt vmcnt(0)
    s_barrier
    buffer_store_dword v14, off, s[36:39], s78 sc1
L_g3_ste:
    s_add_u32 s53, s53, 7
    s_cmp_lt_u32 s53, 64
    s_cbranch_scc1 L_g3
L_rp17:
    v_lshrrev_b32 v14, 2, v1
    buffer_load_dword v14, v14, s[36:39], s62 offen sc1
    s_waitcnt vmcnt(0)
    v_cmp_eq_u32 vcc, 1, v14
    s_cmp_eq_u32 vcc_lo, -1
    s_cbranch_scc1 L_rp17_ok
    s_sub_u32 s100, s100, 1
    s_mov_b32 s101, 17
    s_cbranch_scc1 L_fail
    s_branch L_rp17
L_rp17_ok:
    buffer_load_dwordx4 v[100:103], v9, s[36:39], s64 offen sc1
    s_add_u32 s64, s64, 0x20000
    buffer_load_dwordx4 v[104:107], v9, s[36:39], s64 offen sc1
    s_add_u32 s64, s64, 0x20000
    buffer_load_dwordx4 v[108:111], v9, s[36:39], s64 offen sc1
    s_add_u32 s64, s64, 0x20000
    buffer_load_dwordx4 v[112:115], v9, s[36:39], s64 offen sc1
    s_add_u32 s64, s64, 0x20000
    s_waitcnt vmcnt(3)
    v_mfma_f32_16x16x32_bf16 v[2:5], v[16:19], v[100:103], v[2:5]
    s_waitcnt vmcnt(2)
    v_mfma_f32_16x16x32_bf16 v[2:5], v[16:19], v[104:107], v[2:5]
    s_waitcnt vmcnt(1)
    v_mfma_f32_16x16x32_bf16 v[2:5], v[16:19], v[108:111], v[2:5]
    s_waitcnt vmcnt(0)
    v_mfma_f32_16x16x32_bf16 v[2:5], v[16:19], v[112:115], v[2:5]
    buffer_load_dwordx4 v[100:103], v9, s[36:39], s64 offen sc1
    s_add_u32 s64, s64, 0x20000
    buffer_load_dwordx4 v[104:107], v9, s[36:39], s64 offen sc1
    s_add_u32 s64, s64, 0x20000
    buffer_load_dwordx4 v[108:111], v9, s[36:39], s64 offen sc1
    s_add_u32 s64, s64, 0x20000
    buffer_load_dwordx4 v[112:115], v9, s[36:39], s64 offen sc1
    s_add_u32 s64, s64, 0x20000
    s_waitcnt vmcnt(3)
    v_mfma_f32_16x16x32_bf16 v[2:5], v[16:19], v[100:103], v[2:5]
    s_waitcnt vmcnt(2)
    v_mfma_f32_16x16x32_bf16 v[2:5], v[16:19], v[104:107], v[2:5]
    s_waitcnt vmcnt(1)
    v_mfma_f32_16x16x32_bf16 v[2:5], v[16:19], v[108:111], v[2:5]
    s_waitcnt vmcnt(0)
    v_mfma_f32_16x16x32_bf16 v[2:5], v[16:19], v[112:115], v[2:5]
    s_nop 7
    v_cvt_pk_bf16_f32 v14, v2, v3
    v_cvt_pk_bf16_f32 v15, v4, v5
    buffer_store_dwordx2 v[14:15], v12, s[44:47], s63 offen
    s_waitcnt vmcnt(0)
    s_branch L_end
L_g3_mslow:
    v_cmp_eq_u32 vcc, s59, v40
    s_cbranch_vccnz L_g3_mre
    v_cmp_eq_u32 vcc, s59, v41
    s_cbranch_vccnz L_g3_mre
    v_cmp_eq_u32 vcc, s59, v42
    s_cbranch_vccnz L_g3_mre
    v_cmp_eq_u32 vcc, s59, v43
    s_cbranch_vccnz L_g3_mre
    v_cmp_eq_u32 vcc, s59, v44
    s_cbranch_vccnz L_g3_mre
    v_cmp_eq_u32 vcc, s59, v45
    s_cbranch_vccnz L_g3_mre
    v_cmp_eq_u32 vcc, s59, v46
    s_cbranch_vccnz L_g3_mre
    v_cmp_eq_u32 vcc, s59, v47
    s_cbranch_vccnz L_g3_mre
    v_cmp_eq_u32 vcc, s59, v48
    s_cbranch_vccnz L_g3_mre
    v_cmp_eq_u32 vcc, s59, v49
    s_cbranch_vccnz L_g3_mre
    v_cmp_eq_u32 vcc, s59, v50
    s_cbranch_vccnz L_g3_mre
    v_cmp_eq_u32 vcc, s59, v51
    s_cbranch_vccnz L_g3_mre
    v_cmp_eq_u32 vcc, s59, v52
    s_cbranch_vccnz L_g3_mre
    v_cmp_eq_u32 vcc, s59, v53
    s_cbranch_vccnz L_g3_mre
    v_cmp_eq_u32 vcc, s59, v54
    s_cbranch_vccnz L_g3_mre
    v_cmp_eq_u32 vcc, s59, v55
    s_cbranch_vccnz L_g3_mre
    v_cmp_eq_u32 vcc, s59, v56
    s_cbranch_vccnz L_g3_mre
    v_cmp_eq_u32 vcc, s59, v57
    s_cbranch_vccnz L_g3_mre
    v_cmp_eq_u32 vcc, s59, v58
    s_cbranch_vccnz L_g3_mre
    v_cmp_eq_u32 vcc, s59, v59
    s_cbranch_vccnz L_g3_mre
    v_cmp_eq_u32 vcc, s59, v60
    s_cbranch_vccnz L_g3_mre
    v_cmp_eq_u32 vcc, s59, v61
    s_cbranch_vccnz L_g3_mre
    v_cmp_eq_u32 vcc, s59, v62
    s_cbranch_vccnz L_g3_mre
    v_cmp_eq_u32 vcc, s59, v63
    s_cbranch_vccnz L_g3_mre
    v_cmp_eq_u32 vcc, s59, v64
    s_cbranch_vccnz L_g3_mre
    v_cmp_eq_u32 vcc, s59, v65
    s_cbranch_vccnz L_g3_mre
    v_cmp_eq_u32 vcc, s59, v66
    s_cbranch_vccnz L_g3_mre
    v_cmp_eq_u32 vcc, s59, v67
    s_cbranch_vccnz L_g3_mre
    v_cmp_eq_u32 vcc, s59, v68
    s_cbranch_vccnz L_g3_mre
    v_cmp_eq_u32 vcc, s59, v69
    s_cbranch_vccnz L_g3_mre
    v_cmp_eq_u32 vcc, s59, v70
    s_cbranch_vccnz L_g3_mre
    v_cmp_eq_u32 vcc, s59, v71
    s_cbranch_vccnz L_g3_mre
    s_branch L_g3_mok
L_g3_mre:
    s_sub_u32 s100, s100, 1
    s_mov_b32 s101, 9
    s_cbranch_scc1 L_fail
    s_sleep 0
    s_barrier
    s_branch L_g3_mp
L_chain0:
    v_lshrrev_b32 v1, 4, v0
    v_and_b32 v2, 15, v0
    v_lshlrev_b32 v140, 4, v0
    s_lshl_b32 s80, s34, 11
    v_add_u32 v18, s80, v140
    s_lshl_b32 s80, s34, 9
    v_lshlrev_b32 v132, 3, v0
    v_add_u32 v132, s80, v132
    s_mul_i32 s80, s34, 36864
    s_add_u32 s80, s80, 16384
    v_add_u32 v134, s80, v140
    v_mov_b32 v131, 0x4444
    v_mov_b32 v3, 0xeeee
    v_and_b32 v4, 2, v2
    v_cmp_eq_u32 vcc, 0, v4
    s_nop 1
    v_cndmask_b32 v131, v3, v131, vcc
    s_lshl_b32 s76, s34, 10
    v_lshrrev_b32 v3, 2, v2
    v_lshlrev_b32 v3, 7, v3
    v_lshl_add_u32 v3, v1, 5, v3
    v_and_b32 v4, 3, v2
    v_lshl_add_u32 v3, v4, 2, v3
    v_bfe_u32 v4, v2, 2, 1
    v_lshlrev_b32 v4, 6, v4
    v_xor_b32 v3, v3, v4
    v_add_u32 v3, s76, v3
    v_add_u32 v135, 8192, v3
    v_and_b32 v4, 7, v2
    v_lshlrev_b32 v4, 4, v4
    v_lshl_add_u32 v136, v1, 7, v4
    v_lshrrev_b32 v3, 2, v2
    v_and_b32 v4, 1, v2
    v_lshl_add_u32 v3, v3, 1, v4
    v_lshlrev_b32 v3, 4, v3
    v_lshl_add_u32 v137, v1, 7, v3
    v_and_b32 v4, 1, v1
    v_lshlrev_b32 v4, 6, v4
    v_xor_b32 v136, v136, v4
    v_xor_b32 v137, v137, v4
    v_lshrrev_b32 v5, 3, v2
    v_lshl_add_u32 v138, v5, 9, v136
    v_lshl_add_u32 v139, v5, 3, v136
    s_lshl_b32 s80, s34, 11
    s_lshl_b32 s81, s35, 6
    s_add_u32 s80, s80, s81
    v_mul_u32_u24 v3, 8320, v1
    v_lshl_add_u32 v3, v2, 2, v3
    v_add_u32 v141, s80, v3
    s_lshr_b32 s82, s35, 3
    s_bfe_u32 s83, s35, 0x20001
    s_and_b32 s84, s35, 1
    s_lshl_b32 s80, s82, 9
    s_lshl_b32 s81, s84, 8
    s_add_u32 s80, s80, s81
    s_lshl_b32 s81, s83, 6
    s_add_u32 s80, s80, s81
    v_and_b32 v3, 1, v2
    v_lshrrev_b32 v4, 1, v2
    v_lshrrev_b32 v6, 3, v2
    v_lshl_add_u32 v6, v6, 1, v3
    v_lshlrev_b32 v6, 4, v6
    v_and_b32 v8, 3, v4
    v_lshl_add_u32 v6, v8, 2, v6
    v_add_u32 v6, s80, v6
    v_mov_b32 v7, 0x80000000
    v_cmp_eq_u32 vcc, 0, v1
    s_nop 1
    v_cndmask_b32 v142, v7, v6, vcc
    v_lshlrev_b32 v6, 10, v3
    v_lshl_add_u32 v6, v4, 4, v6
    s_lshl_b32 s80, s83, 11
    s_lshl_b32 s81, s82, 8
    s_add_u32 s80, s80, s81
    s_lshl_b32 s81, s84, 7
    s_add_u32 s80, s80, s81
    s_lshl_b32 s81, s34, 2
    s_add_u32 s80, s80, s81
    s_mov_b32 s40, s6
    s_mov_b32 s41, s7
    s_mov_b32 s42, 0x2000
    s_mov_b32 s43, 0x20000
    buffer_load_dword v9, v6, s[40:43], s80 offen
    v_mov_b32 v143, 0
    v_mov_b32 v3, 0x3f80
    v_cmp_eq_u32 vcc, 0, v2
    s_nop 1
    v_cndmask_b32 v143, v143, v3, vcc
    v_mov_b32 v3, 0x3f800000
    v_cmp_eq_u32 vcc, 1, v2
    s_nop 1
    v_cndmask_b32 v143, v143, v3, vcc
    s_mov_b32 s44, 0
    s_lshl_b32 s45, s34, 11
    s_add_u32 s45, s45, 0
    s_add_u32 s46, s45, 8192
    s_add_u32 s47, s45, 16384
    s_mul_i32 s48, s35, 8320
    s_add_u32 s48, s48, 0x100000
    s_add_u32 s79, s48, 0x42000
    s_add_u32 s49, s79, 0x42000
    s_mov_b32 s57, 0x100000
    s_mov_b32 s58, 0x108200
    s_mov_b32 s59, 0x110400
    s_mov_b32 s60, 0x118600
    s_mov_b32 s61, 0x120800
    s_mov_b32 s62, 0x128a00
    s_mov_b32 s63, 0x130c00
    s_mov_b32 s64, 0x138e00
    s_mul_i32 s80, s35, 0x4000
    s_lshr_b32 s81, s34, 1
    s_lshl_b32 s81, s81, 12
    s_add_u32 s50, s80, s81
    s_and_b32 s81, s34, 1
    s_lshl_b32 s81, s81, 9
    s_add_u32 s50, s50, s81
    s_add_u32 s50, s50, 0x1000000
    s_lshl_b32 s81, s34, 11
    s_add_u32 s51, s80, s81
    s_add_u32 s51, s51, 0x1002000
    s_lshl_b32 s81, s34, 12
    s_add_u32 s52, s80, s81
    s_add_u32 s52, s52, 0x1000000
    s_add_u32 s53, s45, 0x400000
    s_lshl_b32 s65, s34, 7
    s_add_u32 s65, s65, 0x8000
    s_lshl_b32 s90, s35, 2
    s_add_u32 s90, s90, s65
    s_mov_b32 s66, 0x7f817f81
    s_mov_b32 s67, 0x7f817f81
    s_mov_b32 s68, 0x3f803f80
    s_mov_b32 s69, 0x3f803f80
    s_mov_b32 s70, 0x00ff00ff
    s_mov_b32 s71, 0x00ff00ff
    s_mov_b32 s72, 0x3e0293ee
    s_mov_b32 s73, 0x7f800000
    s_mov_b32 s74, 0x21800000
    s_mov_b32 s75, 0x3c000000
    s_mov_b32 s77, 0x05040100
    s_mov_b32 s78, 0x07060302
    v_lshlrev_b32 v3, 4, v2
    v_lshrrev_b32 v4, 1, v1
    v_lshl_add_u32 v3, v4, 19, v3
    v_and_b32 v4, 1, v1
    v_lshl_add_u32 v3, v4, 17, v3
    s_lshl_b32 s80, s34, 14
    s_lshl_b32 s81, s35, 8
    s_add_u32 s80, s80, s81
    v_add_u32 v10, s80, v3
    s_lshl_b32 s80, s34, 12
    s_add_u32 s80, s80, 0
    v_add_u32 v11, s80, v140
    s_lshl_b32 s88, s34, 3
    v_lshrrev_b32 v3, 1, v1
    v_lshlrev_b32 v3, 5, v3
    v_and_b32 v4, 1, v1
    v_add_u32 v3, v3, v4
    v_lshlrev_b32 v3, 10, v3
    v_lshl_add_u32 v3, v2, 4, v3
    s_lshl_b32 s80, s35, 17
    s_lshl_b32 s81, s34, 8
    s_add_u32 s80, s80, s81
    v_add_u32 v17, s80, v3
    s_mov_b32 s40, s12
    s_mov_b32 s41, s13
    s_mov_b32 s42, 0x400000
    s_mov_b32 s43, 0x20000
    s_mov_b32 s80, 0x0
    buffer_load_dwordx4 v[20:23], v10, s[40:43], s80 offen
    s_mov_b32 s80, 0x2000
    buffer_load_dwordx4 v[24:27], v10, s[40:43], s80 offen
    s_mov_b32 s80, 0x40000
    buffer_load_dwordx4 v[28:31], v10, s[40:43], s80 offen
    s_mov_b32 s80, 0x42000
    buffer_load_dwordx4 v[32:35], v10, s[40:43], s80 offen
    s_mov_b32 s80, 0x10000
    buffer_load_dwordx4 v[36:39], v10, s[40:43], s80 offen
    s_mov_b32 s80, 0x12000
    buffer_load_dwordx4 v[40:43], v10, s[40:43], s80 offen
    s_mov_b32 s80, 0x50000
    buffer_load_dwordx4 v[44:47], v10, s[40:43], s80 offen
    s_mov_b32 s80, 0x52000
    buffer_load_dwordx4 v[48:51], v10, s[40:43], s80 offen
    s_mov_b32 s80, 0x100000
    buffer_load_dwordx4 v[52:55], v10, s[40:43], s80 offen
    s_mov_b32 s80, 0x102000
    buffer_load_dwordx4 v[56:59], v10, s[40:43], s80 offen
    s_mov_b32 s80, 0x140000
    buffer_load_dwordx4 v[60:63], v10, s[40:43], s80 offen
    s_mov_b32 s80, 0x142000
    buffer_load_dwordx4 v[64:67], v10, s[40:43], s80 offen
    s_mov_b32 s80, 0x110000
    buffer_load_dwordx4 v[68:71], v10, s[40:43], s80 offen
    s_mov_b32 s80, 0x112000
    buffer_load_dwordx4 v[72:75], v10, s[40:43], s80 offen
    s_mov_b32 s80, 0x150000
    buffer_load_dwordx4 v[76:79], v10, s[40:43], s80 offen
    s_mov_b32 s80, 0x152000
    buffer_load_dwordx4 v[80:83], v10, s[40:43], s80 offen
    s_mov_b32 s40, s12
    s_mov_b32 s41, s13
    s_mov_b32 s42, 0x400000
    s_mov_b32 s43, 0x20000
    s_mov_b32 s80, 0x200000
    buffer_load_dwordx4 v[144:147], v10, s[40:43], s80 offen
    s_mov_b32 s80, 0x202000
    buffer_load_dwordx4 v[148:151], v10, s[40:43], s80 offen
    s_mov_b32 s80, 0x240000
    buffer_load_dwordx4 v[152:155], v10, s[40:43], s80 offen
    s_mov_b32 s80, 0x242000
    buffer_load_dwordx4 v[156:159], v10, s[40:43], s80 offen
    s_mov_b32 s80, 0x210000
    buffer_load_dwordx4 v[160:163], v10, s[40:43], s80 offen
    s_mov_b32 s80, 0x212000
    buffer_load_dwordx4 v[164:167], v10, s[40:43], s80 offen
    s_mov_b32 s80, 0x250000
    buffer_load_dwordx4 v[168:171], v10, s[40:43], s80 offen
    s_mov_b32 s80, 0x252000
    buffer_load_dwordx4 v[172:175], v10, s[40:43], s80 offen
    s_mov_b32 s80, 0x300000
    buffer_load_dwordx4 v[176:179], v10, s[40:43], s80 offen
    s_mov_b32 s80, 0x302000
    buffer_load_dwordx4 v[180:183], v10, s[40:43], s80 offen
    s_mov_b32 s80, 0x340000
    buffer_load_dwordx4 v[184:187], v10, s[40:43], s80 offen
    s_mov_b32 s80, 0x342000
    buffer_load_dwordx4 v[188:191], v10, s[40:43], s80 offen
    s_mov_b32 s80, 0x310000
    buffer_load_dwordx4 v[192:195], v10, s[40:43], s80 offen
    s_mov_b32 s80, 0x312000
    buffer_load_dwordx4 v[196:199], v10, s[40:43], s80 offen
    s_mov_b32 s80, 0x350000
    buffer_load_dwordx4 v[200:203], v10, s[40:43], s80 offen
    s_mov_b32 s80, 0x352000
    buffer_load_dwordx4 v[204:207], v10, s[40:43], s80 offen
    s_waitcnt vmcnt(16)
    s_lshr_b32 s80, 0x1900010e, s88
    s_and_b32 s80, s80, 0xff
    s_lshl_b32 s80, s80, 11
    v_add_u32 v16, s80, v140
    v_perm_b32 v84, v24, v20, s77
    v_perm_b32 v85, v32, v28, s77
    v_perm_b32 v86, v40, v36, s77
    v_perm_b32 v87, v48, v44, s77
    ds_write_b128 v16, v[84:87] offset:0
    v_perm_b32 v88, v56, v52, s77
    v_perm_b32 v89, v64, v60, s77
    v_perm_b32 v90, v72, v68, s77
    v_perm_b32 v91, v80, v76, s77
    ds_write_b128 v16, v[88:91] offset:1024
    s_lshr_b32 s80, 0x15161718, s88
    s_and_b32 s80, s80, 0xff
    s_lshl_b32 s80, s80, 11
    v_add_u32 v16, s80, v140
    v_perm_b32 v92, v24, v20, s78
    v_perm_b32 v93, v32, v28, s78
    v_perm_b32 v94, v40, v36, s78
    v_perm_b32 v95, v48, v44, s78
    ds_write_b128 v16, v[92:95] offset:0
    v_perm_b32 v84, v56, v52, s78
    v_perm_b32 v85, v64, v60, s78
    v_perm_b32 v86, v72, v68, s78
    v_perm_b32 v87, v80, v76, s78
    ds_write_b128 v16, v[84:87] offset:1024
    s_lshr_b32 s80, 0x2b020320, s88
    s_and_b32 s80, s80, 0xff
    s_lshl_b32 s80, s80, 11
    v_add_u32 v16, s80, v140
    v_perm_b32 v88, v25, v21, s77
    v_perm_b32 v89, v33, v29, s77
    v_perm_b32 v90, v41, v37, s77
    v_perm_b32 v91, v49, v45, s77
    ds_write_b128 v16, v[88:91] offset:0
    v_perm_b32 v92, v57, v53, s77
    v_perm_b32 v93, v65, v61, s77
    v_perm_b32 v94, v73, v69, s77
    v_perm_b32 v95, v81, v77, s77
    ds_write_b128 v16, v[92:95] offset:1024
    s_lshr_b32 s80, 0x2728292a, s88
    s_and_b32 s80, s80, 0xff
    s_lshl_b32 s80, s80, 11
    v_add_u32 v16, s80, v140
    v_perm_b32 v84, v25, v21, s78
    v_perm_b32 v85, v33, v29, s78
    v_perm_b32 v86, v41, v37, s78
    v_perm_b32 v87, v49, v45, s78
    ds_write_b128 v16, v[84:87] offset:0
    v_perm_b32 v88, v57, v53, s78
    v_perm_b32 v89, v65, v61, s78
    v_perm_b32 v90, v73, v69, s78
    v_perm_b32 v91, v81, v77, s78
    ds_write_b128 v16, v[88:91] offset:1024
    s_lshr_b32 s80, 0x3d040532, s88
    s_and_b32 s80, s80, 0xff
    s_lshl_b32 s80, s80, 11
    v_add_u32 v16, s80, v140
    v_perm_b32 v92, v26, v22, s77
    v_perm_b32 v93, v34, v30, s77
    v_perm_b32 v94, v42, v38, s77
    v_perm_b32 v95, v50, v46, s77
    ds_write_b128 v16, v[92:95] offset:0
    v_perm_b32 v84, v58, v54, s77
    v_perm_b32 v85, v66, v62, s77
    v_perm_b32 v86, v74, v70, s77
    v_perm_b32 v87, v82, v78, s77
    ds_write_b128 v16, v[84:87] offset:1024
    s_lshr_b32 s80, 0x393a3b3c, s88
    s_and_b32 s80, s80, 0xff
    s_lshl_b32 s80, s80, 11
    v_add_u32 v16, s80, v140
    v_perm_b32 v88, v26, v22, s78
    v_perm_b32 v89, v34, v30, s78
    v_perm_b32 v90, v42, v38, s78
    v_perm_b32 v91, v50, v46, s78
    ds_write_b128 v16, v[88:91] offset:0
    v_perm_b32 v92, v58, v54, s78
    v_perm_b32 v93, v66, v62, s78
    v_perm_b32 v94, v74, v70, s78
    v_perm_b32 v95, v82, v78, s78
    ds_write_b128 v16, v[92:95] offset:1024
    s_lshr_b32 s80, 0x4f060744, s88
    s_and_b32 s80, s80, 0xff
    s_lshl_b32 s80, s80, 11
    v_add_u32 v16, s80, v140
    v_perm_b32 v84, v27, v23, s77
    v_perm_b32 v85, v35, v31, s77
    v_perm_b32 v86, v43, v39, s77
    v_perm_b32 v87, v51, v47, s77
    ds_write_b128 v16, v[84:87] offset:0
    v_perm_b32 v88, v59, v55, s77
    v_perm_b32 v89, v67, v63, s77
    v_perm_b32 v90, v75, v71, s77
    v_perm_b32 v91, v83, v79, s77
    ds_write_b128 v16, v[88:91] offset:1024
    s_lshr_b32 s80, 0x4b4c4d4e, s88
    s_and_b32 s80, s80, 0xff
    s_lshl_b32 s80, s80, 11
    v_add_u32 v16, s80, v140
    v_perm_b32 v92, v27, v23, s78
    v_perm_b32 v93, v35, v31, s78
    v_perm_b32 v94, v43, v39, s78
    v_perm_b32 v95, v51, v47, s78
    ds_write_b128 v16, v[92:95] offset:0
    v_perm_b32 v84, v59, v55, s78
    v_perm_b32 v85, v67, v63, s78
    v_perm_b32 v86, v75, v71, s78
    v_perm_b32 v87, v83, v79, s78
    ds_write_b128 v16, v[84:87] offset:1024
    s_waitcnt lgkmcnt(0)
    s_barrier
    ds_read_b128 a[176:179], v11 offset:2048
    ds_read_b128 a[180:183], v11 offset:3072
    ds_read_b128 a[192:195], v11 offset:0
    ds_read_b128 a[196:199], v11 offset:1024
    ds_read_b128 a[208:211], v134 offset:34816
    ds_read_b128 a[212:215], v134 offset:35840
    ds_read_b128 a[224:227], v134 offset:32768
    ds_read_b128 a[228:231], v134 offset:33792
    ds_read_b128 a[240:243], v134 offset:30720
    ds_read_b128 a[244:247], v134 offset:31744
    ds_read_b128 v[224:227], v134 offset:28672
    ds_read_b128 v[228:231], v134 offset:29696
    s_waitcnt lgkmcnt(4)
    ds_read_b128 v[240:243], v134 offset:26624
    ds_read_b128 v[244:247], v134 offset:27648
    s_mov_b32 s40, s8
    s_mov_b32 s41, s9
    s_mov_b32 s42, 0x400000
    s_mov_b32 s43, 0x20000
    s_mov_b32 s80, 0x200000
    buffer_load_dwordx4 v[20:23], v10, s[40:43], s80 offen
    s_mov_b32 s80, 0x202000
    buffer_load_dwordx4 v[24:27], v10, s[40:43], s80 offen
    s_mov_b32 s80, 0x240000
    buffer_load_dwordx4 v[28:31], v10, s[40:43], s80 offen
    s_mov_b32 s80, 0x242000
    buffer_load_dwordx4 v[32:35], v10, s[40:43], s80 offen
    s_mov_b32 s80, 0x210000
    buffer_load_dwordx4 v[36:39], v10, s[40:43], s80 offen
    s_mov_b32 s80, 0x212000
    buffer_load_dwordx4 v[40:43], v10, s[40:43], s80 offen
    s_mov_b32 s80, 0x250000
    buffer_load_dwordx4 v[44:47], v10, s[40:43], s80 offen
    s_mov_b32 s80, 0x252000
    buffer_load_dwordx4 v[48:51], v10, s[40:43], s80 offen
    s_mov_b32 s80, 0x300000
    buffer_load_dwordx4 v[52:55], v10, s[40:43], s80 offen
    s_mov_b32 s80, 0x302000
    buffer_load_dwordx4 v[56:59], v10, s[40:43], s80 offen
    s_mov_b32 s80, 0x340000
    buffer_load_dwordx4 v[60:63], v10, s[40:43], s80 offen
    s_mov_b32 s80, 0x342000
    buffer_load_dwordx4 v[64:67], v10, s[40:43], s80 offen
    s_mov_b32 s80, 0x310000
    buffer_load_dwordx4 v[68:71], v10, s[40:43], s80 offen
    s_mov_b32 s80, 0x312000
    buffer_load_dwordx4 v[72:75], v10, s[40:43], s80 offen
    s_mov_b32 s80, 0x350000
    buffer_load_dwordx4 v[76:79], v10, s[40:43], s80 offen
    s_mov_b32 s80, 0x352000
    buffer_load_dwordx4 v[80:83], v10, s[40:43], s80 offen
    s_waitcnt vmcnt(16)
    s_waitcnt lgkmcnt(0)
    s_barrier
    s_or_b32 s96, s19, s34
    s_or_b32 s96, s96, s17
    s_cmp_eq_u32 s96, 0
    s_cbranch_scc0 L_rp40x
    s_mov_b64 exec, 1
    s_lshl_b32 s96, s16, 2
    v_mov_b32 v6, s96
    v_mov_b32 v7, 1
    global_atomic_add v6, v7, s[30:31]
    s_mov_b64 exec, -1
L_rp40x:
    s_lshr_b32 s80, 0x18190001, s88
    s_and_b32 s80, s80, 0xff
    s_lshl_b32 s80, s80, 11
    v_add_u32 v16, s80, v140
    v_perm_b32 v88, v148, v144, s77
    v_perm_b32 v89, v156, v152, s77
    v_perm_b32 v90, v164, v160, s77
    v_perm_b32 v91, v172, v168, s77
    ds_write_b128 v16, v[88:91] offset:0
    v_perm_b32 v92, v180, v176, s77
    v_perm_b32 v93, v188, v184, s77
    v_perm_b32 v94, v196, v192, s77
    v_perm_b32 v95, v204, v200, s77
    ds_write_b128 v16, v[92:95] offset:1024
    s_lshr_b32 s80, 0x14151617, s88
    s_and_b32 s80, s80, 0xff
    s_lshl_b32 s80, s80, 11
    v_add_u32 v16, s80, v140
    v_perm_b32 v84, v148, v144, s78
    v_perm_b32 v85, v156, v152, s78
    v_perm_b32 v86, v164, v160, s78
    v_perm_b32 v87, v172, v168, s78
    ds_write_b128 v16, v[84:87] offset:0
    v_perm_b32 v88, v180, v176, s78
    v_perm_b32 v89, v188, v184, s78
    v_perm_b32 v90, v196, v192, s78
    v_perm_b32 v91, v204, v200, s78
    ds_write_b128 v16, v[88:91] offset:1024
    s_lshr_b32 s80, 0x2a2b0203, s88
    s_and_b32 s80, s80, 0xff
    s_lshl_b32 s80, s80, 11
    v_add_u32 v16, s80, v140
    v_perm_b32 v92, v149, v145, s77
    v_perm_b32 v93, v157, v153, s77
    v_perm_b32 v94, v165, v161, s77
    v_perm_b32 v95, v173, v169, s77
    ds_write_b128 v16, v[92:95] offset:0
    v_perm_b32 v84, v181, v177, s77
    v_perm_b32 v85, v189, v185, s77
    v_perm_b32 v86, v197, v193, s77
    v_perm_b32 v87, v205, v201, s77
    ds_write_b128 v16, v[84:87] offset:1024
    s_lshr_b32 s80, 0x26272829, s88
    s_and_b32 s80, s80, 0xff
    s_lshl_b32 s80, s80, 11
    v_add_u32 v16, s80, v140
    v_perm_b32 v88, v149, v145, s78
    v_perm_b32 v89, v157, v153, s78
    v_perm_b32 v90, v165, v161, s78
    v_perm_b32 v91, v173, v169, s78
    ds_write_b128 v16, v[88:91] offset:0
    v_perm_b32 v92, v181, v177, s78
    v_perm_b32 v93, v189, v185, s78
    v_perm_b32 v94, v197, v193, s78
    v_perm_b32 v95, v205, v201, s78
    ds_write_b128 v16, v[92:95] offset:1024
    s_lshr_b32 s80, 0x3c3d0405, s88
    s_and_b32 s80, s80, 0xff
    s_lshl_b32 s80, s80, 11
    v_add_u32 v16, s80, v140
    v_perm_b32 v84, v150, v146, s77
    v_perm_b32 v85, v158, v154, s77
    v_perm_b32 v86, v166, v162, s77
    v_perm_b32 v87, v174, v170, s77
    ds_write_b128 v16, v[84:87] offset:0
    v_perm_b32 v88, v182, v178, s77
    v_perm_b32 v89, v190, v186, s77
    v_perm_b32 v90, v198, v194, s77
    v_perm_b32 v91, v206, v202, s77
    ds_write_b128 v16, v[88:91] offset:1024
    s_lshr_b32 s80, 0x38393a3b, s88
    s_and_b32 s80, s80, 0xff
    s_lshl_b32 s80, s80, 11
    v_add_u32 v16, s80, v140
    v_perm_b32 v92, v150, v146, s78
    v_perm_b32 v93, v158, v154, s78
    v_perm_b32 v94, v166, v162, s78
    v_perm_b32 v95, v174, v170, s78
    ds_write_b128 v16, v[92:95] offset:0
    v_perm_b32 v84, v182, v178, s78
    v_perm_b32 v85, v190, v186, s78
    v_perm_b32 v86, v198, v194, s78
    v_perm_b32 v87, v206, v202, s78
    ds_write_b128 v16, v[84:87] offset:1024
    s_lshr_b32 s80, 0x4e4f0607, s88
    s_and_b32 s80, s80, 0xff
    s_lshl_b32 s80, s80, 11
    v_add_u32 v16, s80, v140
    v_perm_b32 v88, v151, v147, s77
    v_perm_b32 v89, v159, v155, s77
    v_perm_b32 v90, v167, v163, s77
    v_perm_b32 v91, v175, v171, s77
    ds_write_b128 v16, v[88:91] offset:0
    v_perm_b32 v92, v183, v179, s77
    v_perm_b32 v93, v191, v187, s77
    v_perm_b32 v94, v199, v195, s77
    v_perm_b32 v95, v207, v203, s77
    ds_write_b128 v16, v[92:95] offset:1024
    s_lshr_b32 s80, 0x4a4b4c4d, s88
    s_and_b32 s80, s80, 0xff
    s_lshl_b32 s80, s80, 11
    v_add_u32 v16, s80, v140
    v_perm_b32 v84, v151, v147, s78
    v_perm_b32 v85, v159, v155, s78
    v_perm_b32 v86, v167, v163, s78
    v_perm_b32 v87, v175, v171, s78
    ds_write_b128 v16, v[84:87] offset:0
    v_perm_b32 v88, v183, v179, s78
    v_perm_b32 v89, v191, v187, s78
    v_perm_b32 v90, v199, v195, s78
    v_perm_b32 v91, v207, v203, s78
    ds_write_b128 v16, v[88:91] offset:1024
    s_waitcnt lgkmcnt(0)
    s_barrier
    ds_read_b128 a[168:171], v11 offset:2048
    ds_read_b128 a[172:175], v11 offset:3072
    ds_read_b128 a[184:187], v11 offset:0
    ds_read_b128 a[188:191], v11 offset:1024
    ds_read_b128 a[200:203], v134 offset:34816
    ds_read_b128 a[204:207], v134 offset:35840
    ds_read_b128 a[216:219], v134 offset:32768
    ds_read_b128 a[220:223], v134 offset:33792
    ds_read_b128 a[232:235], v134 offset:30720
    ds_read_b128 a[236:239], v134 offset:31744
    ds_read_b128 a[248:251], v134 offset:28672
    ds_read_b128 a[252:255], v134 offset:29696
    s_waitcnt lgkmcnt(4)
    ds_read_b128 v[232:235], v134 offset:26624
    ds_read_b128 v[236:239], v134 offset:27648
    ds_read_b128 v[248:251], v134 offset:24576
    ds_read_b128 v[252:255], v134 offset:25600
    s_mov_b32 s40, s10
    s_mov_b32 s41, s11
    s_mov_b32 s42, 0x400000
    s_mov_b32 s43, 0x20000
    s_mov_b32 s80, 0x200000
    buffer_load_dwordx4 v[144:147], v10, s[40:43], s80 offen
    s_mov_b32 s80, 0x202000
    buffer_load_dwordx4 v[148:151], v10, s[40:43], s80 offen
    s_mov_b32 s80, 0x240000
    buffer_load_dwordx4 v[152:155], v10, s[40:43], s80 offen
    s_mov_b32 s80, 0x242000
    buffer_load_dwordx4 v[156:159], v10, s[40:43], s80 offen
    s_mov_b32 s80, 0x210000
    buffer_load_dwordx4 v[160:163], v10, s[40:43], s80 offen
    s_mov_b32 s80, 0x212000
    buffer_load_dwordx4 v[164:167], v10, s[40:43], s80 offen
    s_mov_b32 s80, 0x250000
    buffer_load_dwordx4 v[168:171], v10, s[40:43], s80 offen
    s_mov_b32 s80, 0x252000
    buffer_load_dwordx4 v[172:175], v10, s[40:43], s80 offen
    s_mov_b32 s80, 0x300000
    buffer_load_dwordx4 v[176:179], v10, s[40:43], s80 offen
    s_mov_b32 s80, 0x302000
    buffer_load_dwordx4 v[180:183], v10, s[40:43], s80 offen
    s_mov_b32 s80, 0x340000
    buffer_load_dwordx4 v[184:187], v10, s[40:43], s80 offen
    s_mov_b32 s80, 0x342000
    buffer_load_dwordx4 v[188:191], v10, s[40:43], s80 offen
    s_mov_b32 s80, 0x310000
    buffer_load_dwordx4 v[192:195], v10, s[40:43], s80 offen
    s_mov_b32 s80, 0x312000
    buffer_load_dwordx4 v[196:199], v10, s[40:43], s80 offen
    s_mov_b32 s80, 0x350000
    buffer_load_dwordx4 v[200:203], v10, s[40:43], s80 offen
    s_mov_b32 s80, 0x352000
    buffer_load_dwordx4 v[204:207], v10, s[40:43], s80 offen
    s_waitcnt vmcnt(16)
    s_waitcnt lgkmcnt(0)
    s_barrier
    s_lshr_b32 s80, 0xf010a, s88
    s_and_b32 s80, s80, 0xff
    s_lshl_b32 s80, s80, 11
    v_add_u32 v16, s80, v140
    v_lshlrev_b32 v96, 16, v20
    v_lshlrev_b32 v97, 16, v24
    v_pk_mul_f32 v[96:97], v[96:97], s[72:73] op_sel_hi:[1,0]
    v_cvt_pk_bf16_f32 v92, v96, v97
    v_lshlrev_b32 v98, 16, v28
    v_lshlrev_b32 v99, 16, v32
    v_pk_mul_f32 v[98:99], v[98:99], s[72:73] op_sel_hi:[1,0]
    v_cvt_pk_bf16_f32 v93, v98, v99
    v_lshlrev_b32 v96, 16, v36
    v_lshlrev_b32 v97, 16, v40
    v_pk_mul_f32 v[96:97], v[96:97], s[72:73] op_sel_hi:[1,0]
    v_cvt_pk_bf16_f32 v94, v96, v97
    v_lshlrev_b32 v98, 16, v44
    v_lshlrev_b32 v99, 16, v48
    v_pk_mul_f32 v[98:99], v[98:99], s[72:73] op_sel_hi:[1,0]
    v_cvt_pk_bf16_f32 v95, v98, v99
    ds_write_b128 v16, v[92:95] offset:0
    v_lshlrev_b32 v96, 16, v52
    v_lshlrev_b32 v97, 16, v56
    v_pk_mul_f32 v[96:97], v[96:97], s[72:73] op_sel_hi:[1,0]
    v_cvt_pk_bf16_f32 v84, v96, v97
    v_lshlrev_b32 v98, 16, v60
    v_lshlrev_b32 v99, 16, v64
    v_pk_mul_f32 v[98:99], v[98:99], s[72:73] op_sel_hi:[1,0]
    v_cvt_pk_bf16_f32 v85, v98, v99
    v_lshlrev_b32 v96, 16, v68
    v_lshlrev_b32 v97, 16, v72
    v_pk_mul_f32 v[96:97], v[96:97], s[72:73] op_sel_hi:[1,0]
    v_cvt_pk_bf16_f32 v86, v96, v97
    v_lshlrev_b32 v98, 16, v76
    v_lshlrev_b32 v99, 16, v80
    v_pk_mul_f32 v[98:99], v[98:99], s[72:73] op_sel_hi:[1,0]
    v_cvt_pk_bf16_f32 v87, v98, v99
    ds_write_b128 v16, v[84:87] offset:1024
    s_lshr_b32 s80, 0x17180d19, s88
    s_and_b32 s80, s80, 0xff
    s_lshl_b32 s80, s80, 11
    v_add_u32 v16, s80, v140
    v_and_b32 v96, 0xffff0000, v20
    v_and_b32 v97, 0xffff0000, v24
    v_pk_mul_f32 v[96:97], v[96:97], s[72:73] op_sel_hi:[1,0]
    v_cvt_pk_bf16_f32 v88, v96, v97
    v_and_b32 v98, 0xffff0000, v28
    v_and_b32 v99, 0xffff0000, v32
    v_pk_mul_f32 v[98:99], v[98:99], s[72:73] op_sel_hi:[1,0]
    v_cvt_pk_bf16_f32 v89, v98, v99
    v_and_b32 v96, 0xffff0000, v36
    v_and_b32 v97, 0xffff0000, v40
    v_pk_mul_f32 v[96:97], v[96:97], s[72:73] op_sel_hi:[1,0]
    v_cvt_pk_bf16_f32 v90, v96, v97
    v_and_b32 v98, 0xffff0000, v44
    v_and_b32 v99, 0xffff0000, v48
    v_pk_mul_f32 v[98:99], v[98:99], s[72:73] op_sel_hi:[1,0]
    v_cvt_pk_bf16_f32 v91, v98, v99
    ds_write_b128 v16, v[88:91] offset:0
    v_and_b32 v96, 0xffff0000, v52
    v_and_b32 v97, 0xffff0000, v56
    v_pk_mul_f32 v[96:97], v[96:97], s[72:73] op_sel_hi:[1,0]
    v_cvt_pk_bf16_f32 v92, v96, v97
    v_and_b32 v98, 0xffff0000, v60
    v_and_b32 v99, 0xffff0000, v64
    v_pk_mul_f32 v[98:99], v[98:99], s[72:73] op_sel_hi:[1,0]
    v_cvt_pk_bf16_f32 v93, v98, v99
    v_and_b32 v96, 0xffff0000, v68
    v_and_b32 v97, 0xffff0000, v72
    v_pk_mul_f32 v[96:97], v[96:97], s[72:73] op_sel_hi:[1,0]
    v_cvt_pk_bf16_f32 v94, v96, v97
    v_and_b32 v98, 0xffff0000, v76
    v_and_b32 v99, 0xffff0000, v80
    v_pk_mul_f32 v[98:99], v[98:99], s[72:73] op_sel_hi:[1,0]
    v_cvt_pk_bf16_f32 v95, v98, v99
    ds_write_b128 v16, v[92:95] offset:1024
    s_lshr_b32 s80, 0x221031c, s88
    s_and_b32 s80, s80, 0xff
    s_lshl_b32 s80, s80, 11
    v_add_u32 v16, s80, v140
    v_lshlrev_b32 v96, 16, v21
    v_lshlrev_b32 v97, 16, v25
    v_pk_mul_f32 v[96:97], v[96:97], s[72:73] op_sel_hi:[1,0]
    v_cvt_pk_bf16_f32 v84, v96, v97
    v_lshlrev_b32 v98, 16, v29
    v_lshlrev_b32 v99, 16, v33
    v_pk_mul_f32 v[98:99], v[98:99], s[72:73] op_sel_hi:[1,0]
    v_cvt_pk_bf16_f32 v85, v98, v99
    v_lshlrev_b32 v96, 16, v37
    v_lshlrev_b32 v97, 16, v41
    v_pk_mul_f32 v[96:97], v[96:97], s[72:73] op_sel_hi:[1,0]
    v_cvt_pk_bf16_f32 v86, v96, v97
    v_lshlrev_b32 v98, 16, v45
    v_lshlrev_b32 v99, 16, v49
    v_pk_mul_f32 v[98:99], v[98:99], s[72:73] op_sel_hi:[1,0]
    v_cvt_pk_bf16_f32 v87, v98, v99
    ds_write_b128 v16, v[84:87] offset:0
    v_lshlrev_b32 v96, 16, v53
    v_lshlrev_b32 v97, 16, v57
    v_pk_mul_f32 v[96:97], v[96:97], s[72:73] op_sel_hi:[1,0]
    v_cvt_pk_bf16_f32 v88, v96, v97
    v_lshlrev_b32 v98, 16, v61
    v_lshlrev_b32 v99, 16, v65
    v_pk_mul_f32 v[98:99], v[98:99], s[72:73] op_sel_hi:[1,0]
    v_cvt_pk_bf16_f32 v89, v98, v99
    v_lshlrev_b32 v96, 16, v69
    v_lshlrev_b32 v97, 16, v73
    v_pk_mul_f32 v[96:97], v[96:97], s[72:73] op_sel_hi:[1,0]
    v_cvt_pk_bf16_f32 v90, v96, v97
    v_lshlrev_b32 v98, 16, v77
    v_lshlrev_b32 v99, 16, v81
    v_pk_mul_f32 v[98:99], v[98:99], s[72:73] op_sel_hi:[1,0]
    v_cvt_pk_bf16_f32 v91, v98, v99
    ds_write_b128 v16, v[88:91] offset:1024
    s_lshr_b32 s80, 0x292a1f2b, s88
    s_and_b32 s80, s80, 0xff
    s_lshl_b32 s80, s80, 11
    v_add_u32 v16, s80, v140
    v_and_b32 v96, 0xffff0000, v21
    v_and_b32 v97, 0xffff0000, v25
    v_pk_mul_f32 v[96:97], v[96:97], s[72:73] op_sel_hi:[1,0]
    v_cvt_pk_bf16_f32 v92, v96, v97
    v_and_b32 v98, 0xffff0000, v29
    v_and_b32 v99, 0xffff0000, v33
    v_pk_mul_f32 v[98:99], v[98:99], s[72:73] op_sel_hi:[1,0]
    v_cvt_pk_bf16_f32 v93, v98, v99
    v_and_b32 v96, 0xffff0000, v37
    v_and_b32 v97, 0xffff0000, v41
    v_pk_mul_f32 v[96:97], v[96:97], s[72:73] op_sel_hi:[1,0]
    v_cvt_pk_bf16_f32 v94, v96, v97
    v_and_b32 v98, 0xffff0000, v45
    v_and_b32 v99, 0xffff0000, v49
    v_pk_mul_f32 v[98:99], v[98:99], s[72:73] op_sel_hi:[1,0]
    v_cvt_pk_bf16_f32 v95, v98, v99
    ds_write_b128 v16, v[92:95] offset:0
    v_and_b32 v96, 0xffff0000, v53
    v_and_b32 v97, 0xffff0000, v57
    v_pk_mul_f32 v[96:97], v[96:97], s[72:73] op_sel_hi:[1,0]
    v_cvt_pk_bf16_f32 v84, v96, v97
    v_and_b32 v98, 0xffff0000, v61
    v_and_b32 v99, 0xffff0000, v65
    v_pk_mul_f32 v[98:99], v[98:99], s[72:73] op_sel_hi:[1,0]
    v_cvt_pk_bf16_f32 v85, v98, v99
    v_and_b32 v96, 0xffff0000, v69
    v_and_b32 v97, 0xffff0000, v73
    v_pk_mul_f32 v[96:97], v[96:97], s[72:73] op_sel_hi:[1,0]
    v_cvt_pk_bf16_f32 v86, v96, v97
    v_and_b32 v98, 0xffff0000, v77
    v_and_b32 v99, 0xffff0000, v81
    v_pk_mul_f32 v[98:99], v[98:99], s[72:73] op_sel_hi:[1,0]
    v_cvt_pk_bf16_f32 v87, v98, v99
    ds_write_b128 v16, v[84:87] offset:1024
    s_lshr_b32 s80, 0x433052e, s88
    s_and_b32 s80, s80, 0xff
    s_lshl_b32 s80, s80, 11
    v_add_u32 v16, s80, v140
    v_lshlrev_b32 v96, 16, v22
    v_lshlrev_b32 v97, 16, v26
    v_pk_mul_f32 v[96:97], v[96:97], s[72:73] op_sel_hi:[1,0]
    v_cvt_pk_bf16_f32 v88, v96, v97
    v_lshlrev_b32 v98, 16, v30
    v_lshlrev_b32 v99, 16, v34
    v_pk_mul_f32 v[98:99], v[98:99], s[72:73] op_sel_hi:[1,0]
    v_cvt_pk_bf16_f32 v89, v98, v99
    v_lshlrev_b32 v96, 16, v38
    v_lshlrev_b32 v97, 16, v42
    v_pk_mul_f32 v[96:97], v[96:97], s[72:73] op_sel_hi:[1,0]
    v_cvt_pk_bf16_f32 v90, v96, v97
    v_lshlrev_b32 v98, 16, v46
    v_lshlrev_b32 v99, 16, v50
    v_pk_mul_f32 v[98:99], v[98:99], s[72:73] op_sel_hi:[1,0]
    v_cvt_pk_bf16_f32 v91, v98, v99
    ds_write_b128 v16, v[88:91] offset:0
    v_lshlrev_b32 v96, 16, v54
    v_lshlrev_b32 v97, 16, v58
    v_pk_mul_f32 v[96:97], v[96:97], s[72:73] op_sel_hi:[1,0]
    v_cvt_pk_bf16_f32 v92, v96, v97
    v_lshlrev_b32 v98, 16, v62
    v_lshlrev_b32 v99, 16, v66
    v_pk_mul_f32 v[98:99], v[98:99], s[72:73] op_sel_hi:[1,0]
    v_cvt_pk_bf16_f32 v93, v98, v99
    v_lshlrev_b32 v96, 16, v70
    v_lshlrev_b32 v97, 16, v74
    v_pk_mul_f32 v[96:97], v[96:97], s[72:73] op_sel_hi:[1,0]
    v_cvt_pk_bf16_f32 v94, v96, v97
    v_lshlrev_b32 v98, 16, v78
    v_lshlrev_b32 v99, 16, v82
    v_pk_mul_f32 v[98:99], v[98:99], s[72:73] op_sel_hi:[1,0]
    v_cvt_pk_bf16_f32 v95, v98, v99
    ds_write_b128 v16, v[92:95] offset:1024
    s_lshr_b32 s80, 0x3b3c313d, s88
    s_and_b32 s80, s80, 0xff
    s_lshl_b32 s80, s80, 11
    v_add_u32 v16, s80, v140
    v_and_b32 v96, 0xffff0000, v22
    v_and_b32 v97, 0xffff0000, v26
    v_pk_mul_f32 v[96:97], v[96:97], s[72:73] op_sel_hi:[1,0]
    v_cvt_pk_bf16_f32 v84, v96, v97
    v_and_b32 v98, 0xffff0000, v30
    v_and_b32 v99, 0xffff0000, v34
    v_pk_mul_f32 v[98:99], v[98:99], s[72:73] op_sel_hi:[1,0]
    v_cvt_pk_bf16_f32 v85, v98, v99
    v_and_b32 v96, 0xffff0000, v38
    v_and_b32 v97, 0xffff0000, v42
    v_pk_mul_f32 v[96:97], v[96:97], s[72:73] op_sel_hi:[1,0]
    v_cvt_pk_bf16_f32 v86, v96, v97
    v_and_b32 v98, 0xffff0000, v46
    v_and_b32 v99, 0xffff0000, v50
    v_pk_mul_f32 v[98:99], v[98:99], s[72:73] op_sel_hi:[1,0]
    v_cvt_pk_bf16_f32 v87, v98, v99
    ds_write_b128 v16, v[84:87] offset:0
    v_and_b32 v96, 0xffff0000, v54
    v_and_b32 v97, 0xffff0000, v58
    v_pk_mul_f32 v[96:97], v[96:97], s[72:73] op_sel_hi:[1,0]
    v_cvt_pk_bf16_f32 v88, v96, v97
    v_and_b32 v98, 0xffff0000, v62
    v_and_b32 v99, 0xffff0000, v66
    v_pk_mul_f32 v[98:99], v[98:99], s[72:73] op_sel_hi:[1,0]
    v_cvt_pk_bf16_f32 v89, v98, v99
    v_and_b32 v96, 0xffff0000, v70
    v_and_b32 v97, 0xffff0000, v74
    v_pk_mul_f32 v[96:97], v[96:97], s[72:73] op_sel_hi:[1,0]
    v_cvt_pk_bf16_f32 v90, v96, v97
    v_and_b32 v98, 0xffff0000, v78
    v_and_b32 v99, 0xffff0000, v82
    v_pk_mul_f32 v[98:99], v[98:99], s[72:73] op_sel_hi:[1,0]
    v_cvt_pk_bf16_f32 v91, v98, v99
    ds_write_b128 v16, v[88:91] offset:1024
    s_lshr_b32 s80, 0x6450740, s88
    s_and_b32 s80, s80, 0xff
    s_lshl_b32 s80, s80, 11
    v_add_u32 v16, s80, v140
    v_lshlrev_b32 v96, 16, v23
    v_lshlrev_b32 v97, 16, v27
    v_pk_mul_f32 v[96:97], v[96:97], s[72:73] op_sel_hi:[1,0]
    v_cvt_pk_bf16_f32 v92, v96, v97
    v_lshlrev_b32 v98, 16, v31
    v_lshlrev_b32 v99, 16, v35
    v_pk_mul_f32 v[98:99], v[98:99], s[72:73] op_sel_hi:[1,0]
    v_cvt_pk_bf16_f32 v93, v98, v99
    v_lshlrev_b32 v96, 16, v39
    v_lshlrev_b32 v97, 16, v43
    v_pk_mul_f32 v[96:97], v[96:97], s[72:73] op_sel_hi:[1,0]
    v_cvt_pk_bf16_f32 v94, v96, v97
    v_lshlrev_b32 v98, 16, v47
    v_lshlrev_b32 v99, 16, v51
    v_pk_mul_f32 v[98:99], v[98:99], s[72:73] op_sel_hi:[1,0]
    v_cvt_pk_bf16_f32 v95, v98, v99
    ds_write_b128 v16, v[92:95] offset:0
    v_lshlrev_b32 v96, 16, v55
    v_lshlrev_b32 v97, 16, v59
    v_pk_mul_f32 v[96:97], v[96:97], s[72:73] op_sel_hi:[1,0]
    v_cvt_pk_bf16_f32 v84, v96, v97
    v_lshlrev_b32 v98, 16, v63
    v_lshlrev_b32 v99, 16, v67
    v_pk_mul_f32 v[98:99], v[98:99], s[72:73] op_sel_hi:[1,0]
    v_cvt_pk_bf16_f32 v85, v98, v99
    v_lshlrev_b32 v96, 16, v71
    v_lshlrev_b32 v97, 16, v75
    v_pk_mul_f32 v[96:97], v[96:97], s[72:73] op_sel_hi:[1,0]
    v_cvt_pk_bf16_f32 v86, v96, v97
    v_lshlrev_b32 v98, 16, v79
    v_lshlrev_b32 v99, 16, v83
    v_pk_mul_f32 v[98:99], v[98:99], s[72:73] op_sel_hi:[1,0]
    v_cvt_pk_bf16_f32 v87, v98, v99
    ds_write_b128 v16, v[84:87] offset:1024
    s_lshr_b32 s80, 0x4d4e434f, s88
    s_and_b32 s80, s80, 0xff
    s_lshl_b32 s80, s80, 11
    v_add_u32 v16, s80, v140
    v_and_b32 v96, 0xffff0000, v23
    v_and_b32 v97, 0xffff0000, v27
    v_pk_mul_f32 v[96:97], v[96:97], s[72:73] op_sel_hi:[1,0]
    v_cvt_pk_bf16_f32 v88, v96, v97
    v_and_b32 v98, 0xffff0000, v31
    v_and_b32 v99, 0xffff0000, v35
    v_pk_mul_f32 v[98:99], v[98:99], s[72:73] op_sel_hi:[1,0]
    v_cvt_pk_bf16_f32 v89, v98, v99
    v_and_b32 v96, 0xffff0000, v39
    v_and_b32 v97, 0xffff0000, v43
    v_pk_mul_f32 v[96:97], v[96:97], s[72:73] op_sel_hi:[1,0]
    v_cvt_pk_bf16_f32 v90, v96, v97
    v_and_b32 v98, 0xffff0000, v47
    v_and_b32 v99, 0xffff0000, v51
    v_pk_mul_f32 v[98:99], v[98:99], s[72:73] op_sel_hi:[1,0]
    v_cvt_pk_bf16_f32 v91, v98, v99
    ds_write_b128 v16, v[88:91] offset:0
    v_and_b32 v96, 0xffff0000, v55
    v_and_b32 v97, 0xffff0000, v59
    v_pk_mul_f32 v[96:97], v[96:97], s[72:73] op_sel_hi:[1,0]
    v_cvt_pk_bf16_f32 v92, v96, v97
    v_and_b32 v98, 0xffff0000, v63
    v_and_b32 v99, 0xffff0000, v67
    v_pk_mul_f32 v[98:99], v[98:99], s[72:73] op_sel_hi:[1,0]
    v_cvt_pk_bf16_f32 v93, v98, v99
    v_and_b32 v96, 0xffff0000, v71
    v_and_b32 v97, 0xffff0000, v75
    v_pk_mul_f32 v[96:97], v[96:97], s[72:73] op_sel_hi:[1,0]
    v_cvt_pk_bf16_f32 v94, v96, v97
    v_and_b32 v98, 0xffff0000, v79
    v_and_b32 v99, 0xffff0000, v83
    v_pk_mul_f32 v[98:99], v[98:99], s[72:73] op_sel_hi:[1,0]
    v_cvt_pk_bf16_f32 v95, v98, v99
    ds_write_b128 v16, v[92:95] offset:1024
    s_waitcnt lgkmcnt(0)
    s_barrier
    ds_read_b128 a[8:11], v11 offset:2048
    ds_read_b128 a[12:15], v11 offset:3072
    ds_read_b128 a[32:35], v11 offset:0
    ds_read_b128 a[36:39], v11 offset:1024
    ds_read_b128 a[48:51], v134 offset:34816
    ds_read_b128 a[52:55], v134 offset:35840
    ds_read_b128 a[56:59], v134 offset:32768
    ds_read_b128 a[60:63], v134 offset:33792
    ds_read_b128 a[72:75], v134 offset:30720
    ds_read_b128 a[76:79], v134 offset:31744
    s_mov_b32 s40, s8
    s_mov_b32 s41, s9
    s_mov_b32 s42, 0x400000
    s_mov_b32 s43, 0x20000
    s_mov_b32 s80, 0x0
    buffer_load_dwordx4 v[20:23], v10, s[40:43], s80 offen
    s_mov_b32 s80, 0x2000
    buffer_load_dwordx4 v[24:27], v10, s[40:43], s80 offen
    s_mov_b32 s80, 0x40000
    buffer_load_dwordx4 v[28:31], v10, s[40:43], s80 offen
    s_mov_b32 s80, 0x42000
    buffer_load_dwordx4 v[32:35], v10, s[40:43], s80 offen
    s_mov_b32 s80, 0x10000
    buffer_load_dwordx4 v[36:39], v10, s[40:43], s80 offen
    s_mov_b32 s80, 0x12000
    buffer_load_dwordx4 v[40:43], v10, s[40:43], s80 offen
    s_mov_b32 s80, 0x50000
    buffer_load_dwordx4 v[44:47], v10, s[40:43], s80 offen
    s_mov_b32 s80, 0x52000
    buffer_load_dwordx4 v[48:51], v10, s[40:43], s80 offen
    s_mov_b32 s80, 0x100000
    buffer_load_dwordx4 v[52:55], v10, s[40:43], s80 offen
    s_mov_b32 s80, 0x102000
    buffer_load_dwordx4 v[56:59], v10, s[40:43], s80 offen
    s_mov_b32 s80, 0x140000
    buffer_load_dwordx4 v[60:63], v10, s[40:43], s80 offen
    s_mov_b32 s80, 0x142000
    buffer_load_dwordx4 v[64:67], v10, s[40:43], s80 offen
    s_mov_b32 s80, 0x110000
    buffer_load_dwordx4 v[68:71], v10, s[40:43], s80 offen
    s_mov_b32 s80, 0x112000
    buffer_load_dwordx4 v[72:75], v10, s[40:43], s80 offen
    s_mov_b32 s80, 0x150000
    buffer_load_dwordx4 v[76:79], v10, s[40:43], s80 offen
    s_mov_b32 s80, 0x152000
    buffer_load_dwordx4 v[80:83], v10, s[40:43], s80 offen
    s_waitcnt vmcnt(16)
    s_waitcnt lgkmcnt(0)
    s_barrier
    s_lshr_b32 s80, 0x1200010b, s88
    s_and_b32 s80, s80, 0xff
    s_lshl_b32 s80, s80, 11
    v_add_u32 v16, s80, v140
    v_perm_b32 v84, v148, v144, s77
    v_perm_b32 v85, v156, v152, s77
    v_perm_b32 v86, v164, v160, s77
    v_perm_b32 v87, v172, v168, s77
    ds_write_b128 v16, v[84:87] offset:0
    v_perm_b32 v88, v180, v176, s77
    v_perm_b32 v89, v188, v184, s77
    v_perm_b32 v90, v196, v192, s77
    v_perm_b32 v91, v204, v200, s77
    ds_write_b128 v16, v[88:91] offset:1024
    s_lshr_b32 s80, 0x13171819, s88
    s_and_b32 s80, s80, 0xff
    s_lshl_b32 s80, s80, 11
    v_add_u32 v16, s80, v140
    v_perm_b32 v92, v148, v144, s78
    v_perm_b32 v93, v156, v152, s78
    v_perm_b32 v94, v164, v160, s78
    v_perm_b32 v95, v172, v168, s78
    ds_write_b128 v16, v[92:95] offset:0
    v_perm_b32 v84, v180, v176, s78
    v_perm_b32 v85, v188, v184, s78
    v_perm_b32 v86, v196, v192, s78
    v_perm_b32 v87, v204, v200, s78
    ds_write_b128 v16, v[84:87] offset:1024
    s_lshr_b32 s80, 0x2402031d, s88
    s_and_b32 s80, s80, 0xff
    s_lshl_b32 s80, s80, 11
    v_add_u32 v16, s80, v140
    v_perm_b32 v88, v149, v145, s77
    v_perm_b32 v89, v157, v153, s77
    v_perm_b32 v90, v165, v161, s77
    v_perm_b32 v91, v173, v169, s77
    ds_write_b128 v16, v[88:91] offset:0
    v_perm_b32 v92, v181, v177, s77
    v_perm_b32 v93, v189, v185, s77
    v_perm_b32 v94, v197, v193, s77
    v_perm_b32 v95, v205, v201, s77
    ds_write_b128 v16, v[92:95] offset:1024
    s_lshr_b32 s80, 0x25292a2b, s88
    s_and_b32 s80, s80, 0xff
    s_lshl_b32 s80, s80, 11
    v_add_u32 v16, s80, v140
    v_perm_b32 v84, v149, v145, s78
    v_perm_b32 v85, v157, v153, s78
    v_perm_b32 v86, v165, v161, s78
    v_perm_b32 v87, v173, v169, s78
    ds_write_b128 v16, v[84:87] offset:0
    v_perm_b32 v88, v181, v177, s78
    v_perm_b32 v89, v189, v185, s78
    v_perm_b32 v90, v197, v193, s78
    v_perm_b32 v91, v205, v201, s78
    ds_write_b128 v16, v[88:91] offset:1024
    s_lshr_b32 s80, 0x3604052f, s88
    s_and_b32 s80, s80, 0xff
    s_lshl_b32 s80, s80, 11
    v_add_u32 v16, s80, v140
    v_perm_b32 v92, v150, v146, s77
    v_perm_b32 v93, v158, v154, s77
    v_perm_b32 v94, v166, v162, s77
    v_perm_b32 v95, v174, v170, s77
    ds_write_b128 v16, v[92:95] offset:0
    v_perm_b32 v84, v182, v178, s77
    v_perm_b32 v85, v190, v186, s77
    v_perm_b32 v86, v198, v194, s77
    v_perm_b32 v87, v206, v202, s77
    ds_write_b128 v16, v[84:87] offset:1024
    s_lshr_b32 s80, 0x373b3c3d, s88
    s_and_b32 s80, s80, 0xff
    s_lshl_b32 s80, s80, 11
    v_add_u32 v16, s80, v140
    v_perm_b32 v88, v150, v146, s78
    v_perm_b32 v89, v158, v154, s78
    v_perm_b32 v90, v166, v162, s78
    v_perm_b32 v91, v174, v170, s78
    ds_write_b128 v16, v[88:91] offset:0
    v_perm_b32 v92, v182, v178, s78
    v_perm_b32 v93, v190, v186, s78
    v_perm_b32 v94, v198, v194, s78
    v_perm_b32 v95, v206, v202, s78
    ds_write_b128 v16, v[92:95] offset:1024
    s_lshr_b32 s80, 0x48060741, s88
    s_and_b32 s80, s80, 0xff
    s_lshl_b32 s80, s80, 11
    v_add_u32 v16, s80, v140
    v_perm_b32 v84, v151, v147, s77
    v_perm_b32 v85, v159, v155, s77
    v_perm_b32 v86, v167, v163, s77
    v_perm_b32 v87, v175, v171, s77
    ds_write_b128 v16, v[84:87] offset:0
    v_perm_b32 v88, v183, v179, s77
    v_perm_b32 v89, v191, v187, s77
    v_perm_b32 v90, v199, v195, s77
    v_perm_b32 v91, v207, v203, s77
    ds_write_b128 v16, v[88:91] offset:1024
    s_lshr_b32 s80, 0x494d4e4f, s88
    s_and_b32 s80, s80, 0xff
    s_lshl_b32 s80, s80, 11
    v_add_u32 v16, s80, v140
    v_perm_b32 v92, v151, v147, s78
    v_perm_b32 v93, v159, v155, s78
    v_perm_b32 v94, v167, v163, s78
    v_perm_b32 v95, v175, v171, s78
    ds_write_b128 v16, v[92:95] offset:0
    v_perm_b32 v84, v183, v179, s78
    v_perm_b32 v85, v191, v187, s78
    v_perm_b32 v86, v199, v195, s78
    v_perm_b32 v87, v207, v203, s78
    ds_write_b128 v16, v[84:87] offset:1024
    s_waitcnt lgkmcnt(0)
    s_barrier
    ds_read_b128 a[88:91], v11 offset:2048
    ds_read_b128 a[92:95], v11 offset:3072
    ds_read_b128 a[96:99], v11 offset:0
    ds_read_b128 a[100:103], v11 offset:1024
    ds_read_b128 a[120:123], v134 offset:34816
    ds_read_b128 a[124:127], v134 offset:35840
    ds_read_b128 a[136:139], v134 offset:32768
    ds_read_b128 a[140:143], v134 offset:33792
    ds_read_b128 a[152:155], v134 offset:30720
    ds_read_b128 a[156:159], v134 offset:31744
    v_mbcnt_lo_u32_b32 v8, -1, 0
    v_mbcnt_hi_u32_b32 v8, -1, v8
    v_lshlrev_b32 v8, 2, v8
    global_load_dword v6, v8, s[30:31] sc1
    s_mov_b32 s40, s10
    s_mov_b32 s41, s11
    s_mov_b32 s42, 0x400000
    s_mov_b32 s43, 0x20000
    s_mov_b32 s80, 0x0
    buffer_load_dwordx4 v[144:147], v10, s[40:43], s80 offen
    s_mov_b32 s80, 0x2000
    buffer_load_dwordx4 v[148:151], v10, s[40:43], s80 offen
    s_mov_b32 s80, 0x40000
    buffer_load_dwordx4 v[152:155], v10, s[40:43], s80 offen
    s_mov_b32 s80, 0x42000
    buffer_load_dwordx4 v[156:159], v10, s[40:43], s80 offen
    s_mov_b32 s80, 0x10000
    buffer_load_dwordx4 v[160:163], v10, s[40:43], s80 offen
    s_mov_b32 s80, 0x12000
    buffer_load_dwordx4 v[164:167], v10, s[40:43], s80 offen
    s_mov_b32 s80, 0x50000
    buffer_load_dwordx4 v[168:171], v10, s[40:43], s80 offen
    s_mov_b32 s80, 0x52000
    buffer_load_dwordx4 v[172:175], v10, s[40:43], s80 offen
    s_mov_b32 s80, 0x100000
    buffer_load_dwordx4 v[176:179], v10, s[40:43], s80 offen
    s_mov_b32 s80, 0x102000
    buffer_load_dwordx4 v[180:183], v10, s[40:43], s80 offen
    s_mov_b32 s80, 0x140000
    buffer_load_dwordx4 v[184:187], v10, s[40:43], s80 offen
    s_mov_b32 s80, 0x142000
    buffer_load_dwordx4 v[188:191], v10, s[40:43], s80 offen
    s_mov_b32 s80, 0x110000
    buffer_load_dwordx4 v[192:195], v10, s[40:43], s80 offen
    s_mov_b32 s80, 0x112000
    buffer_load_dwordx4 v[196:199], v10, s[40:43], s80 offen
    s_mov_b32 s80, 0x150000
    buffer_load_dwordx4 v[200:203], v10, s[40:43], s80 offen
    s_mov_b32 s80, 0x152000
    buffer_load_dwordx4 v[204:207], v10, s[40:43], s80 offen
    s_waitcnt vmcnt(16)
    s_cmp_eq_u32 s17, 1
    s_cbranch_scc1 L_cf40_ok
L_cf40:
    s_mov_b32 s96, 0
    s_mov_b32 s98, 0
    v_readlane_b32 s97, v6, 8
    s_add_u32 s96, s96, s97
    v_readlane_b32 s97, v6, 12
    s_add_u32 s98, s98, s97
    v_readlane_b32 s97, v6, 24
    s_add_u32 s96, s96, s97
    v_readlane_b32 s97, v6, 20
    s_add_u32 s98, s98, s97
    v_readlane_b32 s97, v6, 40
    s_add_u32 s96, s96, s97
    v_readlane_b32 s97, v6, 36
    s_add_u32 s98, s98, s97
    v_readlane_b32 s97, v6, 56
    s_add_u32 s96, s96, s97
    v_readlane_b32 s97, v6, 52
    s_add_u32 s98, s98, s97
    v_readlane_b32 s97, v6, 9
    s_add_u32 s96, s96, s97
    v_readlane_b32 s97, v6, 13
    s_add_u32 s98, s98, s97
    v_readlane_b32 s97, v6, 25
    s_add_u32 s96, s96, s97
    v_readlane_b32 s97, v6, 21
    s_add_u32 s98, s98, s97
    v_readlane_b32 s97, v6, 41
    s_add_u32 s96, s96, s97
    v_readlane_b32 s97, v6, 37
    s_add_u32 s98, s98, s97
    v_readlane_b32 s97, v6, 57
    s_add_u32 s96, s96, s97
    v_readlane_b32 s97, v6, 53
    s_add_u32 s98, s98, s97
    s_cmp_eq_u32 s19, 0
    s_cselect_b32 s96, s98, s96
    s_cmp_eq_u32 s96, 0x100
    s_cbranch_scc1 L_cf40_all
    s_sub_u32 s100, s100, 1
    s_mov_b32 s101, 40
    s_cbranch_scc1 L_fail
    v_mbcnt_lo_u32_b32 v8, -1, 0
    v_mbcnt_hi_u32_b32 v8, -1, v8
    v_lshlrev_b32 v8, 2, v8
    global_load_dword v6, v8, s[30:31] sc1
    s_waitcnt vmcnt(0)
    s_branch L_cf40
L_cf40_all:
    s_cmp_eq_u32 s19, 0
    s_cbranch_scc0 L_cf40_t
    v_readlane_b32 s97, v6, s16
    s_cmp_eq_u32 s97, 256
    s_cbranch_scc1 L_cf40_std
    s_branch L_role_ticket
L_cf40_t:
    v_cmp_eq_u32 vcc, 32, v6
    s_and_b32 s96, vcc_lo, 0x3000300
    s_and_b32 s97, vcc_hi, 0x3000300
    s_xor_b32 s96, s96, 0x3000300
    s_xor_b32 s97, s97, 0x3000300
    s_or_b32 s96, s96, s97
    s_cmp_eq_u32 s96, 0
    s_cbranch_scc1 L_cf40_std
    v_mov_b32 v1, v6
    s_branch L_role_mixed
L_cf40_std:
    s_mov_b32 s17, 1
L_cf40_ok:
    v_mov_b64 v[12:13], s[66:67]
    v_mov_b64 v[14:15], s[66:67]
    buffer_store_dwordx4 v[12:15], v18, s[36:39], s48 offen offset:0
    buffer_store_dwordx4 v[12:15], v18, s[36:39], s48 offen offset:1024
    buffer_store_dwordx4 v[12:15], v18, s[36:39], s79 offen offset:0
    buffer_store_dwordx4 v[12:15], v18, s[36:39], s79 offen offset:1024
    buffer_store_dwordx4 v[12:15], v18, s[36:39], s49 offen offset:0
    buffer_store_dwordx4 v[12:15], v18, s[36:39], s49 offen offset:1024
    buffer_store_dword v12, v142, s[36:39], s46 offen
    buffer_store_dword v12, v142, s[36:39], s47 offen
    buffer_store_dword v9, v142, s[36:39], s45 offen
    buffer_store_dword v9, v142, s[36:39], s53 offen sc1
    s_mov_b32 s54, 0x80000000
    v_mov_b32 v8, 0
    buffer_store_dword v8, off, s[36:39], s90
    s_waitcnt lgkmcnt(0)
    s_barrier
    s_lshr_b32 s80, 0x19000108, s88
    s_and_b32 s80, s80, 0xff
    s_lshl_b32 s80, s80, 11
    v_add_u32 v16, s80, v140
    v_lshlrev_b32 v96, 16, v20
    v_lshlrev_b32 v97, 16, v24
    v_pk_mul_f32 v[96:97], v[96:97], s[72:73] op_sel_hi:[1,0]
    v_cvt_pk_bf16_f32 v88, v96, v97
    v_lshlrev_b32 v98, 16, v28
    v_lshlrev_b32 v99, 16, v32
    v_pk_mul_f32 v[98:99], v[98:99], s[72:73] op_sel_hi:[1,0]
    v_cvt_pk_bf16_f32 v89, v98, v99
    v_lshlrev_b32 v96, 16, v36
    v_lshlrev_b32 v97, 16, v40
    v_pk_mul_f32 v[96:97], v[96:97], s[72:73] op_sel_hi:[1,0]
    v_cvt_pk_bf16_f32 v90, v96, v97
    v_lshlrev_b32 v98, 16, v44
    v_lshlrev_b32 v99, 16, v48
    v_pk_mul_f32 v[98:99], v[98:99], s[72:73] op_sel_hi:[1,0]
    v_cvt_pk_bf16_f32 v91, v98, v99
    ds_write_b128 v16, v[88:91] offset:0
    v_lshlrev_b32 v96, 16, v52
    v_lshlrev_b32 v97, 16, v56
    v_pk_mul_f32 v[96:97], v[96:97], s[72:73] op_sel_hi:[1,0]
    v_cvt_pk_bf16_f32 v92, v96, v97
    v_lshlrev_b32 v98, 16, v60
    v_lshlrev_b32 v99, 16, v64
    v_pk_mul_f32 v[98:99], v[98:99], s[72:73] op_sel_hi:[1,0]
    v_cvt_pk_bf16_f32 v93, v98, v99
    v_lshlrev_b32 v96, 16, v68
    v_lshlrev_b32 v97, 16, v72
    v_pk_mul_f32 v[96:97], v[96:97], s[72:73] op_sel_hi:[1,0]
    v_cvt_pk_bf16_f32 v94, v96, v97
    v_lshlrev_b32 v98, 16, v76
    v_lshlrev_b32 v99, 16, v80
    v_pk_mul_f32 v[98:99], v[98:99], s[72:73] op_sel_hi:[1,0]
    v_cvt_pk_bf16_f32 v95, v98, v99
    ds_write_b128 v16, v[92:95] offset:1024
    s_lshr_b32 s80, 0x17100c18, s88
    s_and_b32 s80, s80, 0xff
    s_lshl_b32 s80, s80, 11
    v_add_u32 v16, s80, v140
    v_and_b32 v96, 0xffff0000, v20
    v_and_b32 v97, 0xffff0000, v24
    v_pk_mul_f32 v[96:97], v[96:97], s[72:73] op_sel_hi:[1,0]
    v_cvt_pk_bf16_f32 v84, v96, v97
    v_and_b32 v98, 0xffff0000, v28
    v_and_b32 v99, 0xffff0000, v32
    v_pk_mul_f32 v[98:99], v[98:99], s[72:73] op_sel_hi:[1,0]
    v_cvt_pk_bf16_f32 v85, v98, v99
    v_and_b32 v96, 0xffff0000, v36
    v_and_b32 v97, 0xffff0000, v40
    v_pk_mul_f32 v[96:97], v[96:97], s[72:73] op_sel_hi:[1,0]
    v_cvt_pk_bf16_f32 v86, v96, v97
    v_and_b32 v98, 0xffff0000, v44
    v_and_b32 v99, 0xffff0000, v48
    v_pk_mul_f32 v[98:99], v[98:99], s[72:73] op_sel_hi:[1,0]
    v_cvt_pk_bf16_f32 v87, v98, v99
    ds_write_b128 v16, v[84:87] offset:0
    v_and_b32 v96, 0xffff0000, v52
    v_and_b32 v97, 0xffff0000, v56
    v_pk_mul_f32 v[96:97], v[96:97], s[72:73] op_sel_hi:[1,0]
    v_cvt_pk_bf16_f32 v88, v96, v97
    v_and_b32 v98, 0xffff0000, v60
    v_and_b32 v99, 0xffff0000, v64
    v_pk_mul_f32 v[98:99], v[98:99], s[72:73] op_sel_hi:[1,0]
    v_cvt_pk_bf16_f32 v89, v98, v99
    v_and_b32 v96, 0xffff0000, v68
    v_and_b32 v97, 0xffff0000, v72
    v_pk_mul_f32 v[96:97], v[96:97], s[72:73] op_sel_hi:[1,0]
    v_cvt_pk_bf16_f32 v90, v96, v97
    v_and_b32 v98, 0xffff0000, v76
    v_and_b32 v99, 0xffff0000, v80
    v_pk_mul_f32 v[98:99], v[98:99], s[72:73] op_sel_hi:[1,0]
    v_cvt_pk_bf16_f32 v91, v98, v99
    ds_write_b128 v16, v[88:91] offset:1024
    s_lshr_b32 s80, 0x2b02031a, s88
    s_and_b32 s80, s80, 0xff
    s_lshl_b32 s80, s80, 11
    v_add_u32 v16, s80, v140
    v_lshlrev_b32 v96, 16, v21
    v_lshlrev_b32 v97, 16, v25
    v_pk_mul_f32 v[96:97], v[96:97], s[72:73] op_sel_hi:[1,0]
    v_cvt_pk_bf16_f32 v92, v96, v97
    v_lshlrev_b32 v98, 16, v29
    v_lshlrev_b32 v99, 16, v33
    v_pk_mul_f32 v[98:99], v[98:99], s[72:73] op_sel_hi:[1,0]
    v_cvt_pk_bf16_f32 v93, v98, v99
    v_lshlrev_b32 v96, 16, v37
    v_lshlrev_b32 v97, 16, v41
    v_pk_mul_f32 v[96:97], v[96:97], s[72:73] op_sel_hi:[1,0]
    v_cvt_pk_bf16_f32 v94, v96, v97
    v_lshlrev_b32 v98, 16, v45
    v_lshlrev_b32 v99, 16, v49
    v_pk_mul_f32 v[98:99], v[98:99], s[72:73] op_sel_hi:[1,0]
    v_cvt_pk_bf16_f32 v95, v98, v99
    ds_write_b128 v16, v[92:95] offset:0
    v_lshlrev_b32 v96, 16, v53
    v_lshlrev_b32 v97, 16, v57
    v_pk_mul_f32 v[96:97], v[96:97], s[72:73] op_sel_hi:[1,0]
    v_cvt_pk_bf16_f32 v84, v96, v97
    v_lshlrev_b32 v98, 16, v61
    v_lshlrev_b32 v99, 16, v65
    v_pk_mul_f32 v[98:99], v[98:99], s[72:73] op_sel_hi:[1,0]
    v_cvt_pk_bf16_f32 v85, v98, v99
    v_lshlrev_b32 v96, 16, v69
    v_lshlrev_b32 v97, 16, v73
    v_pk_mul_f32 v[96:97], v[96:97], s[72:73] op_sel_hi:[1,0]
    v_cvt_pk_bf16_f32 v86, v96, v97
    v_lshlrev_b32 v98, 16, v77
    v_lshlrev_b32 v99, 16, v81
    v_pk_mul_f32 v[98:99], v[98:99], s[72:73] op_sel_hi:[1,0]
    v_cvt_pk_bf16_f32 v87, v98, v99
    ds_write_b128 v16, v[84:87] offset:1024
    s_lshr_b32 s80, 0x29221e2a, s88
    s_and_b32 s80, s80, 0xff
    s_lshl_b32 s80, s80, 11
    v_add_u32 v16, s80, v140
    v_and_b32 v96, 0xffff0000, v21
    v_and_b32 v97, 0xffff0000, v25
    v_pk_mul_f32 v[96:97], v[96:97], s[72:73] op_sel_hi:[1,0]
    v_cvt_pk_bf16_f32 v88, v96, v97
    v_and_b32 v98, 0xffff0000, v29
    v_and_b32 v99, 0xffff0000, v33
    v_pk_mul_f32 v[98:99], v[98:99], s[72:73] op_sel_hi:[1,0]
    v_cvt_pk_bf16_f32 v89, v98, v99
    v_and_b32 v96, 0xffff0000, v37
    v_and_b32 v97, 0xffff0000, v41
    v_pk_mul_f32 v[96:97], v[96:97], s[72:73] op_sel_hi:[1,0]
    v_cvt_pk_bf16_f32 v90, v96, v97
    v_and_b32 v98, 0xffff0000, v45
    v_and_b32 v99, 0xffff0000, v49
    v_pk_mul_f32 v[98:99], v[98:99], s[72:73] op_sel_hi:[1,0]
    v_cvt_pk_bf16_f32 v91, v98, v99
    ds_write_b128 v16, v[88:91] offset:0
    v_and_b32 v96, 0xffff0000, v53
    v_and_b32 v97, 0xffff0000, v57
    v_pk_mul_f32 v[96:97], v[96:97], s[72:73] op_sel_hi:[1,0]
    v_cvt_pk_bf16_f32 v92, v96, v97
    v_and_b32 v98, 0xffff0000, v61
    v_and_b32 v99, 0xffff0000, v65
    v_pk_mul_f32 v[98:99], v[98:99], s[72:73] op_sel_hi:[1,0]
    v_cvt_pk_bf16_f32 v93, v98, v99
    v_and_b32 v96, 0xffff0000, v69
    v_and_b32 v97, 0xffff0000, v73
    v_pk_mul_f32 v[96:97], v[96:97], s[72:73] op_sel_hi:[1,0]
    v_cvt_pk_bf16_f32 v94, v96, v97
    v_and_b32 v98, 0xffff0000, v77
    v_and_b32 v99, 0xffff0000, v81
    v_pk_mul_f32 v[98:99], v[98:99], s[72:73] op_sel_hi:[1,0]
    v_cvt_pk_bf16_f32 v95, v98, v99
    ds_write_b128 v16, v[92:95] offset:1024
    s_lshr_b32 s80, 0x3d04052c, s88
    s_and_b32 s80, s80, 0xff
    s_lshl_b32 s80, s80, 11
    v_add_u32 v16, s80, v140
    v_lshlrev_b32 v96, 16, v22
    v_lshlrev_b32 v97, 16, v26
    v_pk_mul_f32 v[96:97], v[96:97], s[72:73] op_sel_hi:[1,0]
    v_cvt_pk_bf16_f32 v84, v96, v97
    v_lshlrev_b32 v98, 16, v30
    v_lshlrev_b32 v99, 16, v34
    v_pk_mul_f32 v[98:99], v[98:99], s[72:73] op_sel_hi:[1,0]
    v_cvt_pk_bf16_f32 v85, v98, v99
    v_lshlrev_b32 v96, 16, v38
    v_lshlrev_b32 v97, 16, v42
    v_pk_mul_f32 v[96:97], v[96:97], s[72:73] op_sel_hi:[1,0]
    v_cvt_pk_bf16_f32 v86, v96, v97
    v_lshlrev_b32 v98, 16, v46
    v_lshlrev_b32 v99, 16, v50
    v_pk_mul_f32 v[98:99], v[98:99], s[72:73] op_sel_hi:[1,0]
    v_cvt_pk_bf16_f32 v87, v98, v99
    ds_write_b128 v16, v[84:87] offset:0
    v_lshlrev_b32 v96, 16, v54
    v_lshlrev_b32 v97, 16, v58
    v_pk_mul_f32 v[96:97], v[96:97], s[72:73] op_sel_hi:[1,0]
    v_cvt_pk_bf16_f32 v88, v96, v97
    v_lshlrev_b32 v98, 16, v62
    v_lshlrev_b32 v99, 16, v66
    v_pk_mul_f32 v[98:99], v[98:99], s[72:73] op_sel_hi:[1,0]
    v_cvt_pk_bf16_f32 v89, v98, v99
    v_lshlrev_b32 v96, 16, v70
    v_lshlrev_b32 v97, 16, v74
    v_pk_mul_f32 v[96:97], v[96:97], s[72:73] op_sel_hi:[1,0]
    v_cvt_pk_bf16_f32 v90, v96, v97
    v_lshlrev_b32 v98, 16, v78
    v_lshlrev_b32 v99, 16, v82
    v_pk_mul_f32 v[98:99], v[98:99], s[72:73] op_sel_hi:[1,0]
    v_cvt_pk_bf16_f32 v91, v98, v99
    ds_write_b128 v16, v[88:91] offset:1024
    s_lshr_b32 s80, 0x3b34303c, s88
    s_and_b32 s80, s80, 0xff
    s_lshl_b32 s80, s80, 11
    v_add_u32 v16, s80, v140
    v_and_b32 v96, 0xffff0000, v22
    v_and_b32 v97, 0xffff0000, v26
    v_pk_mul_f32 v[96:97], v[96:97], s[72:73] op_sel_hi:[1,0]
    v_cvt_pk_bf16_f32 v92, v96, v97
    v_and_b32 v98, 0xffff0000, v30
    v_and_b32 v99, 0xffff0000, v34
    v_pk_mul_f32 v[98:99], v[98:99], s[72:73] op_sel_hi:[1,0]
    v_cvt_pk_bf16_f32 v93, v98, v99
    v_and_b32 v96, 0xffff0000, v38
    v_and_b32 v97, 0xffff0000, v42
    v_pk_mul_f32 v[96:97], v[96:97], s[72:73] op_sel_hi:[1,0]
    v_cvt_pk_bf16_f32 v94, v96, v97
    v_and_b32 v98, 0xffff0000, v46
    v_and_b32 v99, 0xffff0000, v50
    v_pk_mul_f32 v[98:99], v[98:99], s[72:73] op_sel_hi:[1,0]
    v_cvt_pk_bf16_f32 v95, v98, v99
    ds_write_b128 v16, v[92:95] offset:0
    v_and_b32 v96, 0xffff0000, v54
    v_and_b32 v97, 0xffff0000, v58
    v_pk_mul_f32 v[96:97], v[96:97], s[72:73] op_sel_hi:[1,0]
    v_cvt_pk_bf16_f32 v84, v96, v97
    v_and_b32 v98, 0xffff0000, v62
    v_and_b32 v99, 0xffff0000, v66
    v_pk_mul_f32 v[98:99], v[98:99], s[72:73] op_sel_hi:[1,0]
    v_cvt_pk_bf16_f32 v85, v98, v99
    v_and_b32 v96, 0xffff0000, v70
    v_and_b32 v97, 0xffff0000, v74
    v_pk_mul_f32 v[96:97], v[96:97], s[72:73] op_sel_hi:[1,0]
    v_cvt_pk_bf16_f32 v86, v96, v97
    v_and_b32 v98, 0xffff0000, v78
    v_and_b32 v99, 0xffff0000, v82
    v_pk_mul_f32 v[98:99], v[98:99], s[72:73] op_sel_hi:[1,0]
    v_cvt_pk_bf16_f32 v87, v98, v99
    ds_write_b128 v16, v[84:87] offset:1024
    s_lshr_b32 s80, 0x4f06073e, s88
    s_and_b32 s80, s80, 0xff
    s_lshl_b32 s80, s80, 11
    v_add_u32 v16, s80, v140
    v_lshlrev_b32 v96, 16, v23
    v_lshlrev_b32 v97, 16, v27
    v_pk_mul_f32 v[96:97], v[96:97], s[72:73] op_sel_hi:[1,0]
    v_cvt_pk_bf16_f32 v88, v96, v97
    v_lshlrev_b32 v98, 16, v31
    v_lshlrev_b32 v99, 16, v35
    v_pk_mul_f32 v[98:99], v[98:99], s[72:73] op_sel_hi:[1,0]
    v_cvt_pk_bf16_f32 v89, v98, v99
    v_lshlrev_b32 v96, 16, v39
    v_lshlrev_b32 v97, 16, v43
    v_pk_mul_f32 v[96:97], v[96:97], s[72:73] op_sel_hi:[1,0]
    v_cvt_pk_bf16_f32 v90, v96, v97
    v_lshlrev_b32 v98, 16, v47
    v_lshlrev_b32 v99, 16, v51
    v_pk_mul_f32 v[98:99], v[98:99], s[72:73] op_sel_hi:[1,0]
    v_cvt_pk_bf16_f32 v91, v98, v99
    ds_write_b128 v16, v[88:91] offset:0
    v_lshlrev_b32 v96, 16, v55
    v_lshlrev_b32 v97, 16, v59
    v_pk_mul_f32 v[96:97], v[96:97], s[72:73] op_sel_hi:[1,0]
    v_cvt_pk_bf16_f32 v92, v96, v97
    v_lshlrev_b32 v98, 16, v63
    v_lshlrev_b32 v99, 16, v67
    v_pk_mul_f32 v[98:99], v[98:99], s[72:73] op_sel_hi:[1,0]
    v_cvt_pk_bf16_f32 v93, v98, v99
    v_lshlrev_b32 v96, 16, v71
    v_lshlrev_b32 v97, 16, v75
    v_pk_mul_f32 v[96:97], v[96:97], s[72:73] op_sel_hi:[1,0]
    v_cvt_pk_bf16_f32 v94, v96, v97
    v_lshlrev_b32 v98, 16, v79
    v_lshlrev_b32 v99, 16, v83
    v_pk_mul_f32 v[98:99], v[98:99], s[72:73] op_sel_hi:[1,0]
    v_cvt_pk_bf16_f32 v95, v98, v99
    ds_write_b128 v16, v[92:95] offset:1024
    s_lshr_b32 s80, 0x4d46424e, s88
    s_and_b32 s80, s80, 0xff
    s_lshl_b32 s80, s80, 11
    v_add_u32 v16, s80, v140
    v_and_b32 v96, 0xffff0000, v23
    v_and_b32 v97, 0xffff0000, v27
    v_pk_mul_f32 v[96:97], v[96:97], s[72:73] op_sel_hi:[1,0]
    v_cvt_pk_bf16_f32 v84, v96, v97
    v_and_b32 v98, 0xffff0000, v31
    v_and_b32 v99, 0xffff0000, v35
    v_pk_mul_f32 v[98:99], v[98:99], s[72:73] op_sel_hi:[1,0]
    v_cvt_pk_bf16_f32 v85, v98, v99
    v_and_b32 v96, 0xffff0000, v39
    v_and_b32 v97, 0xffff0000, v43
    v_pk_mul_f32 v[96:97], v[96:97], s[72:73] op_sel_hi:[1,0]
    v_cvt_pk_bf16_f32 v86, v96, v97
    v_and_b32 v98, 0xffff0000, v47
    v_and_b32 v99, 0xffff0000, v51
    v_pk_mul_f32 v[98:99], v[98:99], s[72:73] op_sel_hi:[1,0]
    v_cvt_pk_bf16_f32 v87, v98, v99
    ds_write_b128 v16, v[84:87] offset:0
    v_and_b32 v96, 0xffff0000, v55
    v_and_b32 v97, 0xffff0000, v59
    v_pk_mul_f32 v[96:97], v[96:97], s[72:73] op_sel_hi:[1,0]
    v_cvt_pk_bf16_f32 v88, v96, v97
    v_and_b32 v98, 0xffff0000, v63
    v_and_b32 v99, 0xffff0000, v67
    v_pk_mul_f32 v[98:99], v[98:99], s[72:73] op_sel_hi:[1,0]
    v_cvt_pk_bf16_f32 v89, v98, v99
    v_and_b32 v96, 0xffff0000, v71
    v_and_b32 v97, 0xffff0000, v75
    v_pk_mul_f32 v[96:97], v[96:97], s[72:73] op_sel_hi:[1,0]
    v_cvt_pk_bf16_f32 v90, v96, v97
    v_and_b32 v98, 0xffff0000, v79
    v_and_b32 v99, 0xffff0000, v83
    v_pk_mul_f32 v[98:99], v[98:99], s[72:73] op_sel_hi:[1,0]
    v_cvt_pk_bf16_f32 v91, v98, v99
    ds_write_b128 v16, v[88:91] offset:1024
    s_waitcnt lgkmcnt(0)
    s_barrier
    ds_read_b128 a[0:3], v11 offset:2048
    ds_read_b128 a[4:7], v11 offset:3072
    ds_read_b128 a[16:19], v11 offset:0
    ds_read_b128 a[20:23], v11 offset:1024
    ds_read_b128 a[24:27], v134 offset:34816
    ds_read_b128 a[28:31], v134 offset:35840
    ds_read_b128 a[40:43], v134 offset:32768
    ds_read_b128 a[44:47], v134 offset:33792
    ds_read_b128 a[64:67], v134 offset:30720
    ds_read_b128 a[68:71], v134 offset:31744
    s_mov_b32 s40, s14
    s_mov_b32 s41, s15
    s_mov_b32 s42, 0x400000
    s_mov_b32 s43, 0x20000
    s_mov_b32 s80, 0x0
    buffer_load_dwordx4 v[20:23], v17, s[40:43], s80 offen
    s_mov_b32 s80, 0x2000
    buffer_load_dwordx4 v[24:27], v17, s[40:43], s80 offen
    s_mov_b32 s80, 0x4000
    buffer_load_dwordx4 v[28:31], v17, s[40:43], s80 offen
    s_mov_b32 s80, 0x6000
    buffer_load_dwordx4 v[32:35], v17, s[40:43], s80 offen
    s_mov_b32 s80, 0x10000
    buffer_load_dwordx4 v[36:39], v17, s[40:43], s80 offen
    s_mov_b32 s80, 0x12000
    buffer_load_dwordx4 v[40:43], v17, s[40:43], s80 offen
    s_mov_b32 s80, 0x14000
    buffer_load_dwordx4 v[44:47], v17, s[40:43], s80 offen
    s_mov_b32 s80, 0x16000
    buffer_load_dwordx4 v[48:51], v17, s[40:43], s80 offen
    s_mov_b32 s80, 0x800
    buffer_load_dwordx4 v[52:55], v17, s[40:43], s80 offen
    s_mov_b32 s80, 0x2800
    buffer_load_dwordx4 v[56:59], v17, s[40:43], s80 offen
    s_mov_b32 s80, 0x4800
    buffer_load_dwordx4 v[60:63], v17, s[40:43], s80 offen
    s_mov_b32 s80, 0x6800
    buffer_load_dwordx4 v[64:67], v17, s[40:43], s80 offen
    s_mov_b32 s80, 0x10800
    buffer_load_dwordx4 v[68:71], v17, s[40:43], s80 offen
    s_mov_b32 s80, 0x12800
    buffer_load_dwordx4 v[72:75], v17, s[40:43], s80 offen
    s_mov_b32 s80, 0x14800
    buffer_load_dwordx4 v[76:79], v17, s[40:43], s80 offen
    s_mov_b32 s80, 0x16800
    buffer_load_dwordx4 v[80:83], v17, s[40:43], s80 offen
    s_mov_b32 s80, 0x1000
    buffer_load_dwordx4 v[96:99], v17, s[40:43], s80 offen
    s_mov_b32 s80, 0x3000
    buffer_load_dwordx4 v[100:103], v17, s[40:43], s80 offen
    s_mov_b32 s80, 0x5000
    buffer_load_dwordx4 v[104:107], v17, s[40:43], s80 offen
    s_mov_b32 s80, 0x7000
    buffer_load_dwordx4 v[108:111], v17, s[40:43], s80 offen
    s_mov_b32 s80, 0x11000
    buffer_load_dwordx4 v[112:115], v17, s[40:43], s80 offen
    s_mov_b32 s80, 0x13000
    buffer_load_dwordx4 v[116:119], v17, s[40:43], s80 offen
    s_mov_b32 s80, 0x15000
    buffer_load_dwordx4 v[120:123], v17, s[40:43], s80 offen
    s_mov_b32 s80, 0x17000
    buffer_load_dwordx4 v[124:127], v17, s[40:43], s80 offen
    s_waitcnt vmcnt(24)
    s_waitcnt lgkmcnt(0)
    s_barrier
    s_lshr_b32 s80, 0x110109, s88
    s_and_b32 s80, s80, 0xff
    s_lshl_b32 s80, s80, 11
    v_add_u32 v16, s80, v140
    v_perm_b32 v92, v148, v144, s77
    v_perm_b32 v93, v156, v152, s77
    v_perm_b32 v94, v164, v160, s77
    v_perm_b32 v95, v172, v168, s77
    ds_write_b128 v16, v[92:95] offset:0
    v_perm_b32 v84, v180, v176, s77
    v_perm_b32 v85, v188, v184, s77
    v_perm_b32 v86, v196, v192, s77
    v_perm_b32 v87, v204, v200, s77
    ds_write_b128 v16, v[84:87] offset:1024
    s_lshr_b32 s80, 0x16171819, s88
    s_and_b32 s80, s80, 0xff
    s_lshl_b32 s80, s80, 11
    v_add_u32 v16, s80, v140
    v_perm_b32 v88, v148, v144, s78
    v_perm_b32 v89, v156, v152, s78
    v_perm_b32 v90, v164, v160, s78
    v_perm_b32 v91, v172, v168, s78
    ds_write_b128 v16, v[88:91] offset:0
    v_perm_b32 v92, v180, v176, s78
    v_perm_b32 v93, v188, v184, s78
    v_perm_b32 v94, v196, v192, s78
    v_perm_b32 v95, v204, v200, s78
    ds_write_b128 v16, v[92:95] offset:1024
    s_lshr_b32 s80, 0x223031b, s88
    s_and_b32 s80, s80, 0xff
    s_lshl_b32 s80, s80, 11
    v_add_u32 v16, s80, v140
    v_perm_b32 v84, v149, v145, s77
    v_perm_b32 v85, v157, v153, s77
    v_perm_b32 v86, v165, v161, s77
    v_perm_b32 v87, v173, v169, s77
    ds_write_b128 v16, v[84:87] offset:0
    v_perm_b32 v88, v181, v177, s77
    v_perm_b32 v89, v189, v185, s77
    v_perm_b32 v90, v197, v193, s77
    v_perm_b32 v91, v205, v201, s77
    ds_write_b128 v16, v[88:91] offset:1024
    s_lshr_b32 s80, 0x28292a2b, s88
    s_and_b32 s80, s80, 0xff
    s_lshl_b32 s80, s80, 11
    v_add_u32 v16, s80, v140
    v_perm_b32 v92, v149, v145, s78
    v_perm_b32 v93, v157, v153, s78
    v_perm_b32 v94, v165, v161, s78
    v_perm_b32 v95, v173, v169, s78
    ds_write_b128 v16, v[92:95] offset:0
    v_perm_b32 v84, v181, v177, s78
    v_perm_b32 v85, v189, v185, s78
    v_perm_b32 v86, v197, v193, s78
    v_perm_b32 v87, v205, v201, s78
    ds_write_b128 v16, v[84:87] offset:1024
    s_lshr_b32 s80, 0x435052d, s88
    s_and_b32 s80, s80, 0xff
    s_lshl_b32 s80, s80, 11
    v_add_u32 v16, s80, v140
    v_perm_b32 v88, v150, v146, s77
    v_perm_b32 v89, v158, v154, s77
    v_perm_b32 v90, v166, v162, s77
    v_perm_b32 v91, v174, v170, s77
    ds_write_b128 v16, v[88:91] offset:0
    v_perm_b32 v92, v182, v178, s77
    v_perm_b32 v93, v190, v186, s77
    v_perm_b32 v94, v198, v194, s77
    v_perm_b32 v95, v206, v202, s77
    ds_write_b128 v16, v[92:95] offset:1024
    s_lshr_b32 s80, 0x3a3b3c3d, s88
    s_and_b32 s80, s80, 0xff
    s_lshl_b32 s80, s80, 11
    v_add_u32 v16, s80, v140
    v_perm_b32 v84, v150, v146, s78
    v_perm_b32 v85, v158, v154, s78
    v_perm_b32 v86, v166, v162, s78
    v_perm_b32 v87, v174, v170, s78
    ds_write_b128 v16, v[84:87] offset:0
    v_perm_b32 v88, v182, v178, s78
    v_perm_b32 v89, v190, v186, s78
    v_perm_b32 v90, v198, v194, s78
    v_perm_b32 v91, v206, v202, s78
    ds_write_b128 v16, v[88:91] offset:1024
    s_lshr_b32 s80, 0x647073f, s88
    s_and_b32 s80, s80, 0xff
    s_lshl_b32 s80, s80, 11
    v_add_u32 v16, s80, v140
    v_perm_b32 v92, v151, v147, s77
    v_perm_b32 v93, v159, v155, s77
    v_perm_b32 v94, v167, v163, s77
    v_perm_b32 v95, v175, v171, s77
    ds_write_b128 v16, v[92:95] offset:0
    v_perm_b32 v84, v183, v179, s77
    v_perm_b32 v85, v191, v187, s77
    v_perm_b32 v86, v199, v195, s77
    v_perm_b32 v87, v207, v203, s77
    ds_write_b128 v16, v[84:87] offset:1024
    s_lshr_b32 s80, 0x4c4d4e4f, s88
    s_and_b32 s80, s80, 0xff
    s_lshl_b32 s80, s80, 11
    v_add_u32 v16, s80, v140
    v_perm_b32 v88, v151, v147, s78
    v_perm_b32 v89, v159, v155, s78
    v_perm_b32 v90, v167, v163, s78
    v_perm_b32 v91, v175, v171, s78
    ds_write_b128 v16, v[88:91] offset:0
    v_perm_b32 v92, v183, v179, s78
    v_perm_b32 v93, v191, v187, s78
    v_perm_b32 v94, v199, v195, s78
    v_perm_b32 v95, v207, v203, s78
    ds_write_b128 v16, v[92:95] offset:1024
    s_waitcnt lgkmcnt(0)
    s_barrier
    ds_read_b128 a[80:83], v11 offset:2048
    ds_read_b128 a[84:87], v11 offset:3072
    ds_read_b128 a[104:107], v11 offset:0
    ds_read_b128 a[108:111], v11 offset:1024
    ds_read_b128 a[112:115], v134 offset:34816
    ds_read_b128 a[116:119], v134 offset:35840
    ds_read_b128 a[128:131], v134 offset:32768
    ds_read_b128 a[132:135], v134 offset:33792
    ds_read_b128 a[144:147], v134 offset:30720
    ds_read_b128 a[148:151], v134 offset:31744
    ds_read_b128 a[160:163], v134 offset:28672
    ds_read_b128 a[164:167], v134 offset:29696
    s_waitcnt lgkmcnt(4)
    s_waitcnt lgkmcnt(0)
    s_barrier
    s_lshl_b32 s80, s35, 2
    s_add_u32 s80, s80, 0x41000
    s_cmp_eq_u32 s34, 0
    s_cselect_b32 s80, s80, 0x80000000
    v_mov_b32 v4, 1
    buffer_store_dword v4, off, s[36:39], s80
    s_waitcnt vmcnt(16)
    v_perm_b32 v144, v24, v20, s77
    v_perm_b32 v145, v24, v20, s78
    v_perm_b32 v146, v32, v28, s77
    v_perm_b32 v147, v32, v28, s78
    v_perm_b32 v148, v40, v36, s77
    v_perm_b32 v149, v40, v36, s78
    v_perm_b32 v150, v48, v44, s77
    v_perm_b32 v151, v48, v44, s78
    v_perm_b32 v176, v25, v21, s77
    v_perm_b32 v177, v25, v21, s78
    v_perm_b32 v178, v33, v29, s77
    v_perm_b32 v179, v33, v29, s78
    v_perm_b32 v180, v41, v37, s77
    v_perm_b32 v181, v41, v37, s78
    v_perm_b32 v182, v49, v45, s77
    v_perm_b32 v183, v49, v45, s78
    v_perm_b32 v192, v26, v22, s77
    v_perm_b32 v193, v26, v22, s78
    v_perm_b32 v194, v34, v30, s77
    v_perm_b32 v195, v34, v30, s78
    v_perm_b32 v196, v42, v38, s77
    v_perm_b32 v197, v42, v38, s78
    v_perm_b32 v198, v50, v46, s77
    v_perm_b32 v199, v50, v46, s78
    v_perm_b32 v208, v27, v23, s77
    v_perm_b32 v209, v27, v23, s78
    v_perm_b32 v210, v35, v31, s77
    v_perm_b32 v211, v35, v31, s78
    v_perm_b32 v212, v43, v39, s77
    v_perm_b32 v213, v43, v39, s78
    v_perm_b32 v214, v51, v47, s77
    v_perm_b32 v215, v51, v47, s78
    s_mov_b32 s80, 0x1800
    buffer_load_dwordx4 v[20:23], v17, s[40:43], s80 offen
    s_mov_b32 s80, 0x3800
    buffer_load_dwordx4 v[24:27], v17, s[40:43], s80 offen
    s_mov_b32 s80, 0x5800
    buffer_load_dwordx4 v[28:31], v17, s[40:43], s80 offen
    s_mov_b32 s80, 0x7800
    buffer_load_dwordx4 v[32:35], v17, s[40:43], s80 offen
    s_mov_b32 s80, 0x11800
    buffer_load_dwordx4 v[36:39], v17, s[40:43], s80 offen
    s_mov_b32 s80, 0x13800
    buffer_load_dwordx4 v[40:43], v17, s[40:43], s80 offen
    s_mov_b32 s80, 0x15800
    buffer_load_dwordx4 v[44:47], v17, s[40:43], s80 offen
    s_mov_b32 s80, 0x17800
    buffer_load_dwordx4 v[48:51], v17, s[40:43], s80 offen
    s_waitcnt vmcnt(16)
    v_perm_b32 v152, v56, v52, s77
    v_perm_b32 v153, v56, v52, s78
    v_perm_b32 v154, v64, v60, s77
    v_perm_b32 v155, v64, v60, s78
    v_perm_b32 v156, v72, v68, s77
    v_perm_b32 v157, v72, v68, s78
    v_perm_b32 v158, v80, v76, s77
    v_perm_b32 v159, v80, v76, s78
    v_perm_b32 v92, v57, v53, s77
    v_perm_b32 v93, v57, v53, s78
    v_perm_b32 v94, v65, v61, s77
    v_perm_b32 v95, v65, v61, s78
    ds_write_b128 v134, v[92:95] offset:24576
    v_perm_b32 v84, v73, v69, s77
    v_perm_b32 v85, v73, v69, s78
    v_perm_b32 v86, v81, v77, s77
    v_perm_b32 v87, v81, v77, s78
    ds_write_b128 v134, v[84:87] offset:25600
    v_perm_b32 v88, v58, v54, s77
    v_perm_b32 v89, v58, v54, s78
    v_perm_b32 v90, v66, v62, s77
    v_perm_b32 v91, v66, v62, s78
    ds_write_b128 v134, v[88:91] offset:28672
    v_perm_b32 v92, v74, v70, s77
    v_perm_b32 v93, v74, v70, s78
    v_perm_b32 v94, v82, v78, s77
    v_perm_b32 v95, v82, v78, s78
    ds_write_b128 v134, v[92:95] offset:29696
    v_perm_b32 v84, v59, v55, s77
    v_perm_b32 v85, v59, v55, s78
    v_perm_b32 v86, v67, v63, s77
    v_perm_b32 v87, v67, v63, s78
    ds_write_b128 v134, v[84:87] offset:32768
    v_perm_b32 v88, v75, v71, s77
    v_perm_b32 v89, v75, v71, s78
    v_perm_b32 v90, v83, v79, s77
    v_perm_b32 v91, v83, v79, s78
    ds_write_b128 v134, v[88:91] offset:33792
    s_mov_b32 s80, 0x40000
    v_lshlrev_b32 v8, 2, v140
    buffer_load_dword v8, v8, s[36:39], s80 offen sc1
    s_add_u32 s80, s52, 0x80000
    buffer_load_dwordx3 v[128:130], v140, s[36:39], s52 offen offset:0 sc1
    buffer_load_dwordx3 v[128:130], v140, s[36:39], s52 offen offset:1024 sc1
    buffer_load_dwordx3 v[128:130], v140, s[36:39], s52 offen offset:2048 sc1
    buffer_load_dwordx3 v[128:130], v140, s[36:39], s52 offen offset:3072 sc1
    buffer_load_dwordx3 v[128:130], v140, s[36:39], s80 offen offset:0 sc1
    buffer_load_dwordx3 v[128:130], v140, s[36:39], s80 offen offset:1024 sc1
    buffer_load_dwordx3 v[128:130], v140, s[36:39], s80 offen offset:2048 sc1
    buffer_load_dwordx3 v[128:130], v140, s[36:39], s80 offen offset:3072 sc1
    s_waitcnt vmcnt(17)
    v_perm_b32 v160, v100, v96, s77
    v_perm_b32 v161, v100, v96, s78
    v_perm_b32 v162, v108, v104, s77
    v_perm_b32 v163, v108, v104, s78
    v_perm_b32 v164, v116, v112, s77
    v_perm_b32 v165, v116, v112, s78
    v_perm_b32 v166, v124, v120, s77
    v_perm_b32 v167, v124, v120, s78
    v_perm_b32 v184, v101, v97, s77
    v_perm_b32 v185, v101, v97, s78
    v_perm_b32 v186, v109, v105, s77
    v_perm_b32 v187, v109, v105, s78
    v_perm_b32 v188, v117, v113, s77
    v_perm_b32 v189, v117, v113, s78
    v_perm_b32 v190, v125, v121, s77
    v_perm_b32 v191, v125, v121, s78
    v_perm_b32 v200, v102, v98, s77
    v_perm_b32 v201, v102, v98, s78
    v_perm_b32 v202, v110, v106, s77
    v_perm_b32 v203, v110, v106, s78
    v_perm_b32 v204, v118, v114, s77
    v_perm_b32 v205, v118, v114, s78
    v_perm_b32 v206, v126, v122, s77
    v_perm_b32 v207, v126, v122, s78
    v_perm_b32 v216, v103, v99, s77
    v_perm_b32 v217, v103, v99, s78
    v_perm_b32 v218, v111, v107, s77
    v_perm_b32 v219, v111, v107, s78
    v_perm_b32 v220, v119, v115, s77
    v_perm_b32 v221, v119, v115, s78
    v_perm_b32 v222, v127, v123, s77
    v_perm_b32 v223, v127, v123, s78
    s_waitcnt vmcnt(9)
    v_perm_b32 v168, v24, v20, s77
    v_perm_b32 v169, v24, v20, s78
    v_perm_b32 v170, v32, v28, s77
    v_perm_b32 v171, v32, v28, s78
    v_perm_b32 v172, v40, v36, s77
    v_perm_b32 v173, v40, v36, s78
    v_perm_b32 v174, v48, v44, s77
    v_perm_b32 v175, v48, v44, s78
    v_perm_b32 v92, v25, v21, s77
    v_perm_b32 v93, v25, v21, s78
    v_perm_b32 v94, v33, v29, s77
    v_perm_b32 v95, v33, v29, s78
    ds_write_b128 v134, v[92:95] offset:26624
    v_perm_b32 v84, v41, v37, s77
    v_perm_b32 v85, v41, v37, s78
    v_perm_b32 v86, v49, v45, s77
    v_perm_b32 v87, v49, v45, s78
    ds_write_b128 v134, v[84:87] offset:27648
    v_perm_b32 v88, v26, v22, s77
    v_perm_b32 v89, v26, v22, s78
    v_perm_b32 v90, v34, v30, s77
    v_perm_b32 v91, v34, v30, s78
    ds_write_b128 v134, v[88:91] offset:30720
    v_perm_b32 v92, v42, v38, s77
    v_perm_b32 v93, v42, v38, s78
    v_perm_b32 v94, v50, v46, s77
    v_perm_b32 v95, v50, v46, s78
    ds_write_b128 v134, v[92:95] offset:31744
    v_perm_b32 v84, v27, v23, s77
    v_perm_b32 v85, v27, v23, s78
    v_perm_b32 v86, v35, v31, s77
    v_perm_b32 v87, v35, v31, s78
    ds_write_b128 v134, v[84:87] offset:34816
    v_perm_b32 v88, v43, v39, s77
    v_perm_b32 v89, v43, v39, s78
    v_perm_b32 v90, v51, v47, s77
    v_perm_b32 v91, v51, v47, s78
    ds_write_b128 v134, v[88:91] offset:35840
    v_mov_b32 v3, 0
    v_lshlrev_b32 v4, 3, v0
    v_mov_b32 v6, 0
    v_mov_b32 v7, 0
    ds_write_b64 v4, v[6:7] offset:12288
    ds_write_b64 v4, v[6:7] offset:13312
    v_and_b32 v3, 31, v0
    v_lshlrev_b32 v3, 2, v3
    s_mov_b32 s80, 0x41000
L_c0_bar:
    buffer_load_dword v4, v3, s[36:39], s80 offen sc1
    s_waitcnt vmcnt(0)
    v_cmp_ne_u32 vcc, 1, v4
    s_cbranch_vccz L_c0_bar_ok
    s_sub_u32 s100, s100, 1
    s_mov_b32 s101, 10
    s_cbranch_scc1 L_fail
    s_branch L_c0_bar
L_c0_bar_ok:
    v_cmp_le_u32 vcc, 32, v8
    s_and_b32 s80, vcc_lo, 0xffff
    s_ff0_i32_b32 s56, s80
    s_mov_b32 s87, 0
    s_mov_b32 s91, 0
    s_mov_b32 s80, 0
    s_mov_b32 s89, 0x40000
    s_mov_b32 s88, 0x80000000
    s_mov_b32 s55, s89
    s_cmp_lg_u32 s56, 0
    s_cbranch_scc1 L_c0_kv0_ok
L_c0_kv0:
    s_mov_b32 s82, 0x40000
    v_lshlrev_b32 v128, 2, v140
    s_waitcnt vmcnt(0)
    buffer_load_dword v128, v128, s[36:39], s82 offen sc1
    s_waitcnt vmcnt(0)
    v_cmp_le_u32 vcc, 32, v128
    s_and_b32 s82, vcc_lo, 0xffff
    s_ff0_i32_b32 s56, s82
    s_cmp_lt_u32 s80, s56
    s_cbranch_scc1 L_c0_kv0_ok
    s_sub_u32 s100, s100, 1
    s_mov_b32 s101, 12
    s_cbranch_scc1 L_fail
    s_branch L_c0_kv0
L_c0_kv0_ok:
    s_cmp_lt_u32 s56, 2
    s_cselect_b32 s55, s89, s88
    buffer_load_dwordx4 v[88:91], v137, s[36:39], s50 offen offset:0 sc1
    buffer_load_dwordx4 v[92:95], v137, s[36:39], s50 offen offset:1024 sc1
    buffer_load_dwordx4 v[96:99], v137, s[36:39], s50 offen offset:2048 sc1
    buffer_load_dwordx4 v[100:103], v137, s[36:39], s50 offen offset:3072 sc1
    s_add_u32 s50, s50, 0x80000
    buffer_load_dwordx4 v[104:107], v140, s[36:39], s51 offen offset:0 sc1
    buffer_load_dwordx4 v[108:111], v140, s[36:39], s51 offen offset:1024 sc1
    s_add_u32 s51, s51, 0x80000
    s_add_u32 s52, s52, 0x80000
    buffer_load_dwordx3 v[128:130], v140, s[36:39], s52 offen offset:0 sc1
    buffer_load_dwordx3 v[128:130], v140, s[36:39], s52 offen offset:1024 sc1
    buffer_load_dwordx3 v[128:130], v140, s[36:39], s52 offen offset:2048 sc1
    buffer_load_dwordx3 v[128:130], v140, s[36:39], s52 offen offset:3072 sc1
    s_add_u32 s52, s52, 0x80000
    v_and_b32 v4, 31, v0
    v_lshlrev_b32 v133, 2, v4
    s_waitcnt lgkmcnt(0)
    ds_read_b128 v[56:59], v134 offset:0
    ds_read_b128 v[60:63], v134 offset:1024
    ds_read_b128 v[64:67], v134 offset:2048
    ds_read_b128 v[68:71], v134 offset:3072
    ds_read_b128 v[72:75], v134 offset:4096
    ds_read_b128 v[76:79], v134 offset:5120
    ds_read_b128 v[80:83], v134 offset:6144
    ds_read_b128 v[84:87], v134 offset:7168
    v_mov_b64 v[32:33], 0
    v_mov_b64 v[34:35], 0
    v_mov_b64 v[36:37], 0
    v_mov_b64 v[38:39], 0
    v_mov_b64 v[40:41], 0
    v_mov_b64 v[42:43], 0
    v_mov_b64 v[44:45], 0
    v_mov_b64 v[46:47], 0
    v_mov_b64 v[48:49], 0
    v_mov_b64 v[50:51], 0
    v_mov_b64 v[52:53], 0
    v_mov_b64 v[54:55], 0
    s_lshl_b32 s80, s34, 11
    s_add_u32 m0, s80, 0
    s_waitcnt vmcnt(0)
    s_barrier
    s_cmp_eq_u32 s34, 1
    s_cbranch_scc1 L_c0_enter1
    s_cmp_eq_u32 s34, 2
    s_cbranch_scc1 L_c0_enter2
    s_cmp_eq_u32 s34, 3
    s_cbranch_scc1 L_c0_enter3
L_c0_enter0:
    buffer_load_dword v114, v133, s[36:39], s65 offen sc1
    buffer_load_dwordx4 v140, s[36:39], s45 offen sc1 lds
    buffer_load_dwordx4 v140, s[36:39], s45 offen offset:1024 sc1 lds
    buffer_load_dword v115, v133, s[36:39], s65 offen sc1
    buffer_load_dwordx4 v140, s[36:39], s45 offen sc1 lds
    buffer_load_dwordx4 v140, s[36:39], s45 offen offset:1024 sc1 lds
    s_waitcnt vmcnt(0)
    .p2align 6
L_c0_w0_step:
    s_waitcnt vmcnt(5) lgkmcnt(0)
    v_cmp_ne_u32 vcc, s44, v114
    s_cbranch_vccnz L_c0_w0_spinA
    s_waitcnt vmcnt(3)
L_c0_w0_hit:
    s_barrier
    ds_read_b128 v[0:3], v140 offset:0
    ds_read_b128 v[4:7], v140 offset:1024
    s_waitcnt lgkmcnt(1)
    v_smfmac_f32_16x16x64_bf16 v[32:35], v[0:3], v[56:63], v131
    ds_read_b128 v[8:11], v140 offset:2048
    v_mov_b32 v124, s66
    v_smfmac_f32_16x16x64_bf16 v[36:39], v[0:3], a[40:47], v131
    s_waitcnt lgkmcnt(1)
    ds_read_b128 v[12:15], v140 offset:3072
    buffer_load_dwordx3 v[128:130], v140, s[36:39], s52 offen offset:0 sc1
    v_smfmac_f32_16x16x64_bf16 v[40:43], v[0:3], v[64:71], v131
    ds_read_b128 v[56:59], v134 offset:8192
    v_lshlrev_b32 v126, 2, v140
    v_smfmac_f32_16x16x64_bf16 v[44:47], v[0:3], a[112:119], v131
    ds_read_b128 v[60:63], v134 offset:9216
    v_smfmac_f32_16x16x64_bf16 v[32:35], v[4:7], v[72:79], v131
    ds_read_b128 v[64:67], v134 offset:10240
    buffer_load_dwordx3 v[128:130], v140, s[36:39], s52 offen offset:1024 sc1
    v_smfmac_f32_16x16x64_bf16 v[36:39], v[4:7], a[48:55], v131
    ds_read_b128 v[68:71], v134 offset:11264
    v_smfmac_f32_16x16x64_bf16 v[40:43], v[4:7], v[80:87], v131
    ds_read_b128 v[72:75], v134 offset:12288
    v_smfmac_f32_16x16x64_bf16 v[44:47], v[4:7], a[120:127], v131
    s_waitcnt lgkmcnt(6)
    ds_read_b128 v[76:79], v134 offset:13312
    buffer_load_dwordx3 v[128:130], v140, s[36:39], s52 offen offset:2048 sc1
    v_smfmac_f32_16x16x64_bf16 v[32:35], v[8:11], a[0:7], v131
    s_waitcnt lgkmcnt(4)
    ds_read_b128 v[80:83], v134 offset:14336
    v_smfmac_f32_16x16x64_bf16 v[36:39], v[8:11], v[56:63], v131
    ds_read_b128 v[84:87], v134 offset:15360
    v_smfmac_f32_16x16x64_bf16 v[40:43], v[8:11], a[80:87], v131
    ds_read_b128 v[56:59], v134 offset:16384
    buffer_load_dwordx3 v[128:130], v140, s[36:39], s52 offen offset:3072 sc1
    v_smfmac_f32_16x16x64_bf16 v[44:47], v[8:11], a[128:135], v131
    s_waitcnt lgkmcnt(9)
    ds_read_b128 v[60:63], v134 offset:17408
    v_smfmac_f32_16x16x64_bf16 v[32:35], v[12:15], a[8:15], v131
    s_waitcnt lgkmcnt(6)
    v_smfmac_f32_16x16x64_bf16 v[36:39], v[12:15], v[64:71], v131
    ds_read_b128 v[64:67], v134 offset:18432
    buffer_load_dword v128, v126, s[36:39], s55 offen sc1
    v_smfmac_f32_16x16x64_bf16 v[40:43], v[12:15], a[88:95], v131
    s_barrier
    ds_read_b128 v[16:19], v140 offset:4096
    v_smfmac_f32_16x16x64_bf16 v[44:47], v[12:15], a[136:143], v131
    s_waitcnt lgkmcnt(6)
    ds_read_b128 v[20:23], v140 offset:5120
    v_smfmac_f32_16x16x64_bf16 v[48:51], v[0:3], v[72:79], v131
    ds_read_b128 v[24:27], v140 offset:6144
    v_smfmac_f32_16x16x64_bf16 v[52:55], v[0:3], a[224:231], v131
    ds_read_b128 v[28:31], v140 offset:7168
    v_smfmac_f32_16x16x64_bf16 v[48:51], v[4:7], a[168:175], v131
    s_waitcnt lgkmcnt(3)
    ds_read_b128 v[68:71], v134 offset:19456
    v_smfmac_f32_16x16x64_bf16 v[32:35], v[16:19], a[16:23], v131
    s_waitcnt lgkmcnt(3)
    ds_read_b128 v[72:75], v134 offset:20480
    v_smfmac_f32_16x16x64_bf16 v[32:35], v[20:23], v[80:87], v131
    s_waitcnt lgkmcnt(3)
    ds_read_b128 v[76:79], v134 offset:21504
    v_smfmac_f32_16x16x64_bf16 v[32:35], v[24:27], a[24:31], v131
    s_waitcnt lgkmcnt(3)
    ds_read_b128 v[80:83], v134 offset:22528
    v_smfmac_f32_16x16x64_bf16 v[32:35], v[28:31], a[32:39], v131
    s_waitcnt lgkmcnt(9)
    ds_read_b128 v[84:87], v134 offset:23552
    buffer_store_dword v116, v142, s[36:39], s54 offen sc1
    v_smfmac_f32_16x16x64_bf16 v[36:39], v[16:19], v[56:63], v131
    v_smfmac_f32_16x16x64_bf16 v[36:39], v[20:23], a[56:63], v131
    buffer_store_dword v124, v142, s[36:39], s47 offen
    v_add_f32 v32, v32, v34
    v_smfmac_f32_16x16x64_bf16 v[36:39], v[24:27], a[64:71], v131
    v_add_f32 v33, v33, v35
    v_smfmac_f32_16x16x64_bf16 v[36:39], v[28:31], a[72:79], v131
    s_waitcnt lgkmcnt(4)
    v_smfmac_f32_16x16x64_bf16 v[40:43], v[16:19], v[64:71], v131
    v_mov_b64 v[68:69], s[68:69]
    v_smfmac_f32_16x16x64_bf16 v[40:43], v[20:23], a[96:103], v131
    v_add_f32 v36, v36, v38
    v_add_f32 v37, v37, v39
    v_smfmac_f32_16x16x64_bf16 v[40:43], v[24:27], a[104:111], v131
    s_waitcnt lgkmcnt(2)
    v_cvt_pk_bf16_f32 v32, v32, v36
    v_cvt_pk_bf16_f32 v33, v33, v37
    v_smfmac_f32_16x16x64_bf16 v[40:43], v[28:31], v[72:79], v131
    ds_write2_b32 v135, v32, v33 offset0:0 offset1:4
    v_smfmac_f32_16x16x64_bf16 v[44:47], v[16:19], a[144:151], v131
    ds_read_b128 v[72:75], v134 offset:24576
    v_mov_b64 v[70:71], s[68:69]
    v_smfmac_f32_16x16x64_bf16 v[44:47], v[20:23], a[152:159], v131
    ds_read_b128 v[76:79], v134 offset:25600
    v_add_f32 v40, v40, v42
    v_smfmac_f32_16x16x64_bf16 v[44:47], v[24:27], a[160:167], v131
    s_waitcnt lgkmcnt(3)
    v_add_f32 v41, v41, v43
    v_smfmac_f32_16x16x64_bf16 v[44:47], v[28:31], v[80:87], v131
    ds_read_b128 v[80:83], v134 offset:26624
    v_smfmac_f32_16x16x64_bf16 v[52:55], v[4:7], a[232:239], v131
    s_waitcnt lgkmcnt(3)
    s_barrier
    ds_read_b128 v[112:115], v136 offset:8192
    v_smfmac_f32_16x16x64_bf16 v[48:51], v[8:11], a[176:183], v131
    ds_read_b128 v[116:119], v136 offset:9216
    v_add_f32 v44, v44, v46
    v_smfmac_f32_16x16x64_bf16 v[52:55], v[8:11], a[240:247], v131
    ds_read_b128 v[120:123], v136 offset:10240
    v_add_f32 v45, v45, v47
    v_cvt_pk_bf16_f32 v40, v40, v44
    v_smfmac_f32_16x16x64_bf16 v[48:51], v[12:15], a[184:191], v131
    ds_read_b128 v[124:127], v136 offset:11264
    v_cvt_pk_bf16_f32 v41, v41, v45
    v_smfmac_f32_16x16x64_bf16 v[52:55], v[12:15], a[248:255], v131
    s_waitcnt lgkmcnt(3)
    ds_write2_b32 v135, v40, v41 offset0:128 offset1:132
    v_mfma_f32_16x16x32_bf16 v[32:35], v[88:91], v[112:115], 0
    s_waitcnt lgkmcnt(3)
    ds_read_b128 v[84:87], v134 offset:27648
    v_mfma_f32_16x16x32_bf16 v[32:35], v[92:95], v[116:119], v[32:35]
    s_waitcnt lgkmcnt(3)
    buffer_load_dwordx4 v[88:91], v137, s[36:39], s50 offen offset:0 sc1
    v_mfma_f32_16x16x32_bf16 v[32:35], v[96:99], v[120:123], v[32:35]
    s_waitcnt lgkmcnt(2)
    buffer_load_dwordx4 v[92:95], v137, s[36:39], s50 offen offset:1024 sc1
    v_mfma_f32_16x16x32_bf16 v[32:35], v[100:103], v[124:127], v[32:35]
    s_waitcnt lgkmcnt(1)
    s_barrier
    ds_read_b128 v[0:3], v137 offset:8704
    v_smfmac_f32_16x16x64_bf16 v[48:51], v[16:19], a[192:199], v131
    ds_read_b128 v[4:7], v137 offset:9728
    buffer_load_dwordx4 v[96:99], v137, s[36:39], s50 offen offset:2048 sc1
    v_smfmac_f32_16x16x64_bf16 v[48:51], v[20:23], a[200:207], v131
    ds_read_b128 v[8:11], v137 offset:10752
    v_exp_f32 v36, v32
    v_smfmac_f32_16x16x64_bf16 v[48:51], v[24:27], a[208:215], v131
    s_waitcnt lgkmcnt(2)
    ds_read_b128 v[12:15], v137 offset:11776
    v_exp_f32 v37, v33
    v_mfma_f32_16x16x32_bf16 v[44:47], v[0:3], v[112:115], 0
    s_waitcnt lgkmcnt(2)
    buffer_load_dwordx4 v[100:103], v137, s[36:39], s50 offen offset:3072 sc1
    v_cvt_pk_bf16_f32 v36, v36, v37
    v_mfma_f32_16x16x32_bf16 v[44:47], v[4:7], v[116:119], v[44:47]
    s_waitcnt lgkmcnt(1)
    ds_write_b32 v136, v36 offset:12800
    v_mfma_f32_16x16x32_bf16 v[44:47], v[8:11], v[120:123], v[44:47]
    s_waitcnt lgkmcnt(1)
    v_mov_b64 v[0:1], 0
    v_mov_b64 v[2:3], 0
    v_mfma_f32_16x16x32_bf16 v[44:47], v[12:15], v[124:127], v[44:47]
    v_mov_b64 v[4:5], 0
    v_mov_b64 v[6:7], 0
    v_smfmac_f32_16x16x64_bf16 v[48:51], v[28:31], a[216:223], v131
    v_mov_b64 v[8:9], 0
    v_smfmac_f32_16x16x64_bf16 v[52:55], v[16:19], v[224:231], v131
    s_waitcnt lgkmcnt(0)
    s_barrier
    ds_read_b128 v[64:67], v136 offset:12800
    v_exp_f32 v46, v44
    v_smfmac_f32_16x16x64_bf16 v[52:55], v[20:23], v[232:239], v131
    ds_read_b128 v[56:59], v138 offset:12800
    v_add_f32 v48, v48, v50
    v_exp_f32 v47, v45
    v_smfmac_f32_16x16x64_bf16 v[52:55], v[24:27], v[240:247], v131
    ds_read_b128 v[60:63], v138 offset:12288
    v_add_f32 v49, v49, v51
    v_cvt_pk_bf16_f32 v46, v46, v47
    v_smfmac_f32_16x16x64_bf16 v[52:55], v[28:31], v[248:255], v131
    s_waitcnt lgkmcnt(2)
    v_cvt_pk_bf16_f32 v48, v48, v49
    v_mfma_f32_16x16x32_bf16 v[36:39], v[68:71], v[64:67], 0
    s_waitcnt lgkmcnt(1)
    v_cndmask_b32 v50, 0, v46, s[70:71]
    v_cndmask_b32 v51, v46, 0, s[70:71]
    v_mfma_f32_16x16x32_bf16 v[40:43], v[104:107], v[56:59], 0
    s_waitcnt lgkmcnt(0)
    v_add_f32 v52, v52, v54
    v_add_f32 v53, v53, v55
    v_mfma_f32_16x16x32_bf16 v[40:43], v[108:111], v[60:63], v[40:43]
    v_cvt_pk_bf16_f32 v49, v52, v53
    v_mfma_f32_16x16x16_bf16 v[36:39], v[68:69], v[50:51], v[36:39]
    v_mfma_f32_16x16x16_bf16 v[40:43], v[48:49], v[50:51], v[40:43]
    s_nop 3
    v_rcp_f32 v46, v36
    v_mov_b64 v[10:11], 0
    v_mov_b64 v[12:13], 0
    s_nop 0
    v_pk_mul_f32 v[40:41], v[40:41], v[46:47] op_sel_hi:[1,0]
    v_pk_mul_f32 v[42:43], v[42:43], v[46:47] op_sel_hi:[1,0]
    v_cvt_pk_bf16_f32 v40, v40, v41
    v_cvt_pk_bf16_f32 v41, v42, v43
    ds_write_b64 v139, v[40:41] offset:13824
    v_subrev_u32 v47, s74, v36
    v_cmp_lt_u32 vcc, s75, v47
    v_mov_b64 v[14:15], 0
    s_cbranch_vccnz L_c0_w0_fb
L_c0_w0_fbret:
    buffer_load_dwordx4 v[104:107], v140, s[36:39], s51 offen offset:0 sc1
    buffer_load_dwordx4 v[108:111], v140, s[36:39], s51 offen offset:1024 sc1
    s_waitcnt lgkmcnt(0)
    s_barrier
    ds_read_b128 v[112:115], v137 offset:13824
    ds_read_b128 v[116:119], v137 offset:14336
    ds_read_b128 v[120:123], v137 offset:14848
    ds_read_b128 v[124:127], v137 offset:15360
    s_waitcnt lgkmcnt(3)
    v_smfmac_f32_16x16x64_bf16 v[0:3], v[112:115], v[144:151], v131
    s_waitcnt lgkmcnt(2)
    v_smfmac_f32_16x16x64_bf16 v[0:3], v[116:119], v[152:159], v131
    s_waitcnt lgkmcnt(1)
    ds_read_b128 v[56:59], v134 offset:28672
    v_smfmac_f32_16x16x64_bf16 v[0:3], v[120:123], v[160:167], v131
    s_waitcnt lgkmcnt(1)
    ds_read_b128 v[60:63], v134 offset:29696
    v_smfmac_f32_16x16x64_bf16 v[0:3], v[124:127], v[168:175], v131
    s_add_u32 s84, s48, 4096
    ds_read_b128 v[64:67], v134 offset:30720
    v_smfmac_f32_16x16x64_bf16 v[4:7], v[112:115], v[176:183], v131
    ds_read_b128 v[68:71], v134 offset:31744
    v_smfmac_f32_16x16x64_bf16 v[4:7], v[116:119], v[72:79], v131
    ds_read_b128 v[72:75], v134 offset:32768
    v_cvt_pk_bf16_f32 v16, v0, v2
    v_cvt_pk_bf16_f32 v17, v1, v3
    v_smfmac_f32_16x16x64_bf16 v[4:7], v[120:123], v[184:191], v131
    ds_read_b128 v[76:79], v134 offset:33792
    v_bfi_b32 v16, 1, s87, v16
    v_bfi_b32 v17, 1, s87, v17
    v_smfmac_f32_16x16x64_bf16 v[4:7], v[124:127], v[80:87], v131
    ds_read_b128 v[80:83], v134 offset:34816
    buffer_store_dwordx2 v[16:17], v132, s[36:39], s48 offen offset:0
    v_smfmac_f32_16x16x64_bf16 v[8:11], v[112:115], v[192:199], v131
    s_waitcnt lgkmcnt(5)
    ds_read_b128 v[84:87], v134 offset:35840
    v_smfmac_f32_16x16x64_bf16 v[8:11], v[116:119], v[56:63], v131
    v_cvt_pk_bf16_f32 v18, v4, v6
    v_cvt_pk_bf16_f32 v19, v5, v7
    v_bfi_b32 v18, 1, s87, v18
    v_bfi_b32 v19, 1, s87, v19
    v_smfmac_f32_16x16x64_bf16 v[8:11], v[120:123], v[200:207], v131
    s_waitcnt lgkmcnt(4)
    buffer_store_dwordx2 v[18:19], v132, s[36:39], s48 offen offset:2048
    v_smfmac_f32_16x16x64_bf16 v[8:11], v[124:127], v[64:71], v131
    v_smfmac_f32_16x16x64_bf16 v[12:15], v[112:115], v[208:215], v131
    s_waitcnt lgkmcnt(2)
    v_smfmac_f32_16x16x64_bf16 v[12:15], v[116:119], v[72:79], v131
    v_cvt_pk_bf16_f32 v20, v8, v10
    v_smfmac_f32_16x16x64_bf16 v[12:15], v[120:123], v[216:223], v131
    s_waitcnt lgkmcnt(0)
    v_cvt_pk_bf16_f32 v21, v9, v11
    v_smfmac_f32_16x16x64_bf16 v[12:15], v[124:127], v[80:87], v131
    v_bfi_b32 v20, 1, s87, v20
    v_bfi_b32 v21, 1, s87, v21
    buffer_store_dwordx2 v[20:21], v132, s[36:39], s84 offen offset:0
    s_nop 3
    v_cvt_pk_bf16_f32 v22, v12, v14
    v_cvt_pk_bf16_f32 v23, v13, v15
    v_bfi_b32 v22, 1, s87, v22
    v_bfi_b32 v23, 1, s87, v23
    buffer_store_dwordx2 v[22:23], v132, s[36:39], s84 offen offset:2048
    v_mov_b64 v[40:41], 0
    v_mov_b64 v[42:43], 0
    v_mov_b64 v[44:45], 0
    v_mov_b64 v[46:47], 0
    v_mov_b64 v[48:49], 0
    v_mov_b64 v[50:51], 0
    v_mov_b64 v[52:53], 0
    v_mov_b64 v[54:55], 0
    ds_read_b128 v[56:59], v134 offset:0
    ds_read_b128 v[60:63], v134 offset:1024
    ds_read_b128 v[64:67], v134 offset:2048
    ds_read_b128 v[68:71], v134 offset:3072
    ds_read_b128 v[72:75], v134 offset:4096
    ds_read_b128 v[76:79], v134 offset:5120
    ds_read_b128 v[80:83], v134 offset:6144
    ds_read_b128 v[84:87], v134 offset:7168
    buffer_load_dword v32, v141, s[36:39], s57 offen sc1
    buffer_load_dword v33, v141, s[36:39], s58 offen sc1
    buffer_load_dword v34, v141, s[36:39], s59 offen sc1
    buffer_load_dword v35, v141, s[36:39], s60 offen sc1
    buffer_load_dword v36, v141, s[36:39], s61 offen sc1
    buffer_load_dword v37, v141, s[36:39], s62 offen sc1
    buffer_load_dword v38, v141, s[36:39], s63 offen sc1
    buffer_load_dword v39, v141, s[36:39], s64 offen sc1
    s_mov_b32 s80, s47
    s_mov_b32 s47, s45
    s_mov_b32 s45, s46
    s_mov_b32 s46, s80
    s_add_u32 s53, s53, 8192
    s_mov_b32 s54, s53
    s_add_u32 s44, s44, 1
    v_mov_b32 v112, v143
    v_mov_b32 v113, v143
    v_mov_b32 v114, v143
    v_mov_b32 v115, v143
    v_mov_b32 v2, s44
    s_waitcnt vmcnt(4)
L_c0_w0_p2w:
    v_mfma_f32_16x16x32_bf16 v[116:119], v[112:115], v[32:35], 0
    v_bitop3_b32 v0, v32, v33, s87 bitop3:0x7e
    v_bitop3_b32 v1, v34, v35, s87 bitop3:0x7e
    s_waitcnt vmcnt(0)
    v_mfma_f32_16x16x32_bf16 v[116:119], v[112:115], v[36:39], v[116:119]
    v_bitop3_b32 v3, v36, v37, s87 bitop3:0x7e
    v_bitop3_b32 v4, v38, v39, s87 bitop3:0x7e
    v_or3_b32 v0, v0, v1, v3
    v_bitop3_b32 v0, v0, v4, 1 bitop3:0xa8
    v_cmp_ne_u32 vcc, 0, v0
    s_cbranch_vccnz L_c0_w0_p2retry
L_c0_w0_p2ok:
    s_nop 0
    v_cvt_pk_bf16_f32 v116, v116, v117
    buffer_store_dword v116, v142, s[36:39], s45 offen
    s_cmp_eq_u32 s44, 63
    s_cbranch_scc1 L_c0_fin
    s_nop 2
    buffer_store_dword v2, off, s[36:39], s90
    v_mov_b64 v[32:33], 0
    v_mov_b64 v[34:35], 0
    v_mov_b64 v[36:37], 0
    v_mov_b64 v[38:39], 0
    s_sub_u32 s95, s79, s48
    s_mov_b32 s82, s49
    s_mov_b32 s49, s48
    s_mov_b32 s48, s79
    s_mov_b32 s79, s49
    s_add_u32 s52, s52, 0x80000
    s_mov_b32 s91, 0
    s_add_u32 s50, s50, 524288
    s_add_u32 s51, s51, 524288
    v_cmp_le_u32 vcc, 32, v128
    s_and_b32 s80, vcc_lo, 0xffff
    s_ff0_i32_b32 s80, s80
    s_max_u32 s56, s56, s80
    s_add_u32 s80, s44, 4
    s_lshr_b32 s80, s80, 2
    s_min_u32 s80, s80, 15
    s_cmp_lt_u32 s80, s56
    s_cselect_b32 s55, s88, s89
    s_add_u32 s80, s44, 2
    s_lshr_b32 s80, s80, 2
    s_min_u32 s80, s80, 15
    s_cmp_lt_u32 s80, s56
    s_cbranch_scc0 L_c0_w0_kvwait
L_c0_w0_kvok:
    v_add_u32 v141, s95, v141
    s_bfe_i32 s87, s44, 0x10001
    s_nop 6
    buffer_load_dword v114, v133, s[36:39], s65 offen sc1
    buffer_load_dwordx4 v140, s[36:39], s45 offen sc1 lds
    buffer_load_dwordx4 v140, s[36:39], s45 offen offset:1024 sc1 lds
    s_nop 7
    s_nop 7
    s_nop 7
    buffer_load_dword v115, v133, s[36:39], s65 offen sc1
    buffer_load_dwordx4 v140, s[36:39], s45 offen sc1 lds
    buffer_load_dwordx4 v140, s[36:39], s45 offen offset:1024 sc1 lds
    s_branch L_c0_w0_step
L_c0_w0_spinA:
    buffer_load_dword v114, v133, s[36:39], s65 offen sc1
    buffer_load_dwordx4 v140, s[36:39], s45 offen sc1 lds
    buffer_load_dwordx4 v140, s[36:39], s45 offen offset:1024 sc1 lds
    s_waitcnt vmcnt(5)
    v_cmp_ne_u32 vcc, s44, v115
    s_cbranch_vccz L_c0_w0_spunA
    buffer_load_dword v115, v133, s[36:39], s65 offen sc1
    buffer_load_dwordx4 v140, s[36:39], s45 offen sc1 lds
    buffer_load_dwordx4 v140, s[36:39], s45 offen offset:1024 sc1 lds
    s_branch L_c0_w0_spin0
L_c0_w0_spunA:
    s_waitcnt vmcnt(3)
    s_branch L_c0_w0_hit
L_c0_w0_spin0:
    s_waitcnt vmcnt(5)
    v_cmp_ne_u32 vcc, s44, v114
    s_cbranch_vccz L_c0_w0_spun
L_c0_w0_spin1:
    buffer_load_dword v114, v133, s[36:39], s65 offen sc1
    buffer_load_dwordx4 v140, s[36:39], s45 offen sc1 lds
    buffer_load_dwordx4 v140, s[36:39], s45 offen offset:1024 sc1 lds
    s_waitcnt vmcnt(5)
    v_cmp_ne_u32 vcc, s44, v115
    s_cbranch_vccz L_c0_w0_spun
    buffer_load_dword v115, v133, s[36:39], s65 offen sc1
    buffer_load_dwordx4 v140, s[36:39], s45 offen sc1 lds
    buffer_load_dwordx4 v140, s[36:39], s45 offen offset:1024 sc1 lds
    s_sub_u32 s100, s100, 1
    s_mov_b32 s101, 12
    s_cbranch_scc1 L_fail
    s_branch L_c0_w0_spin0
L_c0_w0_spun:
    s_waitcnt vmcnt(3)
    s_branch L_c0_w0_hit
L_c0_w0_redo:
    s_mov_b32 s91, 1
    s_mov_b32 s54, 0x80000000
    s_sub_u32 s50, s50, 0x80000
    buffer_load_dwordx4 v[88:91], v137, s[36:39], s50 offen offset:0 sc1
    buffer_load_dwordx4 v[92:95], v137, s[36:39], s50 offen offset:1024 sc1
    buffer_load_dwordx4 v[96:99], v137, s[36:39], s50 offen offset:2048 sc1
    buffer_load_dwordx4 v[100:103], v137, s[36:39], s50 offen offset:3072 sc1
    s_add_u32 s50, s50, 0x80000
L_c0_w0_redo1:
    s_waitcnt vmcnt(0) lgkmcnt(0)
    s_barrier
    s_sub_u32 s100, s100, 1
    s_mov_b32 s101, 13
    s_cbranch_scc1 L_fail
    buffer_load_dwordx4 v140, s[36:39], s45 offen sc1 lds
    buffer_load_dwordx4 v140, s[36:39], s45 offen offset:1024 sc1 lds
    s_waitcnt vmcnt(0)
    s_barrier
    ds_read_b128 v[0:3], v140 offset:0
    ds_read_b128 v[4:7], v140 offset:1024
    ds_read_b128 v[8:11], v140 offset:2048
    ds_read_b128 v[12:15], v140 offset:3072
    ds_read_b128 v[16:19], v140 offset:4096
    ds_read_b128 v[20:23], v140 offset:5120
    ds_read_b128 v[24:27], v140 offset:6144
    ds_read_b128 v[28:31], v140 offset:7168
    s_waitcnt lgkmcnt(0)
    v_cmp_eq_u32 vcc, s66, v0
    s_cbranch_vccnz L_c0_w0_redo1
    v_cmp_eq_u32 vcc, s66, v1
    s_cbranch_vccnz L_c0_w0_redo1
    v_cmp_eq_u32 vcc, s66, v2
    s_cbranch_vccnz L_c0_w0_redo1
    v_cmp_eq_u32 vcc, s66, v3
    s_cbranch_vccnz L_c0_w0_redo1
    v_cmp_eq_u32 vcc, s66, v4
    s_cbranch_vccnz L_c0_w0_redo1
    v_cmp_eq_u32 vcc, s66, v5
    s_cbranch_vccnz L_c0_w0_redo1
    v_cmp_eq_u32 vcc, s66, v6
    s_cbranch_vccnz L_c0_w0_redo1
    v_cmp_eq_u32 vcc, s66, v7
    s_cbranch_vccnz L_c0_w0_redo1
    v_cmp_eq_u32 vcc, s66, v8
    s_cbranch_vccnz L_c0_w0_redo1
    v_cmp_eq_u32 vcc, s66, v9
    s_cbranch_vccnz L_c0_w0_redo1
    v_cmp_eq_u32 vcc, s66, v10
    s_cbranch_vccnz L_c0_w0_redo1
    v_cmp_eq_u32 vcc, s66, v11
    s_cbranch_vccnz L_c0_w0_redo1
    v_cmp_eq_u32 vcc, s66, v12
    s_cbranch_vccnz L_c0_w0_redo1
    v_cmp_eq_u32 vcc, s66, v13
    s_cbranch_vccnz L_c0_w0_redo1
    v_cmp_eq_u32 vcc, s66, v14
    s_cbranch_vccnz L_c0_w0_redo1
    v_cmp_eq_u32 vcc, s66, v15
    s_cbranch_vccnz L_c0_w0_redo1
    v_cmp_eq_u32 vcc, s66, v16
    s_cbranch_vccnz L_c0_w0_redo1
    v_cmp_eq_u32 vcc, s66, v17
    s_cbranch_vccnz L_c0_w0_redo1
    v_cmp_eq_u32 vcc, s66, v18
    s_cbranch_vccnz L_c0_w0_redo1
    v_cmp_eq_u32 vcc, s66, v19
    s_cbranch_vccnz L_c0_w0_redo1
    v_cmp_eq_u32 vcc, s66, v20
    s_cbranch_vccnz L_c0_w0_redo1
    v_cmp_eq_u32 vcc, s66, v21
    s_cbranch_vccnz L_c0_w0_redo1
    v_cmp_eq_u32 vcc, s66, v22
    s_cbranch_vccnz L_c0_w0_redo1
    v_cmp_eq_u32 vcc, s66, v23
    s_cbranch_vccnz L_c0_w0_redo1
    v_cmp_eq_u32 vcc, s66, v24
    s_cbranch_vccnz L_c0_w0_redo1
    v_cmp_eq_u32 vcc, s66, v25
    s_cbranch_vccnz L_c0_w0_redo1
    v_cmp_eq_u32 vcc, s66, v26
    s_cbranch_vccnz L_c0_w0_redo1
    v_cmp_eq_u32 vcc, s66, v27
    s_cbranch_vccnz L_c0_w0_redo1
    v_cmp_eq_u32 vcc, s66, v28
    s_cbranch_vccnz L_c0_w0_redo1
    v_cmp_eq_u32 vcc, s66, v29
    s_cbranch_vccnz L_c0_w0_redo1
    v_cmp_eq_u32 vcc, s66, v30
    s_cbranch_vccnz L_c0_w0_redo1
    v_cmp_eq_u32 vcc, s66, v31
    s_cbranch_vccnz L_c0_w0_redo1
    ds_read_b128 v[56:59], v134 offset:0
    ds_read_b128 v[60:63], v134 offset:1024
    ds_read_b128 v[64:67], v134 offset:2048
    ds_read_b128 v[68:71], v134 offset:3072
    ds_read_b128 v[72:75], v134 offset:4096
    ds_read_b128 v[76:79], v134 offset:5120
    ds_read_b128 v[80:83], v134 offset:6144
    ds_read_b128 v[84:87], v134 offset:7168
    v_mov_b64 v[32:33], 0
    v_mov_b64 v[34:35], 0
    v_mov_b64 v[36:37], 0
    v_mov_b64 v[38:39], 0
    v_mov_b64 v[40:41], 0
    v_mov_b64 v[42:43], 0
    v_mov_b64 v[44:45], 0
    v_mov_b64 v[46:47], 0
    v_mov_b64 v[48:49], 0
    v_mov_b64 v[50:51], 0
    v_mov_b64 v[52:53], 0
    v_mov_b64 v[54:55], 0
    v_mov_b32 v114, s44
    v_mov_b32 v115, s44
    v_mov_b32 v115, s44
    s_branch L_c0_w0_step
L_c0_w0_p2slow:
    v_cmp_eq_u32 vcc, s66, v32
    s_cbranch_vccnz L_c0_w0_p2retry
    v_cmp_eq_u32 vcc, s66, v33
    s_cbranch_vccnz L_c0_w0_p2retry
    v_cmp_eq_u32 vcc, s66, v34
    s_cbranch_vccnz L_c0_w0_p2retry
    v_cmp_eq_u32 vcc, s66, v35
    s_cbranch_vccnz L_c0_w0_p2retry
    v_cmp_eq_u32 vcc, s66, v36
    s_cbranch_vccnz L_c0_w0_p2retry
    v_cmp_eq_u32 vcc, s66, v37
    s_cbranch_vccnz L_c0_w0_p2retry
    v_cmp_eq_u32 vcc, s66, v38
    s_cbranch_vccnz L_c0_w0_p2retry
    v_cmp_eq_u32 vcc, s66, v39
    s_cbranch_vccnz L_c0_w0_p2retry
    s_branch L_c0_w0_p2ok
L_c0_w0_p2retry:
    s_sub_u32 s100, s100, 1
    s_mov_b32 s101, 14
    s_cbranch_scc1 L_fail
    buffer_load_dword v32, v141, s[36:39], s57 offen sc1
    buffer_load_dword v33, v141, s[36:39], s58 offen sc1
    buffer_load_dword v34, v141, s[36:39], s59 offen sc1
    buffer_load_dword v35, v141, s[36:39], s60 offen sc1
    buffer_load_dword v36, v141, s[36:39], s61 offen sc1
    buffer_load_dword v37, v141, s[36:39], s62 offen sc1
    buffer_load_dword v38, v141, s[36:39], s63 offen sc1
    buffer_load_dword v39, v141, s[36:39], s64 offen sc1
    s_waitcnt vmcnt(0)
    s_branch L_c0_w0_p2w
L_c0_w0_kvwait:
    s_mov_b32 s82, 0x40000
    v_lshlrev_b32 v128, 2, v140
    s_waitcnt vmcnt(0)
    buffer_load_dword v128, v128, s[36:39], s82 offen sc1
    s_waitcnt vmcnt(0)
    v_cmp_le_u32 vcc, 32, v128
    s_and_b32 s82, vcc_lo, 0xffff
    s_ff0_i32_b32 s56, s82
    s_cmp_lt_u32 s80, s56
    s_cbranch_scc1 L_c0_w0_kvwait_ok
    s_sub_u32 s100, s100, 1
    s_mov_b32 s101, 15
    s_cbranch_scc1 L_fail
    s_branch L_c0_w0_kvwait
L_c0_w0_kvwait_ok:
    s_branch L_c0_w0_kvok
L_c0_w0_fb:
    s_cmp_eq_u32 s91, 0
    s_cbranch_scc0 L_c0_w0_fb1
    v_cmp_u_f32 vcc, v36, v36
    s_cbranch_vccnz L_c0_w0_redo
L_c0_w0_fb1:
    s_waitcnt vmcnt(0)
    s_barrier
    ds_write_b64 v140, v[32:33] offset:0
    s_waitcnt lgkmcnt(0)
    s_barrier
    ds_read_b128 v[0:3], v140 offset:0
    ds_read_b128 v[4:7], v140 offset:1024
    v_mov_b32 v8, v44
    v_mov_b32 v9, v45
    s_waitcnt lgkmcnt(0)
    v_max3_f32 v10, v0, v1, v2
    v_max3_f32 v11, v3, v4, v5
    v_max3_f32 v10, v10, v6, v7
    v_max3_f32 v11, v11, v8, v9
    v_max_f32 v10, v10, v11
    v_mov_b32 v11, v10
    s_nop 1
    v_permlane32_swap_b32 v10, v11
    v_max_f32 v10, v10, v11
    v_mov_b32 v11, v10
    s_nop 1
    v_permlane16_swap_b32 v10, v11
    v_max_f32 v10, v10, v11
    v_sub_f32 v0, v0, v10
    v_sub_f32 v1, v1, v10
    v_sub_f32 v2, v2, v10
    v_sub_f32 v3, v3, v10
    v_sub_f32 v4, v4, v10
    v_sub_f32 v5, v5, v10
    v_sub_f32 v6, v6, v10
    v_sub_f32 v7, v7, v10
    v_sub_f32 v8, v8, v10
    v_sub_f32 v9, v9, v10
    v_exp_f32 v0, v0
    v_exp_f32 v1, v1
    v_exp_f32 v2, v2
    v_exp_f32 v3, v3
    v_exp_f32 v4, v4
    v_exp_f32 v5, v5
    v_exp_f32 v6, v6
    v_exp_f32 v7, v7
    v_exp_f32 v8, v8
    v_exp_f32 v9, v9
    v_cvt_pk_bf16_f32 v64, v0, v1
    v_cvt_pk_bf16_f32 v65, v2, v3
    v_cvt_pk_bf16_f32 v66, v4, v5
    v_cvt_pk_bf16_f32 v67, v6, v7
    v_cvt_pk_bf16_f32 v8, v8, v9
    v_cndmask_b32 v56, 0, v64, s[70:71]
    v_cndmask_b32 v60, v64, 0, s[70:71]
    v_cndmask_b32 v57, 0, v65, s[70:71]
    v_cndmask_b32 v61, v65, 0, s[70:71]
    v_cndmask_b32 v58, 0, v66, s[70:71]
    v_cndmask_b32 v62, v66, 0, s[70:71]
    v_cndmask_b32 v59, 0, v67, s[70:71]
    v_cndmask_b32 v63, v67, 0, s[70:71]
    v_cndmask_b32 v50, 0, v8, s[70:71]
    v_cndmask_b32 v51, v8, 0, s[70:71]
    v_mfma_f32_16x16x32_bf16 v[36:39], v[68:71], v[64:67], 0
    v_mfma_f32_16x16x32_bf16 v[40:43], v[104:107], v[56:59], 0
    v_mfma_f32_16x16x32_bf16 v[40:43], v[108:111], v[60:63], v[40:43]
    v_mfma_f32_16x16x16_bf16 v[36:39], v[68:69], v[50:51], v[36:39]
    v_mfma_f32_16x16x16_bf16 v[40:43], v[48:49], v[50:51], v[40:43]
    v_mov_b64 v[0:1], 0
    v_mov_b64 v[2:3], 0
    v_mov_b64 v[4:5], 0
    v_mov_b64 v[6:7], 0
    v_mov_b64 v[8:9], 0
    v_mov_b64 v[10:11], 0
    v_mov_b64 v[12:13], 0
    v_mov_b64 v[14:15], 0
    v_rcp_f32 v46, v36
    s_nop 0
    v_pk_mul_f32 v[40:41], v[40:41], v[46:47] op_sel_hi:[1,0]
    v_pk_mul_f32 v[42:43], v[42:43], v[46:47] op_sel_hi:[1,0]
    v_cvt_pk_bf16_f32 v40, v40, v41
    v_cvt_pk_bf16_f32 v41, v42, v43
    ds_write_b64 v139, v[40:41] offset:13824
    s_branch L_c0_w0_fbret
L_c0_enter1:
    buffer_load_dword v114, v133, s[36:39], s65 offen sc1
    buffer_load_dwordx4 v140, s[36:39], s45 offen sc1 lds
    buffer_load_dwordx4 v140, s[36:39], s45 offen offset:1024 sc1 lds
    buffer_load_dword v115, v133, s[36:39], s65 offen sc1
    buffer_load_dwordx4 v140, s[36:39], s45 offen sc1 lds
    buffer_load_dwordx4 v140, s[36:39], s45 offen offset:1024 sc1 lds
    s_waitcnt vmcnt(0)
    .p2align 6
L_c0_w1_step:
    s_waitcnt vmcnt(5) lgkmcnt(0)
    v_cmp_ne_u32 vcc, s44, v114
    s_cbranch_vccnz L_c0_w1_spinA
    s_waitcnt vmcnt(3)
L_c0_w1_hit:
    s_barrier
    ds_read_b128 v[0:3], v140 offset:0
    ds_read_b128 v[4:7], v140 offset:1024
    s_waitcnt lgkmcnt(1)
    v_smfmac_f32_16x16x64_bf16 v[32:35], v[0:3], v[56:63], v131
    ds_read_b128 v[8:11], v140 offset:2048
    v_mov_b32 v124, s66
    v_smfmac_f32_16x16x64_bf16 v[36:39], v[0:3], a[40:47], v131
    s_waitcnt lgkmcnt(1)
    ds_read_b128 v[12:15], v140 offset:3072
    v_lshlrev_b32 v126, 2, v140
    v_smfmac_f32_16x16x64_bf16 v[40:43], v[0:3], v[64:71], v131
    ds_read_b128 v[56:59], v134 offset:8192
    buffer_load_dwordx3 v[128:130], v140, s[36:39], s52 offen offset:0 sc1
    v_smfmac_f32_16x16x64_bf16 v[44:47], v[0:3], a[112:119], v131
    ds_read_b128 v[60:63], v134 offset:9216
    v_smfmac_f32_16x16x64_bf16 v[32:35], v[4:7], v[72:79], v131
    ds_read_b128 v[64:67], v134 offset:10240
    v_smfmac_f32_16x16x64_bf16 v[36:39], v[4:7], a[48:55], v131
    ds_read_b128 v[68:71], v134 offset:11264
    buffer_load_dwordx3 v[128:130], v140, s[36:39], s52 offen offset:1024 sc1
    v_smfmac_f32_16x16x64_bf16 v[40:43], v[4:7], v[80:87], v131
    ds_read_b128 v[72:75], v134 offset:12288
    v_smfmac_f32_16x16x64_bf16 v[44:47], v[4:7], a[120:127], v131
    s_waitcnt lgkmcnt(6)
    ds_read_b128 v[76:79], v134 offset:13312
    v_smfmac_f32_16x16x64_bf16 v[32:35], v[8:11], a[0:7], v131
    s_waitcnt lgkmcnt(4)
    ds_read_b128 v[80:83], v134 offset:14336
    buffer_load_dwordx3 v[128:130], v140, s[36:39], s52 offen offset:2048 sc1
    v_smfmac_f32_16x16x64_bf16 v[36:39], v[8:11], v[56:63], v131
    ds_read_b128 v[84:87], v134 offset:15360
    v_smfmac_f32_16x16x64_bf16 v[40:43], v[8:11], a[80:87], v131
    ds_read_b128 v[56:59], v134 offset:16384
    v_smfmac_f32_16x16x64_bf16 v[44:47], v[8:11], a[128:135], v131
    s_waitcnt lgkmcnt(9)
    ds_read_b128 v[60:63], v134 offset:17408
    buffer_load_dwordx3 v[128:130], v140, s[36:39], s52 offen offset:3072 sc1
    v_smfmac_f32_16x16x64_bf16 v[32:35], v[12:15], a[8:15], v131
    s_waitcnt lgkmcnt(6)
    v_smfmac_f32_16x16x64_bf16 v[36:39], v[12:15], v[64:71], v131
    ds_read_b128 v[64:67], v134 offset:18432
    v_smfmac_f32_16x16x64_bf16 v[40:43], v[12:15], a[88:95], v131
    s_barrier
    ds_read_b128 v[16:19], v140 offset:4096
    buffer_load_dword v128, v126, s[36:39], s55 offen sc1
    v_smfmac_f32_16x16x64_bf16 v[44:47], v[12:15], a[136:143], v131
    s_waitcnt lgkmcnt(6)
    ds_read_b128 v[20:23], v140 offset:5120
    v_smfmac_f32_16x16x64_bf16 v[48:51], v[0:3], v[72:79], v131
    ds_read_b128 v[24:27], v140 offset:6144
    v_smfmac_f32_16x16x64_bf16 v[52:55], v[0:3], a[224:231], v131
    ds_read_b128 v[28:31], v140 offset:7168
    v_smfmac_f32_16x16x64_bf16 v[48:51], v[4:7], a[168:175], v131
    s_waitcnt lgkmcnt(3)
    ds_read_b128 v[68:71], v134 offset:19456
    v_smfmac_f32_16x16x64_bf16 v[32:35], v[16:19], a[16:23], v131
    s_waitcnt lgkmcnt(3)
    ds_read_b128 v[72:75], v134 offset:20480
    v_smfmac_f32_16x16x64_bf16 v[32:35], v[20:23], v[80:87], v131
    s_waitcnt lgkmcnt(3)
    ds_read_b128 v[76:79], v134 offset:21504
    v_smfmac_f32_16x16x64_bf16 v[32:35], v[24:27], a[24:31], v131
    s_waitcnt lgkmcnt(3)
    ds_read_b128 v[80:83], v134 offset:22528
    v_smfmac_f32_16x16x64_bf16 v[32:35], v[28:31], a[32:39], v131
    s_waitcnt lgkmcnt(9)
    ds_read_b128 v[84:87], v134 offset:23552
    buffer_store_dword v116, v142, s[36:39], s54 offen sc1
    v_smfmac_f32_16x16x64_bf16 v[36:39], v[16:19], v[56:63], v131
    v_smfmac_f32_16x16x64_bf16 v[36:39], v[20:23], a[56:63], v131
    buffer_store_dword v124, v142, s[36:39], s47 offen
    v_add_f32 v32, v32, v34
    v_smfmac_f32_16x16x64_bf16 v[36:39], v[24:27], a[64:71], v131
    v_add_f32 v33, v33, v35
    v_smfmac_f32_16x16x64_bf16 v[36:39], v[28:31], a[72:79], v131
    s_waitcnt lgkmcnt(4)
    v_smfmac_f32_16x16x64_bf16 v[40:43], v[16:19], v[64:71], v131
    v_mov_b64 v[68:69], s[68:69]
    v_smfmac_f32_16x16x64_bf16 v[40:43], v[20:23], a[96:103], v131
    v_add_f32 v36, v36, v38
    v_add_f32 v37, v37, v39
    v_smfmac_f32_16x16x64_bf16 v[40:43], v[24:27], a[104:111], v131
    s_waitcnt lgkmcnt(2)
    v_cvt_pk_bf16_f32 v32, v32, v36
    v_cvt_pk_bf16_f32 v33, v33, v37
    v_smfmac_f32_16x16x64_bf16 v[40:43], v[28:31], v[72:79], v131
    ds_write2_b32 v135, v32, v33 offset0:0 offset1:4
    v_smfmac_f32_16x16x64_bf16 v[44:47], v[16:19], a[144:151], v131
    ds_read_b128 v[72:75], v134 offset:24576
    v_mov_b64 v[70:71], s[68:69]
    v_smfmac_f32_16x16x64_bf16 v[44:47], v[20:23], a[152:159], v131
    ds_read_b128 v[76:79], v134 offset:25600
    v_add_f32 v40, v40, v42
    v_smfmac_f32_16x16x64_bf16 v[44:47], v[24:27], a[160:167], v131
    s_waitcnt lgkmcnt(3)
    v_add_f32 v41, v41, v43
    v_smfmac_f32_16x16x64_bf16 v[44:47], v[28:31], v[80:87], v131
    ds_read_b128 v[80:83], v134 offset:26624
    v_smfmac_f32_16x16x64_bf16 v[52:55], v[4:7], a[232:239], v131
    s_waitcnt lgkmcnt(3)
    s_barrier
    ds_read_b128 v[112:115], v136 offset:8192
    v_smfmac_f32_16x16x64_bf16 v[48:51], v[8:11], a[176:183], v131
    ds_read_b128 v[116:119], v136 offset:9216
    v_add_f32 v44, v44, v46
    v_smfmac_f32_16x16x64_bf16 v[52:55], v[8:11], a[240:247], v131
    ds_read_b128 v[120:123], v136 offset:10240
    v_add_f32 v45, v45, v47
    v_cvt_pk_bf16_f32 v40, v40, v44
    v_smfmac_f32_16x16x64_bf16 v[48:51], v[12:15], a[184:191], v131
    ds_read_b128 v[124:127], v136 offset:11264
    v_cvt_pk_bf16_f32 v41, v41, v45
    v_smfmac_f32_16x16x64_bf16 v[52:55], v[12:15], a[248:255], v131
    s_waitcnt lgkmcnt(3)
    ds_write2_b32 v135, v40, v41 offset0:128 offset1:132
    v_mfma_f32_16x16x32_bf16 v[32:35], v[88:91], v[112:115], 0
    s_waitcnt lgkmcnt(3)
    ds_read_b128 v[84:87], v134 offset:27648
    v_mfma_f32_16x16x32_bf16 v[32:35], v[92:95], v[116:119], v[32:35]
    s_waitcnt lgkmcnt(3)
    v_mfma_f32_16x16x32_bf16 v[32:35], v[96:99], v[120:123], v[32:35]
    s_waitcnt lgkmcnt(2)
    v_mfma_f32_16x16x32_bf16 v[32:35], v[100:103], v[124:127], v[32:35]
    s_waitcnt lgkmcnt(1)
    s_barrier
    ds_read_b128 v[0:3], v137 offset:8704
    v_smfmac_f32_16x16x64_bf16 v[48:51], v[16:19], a[192:199], v131
    ds_read_b128 v[4:7], v137 offset:9728
    v_smfmac_f32_16x16x64_bf16 v[48:51], v[20:23], a[200:207], v131
    ds_read_b128 v[8:11], v137 offset:10752
    v_exp_f32 v36, v32
    v_smfmac_f32_16x16x64_bf16 v[48:51], v[24:27], a[208:215], v131
    s_waitcnt lgkmcnt(2)
    ds_read_b128 v[12:15], v137 offset:11776
    v_exp_f32 v37, v33
    v_mfma_f32_16x16x32_bf16 v[44:47], v[0:3], v[112:115], 0
    s_waitcnt lgkmcnt(2)
    v_cvt_pk_bf16_f32 v36, v36, v37
    v_mfma_f32_16x16x32_bf16 v[44:47], v[4:7], v[116:119], v[44:47]
    s_waitcnt lgkmcnt(1)
    ds_write_b32 v136, v36 offset:12804
    v_mfma_f32_16x16x32_bf16 v[44:47], v[8:11], v[120:123], v[44:47]
    s_waitcnt lgkmcnt(1)
    v_mov_b64 v[0:1], 0
    v_mov_b64 v[2:3], 0
    v_mfma_f32_16x16x32_bf16 v[44:47], v[12:15], v[124:127], v[44:47]
    v_mov_b64 v[4:5], 0
    v_mov_b64 v[6:7], 0
    v_smfmac_f32_16x16x64_bf16 v[48:51], v[28:31], a[216:223], v131
    buffer_load_dwordx4 v[88:91], v137, s[36:39], s50 offen offset:0 sc1
    v_mov_b64 v[8:9], 0
    v_smfmac_f32_16x16x64_bf16 v[52:55], v[16:19], v[224:231], v131
    s_waitcnt lgkmcnt(0)
    s_barrier
    ds_read_b128 v[64:67], v136 offset:12800
    buffer_load_dwordx4 v[92:95], v137, s[36:39], s50 offen offset:1024 sc1
    v_exp_f32 v46, v44
    v_smfmac_f32_16x16x64_bf16 v[52:55], v[20:23], v[232:239], v131
    ds_read_b128 v[56:59], v138 offset:12800
    buffer_load_dwordx4 v[96:99], v137, s[36:39], s50 offen offset:2048 sc1
    v_add_f32 v48, v48, v50
    v_exp_f32 v47, v45
    v_smfmac_f32_16x16x64_bf16 v[52:55], v[24:27], v[240:247], v131
    ds_read_b128 v[60:63], v138 offset:12288
    v_add_f32 v49, v49, v51
    v_cvt_pk_bf16_f32 v46, v46, v47
    v_smfmac_f32_16x16x64_bf16 v[52:55], v[28:31], v[248:255], v131
    s_waitcnt lgkmcnt(2)
    buffer_load_dwordx4 v[100:103], v137, s[36:39], s50 offen offset:3072 sc1
    v_cvt_pk_bf16_f32 v48, v48, v49
    v_mfma_f32_16x16x32_bf16 v[36:39], v[68:71], v[64:67], 0
    s_waitcnt lgkmcnt(1)
    v_cndmask_b32 v50, 0, v46, s[70:71]
    v_cndmask_b32 v51, v46, 0, s[70:71]
    v_mfma_f32_16x16x32_bf16 v[40:43], v[104:107], v[56:59], 0
    s_waitcnt lgkmcnt(0)
    v_add_f32 v52, v52, v54
    v_add_f32 v53, v53, v55
    v_mfma_f32_16x16x32_bf16 v[40:43], v[108:111], v[60:63], v[40:43]
    v_cvt_pk_bf16_f32 v49, v52, v53
    v_mfma_f32_16x16x16_bf16 v[36:39], v[68:69], v[50:51], v[36:39]
    v_mfma_f32_16x16x16_bf16 v[40:43], v[48:49], v[50:51], v[40:43]
    s_nop 3
    v_rcp_f32 v46, v36
    v_mov_b64 v[10:11], 0
    v_mov_b64 v[12:13], 0
    s_nop 0
    v_pk_mul_f32 v[40:41], v[40:41], v[46:47] op_sel_hi:[1,0]
    v_pk_mul_f32 v[42:43], v[42:43], v[46:47] op_sel_hi:[1,0]
    v_cvt_pk_bf16_f32 v40, v40, v41
    v_cvt_pk_bf16_f32 v41, v42, v43
    ds_write_b64 v139, v[40:41] offset:14336
    v_subrev_u32 v47, s74, v36
    v_cmp_lt_u32 vcc, s75, v47
    v_mov_b64 v[14:15], 0
    s_cbranch_vccnz L_c0_w1_fb
L_c0_w1_fbret:
    buffer_load_dwordx4 v[104:107], v140, s[36:39], s51 offen offset:0 sc1
    buffer_load_dwordx4 v[108:111], v140, s[36:39], s51 offen offset:1024 sc1
    s_waitcnt lgkmcnt(0)
    s_barrier
    ds_read_b128 v[112:115], v137 offset:13824
    ds_read_b128 v[116:119], v137 offset:14336
    ds_read_b128 v[120:123], v137 offset:14848
    ds_read_b128 v[124:127], v137 offset:15360
    s_waitcnt lgkmcnt(3)
    v_smfmac_f32_16x16x64_bf16 v[0:3], v[112:115], v[144:151], v131
    s_waitcnt lgkmcnt(2)
    v_smfmac_f32_16x16x64_bf16 v[0:3], v[116:119], v[152:159], v131
    s_waitcnt lgkmcnt(1)
    ds_read_b128 v[56:59], v134 offset:28672
    v_smfmac_f32_16x16x64_bf16 v[0:3], v[120:123], v[160:167], v131
    s_waitcnt lgkmcnt(1)
    ds_read_b128 v[60:63], v134 offset:29696
    v_smfmac_f32_16x16x64_bf16 v[0:3], v[124:127], v[168:175], v131
    s_add_u32 s84, s48, 4096
    ds_read_b128 v[64:67], v134 offset:30720
    v_smfmac_f32_16x16x64_bf16 v[4:7], v[112:115], v[176:183], v131
    ds_read_b128 v[68:71], v134 offset:31744
    v_smfmac_f32_16x16x64_bf16 v[4:7], v[116:119], v[72:79], v131
    ds_read_b128 v[72:75], v134 offset:32768
    v_cvt_pk_bf16_f32 v16, v0, v2
    v_cvt_pk_bf16_f32 v17, v1, v3
    v_smfmac_f32_16x16x64_bf16 v[4:7], v[120:123], v[184:191], v131
    ds_read_b128 v[76:79], v134 offset:33792
    v_bfi_b32 v16, 1, s87, v16
    v_bfi_b32 v17, 1, s87, v17
    v_smfmac_f32_16x16x64_bf16 v[4:7], v[124:127], v[80:87], v131
    ds_read_b128 v[80:83], v134 offset:34816
    buffer_store_dwordx2 v[16:17], v132, s[36:39], s48 offen offset:0
    v_smfmac_f32_16x16x64_bf16 v[8:11], v[112:115], v[192:199], v131
    s_waitcnt lgkmcnt(5)
    ds_read_b128 v[84:87], v134 offset:35840
    v_smfmac_f32_16x16x64_bf16 v[8:11], v[116:119], v[56:63], v131
    v_cvt_pk_bf16_f32 v18, v4, v6
    v_cvt_pk_bf16_f32 v19, v5, v7
    v_bfi_b32 v18, 1, s87, v18
    v_bfi_b32 v19, 1, s87, v19
    v_smfmac_f32_16x16x64_bf16 v[8:11], v[120:123], v[200:207], v131
    s_waitcnt lgkmcnt(4)
    buffer_store_dwordx2 v[18:19], v132, s[36:39], s48 offen offset:2048
    v_smfmac_f32_16x16x64_bf16 v[8:11], v[124:127], v[64:71], v131
    v_smfmac_f32_16x16x64_bf16 v[12:15], v[112:115], v[208:215], v131
    s_waitcnt lgkmcnt(2)
    v_smfmac_f32_16x16x64_bf16 v[12:15], v[116:119], v[72:79], v131
    v_cvt_pk_bf16_f32 v20, v8, v10
    v_smfmac_f32_16x16x64_bf16 v[12:15], v[120:123], v[216:223], v131
    s_waitcnt lgkmcnt(0)
    v_cvt_pk_bf16_f32 v21, v9, v11
    v_smfmac_f32_16x16x64_bf16 v[12:15], v[124:127], v[80:87], v131
    v_bfi_b32 v20, 1, s87, v20
    v_bfi_b32 v21, 1, s87, v21
    buffer_store_dwordx2 v[20:21], v132, s[36:39], s84 offen offset:0
    s_nop 3
    v_cvt_pk_bf16_f32 v22, v12, v14
    v_cvt_pk_bf16_f32 v23, v13, v15
    v_bfi_b32 v22, 1, s87, v22
    v_bfi_b32 v23, 1, s87, v23
    buffer_store_dwordx2 v[22:23], v132, s[36:39], s84 offen offset:2048
    v_mov_b64 v[40:41], 0
    v_mov_b64 v[42:43], 0
    v_mov_b64 v[44:45], 0
    v_mov_b64 v[46:47], 0
    v_mov_b64 v[48:49], 0
    v_mov_b64 v[50:51], 0
    v_mov_b64 v[52:53], 0
    v_mov_b64 v[54:55], 0
    ds_read_b128 v[56:59], v134 offset:0
    ds_read_b128 v[60:63], v134 offset:1024
    ds_read_b128 v[64:67], v134 offset:2048
    ds_read_b128 v[68:71], v134 offset:3072
    ds_read_b128 v[72:75], v134 offset:4096
    ds_read_b128 v[76:79], v134 offset:5120
    ds_read_b128 v[80:83], v134 offset:6144
    ds_read_b128 v[84:87], v134 offset:7168
    s_sub_u32 s95, s79, s48
    s_mov_b32 s82, s49
    s_mov_b32 s49, s48
    s_mov_b32 s48, s79
    s_mov_b32 s79, s49
    s_add_u32 s52, s52, 0x80000
    s_mov_b32 s91, 0
    s_add_u32 s50, s50, 524288
    s_add_u32 s51, s51, 524288
    s_nop 7
    s_nop 0
    buffer_load_dword v32, v141, s[36:39], s57 offen sc1
    buffer_load_dword v33, v141, s[36:39], s58 offen sc1
    buffer_load_dword v34, v141, s[36:39], s59 offen sc1
    buffer_load_dword v35, v141, s[36:39], s60 offen sc1
    buffer_load_dword v36, v141, s[36:39], s61 offen sc1
    buffer_load_dword v37, v141, s[36:39], s62 offen sc1
    buffer_load_dword v38, v141, s[36:39], s63 offen sc1
    buffer_load_dword v39, v141, s[36:39], s64 offen sc1
    s_mov_b32 s80, s47
    s_mov_b32 s47, s45
    s_mov_b32 s45, s46
    s_mov_b32 s46, s80
    s_add_u32 s53, s53, 8192
    s_mov_b32 s54, s53
    s_add_u32 s44, s44, 1
    v_mov_b32 v112, v143
    v_mov_b32 v113, v143
    v_mov_b32 v114, v143
    v_mov_b32 v115, v143
    v_mov_b32 v2, s44
    s_waitcnt vmcnt(4)
L_c0_w1_p2w:
    v_mfma_f32_16x16x32_bf16 v[116:119], v[112:115], v[32:35], 0
    v_bitop3_b32 v0, v32, v33, s87 bitop3:0x7e
    v_bitop3_b32 v1, v34, v35, s87 bitop3:0x7e
    s_waitcnt vmcnt(0)
    v_mfma_f32_16x16x32_bf16 v[116:119], v[112:115], v[36:39], v[116:119]
    v_bitop3_b32 v3, v36, v37, s87 bitop3:0x7e
    v_bitop3_b32 v4, v38, v39, s87 bitop3:0x7e
    v_or3_b32 v0, v0, v1, v3
    v_bitop3_b32 v0, v0, v4, 1 bitop3:0xa8
    v_cmp_ne_u32 vcc, 0, v0
    s_cbranch_vccnz L_c0_w1_p2retry
L_c0_w1_p2ok:
    s_nop 0
    v_cvt_pk_bf16_f32 v116, v116, v117
    buffer_store_dword v116, v142, s[36:39], s45 offen
    s_cmp_eq_u32 s44, 63
    s_cbranch_scc1 L_c0_fin
    s_nop 2
    buffer_store_dword v2, off, s[36:39], s90
    v_mov_b64 v[32:33], 0
    v_mov_b64 v[34:35], 0
    v_mov_b64 v[36:37], 0
    v_mov_b64 v[38:39], 0
    v_cmp_le_u32 vcc, 32, v128
    s_and_b32 s80, vcc_lo, 0xffff
    s_ff0_i32_b32 s80, s80
    s_max_u32 s56, s56, s80
    s_add_u32 s80, s44, 4
    s_lshr_b32 s80, s80, 2
    s_min_u32 s80, s80, 15
    s_cmp_lt_u32 s80, s56
    s_cselect_b32 s55, s88, s89
    s_add_u32 s80, s44, 2
    s_lshr_b32 s80, s80, 2
    s_min_u32 s80, s80, 15
    s_cmp_lt_u32 s80, s56
    s_cbranch_scc0 L_c0_w1_kvwait
L_c0_w1_kvok:
    v_add_u32 v141, s95, v141
    s_bfe_i32 s87, s44, 0x10001
    s_nop 7
    s_nop 5
    buffer_load_dword v114, v133, s[36:39], s65 offen sc1
    buffer_load_dwordx4 v140, s[36:39], s45 offen sc1 lds
    buffer_load_dwordx4 v140, s[36:39], s45 offen offset:1024 sc1 lds
    s_nop 7
    s_nop 7
    s_nop 7
    buffer_load_dword v115, v133, s[36:39], s65 offen sc1
    buffer_load_dwordx4 v140, s[36:39], s45 offen sc1 lds
    buffer_load_dwordx4 v140, s[36:39], s45 offen offset:1024 sc1 lds
    s_branch L_c0_w1_step
L_c0_w1_spinA:
    buffer_load_dword v114, v133, s[36:39], s65 offen sc1
    buffer_load_dwordx4 v140, s[36:39], s45 offen sc1 lds
    buffer_load_dwordx4 v140, s[36:39], s45 offen offset:1024 sc1 lds
    s_waitcnt vmcnt(5)
    v_cmp_ne_u32 vcc, s44, v115
    s_cbranch_vccz L_c0_w1_spunA
    buffer_load_dword v115, v133, s[36:39], s65 offen sc1
    buffer_load_dwordx4 v140, s[36:39], s45 offen sc1 lds
    buffer_load_dwordx4 v140, s[36:39], s45 offen offset:1024 sc1 lds
    s_branch L_c0_w1_spin0
L_c0_w1_spunA:
    s_waitcnt vmcnt(3)
    s_branch L_c0_w1_hit
L_c0_w1_spin0:
    s_waitcnt vmcnt(5)
    v_cmp_ne_u32 vcc, s44, v114
    s_cbranch_vccz L_c0_w1_spun
L_c0_w1_spin1:
    buffer_load_dword v114, v133, s[36:39], s65 offen sc1
    buffer_load_dwordx4 v140, s[36:39], s45 offen sc1 lds
    buffer_load_dwordx4 v140, s[36:39], s45 offen offset:1024 sc1 lds
    s_waitcnt vmcnt(5)
    v_cmp_ne_u32 vcc, s44, v115
    s_cbranch_vccz L_c0_w1_spun
    buffer_load_dword v115, v133, s[36:39], s65 offen sc1
    buffer_load_dwordx4 v140, s[36:39], s45 offen sc1 lds
    buffer_load_dwordx4 v140, s[36:39], s45 offen offset:1024 sc1 lds
    s_sub_u32 s100, s100, 1
    s_mov_b32 s101, 12
    s_cbranch_scc1 L_fail
    s_branch L_c0_w1_spin0
L_c0_w1_spun:
    s_waitcnt vmcnt(3)
    s_branch L_c0_w1_hit
L_c0_w1_redo:
    s_mov_b32 s91, 1
    s_mov_b32 s54, 0x80000000
    s_sub_u32 s50, s50, 0x80000
    buffer_load_dwordx4 v[88:91], v137, s[36:39], s50 offen offset:0 sc1
    buffer_load_dwordx4 v[92:95], v137, s[36:39], s50 offen offset:1024 sc1
    buffer_load_dwordx4 v[96:99], v137, s[36:39], s50 offen offset:2048 sc1
    buffer_load_dwordx4 v[100:103], v137, s[36:39], s50 offen offset:3072 sc1
    s_add_u32 s50, s50, 0x80000
L_c0_w1_redo1:
    s_waitcnt vmcnt(0) lgkmcnt(0)
    s_barrier
    s_sub_u32 s100, s100, 1
    s_mov_b32 s101, 13
    s_cbranch_scc1 L_fail
    buffer_load_dwordx4 v140, s[36:39], s45 offen sc1 lds
    buffer_load_dwordx4 v140, s[36:39], s45 offen offset:1024 sc1 lds
    s_waitcnt vmcnt(0)
    s_barrier
    ds_read_b128 v[0:3], v140 offset:0
    ds_read_b128 v[4:7], v140 offset:1024
    ds_read_b128 v[8:11], v140 offset:2048
    ds_read_b128 v[12:15], v140 offset:3072
    ds_read_b128 v[16:19], v140 offset:4096
    ds_read_b128 v[20:23], v140 offset:5120
    ds_read_b128 v[24:27], v140 offset:6144
    ds_read_b128 v[28:31], v140 offset:7168
    s_waitcnt lgkmcnt(0)
    v_cmp_eq_u32 vcc, s66, v0
    s_cbranch_vccnz L_c0_w1_redo1
    v_cmp_eq_u32 vcc, s66, v1
    s_cbranch_vccnz L_c0_w1_redo1
    v_cmp_eq_u32 vcc, s66, v2
    s_cbranch_vccnz L_c0_w1_redo1
    v_cmp_eq_u32 vcc, s66, v3
    s_cbranch_vccnz L_c0_w1_redo1
    v_cmp_eq_u32 vcc, s66, v4
    s_cbranch_vccnz L_c0_w1_redo1
    v_cmp_eq_u32 vcc, s66, v5
    s_cbranch_vccnz L_c0_w1_redo1
    v_cmp_eq_u32 vcc, s66, v6
    s_cbranch_vccnz L_c0_w1_redo1
    v_cmp_eq_u32 vcc, s66, v7
    s_cbranch_vccnz L_c0_w1_redo1
    v_cmp_eq_u32 vcc, s66, v8
    s_cbranch_vccnz L_c0_w1_redo1
    v_cmp_eq_u32 vcc, s66, v9
    s_cbranch_vccnz L_c0_w1_redo1
    v_cmp_eq_u32 vcc, s66, v10
    s_cbranch_vccnz L_c0_w1_redo1
    v_cmp_eq_u32 vcc, s66, v11
    s_cbranch_vccnz L_c0_w1_redo1
    v_cmp_eq_u32 vcc, s66, v12
    s_cbranch_vccnz L_c0_w1_redo1
    v_cmp_eq_u32 vcc, s66, v13
    s_cbranch_vccnz L_c0_w1_redo1
    v_cmp_eq_u32 vcc, s66, v14
    s_cbranch_vccnz L_c0_w1_redo1
    v_cmp_eq_u32 vcc, s66, v15
    s_cbranch_vccnz L_c0_w1_redo1
    v_cmp_eq_u32 vcc, s66, v16
    s_cbranch_vccnz L_c0_w1_redo1
    v_cmp_eq_u32 vcc, s66, v17
    s_cbranch_vccnz L_c0_w1_redo1
    v_cmp_eq_u32 vcc, s66, v18
    s_cbranch_vccnz L_c0_w1_redo1
    v_cmp_eq_u32 vcc, s66, v19
    s_cbranch_vccnz L_c0_w1_redo1
    v_cmp_eq_u32 vcc, s66, v20
    s_cbranch_vccnz L_c0_w1_redo1
    v_cmp_eq_u32 vcc, s66, v21
    s_cbranch_vccnz L_c0_w1_redo1
    v_cmp_eq_u32 vcc, s66, v22
    s_cbranch_vccnz L_c0_w1_redo1
    v_cmp_eq_u32 vcc, s66, v23
    s_cbranch_vccnz L_c0_w1_redo1
    v_cmp_eq_u32 vcc, s66, v24
    s_cbranch_vccnz L_c0_w1_redo1
    v_cmp_eq_u32 vcc, s66, v25
    s_cbranch_vccnz L_c0_w1_redo1
    v_cmp_eq_u32 vcc, s66, v26
    s_cbranch_vccnz L_c0_w1_redo1
    v_cmp_eq_u32 vcc, s66, v27
    s_cbranch_vccnz L_c0_w1_redo1
    v_cmp_eq_u32 vcc, s66, v28
    s_cbranch_vccnz L_c0_w1_redo1
    v_cmp_eq_u32 vcc, s66, v29
    s_cbranch_vccnz L_c0_w1_redo1
    v_cmp_eq_u32 vcc, s66, v30
    s_cbranch_vccnz L_c0_w1_redo1
    v_cmp_eq_u32 vcc, s66, v31
    s_cbranch_vccnz L_c0_w1_redo1
    ds_read_b128 v[56:59], v134 offset:0
    ds_read_b128 v[60:63], v134 offset:1024
    ds_read_b128 v[64:67], v134 offset:2048
    ds_read_b128 v[68:71], v134 offset:3072
    ds_read_b128 v[72:75], v134 offset:4096
    ds_read_b128 v[76:79], v134 offset:5120
    ds_read_b128 v[80:83], v134 offset:6144
    ds_read_b128 v[84:87], v134 offset:7168
    v_mov_b64 v[32:33], 0
    v_mov_b64 v[34:35], 0
    v_mov_b64 v[36:37], 0
    v_mov_b64 v[38:39], 0
    v_mov_b64 v[40:41], 0
    v_mov_b64 v[42:43], 0
    v_mov_b64 v[44:45], 0
    v_mov_b64 v[46:47], 0
    v_mov_b64 v[48:49], 0
    v_mov_b64 v[50:51], 0
    v_mov_b64 v[52:53], 0
    v_mov_b64 v[54:55], 0
    v_mov_b32 v114, s44
    v_mov_b32 v115, s44
    v_mov_b32 v115, s44
    s_branch L_c0_w1_step
L_c0_w1_p2slow:
    v_cmp_eq_u32 vcc, s66, v32
    s_cbranch_vccnz L_c0_w1_p2retry
    v_cmp_eq_u32 vcc, s66, v33
    s_cbranch_vccnz L_c0_w1_p2retry
    v_cmp_eq_u32 vcc, s66, v34
    s_cbranch_vccnz L_c0_w1_p2retry
    v_cmp_eq_u32 vcc, s66, v35
    s_cbranch_vccnz L_c0_w1_p2retry
    v_cmp_eq_u32 vcc, s66, v36
    s_cbranch_vccnz L_c0_w1_p2retry
    v_cmp_eq_u32 vcc, s66, v37
    s_cbranch_vccnz L_c0_w1_p2retry
    v_cmp_eq_u32 vcc, s66, v38
    s_cbranch_vccnz L_c0_w1_p2retry
    v_cmp_eq_u32 vcc, s66, v39
    s_cbranch_vccnz L_c0_w1_p2retry
    s_branch L_c0_w1_p2ok
L_c0_w1_p2retry:
    s_sub_u32 s100, s100, 1
    s_mov_b32 s101, 14
    s_cbranch_scc1 L_fail
    buffer_load_dword v32, v141, s[36:39], s57 offen sc1
    buffer_load_dword v33, v141, s[36:39], s58 offen sc1
    buffer_load_dword v34, v141, s[36:39], s59 offen sc1
    buffer_load_dword v35, v141, s[36:39], s60 offen sc1
    buffer_load_dword v36, v141, s[36:39], s61 offen sc1
    buffer_load_dword v37, v141, s[36:39], s62 offen sc1
    buffer_load_dword v38, v141, s[36:39], s63 offen sc1
    buffer_load_dword v39, v141, s[36:39], s64 offen sc1
    s_waitcnt vmcnt(0)
    s_branch L_c0_w1_p2w
L_c0_w1_kvwait:
    s_mov_b32 s82, 0x40000
    v_lshlrev_b32 v128, 2, v140
    s_waitcnt vmcnt(0)
    buffer_load_dword v128, v128, s[36:39], s82 offen sc1
    s_waitcnt vmcnt(0)
    v_cmp_le_u32 vcc, 32, v128
    s_and_b32 s82, vcc_lo, 0xffff
    s_ff0_i32_b32 s56, s82
    s_cmp_lt_u32 s80, s56
    s_cbranch_scc1 L_c0_w1_kvwait_ok
    s_sub_u32 s100, s100, 1
    s_mov_b32 s101, 15
    s_cbranch_scc1 L_fail
    s_branch L_c0_w1_kvwait
L_c0_w1_kvwait_ok:
    s_branch L_c0_w1_kvok
L_c0_w1_fb:
    s_cmp_eq_u32 s91, 0
    s_cbranch_scc0 L_c0_w1_fb1
    v_cmp_u_f32 vcc, v36, v36
    s_cbranch_vccnz L_c0_w1_redo
L_c0_w1_fb1:
    s_waitcnt vmcnt(0)
    s_barrier
    ds_write_b64 v140, v[32:33] offset:8
    s_waitcnt lgkmcnt(0)
    s_barrier
    ds_read_b128 v[0:3], v140 offset:0
    ds_read_b128 v[4:7], v140 offset:1024
    v_mov_b32 v8, v44
    v_mov_b32 v9, v45
    s_waitcnt lgkmcnt(0)
    v_max3_f32 v10, v0, v1, v2
    v_max3_f32 v11, v3, v4, v5
    v_max3_f32 v10, v10, v6, v7
    v_max3_f32 v11, v11, v8, v9
    v_max_f32 v10, v10, v11
    v_mov_b32 v11, v10
    s_nop 1
    v_permlane32_swap_b32 v10, v11
    v_max_f32 v10, v10, v11
    v_mov_b32 v11, v10
    s_nop 1
    v_permlane16_swap_b32 v10, v11
    v_max_f32 v10, v10, v11
    v_sub_f32 v0, v0, v10
    v_sub_f32 v1, v1, v10
    v_sub_f32 v2, v2, v10
    v_sub_f32 v3, v3, v10
    v_sub_f32 v4, v4, v10
    v_sub_f32 v5, v5, v10
    v_sub_f32 v6, v6, v10
    v_sub_f32 v7, v7, v10
    v_sub_f32 v8, v8, v10
    v_sub_f32 v9, v9, v10
    v_exp_f32 v0, v0
    v_exp_f32 v1, v1
    v_exp_f32 v2, v2
    v_exp_f32 v3, v3
    v_exp_f32 v4, v4
    v_exp_f32 v5, v5
    v_exp_f32 v6, v6
    v_exp_f32 v7, v7
    v_exp_f32 v8, v8
    v_exp_f32 v9, v9
    v_cvt_pk_bf16_f32 v64, v0, v1
    v_cvt_pk_bf16_f32 v65, v2, v3
    v_cvt_pk_bf16_f32 v66, v4, v5
    v_cvt_pk_bf16_f32 v67, v6, v7
    v_cvt_pk_bf16_f32 v8, v8, v9
    v_cndmask_b32 v56, 0, v64, s[70:71]
    v_cndmask_b32 v60, v64, 0, s[70:71]
    v_cndmask_b32 v57, 0, v65, s[70:71]
    v_cndmask_b32 v61, v65, 0, s[70:71]
    v_cndmask_b32 v58, 0, v66, s[70:71]
    v_cndmask_b32 v62, v66, 0, s[70:71]
    v_cndmask_b32 v59, 0, v67, s[70:71]
    v_cndmask_b32 v63, v67, 0, s[70:71]
    v_cndmask_b32 v50, 0, v8, s[70:71]
    v_cndmask_b32 v51, v8, 0, s[70:71]
    v_mfma_f32_16x16x32_bf16 v[36:39], v[68:71], v[64:67], 0
    v_mfma_f32_16x16x32_bf16 v[40:43], v[104:107], v[56:59], 0
    v_mfma_f32_16x16x32_bf16 v[40:43], v[108:111], v[60:63], v[40:43]
    v_mfma_f32_16x16x16_bf16 v[36:39], v[68:69], v[50:51], v[36:39]
    v_mfma_f32_16x16x16_bf16 v[40:43], v[48:49], v[50:51], v[40:43]
    v_mov_b64 v[0:1], 0
    v_mov_b64 v[2:3], 0
    v_mov_b64 v[4:5], 0
    v_mov_b64 v[6:7], 0
    v_mov_b64 v[8:9], 0
    v_mov_b64 v[10:11], 0
    v_mov_b64 v[12:13], 0
    v_mov_b64 v[14:15], 0
    v_rcp_f32 v46, v36
    s_nop 0
    v_pk_mul_f32 v[40:41], v[40:41], v[46:47] op_sel_hi:[1,0]
    v_pk_mul_f32 v[42:43], v[42:43], v[46:47] op_sel_hi:[1,0]
    v_cvt_pk_bf16_f32 v40, v40, v41
    v_cvt_pk_bf16_f32 v41, v42, v43
    ds_write_b64 v139, v[40:41] offset:14336
    s_branch L_c0_w1_fbret
L_c0_enter2:
    s_waitcnt vmcnt(0)
    .p2align 6
L_c0_w2_step:
    s_waitcnt lgkmcnt(0)
    s_barrier
    ds_read_b128 v[0:3], v140 offset:0
    ds_read_b128 v[4:7], v140 offset:1024
    buffer_load_dword v114, v133, s[36:39], s65 offen sc1
    buffer_load_dwordx4 v140, s[36:39], s45 offen sc1 lds
    buffer_load_dwordx4 v140, s[36:39], s45 offen offset:1024 sc1 lds
    s_waitcnt lgkmcnt(1)
    v_smfmac_f32_16x16x64_bf16 v[32:35], v[0:3], v[56:63], v131
    ds_read_b128 v[8:11], v140 offset:2048
    v_mov_b32 v124, s66
    v_smfmac_f32_16x16x64_bf16 v[36:39], v[0:3], a[40:47], v131
    s_waitcnt lgkmcnt(1)
    ds_read_b128 v[12:15], v140 offset:3072
    v_lshlrev_b32 v126, 2, v140
    v_smfmac_f32_16x16x64_bf16 v[40:43], v[0:3], v[64:71], v131
    ds_read_b128 v[56:59], v134 offset:8192
    v_smfmac_f32_16x16x64_bf16 v[44:47], v[0:3], a[112:119], v131
    ds_read_b128 v[60:63], v134 offset:9216
    buffer_load_dwordx3 v[128:130], v140, s[36:39], s52 offen offset:0 sc1
    v_smfmac_f32_16x16x64_bf16 v[32:35], v[4:7], v[72:79], v131
    ds_read_b128 v[64:67], v134 offset:10240
    v_smfmac_f32_16x16x64_bf16 v[36:39], v[4:7], a[48:55], v131
    ds_read_b128 v[68:71], v134 offset:11264
    v_smfmac_f32_16x16x64_bf16 v[40:43], v[4:7], v[80:87], v131
    ds_read_b128 v[72:75], v134 offset:12288
    buffer_load_dwordx3 v[128:130], v140, s[36:39], s52 offen offset:1024 sc1
    v_smfmac_f32_16x16x64_bf16 v[44:47], v[4:7], a[120:127], v131
    s_waitcnt lgkmcnt(6)
    ds_read_b128 v[76:79], v134 offset:13312
    v_smfmac_f32_16x16x64_bf16 v[32:35], v[8:11], a[0:7], v131
    s_waitcnt lgkmcnt(4)
    ds_read_b128 v[80:83], v134 offset:14336
    v_smfmac_f32_16x16x64_bf16 v[36:39], v[8:11], v[56:63], v131
    ds_read_b128 v[84:87], v134 offset:15360
    buffer_load_dwordx3 v[128:130], v140, s[36:39], s52 offen offset:2048 sc1
    v_smfmac_f32_16x16x64_bf16 v[40:43], v[8:11], a[80:87], v131
    ds_read_b128 v[56:59], v134 offset:16384
    v_smfmac_f32_16x16x64_bf16 v[44:47], v[8:11], a[128:135], v131
    s_waitcnt lgkmcnt(9)
    ds_read_b128 v[60:63], v134 offset:17408
    v_smfmac_f32_16x16x64_bf16 v[32:35], v[12:15], a[8:15], v131
    s_waitcnt lgkmcnt(6)
    buffer_load_dwordx3 v[128:130], v140, s[36:39], s52 offen offset:3072 sc1
    v_smfmac_f32_16x16x64_bf16 v[36:39], v[12:15], v[64:71], v131
    s_waitcnt vmcnt(6)
    v_cmp_ne_u32 vcc, s44, v114
    s_cbranch_vccnz L_c0_w2_spin1
L_c0_w2_hit:
    v_smfmac_f32_16x16x64_bf16 v[40:43], v[12:15], a[88:95], v131
    s_waitcnt vmcnt(4)
    s_barrier
    ds_read_b128 v[16:19], v140 offset:4096
    v_smfmac_f32_16x16x64_bf16 v[44:47], v[12:15], a[136:143], v131
    s_waitcnt lgkmcnt(5)
    ds_read_b128 v[20:23], v140 offset:5120
    buffer_load_dword v128, v126, s[36:39], s55 offen sc1
    v_smfmac_f32_16x16x64_bf16 v[48:51], v[0:3], v[72:79], v131
    ds_read_b128 v[24:27], v140 offset:6144
    v_smfmac_f32_16x16x64_bf16 v[52:55], v[0:3], a[224:231], v131
    ds_read_b128 v[28:31], v140 offset:7168
    v_smfmac_f32_16x16x64_bf16 v[48:51], v[4:7], a[168:175], v131
    s_waitcnt lgkmcnt(3)
    ds_read_b128 v[64:67], v134 offset:18432
    v_smfmac_f32_16x16x64_bf16 v[32:35], v[16:19], a[16:23], v131
    s_waitcnt lgkmcnt(3)
    ds_read_b128 v[68:71], v134 offset:19456
    v_smfmac_f32_16x16x64_bf16 v[32:35], v[20:23], v[80:87], v131
    s_waitcnt lgkmcnt(3)
    ds_read_b128 v[72:75], v134 offset:20480
    v_smfmac_f32_16x16x64_bf16 v[32:35], v[24:27], a[24:31], v131
    s_waitcnt lgkmcnt(3)
    ds_read_b128 v[76:79], v134 offset:21504
    v_smfmac_f32_16x16x64_bf16 v[32:35], v[28:31], a[32:39], v131
    s_waitcnt lgkmcnt(8)
    ds_read_b128 v[80:83], v134 offset:22528
    buffer_store_dword v116, v142, s[36:39], s54 offen sc1
    v_smfmac_f32_16x16x64_bf16 v[36:39], v[16:19], v[56:63], v131
    ds_read_b128 v[84:87], v134 offset:23552
    v_smfmac_f32_16x16x64_bf16 v[36:39], v[20:23], a[56:63], v131
    buffer_store_dword v124, v142, s[36:39], s47 offen
    v_add_f32 v32, v32, v34
    v_smfmac_f32_16x16x64_bf16 v[36:39], v[24:27], a[64:71], v131
    v_add_f32 v33, v33, v35
    v_smfmac_f32_16x16x64_bf16 v[36:39], v[28:31], a[72:79], v131
    s_waitcnt lgkmcnt(4)
    v_smfmac_f32_16x16x64_bf16 v[40:43], v[16:19], v[64:71], v131
    v_mov_b64 v[68:69], s[68:69]
    v_smfmac_f32_16x16x64_bf16 v[40:43], v[20:23], a[96:103], v131
    v_add_f32 v36, v36, v38
    v_add_f32 v37, v37, v39
    v_smfmac_f32_16x16x64_bf16 v[40:43], v[24:27], a[104:111], v131
    s_waitcnt lgkmcnt(2)
    v_cvt_pk_bf16_f32 v32, v32, v36
    v_cvt_pk_bf16_f32 v33, v33, v37
    v_smfmac_f32_16x16x64_bf16 v[40:43], v[28:31], v[72:79], v131
    ds_write2_b32 v135, v32, v33 offset0:0 offset1:4
    v_smfmac_f32_16x16x64_bf16 v[44:47], v[16:19], a[144:151], v131
    ds_read_b128 v[72:75], v134 offset:24576
    v_mov_b64 v[70:71], s[68:69]
    v_smfmac_f32_16x16x64_bf16 v[44:47], v[20:23], a[152:159], v131
    ds_read_b128 v[76:79], v134 offset:25600
    v_add_f32 v40, v40, v42
    v_smfmac_f32_16x16x64_bf16 v[44:47], v[24:27], a[160:167], v131
    s_waitcnt lgkmcnt(3)
    v_add_f32 v41, v41, v43
    v_smfmac_f32_16x16x64_bf16 v[44:47], v[28:31], v[80:87], v131
    ds_read_b128 v[80:83], v134 offset:26624
    v_smfmac_f32_16x16x64_bf16 v[52:55], v[4:7], a[232:239], v131
    s_waitcnt lgkmcnt(3)
    s_barrier
    ds_read_b128 v[112:115], v136 offset:8192
    v_smfmac_f32_16x16x64_bf16 v[48:51], v[8:11], a[176:183], v131
    ds_read_b128 v[116:119], v136 offset:9216
    v_add_f32 v44, v44, v46
    v_smfmac_f32_16x16x64_bf16 v[52:55], v[8:11], a[240:247], v131
    ds_read_b128 v[120:123], v136 offset:10240
    v_add_f32 v45, v45, v47
    v_cvt_pk_bf16_f32 v40, v40, v44
    v_smfmac_f32_16x16x64_bf16 v[48:51], v[12:15], a[184:191], v131
    ds_read_b128 v[124:127], v136 offset:11264
    v_cvt_pk_bf16_f32 v41, v41, v45
    v_smfmac_f32_16x16x64_bf16 v[52:55], v[12:15], a[248:255], v131
    s_waitcnt lgkmcnt(3)
    ds_write2_b32 v135, v40, v41 offset0:128 offset1:132
    v_mfma_f32_16x16x32_bf16 v[32:35], v[88:91], v[112:115], 0
    s_waitcnt lgkmcnt(3)
    ds_read_b128 v[84:87], v134 offset:27648
    v_mfma_f32_16x16x32_bf16 v[32:35], v[92:95], v[116:119], v[32:35]
    s_waitcnt lgkmcnt(3)
    v_mfma_f32_16x16x32_bf16 v[32:35], v[96:99], v[120:123], v[32:35]
    s_waitcnt lgkmcnt(2)
    v_mfma_f32_16x16x32_bf16 v[32:35], v[100:103], v[124:127], v[32:35]
    s_waitcnt lgkmcnt(1)
    s_barrier
    ds_read_b128 v[0:3], v137 offset:8704
    buffer_load_dwordx4 v[88:91], v137, s[36:39], s50 offen offset:0 sc1
    v_smfmac_f32_16x16x64_bf16 v[48:51], v[16:19], a[192:199], v131
    ds_read_b128 v[4:7], v137 offset:9728
    v_smfmac_f32_16x16x64_bf16 v[48:51], v[20:23], a[200:207], v131
    ds_read_b128 v[8:11], v137 offset:10752
    buffer_load_dwordx4 v[92:95], v137, s[36:39], s50 offen offset:1024 sc1
    v_exp_f32 v36, v32
    v_smfmac_f32_16x16x64_bf16 v[48:51], v[24:27], a[208:215], v131
    s_waitcnt lgkmcnt(2)
    ds_read_b128 v[12:15], v137 offset:11776
    buffer_load_dwordx4 v[96:99], v137, s[36:39], s50 offen offset:2048 sc1
    v_exp_f32 v37, v33
    v_mfma_f32_16x16x32_bf16 v[44:47], v[0:3], v[112:115], 0
    s_waitcnt lgkmcnt(2)
    v_cvt_pk_bf16_f32 v36, v36, v37
    v_mfma_f32_16x16x32_bf16 v[44:47], v[4:7], v[116:119], v[44:47]
    s_waitcnt lgkmcnt(1)
    ds_write_b32 v136, v36 offset:12808
    buffer_load_dwordx4 v[100:103], v137, s[36:39], s50 offen offset:3072 sc1
    v_mfma_f32_16x16x32_bf16 v[44:47], v[8:11], v[120:123], v[44:47]
    s_waitcnt lgkmcnt(1)
    v_mov_b64 v[0:1], 0
    v_mov_b64 v[2:3], 0
    v_mfma_f32_16x16x32_bf16 v[44:47], v[12:15], v[124:127], v[44:47]
    v_mov_b64 v[4:5], 0
    v_mov_b64 v[6:7], 0
    v_smfmac_f32_16x16x64_bf16 v[48:51], v[28:31], a[216:223], v131
    v_mov_b64 v[8:9], 0
    v_smfmac_f32_16x16x64_bf16 v[52:55], v[16:19], v[224:231], v131
    s_waitcnt lgkmcnt(0)
    s_barrier
    ds_read_b128 v[64:67], v136 offset:12800
    v_exp_f32 v46, v44
    v_smfmac_f32_16x16x64_bf16 v[52:55], v[20:23], v[232:239], v131
    ds_read_b128 v[56:59], v138 offset:12800
    v_add_f32 v48, v48, v50
    v_exp_f32 v47, v45
    v_smfmac_f32_16x16x64_bf16 v[52:55], v[24:27], v[240:247], v131
    ds_read_b128 v[60:63], v138 offset:12288
    v_add_f32 v49, v49, v51
    v_cvt_pk_bf16_f32 v46, v46, v47
    v_smfmac_f32_16x16x64_bf16 v[52:55], v[28:31], v[248:255], v131
    s_waitcnt lgkmcnt(2)
    v_cvt_pk_bf16_f32 v48, v48, v49
    v_mfma_f32_16x16x32_bf16 v[36:39], v[68:71], v[64:67], 0
    s_waitcnt lgkmcnt(1)
    v_cndmask_b32 v50, 0, v46, s[70:71]
    v_cndmask_b32 v51, v46, 0, s[70:71]
    v_mfma_f32_16x16x32_bf16 v[40:43], v[104:107], v[56:59], 0
    s_waitcnt lgkmcnt(0)
    v_add_f32 v52, v52, v54
    v_add_f32 v53, v53, v55
    v_mfma_f32_16x16x32_bf16 v[40:43], v[108:111], v[60:63], v[40:43]
    v_cvt_pk_bf16_f32 v49, v52, v53
    v_mfma_f32_16x16x16_bf16 v[36:39], v[68:69], v[50:51], v[36:39]
    v_mfma_f32_16x16x16_bf16 v[40:43], v[48:49], v[50:51], v[40:43]
    s_nop 3
    v_rcp_f32 v46, v36
    v_mov_b64 v[10:11], 0
    v_mov_b64 v[12:13], 0
    s_nop 0
    v_pk_mul_f32 v[40:41], v[40:41], v[46:47] op_sel_hi:[1,0]
    v_pk_mul_f32 v[42:43], v[42:43], v[46:47] op_sel_hi:[1,0]
    v_cvt_pk_bf16_f32 v40, v40, v41
    v_cvt_pk_bf16_f32 v41, v42, v43
    ds_write_b64 v139, v[40:41] offset:14848
    v_subrev_u32 v47, s74, v36
    v_cmp_lt_u32 vcc, s75, v47
    v_mov_b64 v[14:15], 0
    s_cbranch_vccnz L_c0_w2_fb
L_c0_w2_fbret:
    buffer_load_dwordx4 v[104:107], v140, s[36:39], s51 offen offset:0 sc1
    buffer_load_dwordx4 v[108:111], v140, s[36:39], s51 offen offset:1024 sc1
    s_waitcnt lgkmcnt(0)
    s_barrier
    ds_read_b128 v[112:115], v137 offset:13824
    ds_read_b128 v[116:119], v137 offset:14336
    ds_read_b128 v[120:123], v137 offset:14848
    ds_read_b128 v[124:127], v137 offset:15360
    s_waitcnt lgkmcnt(3)
    v_smfmac_f32_16x16x64_bf16 v[0:3], v[112:115], v[144:151], v131
    s_waitcnt lgkmcnt(2)
    v_smfmac_f32_16x16x64_bf16 v[0:3], v[116:119], v[152:159], v131
    s_waitcnt lgkmcnt(1)
    ds_read_b128 v[56:59], v134 offset:28672
    v_smfmac_f32_16x16x64_bf16 v[0:3], v[120:123], v[160:167], v131
    s_waitcnt lgkmcnt(1)
    ds_read_b128 v[60:63], v134 offset:29696
    v_smfmac_f32_16x16x64_bf16 v[0:3], v[124:127], v[168:175], v131
    s_add_u32 s84, s48, 4096
    ds_read_b128 v[64:67], v134 offset:30720
    v_smfmac_f32_16x16x64_bf16 v[4:7], v[112:115], v[176:183], v131
    ds_read_b128 v[68:71], v134 offset:31744
    v_smfmac_f32_16x16x64_bf16 v[4:7], v[116:119], v[72:79], v131
    ds_read_b128 v[72:75], v134 offset:32768
    v_cvt_pk_bf16_f32 v16, v0, v2
    v_cvt_pk_bf16_f32 v17, v1, v3
    v_smfmac_f32_16x16x64_bf16 v[4:7], v[120:123], v[184:191], v131
    ds_read_b128 v[76:79], v134 offset:33792
    v_bfi_b32 v16, 1, s87, v16
    v_bfi_b32 v17, 1, s87, v17
    v_smfmac_f32_16x16x64_bf16 v[4:7], v[124:127], v[80:87], v131
    ds_read_b128 v[80:83], v134 offset:34816
    buffer_store_dwordx2 v[16:17], v132, s[36:39], s48 offen offset:0
    v_smfmac_f32_16x16x64_bf16 v[8:11], v[112:115], v[192:199], v131
    s_waitcnt lgkmcnt(5)
    ds_read_b128 v[84:87], v134 offset:35840
    v_smfmac_f32_16x16x64_bf16 v[8:11], v[116:119], v[56:63], v131
    v_cvt_pk_bf16_f32 v18, v4, v6
    v_cvt_pk_bf16_f32 v19, v5, v7
    v_bfi_b32 v18, 1, s87, v18
    v_bfi_b32 v19, 1, s87, v19
    v_smfmac_f32_16x16x64_bf16 v[8:11], v[120:123], v[200:207], v131
    s_waitcnt lgkmcnt(4)
    buffer_store_dwordx2 v[18:19], v132, s[36:39], s48 offen offset:2048
    v_smfmac_f32_16x16x64_bf16 v[8:11], v[124:127], v[64:71], v131
    v_smfmac_f32_16x16x64_bf16 v[12:15], v[112:115], v[208:215], v131
    s_waitcnt lgkmcnt(2)
    v_smfmac_f32_16x16x64_bf16 v[12:15], v[116:119], v[72:79], v131
    v_cvt_pk_bf16_f32 v20, v8, v10
    v_smfmac_f32_16x16x64_bf16 v[12:15], v[120:123], v[216:223], v131
    s_waitcnt lgkmcnt(0)
    v_cvt_pk_bf16_f32 v21, v9, v11
    v_smfmac_f32_16x16x64_bf16 v[12:15], v[124:127], v[80:87], v131
    v_bfi_b32 v20, 1, s87, v20
    v_bfi_b32 v21, 1, s87, v21
    buffer_store_dwordx2 v[20:21], v132, s[36:39], s84 offen offset:0
    s_nop 3
    v_cvt_pk_bf16_f32 v22, v12, v14
    v_cvt_pk_bf16_f32 v23, v13, v15
    v_bfi_b32 v22, 1, s87, v22
    v_bfi_b32 v23, 1, s87, v23
    buffer_store_dwordx2 v[22:23], v132, s[36:39], s84 offen offset:2048
    v_mov_b64 v[40:41], 0
    v_mov_b64 v[42:43], 0
    v_mov_b64 v[44:45], 0
    v_mov_b64 v[46:47], 0
    v_mov_b64 v[48:49], 0
    v_mov_b64 v[50:51], 0
    v_mov_b64 v[52:53], 0
    v_mov_b64 v[54:55], 0
    ds_read_b128 v[56:59], v134 offset:0
    ds_read_b128 v[60:63], v134 offset:1024
    ds_read_b128 v[64:67], v134 offset:2048
    ds_read_b128 v[68:71], v134 offset:3072
    ds_read_b128 v[72:75], v134 offset:4096
    ds_read_b128 v[76:79], v134 offset:5120
    ds_read_b128 v[80:83], v134 offset:6144
    ds_read_b128 v[84:87], v134 offset:7168
    s_sub_u32 s95, s79, s48
    s_mov_b32 s82, s49
    s_mov_b32 s49, s48
    s_mov_b32 s48, s79
    s_mov_b32 s79, s49
    s_add_u32 s52, s52, 0x80000
    s_mov_b32 s91, 0
    s_add_u32 s50, s50, 524288
    s_add_u32 s51, s51, 524288
    s_nop 7
    s_nop 7
    s_nop 7
    s_nop 7
    s_nop 7
    s_nop 2
    buffer_load_dword v32, v141, s[36:39], s57 offen sc1
    buffer_load_dword v33, v141, s[36:39], s58 offen sc1
    buffer_load_dword v34, v141, s[36:39], s59 offen sc1
    buffer_load_dword v35, v141, s[36:39], s60 offen sc1
    buffer_load_dword v36, v141, s[36:39], s61 offen sc1
    buffer_load_dword v37, v141, s[36:39], s62 offen sc1
    buffer_load_dword v38, v141, s[36:39], s63 offen sc1
    buffer_load_dword v39, v141, s[36:39], s64 offen sc1
    s_mov_b32 s80, s47
    s_mov_b32 s47, s45
    s_mov_b32 s45, s46
    s_mov_b32 s46, s80
    s_add_u32 s53, s53, 8192
    s_mov_b32 s54, s53
    s_add_u32 s44, s44, 1
    v_mov_b32 v112, v143
    v_mov_b32 v113, v143
    v_mov_b32 v114, v143
    v_mov_b32 v115, v143
    v_mov_b32 v2, s44
    s_waitcnt vmcnt(4)
L_c0_w2_p2w:
    v_mfma_f32_16x16x32_bf16 v[116:119], v[112:115], v[32:35], 0
    v_bitop3_b32 v0, v32, v33, s87 bitop3:0x7e
    v_bitop3_b32 v1, v34, v35, s87 bitop3:0x7e
    s_waitcnt vmcnt(0)
    v_mfma_f32_16x16x32_bf16 v[116:119], v[112:115], v[36:39], v[116:119]
    v_bitop3_b32 v3, v36, v37, s87 bitop3:0x7e
    v_bitop3_b32 v4, v38, v39, s87 bitop3:0x7e
    v_or3_b32 v0, v0, v1, v3
    v_bitop3_b32 v0, v0, v4, 1 bitop3:0xa8
    v_cmp_ne_u32 vcc, 0, v0
    s_cbranch_vccnz L_c0_w2_p2retry
L_c0_w2_p2ok:
    s_nop 0
    v_cvt_pk_bf16_f32 v116, v116, v117
    buffer_store_dword v116, v142, s[36:39], s45 offen
    s_cmp_eq_u32 s44, 63
    s_cbranch_scc1 L_c0_fin
    s_nop 2
    buffer_store_dword v2, off, s[36:39], s90
    v_mov_b64 v[32:33], 0
    v_mov_b64 v[34:35], 0
    v_mov_b64 v[36:37], 0
    v_mov_b64 v[38:39], 0
    v_cmp_le_u32 vcc, 32, v128
    s_and_b32 s80, vcc_lo, 0xffff
    s_ff0_i32_b32 s80, s80
    s_max_u32 s56, s56, s80
    s_add_u32 s80, s44, 4
    s_lshr_b32 s80, s80, 2
    s_min_u32 s80, s80, 15
    s_cmp_lt_u32 s80, s56
    s_cselect_b32 s55, s88, s89
    s_add_u32 s80, s44, 2
    s_lshr_b32 s80, s80, 2
    s_min_u32 s80, s80, 15
    s_cmp_lt_u32 s80, s56
    s_cbranch_scc0 L_c0_w2_kvwait
L_c0_w2_kvok:
    v_add_u32 v141, s95, v141
    s_bfe_i32 s87, s44, 0x10001
    s_branch L_c0_w2_step
L_c0_w2_spin0:
    s_waitcnt vmcnt(2)
    v_cmp_ne_u32 vcc, s44, v114
    s_cbranch_vccz L_c0_w2_spun
L_c0_w2_spin1:
    buffer_load_dword v114, v133, s[36:39], s65 offen sc1
    buffer_load_dwordx4 v140, s[36:39], s45 offen sc1 lds
    buffer_load_dwordx4 v140, s[36:39], s45 offen offset:1024 sc1 lds
    s_sub_u32 s100, s100, 1
    s_mov_b32 s101, 12
    s_cbranch_scc1 L_fail
    s_branch L_c0_w2_spin0
L_c0_w2_spun:
    s_waitcnt vmcnt(0)
    s_branch L_c0_w2_hit
L_c0_w2_redo:
    s_mov_b32 s91, 1
    s_mov_b32 s54, 0x80000000
    s_sub_u32 s50, s50, 0x80000
    buffer_load_dwordx4 v[88:91], v137, s[36:39], s50 offen offset:0 sc1
    buffer_load_dwordx4 v[92:95], v137, s[36:39], s50 offen offset:1024 sc1
    buffer_load_dwordx4 v[96:99], v137, s[36:39], s50 offen offset:2048 sc1
    buffer_load_dwordx4 v[100:103], v137, s[36:39], s50 offen offset:3072 sc1
    s_add_u32 s50, s50, 0x80000
L_c0_w2_redo1:
    s_waitcnt vmcnt(0) lgkmcnt(0)
    s_barrier
    s_sub_u32 s100, s100, 1
    s_mov_b32 s101, 13
    s_cbranch_scc1 L_fail
    buffer_load_dwordx4 v140, s[36:39], s45 offen sc1 lds
    buffer_load_dwordx4 v140, s[36:39], s45 offen offset:1024 sc1 lds
    s_waitcnt vmcnt(0)
    s_barrier
    ds_read_b128 v[0:3], v140 offset:0
    ds_read_b128 v[4:7], v140 offset:1024
    ds_read_b128 v[8:11], v140 offset:2048
    ds_read_b128 v[12:15], v140 offset:3072
    ds_read_b128 v[16:19], v140 offset:4096
    ds_read_b128 v[20:23], v140 offset:5120
    ds_read_b128 v[24:27], v140 offset:6144
    ds_read_b128 v[28:31], v140 offset:7168
    s_waitcnt lgkmcnt(0)
    v_cmp_eq_u32 vcc, s66, v0
    s_cbranch_vccnz L_c0_w2_redo1
    v_cmp_eq_u32 vcc, s66, v1
    s_cbranch_vccnz L_c0_w2_redo1
    v_cmp_eq_u32 vcc, s66, v2
    s_cbranch_vccnz L_c0_w2_redo1
    v_cmp_eq_u32 vcc, s66, v3
    s_cbranch_vccnz L_c0_w2_redo1
    v_cmp_eq_u32 vcc, s66, v4
    s_cbranch_vccnz L_c0_w2_redo1
    v_cmp_eq_u32 vcc, s66, v5
    s_cbranch_vccnz L_c0_w2_redo1
    v_cmp_eq_u32 vcc, s66, v6
    s_cbranch_vccnz L_c0_w2_redo1
    v_cmp_eq_u32 vcc, s66, v7
    s_cbranch_vccnz L_c0_w2_redo1
    v_cmp_eq_u32 vcc, s66, v8
    s_cbranch_vccnz L_c0_w2_redo1
    v_cmp_eq_u32 vcc, s66, v9
    s_cbranch_vccnz L_c0_w2_redo1
    v_cmp_eq_u32 vcc, s66, v10
    s_cbranch_vccnz L_c0_w2_redo1
    v_cmp_eq_u32 vcc, s66, v11
    s_cbranch_vccnz L_c0_w2_redo1
    v_cmp_eq_u32 vcc, s66, v12
    s_cbranch_vccnz L_c0_w2_redo1
    v_cmp_eq_u32 vcc, s66, v13
    s_cbranch_vccnz L_c0_w2_redo1
    v_cmp_eq_u32 vcc, s66, v14
    s_cbranch_vccnz L_c0_w2_redo1
    v_cmp_eq_u32 vcc, s66, v15
    s_cbranch_vccnz L_c0_w2_redo1
    v_cmp_eq_u32 vcc, s66, v16
    s_cbranch_vccnz L_c0_w2_redo1
    v_cmp_eq_u32 vcc, s66, v17
    s_cbranch_vccnz L_c0_w2_redo1
    v_cmp_eq_u32 vcc, s66, v18
    s_cbranch_vccnz L_c0_w2_redo1
    v_cmp_eq_u32 vcc, s66, v19
    s_cbranch_vccnz L_c0_w2_redo1
    v_cmp_eq_u32 vcc, s66, v20
    s_cbranch_vccnz L_c0_w2_redo1
    v_cmp_eq_u32 vcc, s66, v21
    s_cbranch_vccnz L_c0_w2_redo1
    v_cmp_eq_u32 vcc, s66, v22
    s_cbranch_vccnz L_c0_w2_redo1
    v_cmp_eq_u32 vcc, s66, v23
    s_cbranch_vccnz L_c0_w2_redo1
    v_cmp_eq_u32 vcc, s66, v24
    s_cbranch_vccnz L_c0_w2_redo1
    v_cmp_eq_u32 vcc, s66, v25
    s_cbranch_vccnz L_c0_w2_redo1
    v_cmp_eq_u32 vcc, s66, v26
    s_cbranch_vccnz L_c0_w2_redo1
    v_cmp_eq_u32 vcc, s66, v27
    s_cbranch_vccnz L_c0_w2_redo1
    v_cmp_eq_u32 vcc, s66, v28
    s_cbranch_vccnz L_c0_w2_redo1
    v_cmp_eq_u32 vcc, s66, v29
    s_cbranch_vccnz L_c0_w2_redo1
    v_cmp_eq_u32 vcc, s66, v30
    s_cbranch_vccnz L_c0_w2_redo1
    v_cmp_eq_u32 vcc, s66, v31
    s_cbranch_vccnz L_c0_w2_redo1
    ds_read_b128 v[56:59], v134 offset:0
    ds_read_b128 v[60:63], v134 offset:1024
    ds_read_b128 v[64:67], v134 offset:2048
    ds_read_b128 v[68:71], v134 offset:3072
    ds_read_b128 v[72:75], v134 offset:4096
    ds_read_b128 v[76:79], v134 offset:5120
    ds_read_b128 v[80:83], v134 offset:6144
    ds_read_b128 v[84:87], v134 offset:7168
    v_mov_b64 v[32:33], 0
    v_mov_b64 v[34:35], 0
    v_mov_b64 v[36:37], 0
    v_mov_b64 v[38:39], 0
    v_mov_b64 v[40:41], 0
    v_mov_b64 v[42:43], 0
    v_mov_b64 v[44:45], 0
    v_mov_b64 v[46:47], 0
    v_mov_b64 v[48:49], 0
    v_mov_b64 v[50:51], 0
    v_mov_b64 v[52:53], 0
    v_mov_b64 v[54:55], 0
    v_mov_b32 v114, s44
    v_mov_b32 v115, s44
    s_branch L_c0_w2_step
L_c0_w2_p2slow:
    v_cmp_eq_u32 vcc, s66, v32
    s_cbranch_vccnz L_c0_w2_p2retry
    v_cmp_eq_u32 vcc, s66, v33
    s_cbranch_vccnz L_c0_w2_p2retry
    v_cmp_eq_u32 vcc, s66, v34
    s_cbranch_vccnz L_c0_w2_p2retry
    v_cmp_eq_u32 vcc, s66, v35
    s_cbranch_vccnz L_c0_w2_p2retry
    v_cmp_eq_u32 vcc, s66, v36
    s_cbranch_vccnz L_c0_w2_p2retry
    v_cmp_eq_u32 vcc, s66, v37
    s_cbranch_vccnz L_c0_w2_p2retry
    v_cmp_eq_u32 vcc, s66, v38
    s_cbranch_vccnz L_c0_w2_p2retry
    v_cmp_eq_u32 vcc, s66, v39
    s_cbranch_vccnz L_c0_w2_p2retry
    s_branch L_c0_w2_p2ok
L_c0_w2_p2retry:
    s_sub_u32 s100, s100, 1
    s_mov_b32 s101, 14
    s_cbranch_scc1 L_fail
    buffer_load_dword v32, v141, s[36:39], s57 offen sc1
    buffer_load_dword v33, v141, s[36:39], s58 offen sc1
    buffer_load_dword v34, v141, s[36:39], s59 offen sc1
    buffer_load_dword v35, v141, s[36:39], s60 offen sc1
    buffer_load_dword v36, v141, s[36:39], s61 offen sc1
    buffer_load_dword v37, v141, s[36:39], s62 offen sc1
    buffer_load_dword v38, v141, s[36:39], s63 offen sc1
    buffer_load_dword v39, v141, s[36:39], s64 offen sc1
    s_waitcnt vmcnt(0)
    s_branch L_c0_w2_p2w
L_c0_w2_kvwait:
    s_mov_b32 s82, 0x40000
    v_lshlrev_b32 v128, 2, v140
    s_waitcnt vmcnt(0)
    buffer_load_dword v128, v128, s[36:39], s82 offen sc1
    s_waitcnt vmcnt(0)
    v_cmp_le_u32 vcc, 32, v128
    s_and_b32 s82, vcc_lo, 0xffff
    s_ff0_i32_b32 s56, s82
    s_cmp_lt_u32 s80, s56
    s_cbranch_scc1 L_c0_w2_kvwait_ok
    s_sub_u32 s100, s100, 1
    s_mov_b32 s101, 15
    s_cbranch_scc1 L_fail
    s_branch L_c0_w2_kvwait
L_c0_w2_kvwait_ok:
    s_branch L_c0_w2_kvok
L_c0_w2_fb:
    s_cmp_eq_u32 s91, 0
    s_cbranch_scc0 L_c0_w2_fb1
    v_cmp_u_f32 vcc, v36, v36
    s_cbranch_vccnz L_c0_w2_redo
L_c0_w2_fb1:
    s_waitcnt vmcnt(0)
    s_barrier
    ds_write_b64 v140, v[32:33] offset:1024
    s_waitcnt lgkmcnt(0)
    s_barrier
    ds_read_b128 v[0:3], v140 offset:0
    ds_read_b128 v[4:7], v140 offset:1024
    v_mov_b32 v8, v44
    v_mov_b32 v9, v45
    s_waitcnt lgkmcnt(0)
    v_max3_f32 v10, v0, v1, v2
    v_max3_f32 v11, v3, v4, v5
    v_max3_f32 v10, v10, v6, v7
    v_max3_f32 v11, v11, v8, v9
    v_max_f32 v10, v10, v11
    v_mov_b32 v11, v10
    s_nop 1
    v_permlane32_swap_b32 v10, v11
    v_max_f32 v10, v10, v11
    v_mov_b32 v11, v10
    s_nop 1
    v_permlane16_swap_b32 v10, v11
    v_max_f32 v10, v10, v11
    v_sub_f32 v0, v0, v10
    v_sub_f32 v1, v1, v10
    v_sub_f32 v2, v2, v10
    v_sub_f32 v3, v3, v10
    v_sub_f32 v4, v4, v10
    v_sub_f32 v5, v5, v10
    v_sub_f32 v6, v6, v10
    v_sub_f32 v7, v7, v10
    v_sub_f32 v8, v8, v10
    v_sub_f32 v9, v9, v10
    v_exp_f32 v0, v0
    v_exp_f32 v1, v1
    v_exp_f32 v2, v2
    v_exp_f32 v3, v3
    v_exp_f32 v4, v4
    v_exp_f32 v5, v5
    v_exp_f32 v6, v6
    v_exp_f32 v7, v7
    v_exp_f32 v8, v8
    v_exp_f32 v9, v9
    v_cvt_pk_bf16_f32 v64, v0, v1
    v_cvt_pk_bf16_f32 v65, v2, v3
    v_cvt_pk_bf16_f32 v66, v4, v5
    v_cvt_pk_bf16_f32 v67, v6, v7
    v_cvt_pk_bf16_f32 v8, v8, v9
    v_cndmask_b32 v56, 0, v64, s[70:71]
    v_cndmask_b32 v60, v64, 0, s[70:71]
    v_cndmask_b32 v57, 0, v65, s[70:71]
    v_cndmask_b32 v61, v65, 0, s[70:71]
    v_cndmask_b32 v58, 0, v66, s[70:71]
    v_cndmask_b32 v62, v66, 0, s[70:71]
    v_cndmask_b32 v59, 0, v67, s[70:71]
    v_cndmask_b32 v63, v67, 0, s[70:71]
    v_cndmask_b32 v50, 0, v8, s[70:71]
    v_cndmask_b32 v51, v8, 0, s[70:71]
    v_mfma_f32_16x16x32_bf16 v[36:39], v[68:71], v[64:67], 0
    v_mfma_f32_16x16x32_bf16 v[40:43], v[104:107], v[56:59], 0
    v_mfma_f32_16x16x32_bf16 v[40:43], v[108:111], v[60:63], v[40:43]
    v_mfma_f32_16x16x16_bf16 v[36:39], v[68:69], v[50:51], v[36:39]
    v_mfma_f32_16x16x16_bf16 v[40:43], v[48:49], v[50:51], v[40:43]
    v_mov_b64 v[0:1], 0
    v_mov_b64 v[2:3], 0
    v_mov_b64 v[4:5], 0
    v_mov_b64 v[6:7], 0
    v_mov_b64 v[8:9], 0
    v_mov_b64 v[10:11], 0
    v_mov_b64 v[12:13], 0
    v_mov_b64 v[14:15], 0
    v_rcp_f32 v46, v36
    s_nop 0
    v_pk_mul_f32 v[40:41], v[40:41], v[46:47] op_sel_hi:[1,0]
    v_pk_mul_f32 v[42:43], v[42:43], v[46:47] op_sel_hi:[1,0]
    v_cvt_pk_bf16_f32 v40, v40, v41
    v_cvt_pk_bf16_f32 v41, v42, v43
    ds_write_b64 v139, v[40:41] offset:14848
    s_branch L_c0_w2_fbret
L_c0_enter3:
    s_waitcnt vmcnt(0)
    .p2align 6
L_c0_w3_step:
    s_waitcnt lgkmcnt(0)
    s_barrier
    ds_read_b128 v[0:3], v140 offset:0
    ds_read_b128 v[4:7], v140 offset:1024
    buffer_load_dword v114, v133, s[36:39], s65 offen sc1
    buffer_load_dwordx4 v140, s[36:39], s45 offen sc1 lds
    buffer_load_dwordx4 v140, s[36:39], s45 offen offset:1024 sc1 lds
    s_waitcnt lgkmcnt(1)
    v_smfmac_f32_16x16x64_bf16 v[32:35], v[0:3], v[56:63], v131
    ds_read_b128 v[8:11], v140 offset:2048
    buffer_load_dwordx3 v[128:130], v140, s[36:39], s52 offen offset:0 sc1
    v_mov_b32 v124, s66
    v_smfmac_f32_16x16x64_bf16 v[36:39], v[0:3], a[40:47], v131
    s_waitcnt lgkmcnt(1)
    ds_read_b128 v[12:15], v140 offset:3072
    v_lshlrev_b32 v126, 2, v140
    v_smfmac_f32_16x16x64_bf16 v[40:43], v[0:3], v[64:71], v131
    ds_read_b128 v[56:59], v134 offset:8192
    v_smfmac_f32_16x16x64_bf16 v[44:47], v[0:3], a[112:119], v131
    ds_read_b128 v[60:63], v134 offset:9216
    buffer_load_dwordx3 v[128:130], v140, s[36:39], s52 offen offset:1024 sc1
    v_smfmac_f32_16x16x64_bf16 v[32:35], v[4:7], v[72:79], v131
    ds_read_b128 v[64:67], v134 offset:10240
    v_smfmac_f32_16x16x64_bf16 v[36:39], v[4:7], a[48:55], v131
    ds_read_b128 v[68:71], v134 offset:11264
    v_smfmac_f32_16x16x64_bf16 v[40:43], v[4:7], v[80:87], v131
    ds_read_b128 v[72:75], v134 offset:12288
    buffer_load_dwordx3 v[128:130], v140, s[36:39], s52 offen offset:2048 sc1
    v_smfmac_f32_16x16x64_bf16 v[44:47], v[4:7], a[120:127], v131
    s_waitcnt lgkmcnt(6)
    ds_read_b128 v[76:79], v134 offset:13312
    v_smfmac_f32_16x16x64_bf16 v[32:35], v[8:11], a[0:7], v131
    s_waitcnt lgkmcnt(4)
    ds_read_b128 v[80:83], v134 offset:14336
    v_smfmac_f32_16x16x64_bf16 v[36:39], v[8:11], v[56:63], v131
    ds_read_b128 v[84:87], v134 offset:15360
    v_smfmac_f32_16x16x64_bf16 v[40:43], v[8:11], a[80:87], v131
    ds_read_b128 v[56:59], v134 offset:16384
    v_smfmac_f32_16x16x64_bf16 v[44:47], v[8:11], a[128:135], v131
    s_waitcnt lgkmcnt(9)
    ds_read_b128 v[60:63], v134 offset:17408
    v_smfmac_f32_16x16x64_bf16 v[32:35], v[12:15], a[8:15], v131
    s_waitcnt lgkmcnt(6)
    v_smfmac_f32_16x16x64_bf16 v[36:39], v[12:15], v[64:71], v131
    s_waitcnt vmcnt(5)
    v_cmp_ne_u32 vcc, s44, v114
    s_cbranch_vccnz L_c0_w3_spin1
L_c0_w3_hit:
    v_smfmac_f32_16x16x64_bf16 v[40:43], v[12:15], a[88:95], v131
    s_waitcnt vmcnt(3)
    s_barrier
    ds_read_b128 v[16:19], v140 offset:4096
    buffer_load_dwordx3 v[128:130], v140, s[36:39], s52 offen offset:3072 sc1
    v_smfmac_f32_16x16x64_bf16 v[44:47], v[12:15], a[136:143], v131
    s_waitcnt lgkmcnt(5)
    ds_read_b128 v[20:23], v140 offset:5120
    v_smfmac_f32_16x16x64_bf16 v[48:51], v[0:3], v[72:79], v131
    ds_read_b128 v[24:27], v140 offset:6144
    v_smfmac_f32_16x16x64_bf16 v[52:55], v[0:3], a[224:231], v131
    ds_read_b128 v[28:31], v140 offset:7168
    buffer_load_dword v128, v126, s[36:39], s55 offen sc1
    v_smfmac_f32_16x16x64_bf16 v[48:51], v[4:7], a[168:175], v131
    s_waitcnt lgkmcnt(3)
    ds_read_b128 v[64:67], v134 offset:18432
    v_smfmac_f32_16x16x64_bf16 v[32:35], v[16:19], a[16:23], v131
    s_waitcnt lgkmcnt(3)
    ds_read_b128 v[68:71], v134 offset:19456
    v_smfmac_f32_16x16x64_bf16 v[32:35], v[20:23], v[80:87], v131
    s_waitcnt lgkmcnt(3)
    ds_read_b128 v[72:75], v134 offset:20480
    v_smfmac_f32_16x16x64_bf16 v[32:35], v[24:27], a[24:31], v131
    s_waitcnt lgkmcnt(3)
    ds_read_b128 v[76:79], v134 offset:21504
    v_smfmac_f32_16x16x64_bf16 v[32:35], v[28:31], a[32:39], v131
    s_waitcnt lgkmcnt(8)
    ds_read_b128 v[80:83], v134 offset:22528
    v_smfmac_f32_16x16x64_bf16 v[36:39], v[16:19], v[56:63], v131
    ds_read_b128 v[84:87], v134 offset:23552
    buffer_store_dword v116, v142, s[36:39], s54 offen sc1
    v_smfmac_f32_16x16x64_bf16 v[36:39], v[20:23], a[56:63], v131
    v_add_f32 v32, v32, v34
    v_smfmac_f32_16x16x64_bf16 v[36:39], v[24:27], a[64:71], v131
    buffer_store_dword v124, v142, s[36:39], s47 offen
    v_add_f32 v33, v33, v35
    v_smfmac_f32_16x16x64_bf16 v[36:39], v[28:31], a[72:79], v131
    s_waitcnt lgkmcnt(4)
    v_smfmac_f32_16x16x64_bf16 v[40:43], v[16:19], v[64:71], v131
    v_mov_b64 v[68:69], s[68:69]
    v_smfmac_f32_16x16x64_bf16 v[40:43], v[20:23], a[96:103], v131
    v_add_f32 v36, v36, v38
    v_add_f32 v37, v37, v39
    v_smfmac_f32_16x16x64_bf16 v[40:43], v[24:27], a[104:111], v131
    s_waitcnt lgkmcnt(2)
    v_cvt_pk_bf16_f32 v32, v32, v36
    v_cvt_pk_bf16_f32 v33, v33, v37
    v_smfmac_f32_16x16x64_bf16 v[40:43], v[28:31], v[72:79], v131
    ds_write2_b32 v135, v32, v33 offset0:0 offset1:4
    v_smfmac_f32_16x16x64_bf16 v[44:47], v[16:19], a[144:151], v131
    ds_read_b128 v[72:75], v134 offset:24576
    v_mov_b64 v[70:71], s[68:69]
    v_smfmac_f32_16x16x64_bf16 v[44:47], v[20:23], a[152:159], v131
    ds_read_b128 v[76:79], v134 offset:25600
    v_add_f32 v40, v40, v42
    v_smfmac_f32_16x16x64_bf16 v[44:47], v[24:27], a[160:167], v131
    s_waitcnt lgkmcnt(3)
    v_add_f32 v41, v41, v43
    v_smfmac_f32_16x16x64_bf16 v[44:47], v[28:31], v[80:87], v131
    ds_read_b128 v[80:83], v134 offset:26624
    v_smfmac_f32_16x16x64_bf16 v[52:55], v[4:7], a[232:239], v131
    s_waitcnt lgkmcnt(3)
    s_barrier
    ds_read_b128 v[112:115], v136 offset:8192
    v_smfmac_f32_16x16x64_bf16 v[48:51], v[8:11], a[176:183], v131
    ds_read_b128 v[116:119], v136 offset:9216
    v_add_f32 v44, v44, v46
    v_smfmac_f32_16x16x64_bf16 v[52:55], v[8:11], a[240:247], v131
    ds_read_b128 v[120:123], v136 offset:10240
    v_add_f32 v45, v45, v47
    v_cvt_pk_bf16_f32 v40, v40, v44
    v_smfmac_f32_16x16x64_bf16 v[48:51], v[12:15], a[184:191], v131
    ds_read_b128 v[124:127], v136 offset:11264
    v_cvt_pk_bf16_f32 v41, v41, v45
    v_smfmac_f32_16x16x64_bf16 v[52:55], v[12:15], a[248:255], v131
    s_waitcnt lgkmcnt(3)
    ds_write2_b32 v135, v40, v41 offset0:128 offset1:132
    v_mfma_f32_16x16x32_bf16 v[32:35], v[88:91], v[112:115], 0
    s_waitcnt lgkmcnt(3)
    ds_read_b128 v[84:87], v134 offset:27648
    v_mfma_f32_16x16x32_bf16 v[32:35], v[92:95], v[116:119], v[32:35]
    s_waitcnt lgkmcnt(3)
    v_mfma_f32_16x16x32_bf16 v[32:35], v[96:99], v[120:123], v[32:35]
    s_waitcnt lgkmcnt(2)
    v_mfma_f32_16x16x32_bf16 v[32:35], v[100:103], v[124:127], v[32:35]
    s_waitcnt lgkmcnt(1)
    s_barrier
    ds_read_b128 v[0:3], v137 offset:8704
    v_smfmac_f32_16x16x64_bf16 v[48:51], v[16:19], a[192:199], v131
    ds_read_b128 v[4:7], v137 offset:9728
    v_smfmac_f32_16x16x64_bf16 v[48:51], v[20:23], a[200:207], v131
    ds_read_b128 v[8:11], v137 offset:10752
    v_exp_f32 v36, v32
    v_smfmac_f32_16x16x64_bf16 v[48:51], v[24:27], a[208:215], v131
    s_waitcnt lgkmcnt(2)
    ds_read_b128 v[12:15], v137 offset:11776
    v_exp_f32 v37, v33
    v_mfma_f32_16x16x32_bf16 v[44:47], v[0:3], v[112:115], 0
    s_waitcnt lgkmcnt(2)
    v_cvt_pk_bf16_f32 v36, v36, v37
    v_mfma_f32_16x16x32_bf16 v[44:47], v[4:7], v[116:119], v[44:47]
    s_waitcnt lgkmcnt(1)
    ds_write_b32 v136, v36 offset:12812
    v_mfma_f32_16x16x32_bf16 v[44:47], v[8:11], v[120:123], v[44:47]
    s_waitcnt lgkmcnt(1)
    buffer_load_dwordx4 v[88:91], v137, s[36:39], s50 offen offset:0 sc1
    v_mov_b64 v[0:1], 0
    v_mov_b64 v[2:3], 0
    v_mfma_f32_16x16x32_bf16 v[44:47], v[12:15], v[124:127], v[44:47]
    buffer_load_dwordx4 v[92:95], v137, s[36:39], s50 offen offset:1024 sc1
    v_mov_b64 v[4:5], 0
    v_mov_b64 v[6:7], 0
    v_smfmac_f32_16x16x64_bf16 v[48:51], v[28:31], a[216:223], v131
    v_mov_b64 v[8:9], 0
    v_smfmac_f32_16x16x64_bf16 v[52:55], v[16:19], v[224:231], v131
    s_waitcnt lgkmcnt(0)
    s_barrier
    ds_read_b128 v[64:67], v136 offset:12800
    v_exp_f32 v46, v44
    v_smfmac_f32_16x16x64_bf16 v[52:55], v[20:23], v[232:239], v131
    ds_read_b128 v[56:59], v138 offset:12800
    v_add_f32 v48, v48, v50
    v_exp_f32 v47, v45
    v_smfmac_f32_16x16x64_bf16 v[52:55], v[24:27], v[240:247], v131
    ds_read_b128 v[60:63], v138 offset:12288
    buffer_load_dwordx4 v[96:99], v137, s[36:39], s50 offen offset:2048 sc1
    v_add_f32 v49, v49, v51
    v_cvt_pk_bf16_f32 v46, v46, v47
    v_smfmac_f32_16x16x64_bf16 v[52:55], v[28:31], v[248:255], v131
    s_waitcnt lgkmcnt(2)
    buffer_load_dwordx4 v[100:103], v137, s[36:39], s50 offen offset:3072 sc1
    v_cvt_pk_bf16_f32 v48, v48, v49
    v_mfma_f32_16x16x32_bf16 v[36:39], v[68:71], v[64:67], 0
    s_waitcnt lgkmcnt(1)
    v_cndmask_b32 v50, 0, v46, s[70:71]
    v_cndmask_b32 v51, v46, 0, s[70:71]
    v_mfma_f32_16x16x32_bf16 v[40:43], v[104:107], v[56:59], 0
    s_waitcnt lgkmcnt(0)
    v_add_f32 v52, v52, v54
    v_add_f32 v53, v53, v55
    v_mfma_f32_16x16x32_bf16 v[40:43], v[108:111], v[60:63], v[40:43]
    v_cvt_pk_bf16_f32 v49, v52, v53
    v_mfma_f32_16x16x16_bf16 v[36:39], v[68:69], v[50:51], v[36:39]
    v_mfma_f32_16x16x16_bf16 v[40:43], v[48:49], v[50:51], v[40:43]
    s_nop 3
    v_rcp_f32 v46, v36
    v_mov_b64 v[10:11], 0
    v_mov_b64 v[12:13], 0
    s_nop 0
    v_pk_mul_f32 v[40:41], v[40:41], v[46:47] op_sel_hi:[1,0]
    v_pk_mul_f32 v[42:43], v[42:43], v[46:47] op_sel_hi:[1,0]
    v_cvt_pk_bf16_f32 v40, v40, v41
    v_cvt_pk_bf16_f32 v41, v42, v43
    ds_write_b64 v139, v[40:41] offset:15360
    v_subrev_u32 v47, s74, v36
    v_cmp_lt_u32 vcc, s75, v47
    v_mov_b64 v[14:15], 0
    s_cbranch_vccnz L_c0_w3_fb
L_c0_w3_fbret:
    buffer_load_dwordx4 v[104:107], v140, s[36:39], s51 offen offset:0 sc1
    buffer_load_dwordx4 v[108:111], v140, s[36:39], s51 offen offset:1024 sc1
    s_waitcnt lgkmcnt(0)
    s_barrier
    ds_read_b128 v[112:115], v137 offset:13824
    ds_read_b128 v[116:119], v137 offset:14336
    ds_read_b128 v[120:123], v137 offset:14848
    ds_read_b128 v[124:127], v137 offset:15360
    s_waitcnt lgkmcnt(3)
    v_smfmac_f32_16x16x64_bf16 v[0:3], v[112:115], v[144:151], v131
    s_waitcnt lgkmcnt(2)
    v_smfmac_f32_16x16x64_bf16 v[0:3], v[116:119], v[152:159], v131
    s_waitcnt lgkmcnt(1)
    ds_read_b128 v[56:59], v134 offset:28672
    v_smfmac_f32_16x16x64_bf16 v[0:3], v[120:123], v[160:167], v131
    s_waitcnt lgkmcnt(1)
    ds_read_b128 v[60:63], v134 offset:29696
    v_smfmac_f32_16x16x64_bf16 v[0:3], v[124:127], v[168:175], v131
    s_add_u32 s84, s48, 4096
    ds_read_b128 v[64:67], v134 offset:30720
    v_smfmac_f32_16x16x64_bf16 v[4:7], v[112:115], v[176:183], v131
    ds_read_b128 v[68:71], v134 offset:31744
    v_smfmac_f32_16x16x64_bf16 v[4:7], v[116:119], v[72:79], v131
    ds_read_b128 v[72:75], v134 offset:32768
    v_cvt_pk_bf16_f32 v16, v0, v2
    v_cvt_pk_bf16_f32 v17, v1, v3
    v_smfmac_f32_16x16x64_bf16 v[4:7], v[120:123], v[184:191], v131
    ds_read_b128 v[76:79], v134 offset:33792
    v_bfi_b32 v16, 1, s87, v16
    v_bfi_b32 v17, 1, s87, v17
    v_smfmac_f32_16x16x64_bf16 v[4:7], v[124:127], v[80:87], v131
    ds_read_b128 v[80:83], v134 offset:34816
    buffer_store_dwordx2 v[16:17], v132, s[36:39], s48 offen offset:0
    v_smfmac_f32_16x16x64_bf16 v[8:11], v[112:115], v[192:199], v131
    s_waitcnt lgkmcnt(5)
    ds_read_b128 v[84:87], v134 offset:35840
    v_smfmac_f32_16x16x64_bf16 v[8:11], v[116:119], v[56:63], v131
    v_cvt_pk_bf16_f32 v18, v4, v6
    v_cvt_pk_bf16_f32 v19, v5, v7
    v_bfi_b32 v18, 1, s87, v18
    v_bfi_b32 v19, 1, s87, v19
    v_smfmac_f32_16x16x64_bf16 v[8:11], v[120:123], v[200:207], v131
    s_waitcnt lgkmcnt(4)
    buffer_store_dwordx2 v[18:19], v132, s[36:39], s48 offen offset:2048
    v_smfmac_f32_16x16x64_bf16 v[8:11], v[124:127], v[64:71], v131
    v_smfmac_f32_16x16x64_bf16 v[12:15], v[112:115], v[208:215], v131
    s_waitcnt lgkmcnt(2)
    v_smfmac_f32_16x16x64_bf16 v[12:15], v[116:119], v[72:79], v131
    v_cvt_pk_bf16_f32 v20, v8, v10
    v_smfmac_f32_16x16x64_bf16 v[12:15], v[120:123], v[216:223], v131
    s_waitcnt lgkmcnt(0)
    v_cvt_pk_bf16_f32 v21, v9, v11
    v_smfmac_f32_16x16x64_bf16 v[12:15], v[124:127], v[80:87], v131
    v_bfi_b32 v20, 1, s87, v20
    v_bfi_b32 v21, 1, s87, v21
    buffer_store_dwordx2 v[20:21], v132, s[36:39], s84 offen offset:0
    s_nop 3
    v_cvt_pk_bf16_f32 v22, v12, v14
    v_cvt_pk_bf16_f32 v23, v13, v15
    v_bfi_b32 v22, 1, s87, v22
    v_bfi_b32 v23, 1, s87, v23
    buffer_store_dwordx2 v[22:23], v132, s[36:39], s84 offen offset:2048
    v_mov_b64 v[40:41], 0
    v_mov_b64 v[42:43], 0
    v_mov_b64 v[44:45], 0
    v_mov_b64 v[46:47], 0
    v_mov_b64 v[48:49], 0
    v_mov_b64 v[50:51], 0
    v_mov_b64 v[52:53], 0
    v_mov_b64 v[54:55], 0
    ds_read_b128 v[56:59], v134 offset:0
    ds_read_b128 v[60:63], v134 offset:1024
    ds_read_b128 v[64:67], v134 offset:2048
    ds_read_b128 v[68:71], v134 offset:3072
    ds_read_b128 v[72:75], v134 offset:4096
    ds_read_b128 v[76:79], v134 offset:5120
    ds_read_b128 v[80:83], v134 offset:6144
    ds_read_b128 v[84:87], v134 offset:7168
    s_sub_u32 s95, s79, s48
    s_mov_b32 s82, s49
    s_mov_b32 s49, s48
    s_mov_b32 s48, s79
    s_mov_b32 s79, s49
    s_add_u32 s52, s52, 0x80000
    s_mov_b32 s91, 0
    s_add_u32 s50, s50, 524288
    s_add_u32 s51, s51, 524288
    s_nop 7
    s_nop 7
    s_nop 7
    s_nop 7
    s_nop 7
    s_nop 7
    s_nop 7
    s_nop 2
    buffer_load_dword v32, v141, s[36:39], s57 offen sc1
    buffer_load_dword v33, v141, s[36:39], s58 offen sc1
    buffer_load_dword v34, v141, s[36:39], s59 offen sc1
    buffer_load_dword v35, v141, s[36:39], s60 offen sc1
    buffer_load_dword v36, v141, s[36:39], s61 offen sc1
    buffer_load_dword v37, v141, s[36:39], s62 offen sc1
    buffer_load_dword v38, v141, s[36:39], s63 offen sc1
    buffer_load_dword v39, v141, s[36:39], s64 offen sc1
    s_mov_b32 s80, s47
    s_mov_b32 s47, s45
    s_mov_b32 s45, s46
    s_mov_b32 s46, s80
    s_add_u32 s53, s53, 8192
    s_mov_b32 s54, s53
    s_add_u32 s44, s44, 1
    v_mov_b32 v112, v143
    v_mov_b32 v113, v143
    v_mov_b32 v114, v143
    v_mov_b32 v115, v143
    v_mov_b32 v2, s44
    s_waitcnt vmcnt(4)
L_c0_w3_p2w:
    v_mfma_f32_16x16x32_bf16 v[116:119], v[112:115], v[32:35], 0
    v_bitop3_b32 v0, v32, v33, s87 bitop3:0x7e
    v_bitop3_b32 v1, v34, v35, s87 bitop3:0x7e
    s_waitcnt vmcnt(0)
    v_mfma_f32_16x16x32_bf16 v[116:119], v[112:115], v[36:39], v[116:119]
    v_bitop3_b32 v3, v36, v37, s87 bitop3:0x7e
    v_bitop3_b32 v4, v38, v39, s87 bitop3:0x7e
    v_or3_b32 v0, v0, v1, v3
    v_bitop3_b32 v0, v0, v4, 1 bitop3:0xa8
    v_cmp_ne_u32 vcc, 0, v0
    s_cbranch_vccnz L_c0_w3_p2retry
L_c0_w3_p2ok:
    s_nop 0
    v_cvt_pk_bf16_f32 v116, v116, v117
    buffer_store_dword v116, v142, s[36:39], s45 offen
    s_cmp_eq_u32 s44, 63
    s_cbranch_scc1 L_c0_fin
    s_nop 2
    buffer_store_dword v2, off, s[36:39], s90
    v_mov_b64 v[32:33], 0
    v_mov_b64 v[34:35], 0
    v_mov_b64 v[36:37], 0
    v_mov_b64 v[38:39], 0
    v_cmp_le_u32 vcc, 32, v128
    s_and_b32 s80, vcc_lo, 0xffff
    s_ff0_i32_b32 s80, s80
    s_max_u32 s56, s56, s80
    s_add_u32 s80, s44, 4
    s_lshr_b32 s80, s80, 2
    s_min_u32 s80, s80, 15
    s_cmp_lt_u32 s80, s56
    s_cselect_b32 s55, s88, s89
    s_add_u32 s80, s44, 2
    s_lshr_b32 s80, s80, 2
    s_min_u32 s80, s80, 15
    s_cmp_lt_u32 s80, s56
    s_cbranch_scc0 L_c0_w3_kvwait
L_c0_w3_kvok:
    v_add_u32 v141, s95, v141
    s_bfe_i32 s87, s44, 0x10001
    s_branch L_c0_w3_step
L_c0_w3_spin0:
    s_waitcnt vmcnt(2)
    v_cmp_ne_u32 vcc, s44, v114
    s_cbranch_vccz L_c0_w3_spun
L_c0_w3_spin1:
    buffer_load_dword v114, v133, s[36:39], s65 offen sc1
    buffer_load_dwordx4 v140, s[36:39], s45 offen sc1 lds
    buffer_load_dwordx4 v140, s[36:39], s45 offen offset:1024 sc1 lds
    s_sub_u32 s100, s100, 1
    s_mov_b32 s101, 12
    s_cbranch_scc1 L_fail
    s_branch L_c0_w3_spin0
L_c0_w3_spun:
    s_waitcnt vmcnt(0)
    s_branch L_c0_w3_hit
L_c0_w3_redo:
    s_mov_b32 s91, 1
    s_mov_b32 s54, 0x80000000
    s_sub_u32 s50, s50, 0x80000
    buffer_load_dwordx4 v[88:91], v137, s[36:39], s50 offen offset:0 sc1
    buffer_load_dwordx4 v[92:95], v137, s[36:39], s50 offen offset:1024 sc1
    buffer_load_dwordx4 v[96:99], v137, s[36:39], s50 offen offset:2048 sc1
    buffer_load_dwordx4 v[100:103], v137, s[36:39], s50 offen offset:3072 sc1
    s_add_u32 s50, s50, 0x80000
L_c0_w3_redo1:
    s_waitcnt vmcnt(0) lgkmcnt(0)
    s_barrier
    s_sub_u32 s100, s100, 1
    s_mov_b32 s101, 13
    s_cbranch_scc1 L_fail
    buffer_load_dwordx4 v140, s[36:39], s45 offen sc1 lds
    buffer_load_dwordx4 v140, s[36:39], s45 offen offset:1024 sc1 lds
    s_waitcnt vmcnt(0)
    s_barrier
    ds_read_b128 v[0:3], v140 offset:0
    ds_read_b128 v[4:7], v140 offset:1024
    ds_read_b128 v[8:11], v140 offset:2048
    ds_read_b128 v[12:15], v140 offset:3072
    ds_read_b128 v[16:19], v140 offset:4096
    ds_read_b128 v[20:23], v140 offset:5120
    ds_read_b128 v[24:27], v140 offset:6144
    ds_read_b128 v[28:31], v140 offset:7168
    s_waitcnt lgkmcnt(0)
    v_cmp_eq_u32 vcc, s66, v0
    s_cbranch_vccnz L_c0_w3_redo1
    v_cmp_eq_u32 vcc, s66, v1
    s_cbranch_vccnz L_c0_w3_redo1
    v_cmp_eq_u32 vcc, s66, v2
    s_cbranch_vccnz L_c0_w3_redo1
    v_cmp_eq_u32 vcc, s66, v3
    s_cbranch_vccnz L_c0_w3_redo1
    v_cmp_eq_u32 vcc, s66, v4
    s_cbranch_vccnz L_c0_w3_redo1
    v_cmp_eq_u32 vcc, s66, v5
    s_cbranch_vccnz L_c0_w3_redo1
    v_cmp_eq_u32 vcc, s66, v6
    s_cbranch_vccnz L_c0_w3_redo1
    v_cmp_eq_u32 vcc, s66, v7
    s_cbranch_vccnz L_c0_w3_redo1
    v_cmp_eq_u32 vcc, s66, v8
    s_cbranch_vccnz L_c0_w3_redo1
    v_cmp_eq_u32 vcc, s66, v9
    s_cbranch_vccnz L_c0_w3_redo1
    v_cmp_eq_u32 vcc, s66, v10
    s_cbranch_vccnz L_c0_w3_redo1
    v_cmp_eq_u32 vcc, s66, v11
    s_cbranch_vccnz L_c0_w3_redo1
    v_cmp_eq_u32 vcc, s66, v12
    s_cbranch_vccnz L_c0_w3_redo1
    v_cmp_eq_u32 vcc, s66, v13
    s_cbranch_vccnz L_c0_w3_redo1
    v_cmp_eq_u32 vcc, s66, v14
    s_cbranch_vccnz L_c0_w3_redo1
    v_cmp_eq_u32 vcc, s66, v15
    s_cbranch_vccnz L_c0_w3_redo1
    v_cmp_eq_u32 vcc, s66, v16
    s_cbranch_vccnz L_c0_w3_redo1
    v_cmp_eq_u32 vcc, s66, v17
    s_cbranch_vccnz L_c0_w3_redo1
    v_cmp_eq_u32 vcc, s66, v18
    s_cbranch_vccnz L_c0_w3_redo1
    v_cmp_eq_u32 vcc, s66, v19
    s_cbranch_vccnz L_c0_w3_redo1
    v_cmp_eq_u32 vcc, s66, v20
    s_cbranch_vccnz L_c0_w3_redo1
    v_cmp_eq_u32 vcc, s66, v21
    s_cbranch_vccnz L_c0_w3_redo1
    v_cmp_eq_u32 vcc, s66, v22
    s_cbranch_vccnz L_c0_w3_redo1
    v_cmp_eq_u32 vcc, s66, v23
    s_cbranch_vccnz L_c0_w3_redo1
    v_cmp_eq_u32 vcc, s66, v24
    s_cbranch_vccnz L_c0_w3_redo1
    v_cmp_eq_u32 vcc, s66, v25
    s_cbranch_vccnz L_c0_w3_redo1
    v_cmp_eq_u32 vcc, s66, v26
    s_cbranch_vccnz L_c0_w3_redo1
    v_cmp_eq_u32 vcc, s66, v27
    s_cbranch_vccnz L_c0_w3_redo1
    v_cmp_eq_u32 vcc, s66, v28
    s_cbranch_vccnz L_c0_w3_redo1
    v_cmp_eq_u32 vcc, s66, v29
    s_cbranch_vccnz L_c0_w3_redo1
    v_cmp_eq_u32 vcc, s66, v30
    s_cbranch_vccnz L_c0_w3_redo1
    v_cmp_eq_u32 vcc, s66, v31
    s_cbranch_vccnz L_c0_w3_redo1
    ds_read_b128 v[56:59], v134 offset:0
    ds_read_b128 v[60:63], v134 offset:1024
    ds_read_b128 v[64:67], v134 offset:2048
    ds_read_b128 v[68:71], v134 offset:3072
    ds_read_b128 v[72:75], v134 offset:4096
    ds_read_b128 v[76:79], v134 offset:5120
    ds_read_b128 v[80:83], v134 offset:6144
    ds_read_b128 v[84:87], v134 offset:7168
    v_mov_b64 v[32:33], 0
    v_mov_b64 v[34:35], 0
    v_mov_b64 v[36:37], 0
    v_mov_b64 v[38:39], 0
    v_mov_b64 v[40:41], 0
    v_mov_b64 v[42:43], 0
    v_mov_b64 v[44:45], 0
    v_mov_b64 v[46:47], 0
    v_mov_b64 v[48:49], 0
    v_mov_b64 v[50:51], 0
    v_mov_b64 v[52:53], 0
    v_mov_b64 v[54:55], 0
    v_mov_b32 v114, s44
    v_mov_b32 v115, s44
    s_branch L_c0_w3_step
L_c0_w3_p2slow:
    v_cmp_eq_u32 vcc, s66, v32
    s_cbranch_vccnz L_c0_w3_p2retry
    v_cmp_eq_u32 vcc, s66, v33
    s_cbranch_vccnz L_c0_w3_p2retry
    v_cmp_eq_u32 vcc, s66, v34
    s_cbranch_vccnz L_c0_w3_p2retry
    v_cmp_eq_u32 vcc, s66, v35
    s_cbranch_vccnz L_c0_w3_p2retry
    v_cmp_eq_u32 vcc, s66, v36
    s_cbranch_vccnz L_c0_w3_p2retry
    v_cmp_eq_u32 vcc, s66, v37
    s_cbranch_vccnz L_c0_w3_p2retry
    v_cmp_eq_u32 vcc, s66, v38
    s_cbranch_vccnz L_c0_w3_p2retry
    v_cmp_eq_u32 vcc, s66, v39
    s_cbranch_vccnz L_c0_w3_p2retry
    s_branch L_c0_w3_p2ok
L_c0_w3_p2retry:
    s_sub_u32 s100, s100, 1
    s_mov_b32 s101, 14
    s_cbranch_scc1 L_fail
    buffer_load_dword v32, v141, s[36:39], s57 offen sc1
    buffer_load_dword v33, v141, s[36:39], s58 offen sc1
    buffer_load_dword v34, v141, s[36:39], s59 offen sc1
    buffer_load_dword v35, v141, s[36:39], s60 offen sc1
    buffer_load_dword v36, v141, s[36:39], s61 offen sc1
    buffer_load_dword v37, v141, s[36:39], s62 offen sc1
    buffer_load_dword v38, v141, s[36:39], s63 offen sc1
    buffer_load_dword v39, v141, s[36:39], s64 offen sc1
    s_waitcnt vmcnt(0)
    s_branch L_c0_w3_p2w
L_c0_w3_kvwait:
    s_mov_b32 s82, 0x40000
    v_lshlrev_b32 v128, 2, v140
    s_waitcnt vmcnt(0)
    buffer_load_dword v128, v128, s[36:39], s82 offen sc1
    s_waitcnt vmcnt(0)
    v_cmp_le_u32 vcc, 32, v128
    s_and_b32 s82, vcc_lo, 0xffff
    s_ff0_i32_b32 s56, s82
    s_cmp_lt_u32 s80, s56
    s_cbranch_scc1 L_c0_w3_kvwait_ok
    s_sub_u32 s100, s100, 1
    s_mov_b32 s101, 15
    s_cbranch_scc1 L_fail
    s_branch L_c0_w3_kvwait
L_c0_w3_kvwait_ok:
    s_branch L_c0_w3_kvok
L_c0_w3_fb:
    s_cmp_eq_u32 s91, 0
    s_cbranch_scc0 L_c0_w3_fb1
    v_cmp_u_f32 vcc, v36, v36
    s_cbranch_vccnz L_c0_w3_redo
L_c0_w3_fb1:
    s_waitcnt vmcnt(0)
    s_barrier
    ds_write_b64 v140, v[32:33] offset:1032
    s_waitcnt lgkmcnt(0)
    s_barrier
    ds_read_b128 v[0:3], v140 offset:0
    ds_read_b128 v[4:7], v140 offset:1024
    v_mov_b32 v8, v44
    v_mov_b32 v9, v45
    s_waitcnt lgkmcnt(0)
    v_max3_f32 v10, v0, v1, v2
    v_max3_f32 v11, v3, v4, v5
    v_max3_f32 v10, v10, v6, v7
    v_max3_f32 v11, v11, v8, v9
    v_max_f32 v10, v10, v11
    v_mov_b32 v11, v10
    s_nop 1
    v_permlane32_swap_b32 v10, v11
    v_max_f32 v10, v10, v11
    v_mov_b32 v11, v10
    s_nop 1
    v_permlane16_swap_b32 v10, v11
    v_max_f32 v10, v10, v11
    v_sub_f32 v0, v0, v10
    v_sub_f32 v1, v1, v10
    v_sub_f32 v2, v2, v10
    v_sub_f32 v3, v3, v10
    v_sub_f32 v4, v4, v10
    v_sub_f32 v5, v5, v10
    v_sub_f32 v6, v6, v10
    v_sub_f32 v7, v7, v10
    v_sub_f32 v8, v8, v10
    v_sub_f32 v9, v9, v10
    v_exp_f32 v0, v0
    v_exp_f32 v1, v1
    v_exp_f32 v2, v2
    v_exp_f32 v3, v3
    v_exp_f32 v4, v4
    v_exp_f32 v5, v5
    v_exp_f32 v6, v6
    v_exp_f32 v7, v7
    v_exp_f32 v8, v8
    v_exp_f32 v9, v9
    v_cvt_pk_bf16_f32 v64, v0, v1
    v_cvt_pk_bf16_f32 v65, v2, v3
    v_cvt_pk_bf16_f32 v66, v4, v5
    v_cvt_pk_bf16_f32 v67, v6, v7
    v_cvt_pk_bf16_f32 v8, v8, v9
    v_cndmask_b32 v56, 0, v64, s[70:71]
    v_cndmask_b32 v60, v64, 0, s[70:71]
    v_cndmask_b32 v57, 0, v65, s[70:71]
    v_cndmask_b32 v61, v65, 0, s[70:71]
    v_cndmask_b32 v58, 0, v66, s[70:71]
    v_cndmask_b32 v62, v66, 0, s[70:71]
    v_cndmask_b32 v59, 0, v67, s[70:71]
    v_cndmask_b32 v63, v67, 0, s[70:71]
    v_cndmask_b32 v50, 0, v8, s[70:71]
    v_cndmask_b32 v51, v8, 0, s[70:71]
    v_mfma_f32_16x16x32_bf16 v[36:39], v[68:71], v[64:67], 0
    v_mfma_f32_16x16x32_bf16 v[40:43], v[104:107], v[56:59], 0
    v_mfma_f32_16x16x32_bf16 v[40:43], v[108:111], v[60:63], v[40:43]
    v_mfma_f32_16x16x16_bf16 v[36:39], v[68:69], v[50:51], v[36:39]
    v_mfma_f32_16x16x16_bf16 v[40:43], v[48:49], v[50:51], v[40:43]
    v_mov_b64 v[0:1], 0
    v_mov_b64 v[2:3], 0
    v_mov_b64 v[4:5], 0
    v_mov_b64 v[6:7], 0
    v_mov_b64 v[8:9], 0
    v_mov_b64 v[10:11], 0
    v_mov_b64 v[12:13], 0
    v_mov_b64 v[14:15], 0
    v_rcp_f32 v46, v36
    s_nop 0
    v_pk_mul_f32 v[40:41], v[40:41], v[46:47] op_sel_hi:[1,0]
    v_pk_mul_f32 v[42:43], v[42:43], v[46:47] op_sel_hi:[1,0]
    v_cvt_pk_bf16_f32 v40, v40, v41
    v_cvt_pk_bf16_f32 v41, v42, v43
    ds_write_b64 v139, v[40:41] offset:15360
    s_branch L_c0_w3_fbret
L_c0_fin:
    buffer_store_dword v116, v142, s[36:39], s53 offen sc1
    s_waitcnt vmcnt(0)
    s_branch L_end
L_chain1:
    v_lshrrev_b32 v1, 4, v0
    v_and_b32 v2, 15, v0
    v_lshlrev_b32 v140, 4, v0
    s_lshl_b32 s80, s34, 11
    v_add_u32 v18, s80, v140
    s_lshl_b32 s80, s34, 9
    v_lshlrev_b32 v132, 3, v0
    v_add_u32 v132, s80, v132
    s_mul_i32 s80, s34, 36864
    s_add_u32 s80, s80, 16384
    v_add_u32 v134, s80, v140
    v_mov_b32 v131, 0x4444
    v_mov_b32 v3, 0xeeee
    v_and_b32 v4, 2, v2
    v_cmp_eq_u32 vcc, 0, v4
    s_nop 1
    v_cndmask_b32 v131, v3, v131, vcc
    s_lshl_b32 s76, s34, 10
    v_lshrrev_b32 v3, 2, v2
    v_lshlrev_b32 v3, 7, v3
    v_lshl_add_u32 v3, v1, 5, v3
    v_and_b32 v4, 3, v2
    v_lshl_add_u32 v3, v4, 2, v3
    v_bfe_u32 v4, v2, 2, 1
    v_lshlrev_b32 v4, 6, v4
    v_xor_b32 v3, v3, v4
    v_add_u32 v3, s76, v3
    v_add_u32 v135, 8192, v3
    v_and_b32 v4, 7, v2
    v_lshlrev_b32 v4, 4, v4
    v_lshl_add_u32 v136, v1, 7, v4
    v_lshrrev_b32 v3, 2, v2
    v_and_b32 v4, 1, v2
    v_lshl_add_u32 v3, v3, 1, v4
    v_lshlrev_b32 v3, 4, v3
    v_lshl_add_u32 v137, v1, 7, v3
    v_and_b32 v4, 1, v1
    v_lshlrev_b32 v4, 6, v4
    v_xor_b32 v136, v136, v4
    v_xor_b32 v137, v137, v4
    v_lshrrev_b32 v5, 3, v2
    v_lshl_add_u32 v138, v5, 9, v136
    v_lshl_add_u32 v139, v5, 3, v136
    s_lshl_b32 s80, s34, 11
    s_lshl_b32 s81, s35, 6
    s_add_u32 s80, s80, s81
    v_mul_u32_u24 v3, 8320, v1
    v_lshl_add_u32 v3, v2, 2, v3
    v_add_u32 v141, s80, v3
    s_lshr_b32 s82, s35, 3
    s_bfe_u32 s83, s35, 0x20001
    s_and_b32 s84, s35, 1
    s_lshl_b32 s80, s82, 9
    s_lshl_b32 s81, s84, 8
    s_add_u32 s80, s80, s81
    s_lshl_b32 s81, s83, 6
    s_add_u32 s80, s80, s81
    v_and_b32 v3, 1, v2
    v_lshrrev_b32 v4, 1, v2
    v_lshrrev_b32 v6, 3, v2
    v_lshl_add_u32 v6, v6, 1, v3
    v_lshlrev_b32 v6, 4, v6
    v_and_b32 v8, 3, v4
    v_lshl_add_u32 v6, v8, 2, v6
    v_add_u32 v6, s80, v6
    v_mov_b32 v7, 0x80000000
    v_cmp_eq_u32 vcc, 0, v1
    s_nop 1
    v_cndmask_b32 v142, v7, v6, vcc
    v_lshlrev_b32 v6, 10, v3
    v_lshl_add_u32 v6, v4, 4, v6
    s_lshl_b32 s80, s83, 11
    s_lshl_b32 s81, s82, 8
    s_add_u32 s80, s80, s81
    s_lshl_b32 s81, s84, 7
    s_add_u32 s80, s80, s81
    s_lshl_b32 s81, s34, 2
    s_add_u32 s80, s80, s81
    s_mov_b32 s40, s6
    s_mov_b32 s41, s7
    s_mov_b32 s42, 0x2000
    s_mov_b32 s43, 0x20000
    buffer_load_dword v9, v6, s[40:43], s80 offen
    v_mov_b32 v143, 0
    v_mov_b32 v3, 0x3f80
    v_cmp_eq_u32 vcc, 0, v2
    s_nop 1
    v_cndmask_b32 v143, v143, v3, vcc
    v_mov_b32 v3, 0x3f800000
    v_cmp_eq_u32 vcc, 1, v2
    s_nop 1
    v_cndmask_b32 v143, v143, v3, vcc
    s_mov_b32 s44, 0
    s_lshl_b32 s45, s34, 11
    s_add_u32 s45, s45, 0
    s_add_u32 s46, s45, 8192
    s_add_u32 s47, s45, 16384
    s_mul_i32 s48, s35, 8320
    s_add_u32 s48, s48, 0x100000
    s_add_u32 s79, s48, 0x42000
    s_add_u32 s49, s79, 0x42000
    s_mov_b32 s57, 0x100000
    s_mov_b32 s58, 0x108200
    s_mov_b32 s59, 0x110400
    s_mov_b32 s60, 0x118600
    s_mov_b32 s61, 0x120800
    s_mov_b32 s62, 0x128a00
    s_mov_b32 s63, 0x130c00
    s_mov_b32 s64, 0x138e00
    s_mul_i32 s80, s35, 0x4000
    s_lshr_b32 s81, s34, 1
    s_lshl_b32 s81, s81, 12
    s_add_u32 s50, s80, s81
    s_and_b32 s81, s34, 1
    s_lshl_b32 s81, s81, 9
    s_add_u32 s50, s50, s81
    s_add_u32 s50, s50, 0x1000000
    s_lshl_b32 s81, s34, 11
    s_add_u32 s51, s80, s81
    s_add_u32 s51, s51, 0x1002000
    s_lshl_b32 s81, s34, 12
    s_add_u32 s52, s80, s81
    s_add_u32 s52, s52, 0x1000000
    s_add_u32 s53, s45, 0x400000
    s_lshl_b32 s65, s34, 7
    s_add_u32 s65, s65, 0x8000
    s_lshl_b32 s90, s35, 2
    s_add_u32 s90, s90, s65
    s_mov_b32 s66, 0x7f817f81
    s_mov_b32 s67, 0x7f817f81
    s_mov_b32 s68, 0x3f803f80
    s_mov_b32 s69, 0x3f803f80
    s_mov_b32 s70, 0x00ff00ff
    s_mov_b32 s71, 0x00ff00ff
    s_mov_b32 s72, 0x3e0293ee
    s_mov_b32 s73, 0x7f800000
    s_mov_b32 s74, 0x21800000
    s_mov_b32 s75, 0x3c000000
    s_mov_b32 s77, 0x05040100
    s_mov_b32 s78, 0x07060302
    v_lshlrev_b32 v3, 4, v2
    v_lshrrev_b32 v4, 1, v1
    v_lshl_add_u32 v3, v4, 19, v3
    v_and_b32 v4, 1, v1
    v_lshl_add_u32 v3, v4, 17, v3
    s_lshl_b32 s80, s34, 14
    s_lshl_b32 s81, s35, 8
    s_add_u32 s80, s80, s81
    v_add_u32 v10, s80, v3
    s_lshl_b32 s80, s34, 12
    s_add_u32 s80, s80, 0
    v_add_u32 v11, s80, v140
    s_lshl_b32 s88, s34, 3
    v_lshrrev_b32 v3, 1, v1
    v_lshlrev_b32 v3, 5, v3
    v_and_b32 v4, 1, v1
    v_add_u32 v3, v3, v4
    v_lshlrev_b32 v3, 10, v3
    v_lshl_add_u32 v3, v2, 4, v3
    s_lshl_b32 s80, s35, 17
    s_lshl_b32 s81, s34, 8
    s_add_u32 s80, s80, s81
    v_add_u32 v17, s80, v3
    s_mov_b32 s40, s12
    s_mov_b32 s41, s13
    s_mov_b32 s42, 0x400000
    s_mov_b32 s43, 0x20000
    s_mov_b32 s80, 0x0
    buffer_load_dwordx4 v[20:23], v10, s[40:43], s80 offen
    s_mov_b32 s80, 0x2000
    buffer_load_dwordx4 v[24:27], v10, s[40:43], s80 offen
    s_mov_b32 s80, 0x40000
    buffer_load_dwordx4 v[28:31], v10, s[40:43], s80 offen
    s_mov_b32 s80, 0x42000
    buffer_load_dwordx4 v[32:35], v10, s[40:43], s80 offen
    s_mov_b32 s80, 0x10000
    buffer_load_dwordx4 v[36:39], v10, s[40:43], s80 offen
    s_mov_b32 s80, 0x12000
    buffer_load_dwordx4 v[40:43], v10, s[40:43], s80 offen
    s_mov_b32 s80, 0x50000
    buffer_load_dwordx4 v[44:47], v10, s[40:43], s80 offen
    s_mov_b32 s80, 0x52000
    buffer_load_dwordx4 v[48:51], v10, s[40:43], s80 offen
    s_mov_b32 s80, 0x100000
    buffer_load_dwordx4 v[52:55], v10, s[40:43], s80 offen
    s_mov_b32 s80, 0x102000
    buffer_load_dwordx4 v[56:59], v10, s[40:43], s80 offen
    s_mov_b32 s80, 0x140000
    buffer_load_dwordx4 v[60:63], v10, s[40:43], s80 offen
    s_mov_b32 s80, 0x142000
    buffer_load_dwordx4 v[64:67], v10, s[40:43], s80 offen
    s_mov_b32 s80, 0x110000
    buffer_load_dwordx4 v[68:71], v10, s[40:43], s80 offen
    s_mov_b32 s80, 0x112000
    buffer_load_dwordx4 v[72:75], v10, s[40:43], s80 offen
    s_mov_b32 s80, 0x150000
    buffer_load_dwordx4 v[76:79], v10, s[40:43], s80 offen
    s_mov_b32 s80, 0x152000
    buffer_load_dwordx4 v[80:83], v10, s[40:43], s80 offen
    s_mov_b32 s40, s12
    s_mov_b32 s41, s13
    s_mov_b32 s42, 0x400000
    s_mov_b32 s43, 0x20000
    s_mov_b32 s80, 0x200000
    buffer_load_dwordx4 v[144:147], v10, s[40:43], s80 offen
    s_mov_b32 s80, 0x202000
    buffer_load_dwordx4 v[148:151], v10, s[40:43], s80 offen
    s_mov_b32 s80, 0x240000
    buffer_load_dwordx4 v[152:155], v10, s[40:43], s80 offen
    s_mov_b32 s80, 0x242000
    buffer_load_dwordx4 v[156:159], v10, s[40:43], s80 offen
    s_mov_b32 s80, 0x210000
    buffer_load_dwordx4 v[160:163], v10, s[40:43], s80 offen
    s_mov_b32 s80, 0x212000
    buffer_load_dwordx4 v[164:167], v10, s[40:43], s80 offen
    s_mov_b32 s80, 0x250000
    buffer_load_dwordx4 v[168:171], v10, s[40:43], s80 offen
    s_mov_b32 s80, 0x252000
    buffer_load_dwordx4 v[172:175], v10, s[40:43], s80 offen
    s_mov_b32 s80, 0x300000
    buffer_load_dwordx4 v[176:179], v10, s[40:43], s80 offen
    s_mov_b32 s80, 0x302000
    buffer_load_dwordx4 v[180:183], v10, s[40:43], s80 offen
    s_mov_b32 s80, 0x340000
    buffer_load_dwordx4 v[184:187], v10, s[40:43], s80 offen
    s_mov_b32 s80, 0x342000
    buffer_load_dwordx4 v[188:191], v10, s[40:43], s80 offen
    s_mov_b32 s80, 0x310000
    buffer_load_dwordx4 v[192:195], v10, s[40:43], s80 offen
    s_mov_b32 s80, 0x312000
    buffer_load_dwordx4 v[196:199], v10, s[40:43], s80 offen
    s_mov_b32 s80, 0x350000
    buffer_load_dwordx4 v[200:203], v10, s[40:43], s80 offen
    s_mov_b32 s80, 0x352000
    buffer_load_dwordx4 v[204:207], v10, s[40:43], s80 offen
    s_waitcnt vmcnt(16)
    s_lshr_b32 s80, 0x1900010e, s88
    s_and_b32 s80, s80, 0xff
    s_lshl_b32 s80, s80, 11
    v_add_u32 v16, s80, v140
    v_perm_b32 v84, v24, v20, s77
    v_perm_b32 v85, v32, v28, s77
    v_perm_b32 v86, v40, v36, s77
    v_perm_b32 v87, v48, v44, s77
    ds_write_b128 v16, v[84:87] offset:0
    v_perm_b32 v88, v56, v52, s77
    v_perm_b32 v89, v64, v60, s77
    v_perm_b32 v90, v72, v68, s77
    v_perm_b32 v91, v80, v76, s77
    ds_write_b128 v16, v[88:91] offset:1024
    s_lshr_b32 s80, 0x15161718, s88
    s_and_b32 s80, s80, 0xff
    s_lshl_b32 s80, s80, 11
    v_add_u32 v16, s80, v140
    v_perm_b32 v92, v24, v20, s78
    v_perm_b32 v93, v32, v28, s78
    v_perm_b32 v94, v40, v36, s78
    v_perm_b32 v95, v48, v44, s78
    ds_write_b128 v16, v[92:95] offset:0
    v_perm_b32 v84, v56, v52, s78
    v_perm_b32 v85, v64, v60, s78
    v_perm_b32 v86, v72, v68, s78
    v_perm_b32 v87, v80, v76, s78
    ds_write_b128 v16, v[84:87] offset:1024
    s_lshr_b32 s80, 0x2b020320, s88
    s_and_b32 s80, s80, 0xff
    s_lshl_b32 s80, s80, 11
    v_add_u32 v16, s80, v140
    v_perm_b32 v88, v25, v21, s77
    v_perm_b32 v89, v33, v29, s77
    v_perm_b32 v90, v41, v37, s77
    v_perm_b32 v91, v49, v45, s77
    ds_write_b128 v16, v[88:91] offset:0
    v_perm_b32 v92, v57, v53, s77
    v_perm_b32 v93, v65, v61, s77
    v_perm_b32 v94, v73, v69, s77
    v_perm_b32 v95, v81, v77, s77
    ds_write_b128 v16, v[92:95] offset:1024
    s_lshr_b32 s80, 0x2728292a, s88
    s_and_b32 s80, s80, 0xff
    s_lshl_b32 s80, s80, 11
    v_add_u32 v16, s80, v140
    v_perm_b32 v84, v25, v21, s78
    v_perm_b32 v85, v33, v29, s78
    v_perm_b32 v86, v41, v37, s78
    v_perm_b32 v87, v49, v45, s78
    ds_write_b128 v16, v[84:87] offset:0
    v_perm_b32 v88, v57, v53, s78
    v_perm_b32 v89, v65, v61, s78
    v_perm_b32 v90, v73, v69, s78
    v_perm_b32 v91, v81, v77, s78
    ds_write_b128 v16, v[88:91] offset:1024
    s_lshr_b32 s80, 0x3d040532, s88
    s_and_b32 s80, s80, 0xff
    s_lshl_b32 s80, s80, 11
    v_add_u32 v16, s80, v140
    v_perm_b32 v92, v26, v22, s77
    v_perm_b32 v93, v34, v30, s77
    v_perm_b32 v94, v42, v38, s77
    v_perm_b32 v95, v50, v46, s77
    ds_write_b128 v16, v[92:95] offset:0
    v_perm_b32 v84, v58, v54, s77
    v_perm_b32 v85, v66, v62, s77
    v_perm_b32 v86, v74, v70, s77
    v_perm_b32 v87, v82, v78, s77
    ds_write_b128 v16, v[84:87] offset:1024
    s_lshr_b32 s80, 0x393a3b3c, s88
    s_and_b32 s80, s80, 0xff
    s_lshl_b32 s80, s80, 11
    v_add_u32 v16, s80, v140
    v_perm_b32 v88, v26, v22, s78
    v_perm_b32 v89, v34, v30, s78
    v_perm_b32 v90, v42, v38, s78
    v_perm_b32 v91, v50, v46, s78
    ds_write_b128 v16, v[88:91] offset:0
    v_perm_b32 v92, v58, v54, s78
    v_perm_b32 v93, v66, v62, s78
    v_perm_b32 v94, v74, v70, s78
    v_perm_b32 v95, v82, v78, s78
    ds_write_b128 v16, v[92:95] offset:1024
    s_lshr_b32 s80, 0x4f060744, s88
    s_and_b32 s80, s80, 0xff
    s_lshl_b32 s80, s80, 11
    v_add_u32 v16, s80, v140
    v_perm_b32 v84, v27, v23, s77
    v_perm_b32 v85, v35, v31, s77
    v_perm_b32 v86, v43, v39, s77
    v_perm_b32 v87, v51, v47, s77
    ds_write_b128 v16, v[84:87] offset:0
    v_perm_b32 v88, v59, v55, s77
    v_perm_b32 v89, v67, v63, s77
    v_perm_b32 v90, v75, v71, s77
    v_perm_b32 v91, v83, v79, s77
    ds_write_b128 v16, v[88:91] offset:1024
    s_lshr_b32 s80, 0x4b4c4d4e, s88
    s_and_b32 s80, s80, 0xff
    s_lshl_b32 s80, s80, 11
    v_add_u32 v16, s80, v140
    v_perm_b32 v92, v27, v23, s78
    v_perm_b32 v93, v35, v31, s78
    v_perm_b32 v94, v43, v39, s78
    v_perm_b32 v95, v51, v47, s78
    ds_write_b128 v16, v[92:95] offset:0
    v_perm_b32 v84, v59, v55, s78
    v_perm_b32 v85, v67, v63, s78
    v_perm_b32 v86, v75, v71, s78
    v_perm_b32 v87, v83, v79, s78
    ds_write_b128 v16, v[84:87] offset:1024
    s_waitcnt lgkmcnt(0)
    s_barrier
    ds_read_b128 a[176:179], v11 offset:2048
    ds_read_b128 a[180:183], v11 offset:3072
    ds_read_b128 a[192:195], v11 offset:0
    ds_read_b128 a[196:199], v11 offset:1024
    ds_read_b128 a[208:211], v134 offset:34816
    ds_read_b128 a[212:215], v134 offset:35840
    ds_read_b128 a[224:227], v134 offset:32768
    ds_read_b128 a[228:231], v134 offset:33792
    ds_read_b128 a[240:243], v134 offset:30720
    ds_read_b128 a[244:247], v134 offset:31744
    ds_read_b128 v[224:227], v134 offset:28672
    ds_read_b128 v[228:231], v134 offset:29696
    s_waitcnt lgkmcnt(4)
    ds_read_b128 v[240:243], v134 offset:26624
    ds_read_b128 v[244:247], v134 offset:27648
    s_mov_b32 s40, s8
    s_mov_b32 s41, s9
    s_mov_b32 s42, 0x400000
    s_mov_b32 s43, 0x20000
    s_mov_b32 s80, 0x200000
    buffer_load_dwordx4 v[20:23], v10, s[40:43], s80 offen
    s_mov_b32 s80, 0x202000
    buffer_load_dwordx4 v[24:27], v10, s[40:43], s80 offen
    s_mov_b32 s80, 0x240000
    buffer_load_dwordx4 v[28:31], v10, s[40:43], s80 offen
    s_mov_b32 s80, 0x242000
    buffer_load_dwordx4 v[32:35], v10, s[40:43], s80 offen
    s_mov_b32 s80, 0x210000
    buffer_load_dwordx4 v[36:39], v10, s[40:43], s80 offen
    s_mov_b32 s80, 0x212000
    buffer_load_dwordx4 v[40:43], v10, s[40:43], s80 offen
    s_mov_b32 s80, 0x250000
    buffer_load_dwordx4 v[44:47], v10, s[40:43], s80 offen
    s_mov_b32 s80, 0x252000
    buffer_load_dwordx4 v[48:51], v10, s[40:43], s80 offen
    s_mov_b32 s80, 0x300000
    buffer_load_dwordx4 v[52:55], v10, s[40:43], s80 offen
    s_mov_b32 s80, 0x302000
    buffer_load_dwordx4 v[56:59], v10, s[40:43], s80 offen
    s_mov_b32 s80, 0x340000
    buffer_load_dwordx4 v[60:63], v10, s[40:43], s80 offen
    s_mov_b32 s80, 0x342000
    buffer_load_dwordx4 v[64:67], v10, s[40:43], s80 offen
    s_mov_b32 s80, 0x310000
    buffer_load_dwordx4 v[68:71], v10, s[40:43], s80 offen
    s_mov_b32 s80, 0x312000
    buffer_load_dwordx4 v[72:75], v10, s[40:43], s80 offen
    s_mov_b32 s80, 0x350000
    buffer_load_dwordx4 v[76:79], v10, s[40:43], s80 offen
    s_mov_b32 s80, 0x352000
    buffer_load_dwordx4 v[80:83], v10, s[40:43], s80 offen
    s_waitcnt vmcnt(16)
    s_waitcnt lgkmcnt(0)
    s_barrier
    s_or_b32 s96, s19, s34
    s_or_b32 s96, s96, s17
    s_cmp_eq_u32 s96, 0
    s_cbranch_scc0 L_rp41x
    s_mov_b64 exec, 1
    s_lshl_b32 s96, s16, 2
    v_mov_b32 v6, s96
    v_mov_b32 v7, 1
    global_atomic_add v6, v7, s[30:31]
    s_mov_b64 exec, -1
L_rp41x:
    s_lshr_b32 s80, 0x18190001, s88
    s_and_b32 s80, s80, 0xff
    s_lshl_b32 s80, s80, 11
    v_add_u32 v16, s80, v140
    v_perm_b32 v88, v148, v144, s77
    v_perm_b32 v89, v156, v152, s77
    v_perm_b32 v90, v164, v160, s77
    v_perm_b32 v91, v172, v168, s77
    ds_write_b128 v16, v[88:91] offset:0
    v_perm_b32 v92, v180, v176, s77
    v_perm_b32 v93, v188, v184, s77
    v_perm_b32 v94, v196, v192, s77
    v_perm_b32 v95, v204, v200, s77
    ds_write_b128 v16, v[92:95] offset:1024
    s_lshr_b32 s80, 0x14151617, s88
    s_and_b32 s80, s80, 0xff
    s_lshl_b32 s80, s80, 11
    v_add_u32 v16, s80, v140
    v_perm_b32 v84, v148, v144, s78
    v_perm_b32 v85, v156, v152, s78
    v_perm_b32 v86, v164, v160, s78
    v_perm_b32 v87, v172, v168, s78
    ds_write_b128 v16, v[84:87] offset:0
    v_perm_b32 v88, v180, v176, s78
    v_perm_b32 v89, v188, v184, s78
    v_perm_b32 v90, v196, v192, s78
    v_perm_b32 v91, v204, v200, s78
    ds_write_b128 v16, v[88:91] offset:1024
    s_lshr_b32 s80, 0x2a2b0203, s88
    s_and_b32 s80, s80, 0xff
    s_lshl_b32 s80, s80, 11
    v_add_u32 v16, s80, v140
    v_perm_b32 v92, v149, v145, s77
    v_perm_b32 v93, v157, v153, s77
    v_perm_b32 v94, v165, v161, s77
    v_perm_b32 v95, v173, v169, s77
    ds_write_b128 v16, v[92:95] offset:0
    v_perm_b32 v84, v181, v177, s77
    v_perm_b32 v85, v189, v185, s77
    v_perm_b32 v86, v197, v193, s77
    v_perm_b32 v87, v205, v201, s77
    ds_write_b128 v16, v[84:87] offset:1024
    s_lshr_b32 s80, 0x26272829, s88
    s_and_b32 s80, s80, 0xff
    s_lshl_b32 s80, s80, 11
    v_add_u32 v16, s80, v140
    v_perm_b32 v88, v149, v145, s78
    v_perm_b32 v89, v157, v153, s78
    v_perm_b32 v90, v165, v161, s78
    v_perm_b32 v91, v173, v169, s78
    ds_write_b128 v16, v[88:91] offset:0
    v_perm_b32 v92, v181, v177, s78
    v_perm_b32 v93, v189, v185, s78
    v_perm_b32 v94, v197, v193, s78
    v_perm_b32 v95, v205, v201, s78
    ds_write_b128 v16, v[92:95] offset:1024
    s_lshr_b32 s80, 0x3c3d0405, s88
    s_and_b32 s80, s80, 0xff
    s_lshl_b32 s80, s80, 11
    v_add_u32 v16, s80, v140
    v_perm_b32 v84, v150, v146, s77
    v_perm_b32 v85, v158, v154, s77
    v_perm_b32 v86, v166, v162, s77
    v_perm_b32 v87, v174, v170, s77
    ds_write_b128 v16, v[84:87] offset:0
    v_perm_b32 v88, v182, v178, s77
    v_perm_b32 v89, v190, v186, s77
    v_perm_b32 v90, v198, v194, s77
    v_perm_b32 v91, v206, v202, s77
    ds_write_b128 v16, v[88:91] offset:1024
    s_lshr_b32 s80, 0x38393a3b, s88
    s_and_b32 s80, s80, 0xff
    s_lshl_b32 s80, s80, 11
    v_add_u32 v16, s80, v140
    v_perm_b32 v92, v150, v146, s78
    v_perm_b32 v93, v158, v154, s78
    v_perm_b32 v94, v166, v162, s78
    v_perm_b32 v95, v174, v170, s78
    ds_write_b128 v16, v[92:95] offset:0
    v_perm_b32 v84, v182, v178, s78
    v_perm_b32 v85, v190, v186, s78
    v_perm_b32 v86, v198, v194, s78
    v_perm_b32 v87, v206, v202, s78
    ds_write_b128 v16, v[84:87] offset:1024
    s_lshr_b32 s80, 0x4e4f0607, s88
    s_and_b32 s80, s80, 0xff
    s_lshl_b32 s80, s80, 11
    v_add_u32 v16, s80, v140
    v_perm_b32 v88, v151, v147, s77
    v_perm_b32 v89, v159, v155, s77
    v_perm_b32 v90, v167, v163, s77
    v_perm_b32 v91, v175, v171, s77
    ds_write_b128 v16, v[88:91] offset:0
    v_perm_b32 v92, v183, v179, s77
    v_perm_b32 v93, v191, v187, s77
    v_perm_b32 v94, v199, v195, s77
    v_perm_b32 v95, v207, v203, s77
    ds_write_b128 v16, v[92:95] offset:1024
    s_lshr_b32 s80, 0x4a4b4c4d, s88
    s_and_b32 s80, s80, 0xff
    s_lshl_b32 s80, s80, 11
    v_add_u32 v16, s80, v140
    v_perm_b32 v84, v151, v147, s78
    v_perm_b32 v85, v159, v155, s78
    v_perm_b32 v86, v167, v163, s78
    v_perm_b32 v87, v175, v171, s78
    ds_write_b128 v16, v[84:87] offset:0
    v_perm_b32 v88, v183, v179, s78
    v_perm_b32 v89, v191, v187, s78
    v_perm_b32 v90, v199, v195, s78
    v_perm_b32 v91, v207, v203, s78
    ds_write_b128 v16, v[88:91] offset:1024
    s_waitcnt lgkmcnt(0)
    s_barrier
    ds_read_b128 a[168:171], v11 offset:2048
    ds_read_b128 a[172:175], v11 offset:3072
    ds_read_b128 a[184:187], v11 offset:0
    ds_read_b128 a[188:191], v11 offset:1024
    ds_read_b128 a[200:203], v134 offset:34816
    ds_read_b128 a[204:207], v134 offset:35840
    ds_read_b128 a[216:219], v134 offset:32768
    ds_read_b128 a[220:223], v134 offset:33792
    ds_read_b128 a[232:235], v134 offset:30720
    ds_read_b128 a[236:239], v134 offset:31744
    ds_read_b128 a[248:251], v134 offset:28672
    ds_read_b128 a[252:255], v134 offset:29696
    s_waitcnt lgkmcnt(4)
    ds_read_b128 v[232:235], v134 offset:26624
    ds_read_b128 v[236:239], v134 offset:27648
    ds_read_b128 v[248:251], v134 offset:24576
    ds_read_b128 v[252:255], v134 offset:25600
    s_mov_b32 s40, s10
    s_mov_b32 s41, s11
    s_mov_b32 s42, 0x400000
    s_mov_b32 s43, 0x20000
    s_mov_b32 s80, 0x200000
    buffer_load_dwordx4 v[144:147], v10, s[40:43], s80 offen
    s_mov_b32 s80, 0x202000
    buffer_load_dwordx4 v[148:151], v10, s[40:43], s80 offen
    s_mov_b32 s80, 0x240000
    buffer_load_dwordx4 v[152:155], v10, s[40:43], s80 offen
    s_mov_b32 s80, 0x242000
    buffer_load_dwordx4 v[156:159], v10, s[40:43], s80 offen
    s_mov_b32 s80, 0x210000
    buffer_load_dwordx4 v[160:163], v10, s[40:43], s80 offen
    s_mov_b32 s80, 0x212000
    buffer_load_dwordx4 v[164:167], v10, s[40:43], s80 offen
    s_mov_b32 s80, 0x250000
    buffer_load_dwordx4 v[168:171], v10, s[40:43], s80 offen
    s_mov_b32 s80, 0x252000
    buffer_load_dwordx4 v[172:175], v10, s[40:43], s80 offen
    s_mov_b32 s80, 0x300000
    buffer_load_dwordx4 v[176:179], v10, s[40:43], s80 offen
    s_mov_b32 s80, 0x302000
    buffer_load_dwordx4 v[180:183], v10, s[40:43], s80 offen
    s_mov_b32 s80, 0x340000
    buffer_load_dwordx4 v[184:187], v10, s[40:43], s80 offen
    s_mov_b32 s80, 0x342000
    buffer_load_dwordx4 v[188:191], v10, s[40:43], s80 offen
    s_mov_b32 s80, 0x310000
    buffer_load_dwordx4 v[192:195], v10, s[40:43], s80 offen
    s_mov_b32 s80, 0x312000
    buffer_load_dwordx4 v[196:199], v10, s[40:43], s80 offen
    s_mov_b32 s80, 0x350000
    buffer_load_dwordx4 v[200:203], v10, s[40:43], s80 offen
    s_mov_b32 s80, 0x352000
    buffer_load_dwordx4 v[204:207], v10, s[40:43], s80 offen
    s_waitcnt vmcnt(16)
    s_waitcnt lgkmcnt(0)
    s_barrier
    s_lshr_b32 s80, 0xf010a, s88
    s_and_b32 s80, s80, 0xff
    s_lshl_b32 s80, s80, 11
    v_add_u32 v16, s80, v140
    v_lshlrev_b32 v96, 16, v20
    v_lshlrev_b32 v97, 16, v24
    v_pk_mul_f32 v[96:97], v[96:97], s[72:73] op_sel_hi:[1,0]
    v_cvt_pk_bf16_f32 v92, v96, v97
    v_lshlrev_b32 v98, 16, v28
    v_lshlrev_b32 v99, 16, v32
    v_pk_mul_f32 v[98:99], v[98:99], s[72:73] op_sel_hi:[1,0]
    v_cvt_pk_bf16_f32 v93, v98, v99
    v_lshlrev_b32 v96, 16, v36
    v_lshlrev_b32 v97, 16, v40
    v_pk_mul_f32 v[96:97], v[96:97], s[72:73] op_sel_hi:[1,0]
    v_cvt_pk_bf16_f32 v94, v96, v97
    v_lshlrev_b32 v98, 16, v44
    v_lshlrev_b32 v99, 16, v48
    v_pk_mul_f32 v[98:99], v[98:99], s[72:73] op_sel_hi:[1,0]
    v_cvt_pk_bf16_f32 v95, v98, v99
    ds_write_b128 v16, v[92:95] offset:0
    v_lshlrev_b32 v96, 16, v52
    v_lshlrev_b32 v97, 16, v56
    v_pk_mul_f32 v[96:97], v[96:97], s[72:73] op_sel_hi:[1,0]
    v_cvt_pk_bf16_f32 v84, v96, v97
    v_lshlrev_b32 v98, 16, v60
    v_lshlrev_b32 v99, 16, v64
    v_pk_mul_f32 v[98:99], v[98:99], s[72:73] op_sel_hi:[1,0]
    v_cvt_pk_bf16_f32 v85, v98, v99
    v_lshlrev_b32 v96, 16, v68
    v_lshlrev_b32 v97, 16, v72
    v_pk_mul_f32 v[96:97], v[96:97], s[72:73] op_sel_hi:[1,0]
    v_cvt_pk_bf16_f32 v86, v96, v97
    v_lshlrev_b32 v98, 16, v76
    v_lshlrev_b32 v99, 16, v80
    v_pk_mul_f32 v[98:99], v[98:99], s[72:73] op_sel_hi:[1,0]
    v_cvt_pk_bf16_f32 v87, v98, v99
    ds_write_b128 v16, v[84:87] offset:1024
    s_lshr_b32 s80, 0x17180d19, s88
    s_and_b32 s80, s80, 0xff
    s_lshl_b32 s80, s80, 11
    v_add_u32 v16, s80, v140
    v_and_b32 v96, 0xffff0000, v20
    v_and_b32 v97, 0xffff0000, v24
    v_pk_mul_f32 v[96:97], v[96:97], s[72:73] op_sel_hi:[1,0]
    v_cvt_pk_bf16_f32 v88, v96, v97
    v_and_b32 v98, 0xffff0000, v28
    v_and_b32 v99, 0xffff0000, v32
    v_pk_mul_f32 v[98:99], v[98:99], s[72:73] op_sel_hi:[1,0]
    v_cvt_pk_bf16_f32 v89, v98, v99
    v_and_b32 v96, 0xffff0000, v36
    v_and_b32 v97, 0xffff0000, v40
    v_pk_mul_f32 v[96:97], v[96:97], s[72:73] op_sel_hi:[1,0]
    v_cvt_pk_bf16_f32 v90, v96, v97
    v_and_b32 v98, 0xffff0000, v44
    v_and_b32 v99, 0xffff0000, v48
    v_pk_mul_f32 v[98:99], v[98:99], s[72:73] op_sel_hi:[1,0]
    v_cvt_pk_bf16_f32 v91, v98, v99
    ds_write_b128 v16, v[88:91] offset:0
    v_and_b32 v96, 0xffff0000, v52
    v_and_b32 v97, 0xffff0000, v56
    v_pk_mul_f32 v[96:97], v[96:97], s[72:73] op_sel_hi:[1,0]
    v_cvt_pk_bf16_f32 v92, v96, v97
    v_and_b32 v98, 0xffff0000, v60
    v_and_b32 v99, 0xffff0000, v64
    v_pk_mul_f32 v[98:99], v[98:99], s[72:73] op_sel_hi:[1,0]
    v_cvt_pk_bf16_f32 v93, v98, v99
    v_and_b32 v96, 0xffff0000, v68
    v_and_b32 v97, 0xffff0000, v72
    v_pk_mul_f32 v[96:97], v[96:97], s[72:73] op_sel_hi:[1,0]
    v_cvt_pk_bf16_f32 v94, v96, v97
    v_and_b32 v98, 0xffff0000, v76
    v_and_b32 v99, 0xffff0000, v80
    v_pk_mul_f32 v[98:99], v[98:99], s[72:73] op_sel_hi:[1,0]
    v_cvt_pk_bf16_f32 v95, v98, v99
    ds_write_b128 v16, v[92:95] offset:1024
    s_lshr_b32 s80, 0x221031c, s88
    s_and_b32 s80, s80, 0xff
    s_lshl_b32 s80, s80, 11
    v_add_u32 v16, s80, v140
    v_lshlrev_b32 v96, 16, v21
    v_lshlrev_b32 v97, 16, v25
    v_pk_mul_f32 v[96:97], v[96:97], s[72:73] op_sel_hi:[1,0]
    v_cvt_pk_bf16_f32 v84, v96, v97
    v_lshlrev_b32 v98, 16, v29
    v_lshlrev_b32 v99, 16, v33
    v_pk_mul_f32 v[98:99], v[98:99], s[72:73] op_sel_hi:[1,0]
    v_cvt_pk_bf16_f32 v85, v98, v99
    v_lshlrev_b32 v96, 16, v37
    v_lshlrev_b32 v97, 16, v41
    v_pk_mul_f32 v[96:97], v[96:97], s[72:73] op_sel_hi:[1,0]
    v_cvt_pk_bf16_f32 v86, v96, v97
    v_lshlrev_b32 v98, 16, v45
    v_lshlrev_b32 v99, 16, v49
    v_pk_mul_f32 v[98:99], v[98:99], s[72:73] op_sel_hi:[1,0]
    v_cvt_pk_bf16_f32 v87, v98, v99
    ds_write_b128 v16, v[84:87] offset:0
    v_lshlrev_b32 v96, 16, v53
    v_lshlrev_b32 v97, 16, v57
    v_pk_mul_f32 v[96:97], v[96:97], s[72:73] op_sel_hi:[1,0]
    v_cvt_pk_bf16_f32 v88, v96, v97
    v_lshlrev_b32 v98, 16, v61
    v_lshlrev_b32 v99, 16, v65
    v_pk_mul_f32 v[98:99], v[98:99], s[72:73] op_sel_hi:[1,0]
    v_cvt_pk_bf16_f32 v89, v98, v99
    v_lshlrev_b32 v96, 16, v69
    v_lshlrev_b32 v97, 16, v73
    v_pk_mul_f32 v[96:97], v[96:97], s[72:73] op_sel_hi:[1,0]
    v_cvt_pk_bf16_f32 v90, v96, v97
    v_lshlrev_b32 v98, 16, v77
    v_lshlrev_b32 v99, 16, v81
    v_pk_mul_f32 v[98:99], v[98:99], s[72:73] op_sel_hi:[1,0]
    v_cvt_pk_bf16_f32 v91, v98, v99
    ds_write_b128 v16, v[88:91] offset:1024
    s_lshr_b32 s80, 0x292a1f2b, s88
    s_and_b32 s80, s80, 0xff
    s_lshl_b32 s80, s80, 11
    v_add_u32 v16, s80, v140
    v_and_b32 v96, 0xffff0000, v21
    v_and_b32 v97, 0xffff0000, v25
    v_pk_mul_f32 v[96:97], v[96:97], s[72:73] op_sel_hi:[1,0]
    v_cvt_pk_bf16_f32 v92, v96, v97
    v_and_b32 v98, 0xffff0000, v29
    v_and_b32 v99, 0xffff0000, v33
    v_pk_mul_f32 v[98:99], v[98:99], s[72:73] op_sel_hi:[1,0]
    v_cvt_pk_bf16_f32 v93, v98, v99
    v_and_b32 v96, 0xffff0000, v37
    v_and_b32 v97, 0xffff0000, v41
    v_pk_mul_f32 v[96:97], v[96:97], s[72:73] op_sel_hi:[1,0]
    v_cvt_pk_bf16_f32 v94, v96, v97
    v_and_b32 v98, 0xffff0000, v45
    v_and_b32 v99, 0xffff0000, v49
    v_pk_mul_f32 v[98:99], v[98:99], s[72:73] op_sel_hi:[1,0]
    v_cvt_pk_bf16_f32 v95, v98, v99
    ds_write_b128 v16, v[92:95] offset:0
    v_and_b32 v96, 0xffff0000, v53
    v_and_b32 v97, 0xffff0000, v57
    v_pk_mul_f32 v[96:97], v[96:97], s[72:73] op_sel_hi:[1,0]
    v_cvt_pk_bf16_f32 v84, v96, v97
    v_and_b32 v98, 0xffff0000, v61
    v_and_b32 v99, 0xffff0000, v65
    v_pk_mul_f32 v[98:99], v[98:99], s[72:73] op_sel_hi:[1,0]
    v_cvt_pk_bf16_f32 v85, v98, v99
    v_and_b32 v96, 0xffff0000, v69
    v_and_b32 v97, 0xffff0000, v73
    v_pk_mul_f32 v[96:97], v[96:97], s[72:73] op_sel_hi:[1,0]
    v_cvt_pk_bf16_f32 v86, v96, v97
    v_and_b32 v98, 0xffff0000, v77
    v_and_b32 v99, 0xffff0000, v81
    v_pk_mul_f32 v[98:99], v[98:99], s[72:73] op_sel_hi:[1,0]
    v_cvt_pk_bf16_f32 v87, v98, v99
    ds_write_b128 v16, v[84:87] offset:1024
    s_lshr_b32 s80, 0x433052e, s88
    s_and_b32 s80, s80, 0xff
    s_lshl_b32 s80, s80, 11
    v_add_u32 v16, s80, v140
    v_lshlrev_b32 v96, 16, v22
    v_lshlrev_b32 v97, 16, v26
    v_pk_mul_f32 v[96:97], v[96:97], s[72:73] op_sel_hi:[1,0]
    v_cvt_pk_bf16_f32 v88, v96, v97
    v_lshlrev_b32 v98, 16, v30
    v_lshlrev_b32 v99, 16, v34
    v_pk_mul_f32 v[98:99], v[98:99], s[72:73] op_sel_hi:[1,0]
    v_cvt_pk_bf16_f32 v89, v98, v99
    v_lshlrev_b32 v96, 16, v38
    v_lshlrev_b32 v97, 16, v42
    v_pk_mul_f32 v[96:97], v[96:97], s[72:73] op_sel_hi:[1,0]
    v_cvt_pk_bf16_f32 v90, v96, v97
    v_lshlrev_b32 v98, 16, v46
    v_lshlrev_b32 v99, 16, v50
    v_pk_mul_f32 v[98:99], v[98:99], s[72:73] op_sel_hi:[1,0]
    v_cvt_pk_bf16_f32 v91, v98, v99
    ds_write_b128 v16, v[88:91] offset:0
    v_lshlrev_b32 v96, 16, v54
    v_lshlrev_b32 v97, 16, v58
    v_pk_mul_f32 v[96:97], v[96:97], s[72:73] op_sel_hi:[1,0]
    v_cvt_pk_bf16_f32 v92, v96, v97
    v_lshlrev_b32 v98, 16, v62
    v_lshlrev_b32 v99, 16, v66
    v_pk_mul_f32 v[98:99], v[98:99], s[72:73] op_sel_hi:[1,0]
    v_cvt_pk_bf16_f32 v93, v98, v99
    v_lshlrev_b32 v96, 16, v70
    v_lshlrev_b32 v97, 16, v74
    v_pk_mul_f32 v[96:97], v[96:97], s[72:73] op_sel_hi:[1,0]
    v_cvt_pk_bf16_f32 v94, v96, v97
    v_lshlrev_b32 v98, 16, v78
    v_lshlrev_b32 v99, 16, v82
    v_pk_mul_f32 v[98:99], v[98:99], s[72:73] op_sel_hi:[1,0]
    v_cvt_pk_bf16_f32 v95, v98, v99
    ds_write_b128 v16, v[92:95] offset:1024
    s_lshr_b32 s80, 0x3b3c313d, s88
    s_and_b32 s80, s80, 0xff
    s_lshl_b32 s80, s80, 11
    v_add_u32 v16, s80, v140
    v_and_b32 v96, 0xffff0000, v22
    v_and_b32 v97, 0xffff0000, v26
    v_pk_mul_f32 v[96:97], v[96:97], s[72:73] op_sel_hi:[1,0]
    v_cvt_pk_bf16_f32 v84, v96, v97
    v_and_b32 v98, 0xffff0000, v30
    v_and_b32 v99, 0xffff0000, v34
    v_pk_mul_f32 v[98:99], v[98:99], s[72:73] op_sel_hi:[1,0]
    v_cvt_pk_bf16_f32 v85, v98, v99
    v_and_b32 v96, 0xffff0000, v38
    v_and_b32 v97, 0xffff0000, v42
    v_pk_mul_f32 v[96:97], v[96:97], s[72:73] op_sel_hi:[1,0]
    v_cvt_pk_bf16_f32 v86, v96, v97
    v_and_b32 v98, 0xffff0000, v46
    v_and_b32 v99, 0xffff0000, v50
    v_pk_mul_f32 v[98:99], v[98:99], s[72:73] op_sel_hi:[1,0]
    v_cvt_pk_bf16_f32 v87, v98, v99
    ds_write_b128 v16, v[84:87] offset:0
    v_and_b32 v96, 0xffff0000, v54
    v_and_b32 v97, 0xffff0000, v58
    v_pk_mul_f32 v[96:97], v[96:97], s[72:73] op_sel_hi:[1,0]
    v_cvt_pk_bf16_f32 v88, v96, v97
    v_and_b32 v98, 0xffff0000, v62
    v_and_b32 v99, 0xffff0000, v66
    v_pk_mul_f32 v[98:99], v[98:99], s[72:73] op_sel_hi:[1,0]
    v_cvt_pk_bf16_f32 v89, v98, v99
    v_and_b32 v96, 0xffff0000, v70
    v_and_b32 v97, 0xffff0000, v74
    v_pk_mul_f32 v[96:97], v[96:97], s[72:73] op_sel_hi:[1,0]
    v_cvt_pk_bf16_f32 v90, v96, v97
    v_and_b32 v98, 0xffff0000, v78
    v_and_b32 v99, 0xffff0000, v82
    v_pk_mul_f32 v[98:99], v[98:99], s[72:73] op_sel_hi:[1,0]
    v_cvt_pk_bf16_f32 v91, v98, v99
    ds_write_b128 v16, v[88:91] offset:1024
    s_lshr_b32 s80, 0x6450740, s88
    s_and_b32 s80, s80, 0xff
    s_lshl_b32 s80, s80, 11
    v_add_u32 v16, s80, v140
    v_lshlrev_b32 v96, 16, v23
    v_lshlrev_b32 v97, 16, v27
    v_pk_mul_f32 v[96:97], v[96:97], s[72:73] op_sel_hi:[1,0]
    v_cvt_pk_bf16_f32 v92, v96, v97
    v_lshlrev_b32 v98, 16, v31
    v_lshlrev_b32 v99, 16, v35
    v_pk_mul_f32 v[98:99], v[98:99], s[72:73] op_sel_hi:[1,0]
    v_cvt_pk_bf16_f32 v93, v98, v99
    v_lshlrev_b32 v96, 16, v39
    v_lshlrev_b32 v97, 16, v43
    v_pk_mul_f32 v[96:97], v[96:97], s[72:73] op_sel_hi:[1,0]
    v_cvt_pk_bf16_f32 v94, v96, v97
    v_lshlrev_b32 v98, 16, v47
    v_lshlrev_b32 v99, 16, v51
    v_pk_mul_f32 v[98:99], v[98:99], s[72:73] op_sel_hi:[1,0]
    v_cvt_pk_bf16_f32 v95, v98, v99
    ds_write_b128 v16, v[92:95] offset:0
    v_lshlrev_b32 v96, 16, v55
    v_lshlrev_b32 v97, 16, v59
    v_pk_mul_f32 v[96:97], v[96:97], s[72:73] op_sel_hi:[1,0]
    v_cvt_pk_bf16_f32 v84, v96, v97
    v_lshlrev_b32 v98, 16, v63
    v_lshlrev_b32 v99, 16, v67
    v_pk_mul_f32 v[98:99], v[98:99], s[72:73] op_sel_hi:[1,0]
    v_cvt_pk_bf16_f32 v85, v98, v99
    v_lshlrev_b32 v96, 16, v71
    v_lshlrev_b32 v97, 16, v75
    v_pk_mul_f32 v[96:97], v[96:97], s[72:73] op_sel_hi:[1,0]
    v_cvt_pk_bf16_f32 v86, v96, v97
    v_lshlrev_b32 v98, 16, v79
    v_lshlrev_b32 v99, 16, v83
    v_pk_mul_f32 v[98:99], v[98:99], s[72:73] op_sel_hi:[1,0]
    v_cvt_pk_bf16_f32 v87, v98, v99
    ds_write_b128 v16, v[84:87] offset:1024
    s_lshr_b32 s80, 0x4d4e434f, s88
    s_and_b32 s80, s80, 0xff
    s_lshl_b32 s80, s80, 11
    v_add_u32 v16, s80, v140
    v_and_b32 v96, 0xffff0000, v23
    v_and_b32 v97, 0xffff0000, v27
    v_pk_mul_f32 v[96:97], v[96:97], s[72:73] op_sel_hi:[1,0]
    v_cvt_pk_bf16_f32 v88, v96, v97
    v_and_b32 v98, 0xffff0000, v31
    v_and_b32 v99, 0xffff0000, v35
    v_pk_mul_f32 v[98:99], v[98:99], s[72:73] op_sel_hi:[1,0]
    v_cvt_pk_bf16_f32 v89, v98, v99
    v_and_b32 v96, 0xffff0000, v39
    v_and_b32 v97, 0xffff0000, v43
    v_pk_mul_f32 v[96:97], v[96:97], s[72:73] op_sel_hi:[1,0]
    v_cvt_pk_bf16_f32 v90, v96, v97
    v_and_b32 v98, 0xffff0000, v47
    v_and_b32 v99, 0xffff0000, v51
    v_pk_mul_f32 v[98:99], v[98:99], s[72:73] op_sel_hi:[1,0]
    v_cvt_pk_bf16_f32 v91, v98, v99
    ds_write_b128 v16, v[88:91] offset:0
    v_and_b32 v96, 0xffff0000, v55
    v_and_b32 v97, 0xffff0000, v59
    v_pk_mul_f32 v[96:97], v[96:97], s[72:73] op_sel_hi:[1,0]
    v_cvt_pk_bf16_f32 v92, v96, v97
    v_and_b32 v98, 0xffff0000, v63
    v_and_b32 v99, 0xffff0000, v67
    v_pk_mul_f32 v[98:99], v[98:99], s[72:73] op_sel_hi:[1,0]
    v_cvt_pk_bf16_f32 v93, v98, v99
    v_and_b32 v96, 0xffff0000, v71
    v_and_b32 v97, 0xffff0000, v75
    v_pk_mul_f32 v[96:97], v[96:97], s[72:73] op_sel_hi:[1,0]
    v_cvt_pk_bf16_f32 v94, v96, v97
    v_and_b32 v98, 0xffff0000, v79
    v_and_b32 v99, 0xffff0000, v83
    v_pk_mul_f32 v[98:99], v[98:99], s[72:73] op_sel_hi:[1,0]
    v_cvt_pk_bf16_f32 v95, v98, v99
    ds_write_b128 v16, v[92:95] offset:1024
    s_waitcnt lgkmcnt(0)
    s_barrier
    ds_read_b128 a[8:11], v11 offset:2048
    ds_read_b128 a[12:15], v11 offset:3072
    ds_read_b128 a[32:35], v11 offset:0
    ds_read_b128 a[36:39], v11 offset:1024
    ds_read_b128 a[48:51], v134 offset:34816
    ds_read_b128 a[52:55], v134 offset:35840
    ds_read_b128 a[56:59], v134 offset:32768
    ds_read_b128 a[60:63], v134 offset:33792
    ds_read_b128 a[72:75], v134 offset:30720
    ds_read_b128 a[76:79], v134 offset:31744
    s_mov_b32 s40, s8
    s_mov_b32 s41, s9
    s_mov_b32 s42, 0x400000
    s_mov_b32 s43, 0x20000
    s_mov_b32 s80, 0x0
    buffer_load_dwordx4 v[20:23], v10, s[40:43], s80 offen
    s_mov_b32 s80, 0x2000
    buffer_load_dwordx4 v[24:27], v10, s[40:43], s80 offen
    s_mov_b32 s80, 0x40000
    buffer_load_dwordx4 v[28:31], v10, s[40:43], s80 offen
    s_mov_b32 s80, 0x42000
    buffer_load_dwordx4 v[32:35], v10, s[40:43], s80 offen
    s_mov_b32 s80, 0x10000
    buffer_load_dwordx4 v[36:39], v10, s[40:43], s80 offen
    s_mov_b32 s80, 0x12000
    buffer_load_dwordx4 v[40:43], v10, s[40:43], s80 offen
    s_mov_b32 s80, 0x50000
    buffer_load_dwordx4 v[44:47], v10, s[40:43], s80 offen
    s_mov_b32 s80, 0x52000
    buffer_load_dwordx4 v[48:51], v10, s[40:43], s80 offen
    s_mov_b32 s80, 0x100000
    buffer_load_dwordx4 v[52:55], v10, s[40:43], s80 offen
    s_mov_b32 s80, 0x102000
    buffer_load_dwordx4 v[56:59], v10, s[40:43], s80 offen
    s_mov_b32 s80, 0x140000
    buffer_load_dwordx4 v[60:63], v10, s[40:43], s80 offen
    s_mov_b32 s80, 0x142000
    buffer_load_dwordx4 v[64:67], v10, s[40:43], s80 offen
    s_mov_b32 s80, 0x110000
    buffer_load_dwordx4 v[68:71], v10, s[40:43], s80 offen
    s_mov_b32 s80, 0x112000
    buffer_load_dwordx4 v[72:75], v10, s[40:43], s80 offen
    s_mov_b32 s80, 0x150000
    buffer_load_dwordx4 v[76:79], v10, s[40:43], s80 offen
    s_mov_b32 s80, 0x152000
    buffer_load_dwordx4 v[80:83], v10, s[40:43], s80 offen
    s_waitcnt vmcnt(16)
    s_waitcnt lgkmcnt(0)
    s_barrier
    s_lshr_b32 s80, 0x1200010b, s88
    s_and_b32 s80, s80, 0xff
    s_lshl_b32 s80, s80, 11
    v_add_u32 v16, s80, v140
    v_perm_b32 v84, v148, v144, s77
    v_perm_b32 v85, v156, v152, s77
    v_perm_b32 v86, v164, v160, s77
    v_perm_b32 v87, v172, v168, s77
    ds_write_b128 v16, v[84:87] offset:0
    v_perm_b32 v88, v180, v176, s77
    v_perm_b32 v89, v188, v184, s77
    v_perm_b32 v90, v196, v192, s77
    v_perm_b32 v91, v204, v200, s77
    ds_write_b128 v16, v[88:91] offset:1024
    s_lshr_b32 s80, 0x13171819, s88
    s_and_b32 s80, s80, 0xff
    s_lshl_b32 s80, s80, 11
    v_add_u32 v16, s80, v140
    v_perm_b32 v92, v148, v144, s78
    v_perm_b32 v93, v156, v152, s78
    v_perm_b32 v94, v164, v160, s78
    v_perm_b32 v95, v172, v168, s78
    ds_write_b128 v16, v[92:95] offset:0
    v_perm_b32 v84, v180, v176, s78
    v_perm_b32 v85, v188, v184, s78
    v_perm_b32 v86, v196, v192, s78
    v_perm_b32 v87, v204, v200, s78
    ds_write_b128 v16, v[84:87] offset:1024
    s_lshr_b32 s80, 0x2402031d, s88
    s_and_b32 s80, s80, 0xff
    s_lshl_b32 s80, s80, 11
    v_add_u32 v16, s80, v140
    v_perm_b32 v88, v149, v145, s77
    v_perm_b32 v89, v157, v153, s77
    v_perm_b32 v90, v165, v161, s77
    v_perm_b32 v91, v173, v169, s77
    ds_write_b128 v16, v[88:91] offset:0
    v_perm_b32 v92, v181, v177, s77
    v_perm_b32 v93, v189, v185, s77
    v_perm_b32 v94, v197, v193, s77
    v_perm_b32 v95, v205, v201, s77
    ds_write_b128 v16, v[92:95] offset:1024
    s_lshr_b32 s80, 0x25292a2b, s88
    s_and_b32 s80, s80, 0xff
    s_lshl_b32 s80, s80, 11
    v_add_u32 v16, s80, v140
    v_perm_b32 v84, v149, v145, s78
    v_perm_b32 v85, v157, v153, s78
    v_perm_b32 v86, v165, v161, s78
    v_perm_b32 v87, v173, v169, s78
    ds_write_b128 v16, v[84:87] offset:0
    v_perm_b32 v88, v181, v177, s78
    v_perm_b32 v89, v189, v185, s78
    v_perm_b32 v90, v197, v193, s78
    v_perm_b32 v91, v205, v201, s78
    ds_write_b128 v16, v[88:91] offset:1024
    s_lshr_b32 s80, 0x3604052f, s88
    s_and_b32 s80, s80, 0xff
    s_lshl_b32 s80, s80, 11
    v_add_u32 v16, s80, v140
    v_perm_b32 v92, v150, v146, s77
    v_perm_b32 v93, v158, v154, s77
    v_perm_b32 v94, v166, v162, s77
    v_perm_b32 v95, v174, v170, s77
    ds_write_b128 v16, v[92:95] offset:0
    v_perm_b32 v84, v182, v178, s77
    v_perm_b32 v85, v190, v186, s77
    v_perm_b32 v86, v198, v194, s77
    v_perm_b32 v87, v206, v202, s77
    ds_write_b128 v16, v[84:87] offset:1024
    s_lshr_b32 s80, 0x373b3c3d, s88
    s_and_b32 s80, s80, 0xff
    s_lshl_b32 s80, s80, 11
    v_add_u32 v16, s80, v140
    v_perm_b32 v88, v150, v146, s78
    v_perm_b32 v89, v158, v154, s78
    v_perm_b32 v90, v166, v162, s78
    v_perm_b32 v91, v174, v170, s78
    ds_write_b128 v16, v[88:91] offset:0
    v_perm_b32 v92, v182, v178, s78
    v_perm_b32 v93, v190, v186, s78
    v_perm_b32 v94, v198, v194, s78
    v_perm_b32 v95, v206, v202, s78
    ds_write_b128 v16, v[92:95] offset:1024
    s_lshr_b32 s80, 0x48060741, s88
    s_and_b32 s80, s80, 0xff
    s_lshl_b32 s80, s80, 11
    v_add_u32 v16, s80, v140
    v_perm_b32 v84, v151, v147, s77
    v_perm_b32 v85, v159, v155, s77
    v_perm_b32 v86, v167, v163, s77
    v_perm_b32 v87, v175, v171, s77
    ds_write_b128 v16, v[84:87] offset:0
    v_perm_b32 v88, v183, v179, s77
    v_perm_b32 v89, v191, v187, s77
    v_perm_b32 v90, v199, v195, s77
    v_perm_b32 v91, v207, v203, s77
    ds_write_b128 v16, v[88:91] offset:1024
    s_lshr_b32 s80, 0x494d4e4f, s88
    s_and_b32 s80, s80, 0xff
    s_lshl_b32 s80, s80, 11
    v_add_u32 v16, s80, v140
    v_perm_b32 v92, v151, v147, s78
    v_perm_b32 v93, v159, v155, s78
    v_perm_b32 v94, v167, v163, s78
    v_perm_b32 v95, v175, v171, s78
    ds_write_b128 v16, v[92:95] offset:0
    v_perm_b32 v84, v183, v179, s78
    v_perm_b32 v85, v191, v187, s78
    v_perm_b32 v86, v199, v195, s78
    v_perm_b32 v87, v207, v203, s78
    ds_write_b128 v16, v[84:87] offset:1024
    s_waitcnt lgkmcnt(0)
    s_barrier
    ds_read_b128 a[88:91], v11 offset:2048
    ds_read_b128 a[92:95], v11 offset:3072
    ds_read_b128 a[96:99], v11 offset:0
    ds_read_b128 a[100:103], v11 offset:1024
    ds_read_b128 a[120:123], v134 offset:34816
    ds_read_b128 a[124:127], v134 offset:35840
    ds_read_b128 a[136:139], v134 offset:32768
    ds_read_b128 a[140:143], v134 offset:33792
    ds_read_b128 a[152:155], v134 offset:30720
    ds_read_b128 a[156:159], v134 offset:31744
    v_mbcnt_lo_u32_b32 v8, -1, 0
    v_mbcnt_hi_u32_b32 v8, -1, v8
    v_lshlrev_b32 v8, 2, v8
    global_load_dword v6, v8, s[30:31] sc1
    s_mov_b32 s40, s10
    s_mov_b32 s41, s11
    s_mov_b32 s42, 0x400000
    s_mov_b32 s43, 0x20000
    s_mov_b32 s80, 0x0
    buffer_load_dwordx4 v[144:147], v10, s[40:43], s80 offen
    s_mov_b32 s80, 0x2000
    buffer_load_dwordx4 v[148:151], v10, s[40:43], s80 offen
    s_mov_b32 s80, 0x40000
    buffer_load_dwordx4 v[152:155], v10, s[40:43], s80 offen
    s_mov_b32 s80, 0x42000
    buffer_load_dwordx4 v[156:159], v10, s[40:43], s80 offen
    s_mov_b32 s80, 0x10000
    buffer_load_dwordx4 v[160:163], v10, s[40:43], s80 offen
    s_mov_b32 s80, 0x12000
    buffer_load_dwordx4 v[164:167], v10, s[40:43], s80 offen
    s_mov_b32 s80, 0x50000
    buffer_load_dwordx4 v[168:171], v10, s[40:43], s80 offen
    s_mov_b32 s80, 0x52000
    buffer_load_dwordx4 v[172:175], v10, s[40:43], s80 offen
    s_mov_b32 s80, 0x100000
    buffer_load_dwordx4 v[176:179], v10, s[40:43], s80 offen
    s_mov_b32 s80, 0x102000
    buffer_load_dwordx4 v[180:183], v10, s[40:43], s80 offen
    s_mov_b32 s80, 0x140000
    buffer_load_dwordx4 v[184:187], v10, s[40:43], s80 offen
    s_mov_b32 s80, 0x142000
    buffer_load_dwordx4 v[188:191], v10, s[40:43], s80 offen
    s_mov_b32 s80, 0x110000
    buffer_load_dwordx4 v[192:195], v10, s[40:43], s80 offen
    s_mov_b32 s80, 0x112000
    buffer_load_dwordx4 v[196:199], v10, s[40:43], s80 offen
    s_mov_b32 s80, 0x150000
    buffer_load_dwordx4 v[200:203], v10, s[40:43], s80 offen
    s_mov_b32 s80, 0x152000
    buffer_load_dwordx4 v[204:207], v10, s[40:43], s80 offen
    s_waitcnt vmcnt(16)
    s_cmp_eq_u32 s17, 1
    s_cbranch_scc1 L_cf41_ok
L_cf41:
    s_mov_b32 s96, 0
    s_mov_b32 s98, 0
    v_readlane_b32 s97, v6, 8
    s_add_u32 s96, s96, s97
    v_readlane_b32 s97, v6, 12
    s_add_u32 s98, s98, s97
    v_readlane_b32 s97, v6, 24
    s_add_u32 s96, s96, s97
    v_readlane_b32 s97, v6, 20
    s_add_u32 s98, s98, s97
    v_readlane_b32 s97, v6, 40
    s_add_u32 s96, s96, s97
    v_readlane_b32 s97, v6, 36
    s_add_u32 s98, s98, s97
    v_readlane_b32 s97, v6, 56
    s_add_u32 s96, s96, s97
    v_readlane_b32 s97, v6, 52
    s_add_u32 s98, s98, s97
    v_readlane_b32 s97, v6, 9
    s_add_u32 s96, s96, s97
    v_readlane_b32 s97, v6, 13
    s_add_u32 s98, s98, s97
    v_readlane_b32 s97, v6, 25
    s_add_u32 s96, s96, s97
    v_readlane_b32 s97, v6, 21
    s_add_u32 s98, s98, s97
    v_readlane_b32 s97, v6, 41
    s_add_u32 s96, s96, s97
    v_readlane_b32 s97, v6, 37
    s_add_u32 s98, s98, s97
    v_readlane_b32 s97, v6, 57
    s_add_u32 s96, s96, s97
    v_readlane_b32 s97, v6, 53
    s_add_u32 s98, s98, s97
    s_cmp_eq_u32 s19, 0
    s_cselect_b32 s96, s98, s96
    s_cmp_eq_u32 s96, 0x100
    s_cbranch_scc1 L_cf41_all
    s_sub_u32 s100, s100, 1
    s_mov_b32 s101, 41
    s_cbranch_scc1 L_fail
    v_mbcnt_lo_u32_b32 v8, -1, 0
    v_mbcnt_hi_u32_b32 v8, -1, v8
    v_lshlrev_b32 v8, 2, v8
    global_load_dword v6, v8, s[30:31] sc1
    s_waitcnt vmcnt(0)
    s_branch L_cf41
L_cf41_all:
    s_cmp_eq_u32 s19, 0
    s_cbranch_scc0 L_cf41_t
    v_readlane_b32 s97, v6, s16
    s_cmp_eq_u32 s97, 256
    s_cbranch_scc1 L_cf41_std
    s_branch L_role_ticket
L_cf41_t:
    v_cmp_eq_u32 vcc, 32, v6
    s_and_b32 s96, vcc_lo, 0x3000300
    s_and_b32 s97, vcc_hi, 0x3000300
    s_xor_b32 s96, s96, 0x3000300
    s_xor_b32 s97, s97, 0x3000300
    s_or_b32 s96, s96, s97
    s_cmp_eq_u32 s96, 0
    s_cbranch_scc1 L_cf41_std
    v_mov_b32 v1, v6
    s_branch L_role_mixed
L_cf41_std:
    s_mov_b32 s17, 1
L_cf41_ok:
    v_mov_b64 v[12:13], s[66:67]
    v_mov_b64 v[14:15], s[66:67]
    buffer_store_dwordx4 v[12:15], v18, s[36:39], s48 offen offset:0 sc1
    buffer_store_dwordx4 v[12:15], v18, s[36:39], s48 offen offset:1024 sc1
    buffer_store_dwordx4 v[12:15], v18, s[36:39], s79 offen offset:0 sc1
    buffer_store_dwordx4 v[12:15], v18, s[36:39], s79 offen offset:1024 sc1
    buffer_store_dwordx4 v[12:15], v18, s[36:39], s49 offen offset:0 sc1
    buffer_store_dwordx4 v[12:15], v18, s[36:39], s49 offen offset:1024 sc1
    buffer_store_dword v12, v142, s[36:39], s46 offen sc1
    buffer_store_dword v12, v142, s[36:39], s47 offen sc1
    buffer_store_dword v9, v142, s[36:39], s45 offen sc1
    buffer_store_dword v9, v142, s[36:39], s53 offen sc1
    s_mov_b32 s54, 0x80000000
    v_mov_b32 v8, 0
    buffer_store_dword v8, off, s[36:39], s90 sc1
    s_waitcnt lgkmcnt(0)
    s_barrier
    s_lshr_b32 s80, 0x19000108, s88
    s_and_b32 s80, s80, 0xff
    s_lshl_b32 s80, s80, 11
    v_add_u32 v16, s80, v140
    v_lshlrev_b32 v96, 16, v20
    v_lshlrev_b32 v97, 16, v24
    v_pk_mul_f32 v[96:97], v[96:97], s[72:73] op_sel_hi:[1,0]
    v_cvt_pk_bf16_f32 v88, v96, v97
    v_lshlrev_b32 v98, 16, v28
    v_lshlrev_b32 v99, 16, v32
    v_pk_mul_f32 v[98:99], v[98:99], s[72:73] op_sel_hi:[1,0]
    v_cvt_pk_bf16_f32 v89, v98, v99
    v_lshlrev_b32 v96, 16, v36
    v_lshlrev_b32 v97, 16, v40
    v_pk_mul_f32 v[96:97], v[96:97], s[72:73] op_sel_hi:[1,0]
    v_cvt_pk_bf16_f32 v90, v96, v97
    v_lshlrev_b32 v98, 16, v44
    v_lshlrev_b32 v99, 16, v48
    v_pk_mul_f32 v[98:99], v[98:99], s[72:73] op_sel_hi:[1,0]
    v_cvt_pk_bf16_f32 v91, v98, v99
    ds_write_b128 v16, v[88:91] offset:0
    v_lshlrev_b32 v96, 16, v52
    v_lshlrev_b32 v97, 16, v56
    v_pk_mul_f32 v[96:97], v[96:97], s[72:73] op_sel_hi:[1,0]
    v_cvt_pk_bf16_f32 v92, v96, v97
    v_lshlrev_b32 v98, 16, v60
    v_lshlrev_b32 v99, 16, v64
    v_pk_mul_f32 v[98:99], v[98:99], s[72:73] op_sel_hi:[1,0]
    v_cvt_pk_bf16_f32 v93, v98, v99
    v_lshlrev_b32 v96, 16, v68
    v_lshlrev_b32 v97, 16, v72
    v_pk_mul_f32 v[96:97], v[96:97], s[72:73] op_sel_hi:[1,0]
    v_cvt_pk_bf16_f32 v94, v96, v97
    v_lshlrev_b32 v98, 16, v76
    v_lshlrev_b32 v99, 16, v80
    v_pk_mul_f32 v[98:99], v[98:99], s[72:73] op_sel_hi:[1,0]
    v_cvt_pk_bf16_f32 v95, v98, v99
    ds_write_b128 v16, v[92:95] offset:1024
    s_lshr_b32 s80, 0x17100c18, s88
    s_and_b32 s80, s80, 0xff
    s_lshl_b32 s80, s80, 11
    v_add_u32 v16, s80, v140
    v_and_b32 v96, 0xffff0000, v20
    v_and_b32 v97, 0xffff0000, v24
    v_pk_mul_f32 v[96:97], v[96:97], s[72:73] op_sel_hi:[1,0]
    v_cvt_pk_bf16_f32 v84, v96, v97
    v_and_b32 v98, 0xffff0000, v28
    v_and_b32 v99, 0xffff0000, v32
    v_pk_mul_f32 v[98:99], v[98:99], s[72:73] op_sel_hi:[1,0]
    v_cvt_pk_bf16_f32 v85, v98, v99
    v_and_b32 v96, 0xffff0000, v36
    v_and_b32 v97, 0xffff0000, v40
    v_pk_mul_f32 v[96:97], v[96:97], s[72:73] op_sel_hi:[1,0]
    v_cvt_pk_bf16_f32 v86, v96, v97
    v_and_b32 v98, 0xffff0000, v44
    v_and_b32 v99, 0xffff0000, v48
    v_pk_mul_f32 v[98:99], v[98:99], s[72:73] op_sel_hi:[1,0]
    v_cvt_pk_bf16_f32 v87, v98, v99
    ds_write_b128 v16, v[84:87] offset:0
    v_and_b32 v96, 0xffff0000, v52
    v_and_b32 v97, 0xffff0000, v56
    v_pk_mul_f32 v[96:97], v[96:97], s[72:73] op_sel_hi:[1,0]
    v_cvt_pk_bf16_f32 v88, v96, v97
    v_and_b32 v98, 0xffff0000, v60
    v_and_b32 v99, 0xffff0000, v64
    v_pk_mul_f32 v[98:99], v[98:99], s[72:73] op_sel_hi:[1,0]
    v_cvt_pk_bf16_f32 v89, v98, v99
    v_and_b32 v96, 0xffff0000, v68
    v_and_b32 v97, 0xffff0000, v72
    v_pk_mul_f32 v[96:97], v[96:97], s[72:73] op_sel_hi:[1,0]
    v_cvt_pk_bf16_f32 v90, v96, v97
    v_and_b32 v98, 0xffff0000, v76
    v_and_b32 v99, 0xffff0000, v80
    v_pk_mul_f32 v[98:99], v[98:99], s[72:73] op_sel_hi:[1,0]
    v_cvt_pk_bf16_f32 v91, v98, v99
    ds_write_b128 v16, v[88:91] offset:1024
    s_lshr_b32 s80, 0x2b02031a, s88
    s_and_b32 s80, s80, 0xff
    s_lshl_b32 s80, s80, 11
    v_add_u32 v16, s80, v140
    v_lshlrev_b32 v96, 16, v21
    v_lshlrev_b32 v97, 16, v25
    v_pk_mul_f32 v[96:97], v[96:97], s[72:73] op_sel_hi:[1,0]
    v_cvt_pk_bf16_f32 v92, v96, v97
    v_lshlrev_b32 v98, 16, v29
    v_lshlrev_b32 v99, 16, v33
    v_pk_mul_f32 v[98:99], v[98:99], s[72:73] op_sel_hi:[1,0]
    v_cvt_pk_bf16_f32 v93, v98, v99
    v_lshlrev_b32 v96, 16, v37
    v_lshlrev_b32 v97, 16, v41
    v_pk_mul_f32 v[96:97], v[96:97], s[72:73] op_sel_hi:[1,0]
    v_cvt_pk_bf16_f32 v94, v96, v97
    v_lshlrev_b32 v98, 16, v45
    v_lshlrev_b32 v99, 16, v49
    v_pk_mul_f32 v[98:99], v[98:99], s[72:73] op_sel_hi:[1,0]
    v_cvt_pk_bf16_f32 v95, v98, v99
    ds_write_b128 v16, v[92:95] offset:0
    v_lshlrev_b32 v96, 16, v53
    v_lshlrev_b32 v97, 16, v57
    v_pk_mul_f32 v[96:97], v[96:97], s[72:73] op_sel_hi:[1,0]
    v_cvt_pk_bf16_f32 v84, v96, v97
    v_lshlrev_b32 v98, 16, v61
    v_lshlrev_b32 v99, 16, v65
    v_pk_mul_f32 v[98:99], v[98:99], s[72:73] op_sel_hi:[1,0]
    v_cvt_pk_bf16_f32 v85, v98, v99
    v_lshlrev_b32 v96, 16, v69
    v_lshlrev_b32 v97, 16, v73
    v_pk_mul_f32 v[96:97], v[96:97], s[72:73] op_sel_hi:[1,0]
    v_cvt_pk_bf16_f32 v86, v96, v97
    v_lshlrev_b32 v98, 16, v77
    v_lshlrev_b32 v99, 16, v81
    v_pk_mul_f32 v[98:99], v[98:99], s[72:73] op_sel_hi:[1,0]
    v_cvt_pk_bf16_f32 v87, v98, v99
    ds_write_b128 v16, v[84:87] offset:1024
    s_lshr_b32 s80, 0x29221e2a, s88
    s_and_b32 s80, s80, 0xff
    s_lshl_b32 s80, s80, 11
    v_add_u32 v16, s80, v140
    v_and_b32 v96, 0xffff0000, v21
    v_and_b32 v97, 0xffff0000, v25
    v_pk_mul_f32 v[96:97], v[96:97], s[72:73] op_sel_hi:[1,0]
    v_cvt_pk_bf16_f32 v88, v96, v97
    v_and_b32 v98, 0xffff0000, v29
    v_and_b32 v99, 0xffff0000, v33
    v_pk_mul_f32 v[98:99], v[98:99], s[72:73] op_sel_hi:[1,0]
    v_cvt_pk_bf16_f32 v89, v98, v99
    v_and_b32 v96, 0xffff0000, v37
    v_and_b32 v97, 0xffff0000, v41
    v_pk_mul_f32 v[96:97], v[96:97], s[72:73] op_sel_hi:[1,0]
    v_cvt_pk_bf16_f32 v90, v96, v97
    v_and_b32 v98, 0xffff0000, v45
    v_and_b32 v99, 0xffff0000, v49
    v_pk_mul_f32 v[98:99], v[98:99], s[72:73] op_sel_hi:[1,0]
    v_cvt_pk_bf16_f32 v91, v98, v99
    ds_write_b128 v16, v[88:91] offset:0
    v_and_b32 v96, 0xffff0000, v53
    v_and_b32 v97, 0xffff0000, v57
    v_pk_mul_f32 v[96:97], v[96:97], s[72:73] op_sel_hi:[1,0]
    v_cvt_pk_bf16_f32 v92, v96, v97
    v_and_b32 v98, 0xffff0000, v61
    v_and_b32 v99, 0xffff0000, v65
    v_pk_mul_f32 v[98:99], v[98:99], s[72:73] op_sel_hi:[1,0]
    v_cvt_pk_bf16_f32 v93, v98, v99
    v_and_b32 v96, 0xffff0000, v69
    v_and_b32 v97, 0xffff0000, v73
    v_pk_mul_f32 v[96:97], v[96:97], s[72:73] op_sel_hi:[1,0]
    v_cvt_pk_bf16_f32 v94, v96, v97
    v_and_b32 v98, 0xffff0000, v77
    v_and_b32 v99, 0xffff0000, v81
    v_pk_mul_f32 v[98:99], v[98:99], s[72:73] op_sel_hi:[1,0]
    v_cvt_pk_bf16_f32 v95, v98, v99
    ds_write_b128 v16, v[92:95] offset:1024
    s_lshr_b32 s80, 0x3d04052c, s88
    s_and_b32 s80, s80, 0xff
    s_lshl_b32 s80, s80, 11
    v_add_u32 v16, s80, v140
    v_lshlrev_b32 v96, 16, v22
    v_lshlrev_b32 v97, 16, v26
    v_pk_mul_f32 v[96:97], v[96:97], s[72:73] op_sel_hi:[1,0]
    v_cvt_pk_bf16_f32 v84, v96, v97
    v_lshlrev_b32 v98, 16, v30
    v_lshlrev_b32 v99, 16, v34
    v_pk_mul_f32 v[98:99], v[98:99], s[72:73] op_sel_hi:[1,0]
    v_cvt_pk_bf16_f32 v85, v98, v99
    v_lshlrev_b32 v96, 16, v38
    v_lshlrev_b32 v97, 16, v42
    v_pk_mul_f32 v[96:97], v[96:97], s[72:73] op_sel_hi:[1,0]
    v_cvt_pk_bf16_f32 v86, v96, v97
    v_lshlrev_b32 v98, 16, v46
    v_lshlrev_b32 v99, 16, v50
    v_pk_mul_f32 v[98:99], v[98:99], s[72:73] op_sel_hi:[1,0]
    v_cvt_pk_bf16_f32 v87, v98, v99
    ds_write_b128 v16, v[84:87] offset:0
    v_lshlrev_b32 v96, 16, v54
    v_lshlrev_b32 v97, 16, v58
    v_pk_mul_f32 v[96:97], v[96:97], s[72:73] op_sel_hi:[1,0]
    v_cvt_pk_bf16_f32 v88, v96, v97
    v_lshlrev_b32 v98, 16, v62
    v_lshlrev_b32 v99, 16, v66
    v_pk_mul_f32 v[98:99], v[98:99], s[72:73] op_sel_hi:[1,0]
    v_cvt_pk_bf16_f32 v89, v98, v99
    v_lshlrev_b32 v96, 16, v70
    v_lshlrev_b32 v97, 16, v74
    v_pk_mul_f32 v[96:97], v[96:97], s[72:73] op_sel_hi:[1,0]
    v_cvt_pk_bf16_f32 v90, v96, v97
    v_lshlrev_b32 v98, 16, v78
    v_lshlrev_b32 v99, 16, v82
    v_pk_mul_f32 v[98:99], v[98:99], s[72:73] op_sel_hi:[1,0]
    v_cvt_pk_bf16_f32 v91, v98, v99
    ds_write_b128 v16, v[88:91] offset:1024
    s_lshr_b32 s80, 0x3b34303c, s88
    s_and_b32 s80, s80, 0xff
    s_lshl_b32 s80, s80, 11
    v_add_u32 v16, s80, v140
    v_and_b32 v96, 0xffff0000, v22
    v_and_b32 v97, 0xffff0000, v26
    v_pk_mul_f32 v[96:97], v[96:97], s[72:73] op_sel_hi:[1,0]
    v_cvt_pk_bf16_f32 v92, v96, v97
    v_and_b32 v98, 0xffff0000, v30
    v_and_b32 v99, 0xffff0000, v34
    v_pk_mul_f32 v[98:99], v[98:99], s[72:73] op_sel_hi:[1,0]
    v_cvt_pk_bf16_f32 v93, v98, v99
    v_and_b32 v96, 0xffff0000, v38
    v_and_b32 v97, 0xffff0000, v42
    v_pk_mul_f32 v[96:97], v[96:97], s[72:73] op_sel_hi:[1,0]
    v_cvt_pk_bf16_f32 v94, v96, v97
    v_and_b32 v98, 0xffff0000, v46
    v_and_b32 v99, 0xffff0000, v50
    v_pk_mul_f32 v[98:99], v[98:99], s[72:73] op_sel_hi:[1,0]
    v_cvt_pk_bf16_f32 v95, v98, v99
    ds_write_b128 v16, v[92:95] offset:0
    v_and_b32 v96, 0xffff0000, v54
    v_and_b32 v97, 0xffff0000, v58
    v_pk_mul_f32 v[96:97], v[96:97], s[72:73] op_sel_hi:[1,0]
    v_cvt_pk_bf16_f32 v84, v96, v97
    v_and_b32 v98, 0xffff0000, v62
    v_and_b32 v99, 0xffff0000, v66
    v_pk_mul_f32 v[98:99], v[98:99], s[72:73] op_sel_hi:[1,0]
    v_cvt_pk_bf16_f32 v85, v98, v99
    v_and_b32 v96, 0xffff0000, v70
    v_and_b32 v97, 0xffff0000, v74
    v_pk_mul_f32 v[96:97], v[96:97], s[72:73] op_sel_hi:[1,0]
    v_cvt_pk_bf16_f32 v86, v96, v97
    v_and_b32 v98, 0xffff0000, v78
    v_and_b32 v99, 0xffff0000, v82
    v_pk_mul_f32 v[98:99], v[98:99], s[72:73] op_sel_hi:[1,0]
    v_cvt_pk_bf16_f32 v87, v98, v99
    ds_write_b128 v16, v[84:87] offset:1024
    s_lshr_b32 s80, 0x4f06073e, s88
    s_and_b32 s80, s80, 0xff
    s_lshl_b32 s80, s80, 11
    v_add_u32 v16, s80, v140
    v_lshlrev_b32 v96, 16, v23
    v_lshlrev_b32 v97, 16, v27
    v_pk_mul_f32 v[96:97], v[96:97], s[72:73] op_sel_hi:[1,0]
    v_cvt_pk_bf16_f32 v88, v96, v97
    v_lshlrev_b32 v98, 16, v31
    v_lshlrev_b32 v99, 16, v35
    v_pk_mul_f32 v[98:99], v[98:99], s[72:73] op_sel_hi:[1,0]
    v_cvt_pk_bf16_f32 v89, v98, v99
    v_lshlrev_b32 v96, 16, v39
    v_lshlrev_b32 v97, 16, v43
    v_pk_mul_f32 v[96:97], v[96:97], s[72:73] op_sel_hi:[1,0]
    v_cvt_pk_bf16_f32 v90, v96, v97
    v_lshlrev_b32 v98, 16, v47
    v_lshlrev_b32 v99, 16, v51
    v_pk_mul_f32 v[98:99], v[98:99], s[72:73] op_sel_hi:[1,0]
    v_cvt_pk_bf16_f32 v91, v98, v99
    ds_write_b128 v16, v[88:91] offset:0
    v_lshlrev_b32 v96, 16, v55
    v_lshlrev_b32 v97, 16, v59
    v_pk_mul_f32 v[96:97], v[96:97], s[72:73] op_sel_hi:[1,0]
    v_cvt_pk_bf16_f32 v92, v96, v97
    v_lshlrev_b32 v98, 16, v63
    v_lshlrev_b32 v99, 16, v67
    v_pk_mul_f32 v[98:99], v[98:99], s[72:73] op_sel_hi:[1,0]
    v_cvt_pk_bf16_f32 v93, v98, v99
    v_lshlrev_b32 v96, 16, v71
    v_lshlrev_b32 v97, 16, v75
    v_pk_mul_f32 v[96:97], v[96:97], s[72:73] op_sel_hi:[1,0]
    v_cvt_pk_bf16_f32 v94, v96, v97
    v_lshlrev_b32 v98, 16, v79
    v_lshlrev_b32 v99, 16, v83
    v_pk_mul_f32 v[98:99], v[98:99], s[72:73] op_sel_hi:[1,0]
    v_cvt_pk_bf16_f32 v95, v98, v99
    ds_write_b128 v16, v[92:95] offset:1024
    s_lshr_b32 s80, 0x4d46424e, s88
    s_and_b32 s80, s80, 0xff
    s_lshl_b32 s80, s80, 11
    v_add_u32 v16, s80, v140
    v_and_b32 v96, 0xffff0000, v23
    v_and_b32 v97, 0xffff0000, v27
    v_pk_mul_f32 v[96:97], v[96:97], s[72:73] op_sel_hi:[1,0]
    v_cvt_pk_bf16_f32 v84, v96, v97
    v_and_b32 v98, 0xffff0000, v31
    v_and_b32 v99, 0xffff0000, v35
    v_pk_mul_f32 v[98:99], v[98:99], s[72:73] op_sel_hi:[1,0]
    v_cvt_pk_bf16_f32 v85, v98, v99
    v_and_b32 v96, 0xffff0000, v39
    v_and_b32 v97, 0xffff0000, v43
    v_pk_mul_f32 v[96:97], v[96:97], s[72:73] op_sel_hi:[1,0]
    v_cvt_pk_bf16_f32 v86, v96, v97
    v_and_b32 v98, 0xffff0000, v47
    v_and_b32 v99, 0xffff0000, v51
    v_pk_mul_f32 v[98:99], v[98:99], s[72:73] op_sel_hi:[1,0]
    v_cvt_pk_bf16_f32 v87, v98, v99
    ds_write_b128 v16, v[84:87] offset:0
    v_and_b32 v96, 0xffff0000, v55
    v_and_b32 v97, 0xffff0000, v59
    v_pk_mul_f32 v[96:97], v[96:97], s[72:73] op_sel_hi:[1,0]
    v_cvt_pk_bf16_f32 v88, v96, v97
    v_and_b32 v98, 0xffff0000, v63
    v_and_b32 v99, 0xffff0000, v67
    v_pk_mul_f32 v[98:99], v[98:99], s[72:73] op_sel_hi:[1,0]
    v_cvt_pk_bf16_f32 v89, v98, v99
    v_and_b32 v96, 0xffff0000, v71
    v_and_b32 v97, 0xffff0000, v75
    v_pk_mul_f32 v[96:97], v[96:97], s[72:73] op_sel_hi:[1,0]
    v_cvt_pk_bf16_f32 v90, v96, v97
    v_and_b32 v98, 0xffff0000, v79
    v_and_b32 v99, 0xffff0000, v83
    v_pk_mul_f32 v[98:99], v[98:99], s[72:73] op_sel_hi:[1,0]
    v_cvt_pk_bf16_f32 v91, v98, v99
    ds_write_b128 v16, v[88:91] offset:1024
    s_waitcnt lgkmcnt(0)
    s_barrier
    ds_read_b128 a[0:3], v11 offset:2048
    ds_read_b128 a[4:7], v11 offset:3072
    ds_read_b128 a[16:19], v11 offset:0
    ds_read_b128 a[20:23], v11 offset:1024
    ds_read_b128 a[24:27], v134 offset:34816
    ds_read_b128 a[28:31], v134 offset:35840
    ds_read_b128 a[40:43], v134 offset:32768
    ds_read_b128 a[44:47], v134 offset:33792
    ds_read_b128 a[64:67], v134 offset:30720
    ds_read_b128 a[68:71], v134 offset:31744
    s_mov_b32 s40, s14
    s_mov_b32 s41, s15
    s_mov_b32 s42, 0x400000
    s_mov_b32 s43, 0x20000
    s_mov_b32 s80, 0x0
    buffer_load_dwordx4 v[20:23], v17, s[40:43], s80 offen
    s_mov_b32 s80, 0x2000
    buffer_load_dwordx4 v[24:27], v17, s[40:43], s80 offen
    s_mov_b32 s80, 0x4000
    buffer_load_dwordx4 v[28:31], v17, s[40:43], s80 offen
    s_mov_b32 s80, 0x6000
    buffer_load_dwordx4 v[32:35], v17, s[40:43], s80 offen
    s_mov_b32 s80, 0x10000
    buffer_load_dwordx4 v[36:39], v17, s[40:43], s80 offen
    s_mov_b32 s80, 0x12000
    buffer_load_dwordx4 v[40:43], v17, s[40:43], s80 offen
    s_mov_b32 s80, 0x14000
    buffer_load_dwordx4 v[44:47], v17, s[40:43], s80 offen
    s_mov_b32 s80, 0x16000
    buffer_load_dwordx4 v[48:51], v17, s[40:43], s80 offen
    s_mov_b32 s80, 0x800
    buffer_load_dwordx4 v[52:55], v17, s[40:43], s80 offen
    s_mov_b32 s80, 0x2800
    buffer_load_dwordx4 v[56:59], v17, s[40:43], s80 offen
    s_mov_b32 s80, 0x4800
    buffer_load_dwordx4 v[60:63], v17, s[40:43], s80 offen
    s_mov_b32 s80, 0x6800
    buffer_load_dwordx4 v[64:67], v17, s[40:43], s80 offen
    s_mov_b32 s80, 0x10800
    buffer_load_dwordx4 v[68:71], v17, s[40:43], s80 offen
    s_mov_b32 s80, 0x12800
    buffer_load_dwordx4 v[72:75], v17, s[40:43], s80 offen
    s_mov_b32 s80, 0x14800
    buffer_load_dwordx4 v[76:79], v17, s[40:43], s80 offen
    s_mov_b32 s80, 0x16800
    buffer_load_dwordx4 v[80:83], v17, s[40:43], s80 offen
    s_mov_b32 s80, 0x1000
    buffer_load_dwordx4 v[96:99], v17, s[40:43], s80 offen
    s_mov_b32 s80, 0x3000
    buffer_load_dwordx4 v[100:103], v17, s[40:43], s80 offen
    s_mov_b32 s80, 0x5000
    buffer_load_dwordx4 v[104:107], v17, s[40:43], s80 offen
    s_mov_b32 s80, 0x7000
    buffer_load_dwordx4 v[108:111], v17, s[40:43], s80 offen
    s_mov_b32 s80, 0x11000
    buffer_load_dwordx4 v[112:115], v17, s[40:43], s80 offen
    s_mov_b32 s80, 0x13000
    buffer_load_dwordx4 v[116:119], v17, s[40:43], s80 offen
    s_mov_b32 s80, 0x15000
    buffer_load_dwordx4 v[120:123], v17, s[40:43], s80 offen
    s_mov_b32 s80, 0x17000
    buffer_load_dwordx4 v[124:127], v17, s[40:43], s80 offen
    s_waitcnt vmcnt(24)
    s_waitcnt lgkmcnt(0)
    s_barrier
    s_lshr_b32 s80, 0x110109, s88
    s_and_b32 s80, s80, 0xff
    s_lshl_b32 s80, s80, 11
    v_add_u32 v16, s80, v140
    v_perm_b32 v92, v148, v144, s77
    v_perm_b32 v93, v156, v152, s77
    v_perm_b32 v94, v164, v160, s77
    v_perm_b32 v95, v172, v168, s77
    ds_write_b128 v16, v[92:95] offset:0
    v_perm_b32 v84, v180, v176, s77
    v_perm_b32 v85, v188, v184, s77
    v_perm_b32 v86, v196, v192, s77
    v_perm_b32 v87, v204, v200, s77
    ds_write_b128 v16, v[84:87] offset:1024
    s_lshr_b32 s80, 0x16171819, s88
    s_and_b32 s80, s80, 0xff
    s_lshl_b32 s80, s80, 11
    v_add_u32 v16, s80, v140
    v_perm_b32 v88, v148, v144, s78
    v_perm_b32 v89, v156, v152, s78
    v_perm_b32 v90, v164, v160, s78
    v_perm_b32 v91, v172, v168, s78
    ds_write_b128 v16, v[88:91] offset:0
    v_perm_b32 v92, v180, v176, s78
    v_perm_b32 v93, v188, v184, s78
    v_perm_b32 v94, v196, v192, s78
    v_perm_b32 v95, v204, v200, s78
    ds_write_b128 v16, v[92:95] offset:1024
    s_lshr_b32 s80, 0x223031b, s88
    s_and_b32 s80, s80, 0xff
    s_lshl_b32 s80, s80, 11
    v_add_u32 v16, s80, v140
    v_perm_b32 v84, v149, v145, s77
    v_perm_b32 v85, v157, v153, s77
    v_perm_b32 v86, v165, v161, s77
    v_perm_b32 v87, v173, v169, s77
    ds_write_b128 v16, v[84:87] offset:0
    v_perm_b32 v88, v181, v177, s77
    v_perm_b32 v89, v189, v185, s77
    v_perm_b32 v90, v197, v193, s77
    v_perm_b32 v91, v205, v201, s77
    ds_write_b128 v16, v[88:91] offset:1024
    s_lshr_b32 s80, 0x28292a2b, s88
    s_and_b32 s80, s80, 0xff
    s_lshl_b32 s80, s80, 11
    v_add_u32 v16, s80, v140
    v_perm_b32 v92, v149, v145, s78
    v_perm_b32 v93, v157, v153, s78
    v_perm_b32 v94, v165, v161, s78
    v_perm_b32 v95, v173, v169, s78
    ds_write_b128 v16, v[92:95] offset:0
    v_perm_b32 v84, v181, v177, s78
    v_perm_b32 v85, v189, v185, s78
    v_perm_b32 v86, v197, v193, s78
    v_perm_b32 v87, v205, v201, s78
    ds_write_b128 v16, v[84:87] offset:1024
    s_lshr_b32 s80, 0x435052d, s88
    s_and_b32 s80, s80, 0xff
    s_lshl_b32 s80, s80, 11
    v_add_u32 v16, s80, v140
    v_perm_b32 v88, v150, v146, s77
    v_perm_b32 v89, v158, v154, s77
    v_perm_b32 v90, v166, v162, s77
    v_perm_b32 v91, v174, v170, s77
    ds_write_b128 v16, v[88:91] offset:0
    v_perm_b32 v92, v182, v178, s77
    v_perm_b32 v93, v190, v186, s77
    v_perm_b32 v94, v198, v194, s77
    v_perm_b32 v95, v206, v202, s77
    ds_write_b128 v16, v[92:95] offset:1024
    s_lshr_b32 s80, 0x3a3b3c3d, s88
    s_and_b32 s80, s80, 0xff
    s_lshl_b32 s80, s80, 11
    v_add_u32 v16, s80, v140
    v_perm_b32 v84, v150, v146, s78
    v_perm_b32 v85, v158, v154, s78
    v_perm_b32 v86, v166, v162, s78
    v_perm_b32 v87, v174, v170, s78
    ds_write_b128 v16, v[84:87] offset:0
    v_perm_b32 v88, v182, v178, s78
    v_perm_b32 v89, v190, v186, s78
    v_perm_b32 v90, v198, v194, s78
    v_perm_b32 v91, v206, v202, s78
    ds_write_b128 v16, v[88:91] offset:1024
    s_lshr_b32 s80, 0x647073f, s88
    s_and_b32 s80, s80, 0xff
    s_lshl_b32 s80, s80, 11
    v_add_u32 v16, s80, v140
    v_perm_b32 v92, v151, v147, s77
    v_perm_b32 v93, v159, v155, s77
    v_perm_b32 v94, v167, v163, s77
    v_perm_b32 v95, v175, v171, s77
    ds_write_b128 v16, v[92:95] offset:0
    v_perm_b32 v84, v183, v179, s77
    v_perm_b32 v85, v191, v187, s77
    v_perm_b32 v86, v199, v195, s77
    v_perm_b32 v87, v207, v203, s77
    ds_write_b128 v16, v[84:87] offset:1024
    s_lshr_b32 s80, 0x4c4d4e4f, s88
    s_and_b32 s80, s80, 0xff
    s_lshl_b32 s80, s80, 11
    v_add_u32 v16, s80, v140
    v_perm_b32 v88, v151, v147, s78
    v_perm_b32 v89, v159, v155, s78
    v_perm_b32 v90, v167, v163, s78
    v_perm_b32 v91, v175, v171, s78
    ds_write_b128 v16, v[88:91] offset:0
    v_perm_b32 v92, v183, v179, s78
    v_perm_b32 v93, v191, v187, s78
    v_perm_b32 v94, v199, v195, s78
    v_perm_b32 v95, v207, v203, s78
    ds_write_b128 v16, v[92:95] offset:1024
    s_waitcnt lgkmcnt(0)
    s_barrier
    ds_read_b128 a[80:83], v11 offset:2048
    ds_read_b128 a[84:87], v11 offset:3072
    ds_read_b128 a[104:107], v11 offset:0
    ds_read_b128 a[108:111], v11 offset:1024
    ds_read_b128 a[112:115], v134 offset:34816
    ds_read_b128 a[116:119], v134 offset:35840
    ds_read_b128 a[128:131], v134 offset:32768
    ds_read_b128 a[132:135], v134 offset:33792
    ds_read_b128 a[144:147], v134 offset:30720
    ds_read_b128 a[148:151], v134 offset:31744
    ds_read_b128 a[160:163], v134 offset:28672
    ds_read_b128 a[164:167], v134 offset:29696
    s_waitcnt lgkmcnt(4)
    s_waitcnt lgkmcnt(0)
    s_barrier
    s_lshl_b32 s80, s35, 2
    s_add_u32 s80, s80, 0x41000
    s_cmp_eq_u32 s34, 0
    s_cselect_b32 s80, s80, 0x80000000
    v_mov_b32 v4, 1
    buffer_store_dword v4, off, s[36:39], s80 sc1
    s_waitcnt vmcnt(16)
    v_perm_b32 v144, v24, v20, s77
    v_perm_b32 v145, v24, v20, s78
    v_perm_b32 v146, v32, v28, s77
    v_perm_b32 v147, v32, v28, s78
    v_perm_b32 v148, v40, v36, s77
    v_perm_b32 v149, v40, v36, s78
    v_perm_b32 v150, v48, v44, s77
    v_perm_b32 v151, v48, v44, s78
    v_perm_b32 v176, v25, v21, s77
    v_perm_b32 v177, v25, v21, s78
    v_perm_b32 v178, v33, v29, s77
    v_perm_b32 v179, v33, v29, s78
    v_perm_b32 v180, v41, v37, s77
    v_perm_b32 v181, v41, v37, s78
    v_perm_b32 v182, v49, v45, s77
    v_perm_b32 v183, v49, v45, s78
    v_perm_b32 v192, v26, v22, s77
    v_perm_b32 v193, v26, v22, s78
    v_perm_b32 v194, v34, v30, s77
    v_perm_b32 v195, v34, v30, s78
    v_perm_b32 v196, v42, v38, s77
    v_perm_b32 v197, v42, v38, s78
    v_perm_b32 v198, v50, v46, s77
    v_perm_b32 v199, v50, v46, s78
    v_perm_b32 v208, v27, v23, s77
    v_perm_b32 v209, v27, v23, s78
    v_perm_b32 v210, v35, v31, s77
    v_perm_b32 v211, v35, v31, s78
    v_perm_b32 v212, v43, v39, s77
    v_perm_b32 v213, v43, v39, s78
    v_perm_b32 v214, v51, v47, s77
    v_perm_b32 v215, v51, v47, s78
    s_mov_b32 s80, 0x1800
    buffer_load_dwordx4 v[20:23], v17, s[40:43], s80 offen
    s_mov_b32 s80, 0x3800
    buffer_load_dwordx4 v[24:27], v17, s[40:43], s80 offen
    s_mov_b32 s80, 0x5800
    buffer_load_dwordx4 v[28:31], v17, s[40:43], s80 offen
    s_mov_b32 s80, 0x7800
    buffer_load_dwordx4 v[32:35], v17, s[40:43], s80 offen
    s_mov_b32 s80, 0x11800
    buffer_load_dwordx4 v[36:39], v17, s[40:43], s80 offen
    s_mov_b32 s80, 0x13800
    buffer_load_dwordx4 v[40:43], v17, s[40:43], s80 offen
    s_mov_b32 s80, 0x15800
    buffer_load_dwordx4 v[44:47], v17, s[40:43], s80 offen
    s_mov_b32 s80, 0x17800
    buffer_load_dwordx4 v[48:51], v17, s[40:43], s80 offen
    s_waitcnt vmcnt(16)
    v_perm_b32 v152, v56, v52, s77
    v_perm_b32 v153, v56, v52, s78
    v_perm_b32 v154, v64, v60, s77
    v_perm_b32 v155, v64, v60, s78
    v_perm_b32 v156, v72, v68, s77
    v_perm_b32 v157, v72, v68, s78
    v_perm_b32 v158, v80, v76, s77
    v_perm_b32 v159, v80, v76, s78
    v_perm_b32 v92, v57, v53, s77
    v_perm_b32 v93, v57, v53, s78
    v_perm_b32 v94, v65, v61, s77
    v_perm_b32 v95, v65, v61, s78
    ds_write_b128 v134, v[92:95] offset:24576
    v_perm_b32 v84, v73, v69, s77
    v_perm_b32 v85, v73, v69, s78
    v_perm_b32 v86, v81, v77, s77
    v_perm_b32 v87, v81, v77, s78
    ds_write_b128 v134, v[84:87] offset:25600
    v_perm_b32 v88, v58, v54, s77
    v_perm_b32 v89, v58, v54, s78
    v_perm_b32 v90, v66, v62, s77
    v_perm_b32 v91, v66, v62, s78
    ds_write_b128 v134, v[88:91] offset:28672
    v_perm_b32 v92, v74, v70, s77
    v_perm_b32 v93, v74, v70, s78
    v_perm_b32 v94, v82, v78, s77
    v_perm_b32 v95, v82, v78, s78
    ds_write_b128 v134, v[92:95] offset:29696
    v_perm_b32 v84, v59, v55, s77
    v_perm_b32 v85, v59, v55, s78
    v_perm_b32 v86, v67, v63, s77
    v_perm_b32 v87, v67, v63, s78
    ds_write_b128 v134, v[84:87] offset:32768
    v_perm_b32 v88, v75, v71, s77
    v_perm_b32 v89, v75, v71, s78
    v_perm_b32 v90, v83, v79, s77
    v_perm_b32 v91, v83, v79, s78
    ds_write_b128 v134, v[88:91] offset:33792
    s_mov_b32 s80, 0x40000
    v_lshlrev_b32 v8, 2, v140
    buffer_load_dword v8, v8, s[36:39], s80 offen sc1
    s_add_u32 s80, s52, 0x80000
    buffer_load_dwordx3 v[128:130], v140, s[36:39], s52 offen offset:0 sc1
    buffer_load_dwordx3 v[128:130], v140, s[36:39], s52 offen offset:1024 sc1
    buffer_load_dwordx3 v[128:130], v140, s[36:39], s52 offen offset:2048 sc1
    buffer_load_dwordx3 v[128:130], v140, s[36:39], s52 offen offset:3072 sc1
    buffer_load_dwordx3 v[128:130], v140, s[36:39], s80 offen offset:0 sc1
    buffer_load_dwordx3 v[128:130], v140, s[36:39], s80 offen offset:1024 sc1
    buffer_load_dwordx3 v[128:130], v140, s[36:39], s80 offen offset:2048 sc1
    buffer_load_dwordx3 v[128:130], v140, s[36:39], s80 offen offset:3072 sc1
    s_waitcnt vmcnt(17)
    v_perm_b32 v160, v100, v96, s77
    v_perm_b32 v161, v100, v96, s78
    v_perm_b32 v162, v108, v104, s77
    v_perm_b32 v163, v108, v104, s78
    v_perm_b32 v164, v116, v112, s77
    v_perm_b32 v165, v116, v112, s78
    v_perm_b32 v166, v124, v120, s77
    v_perm_b32 v167, v124, v120, s78
    v_perm_b32 v184, v101, v97, s77
    v_perm_b32 v185, v101, v97, s78
    v_perm_b32 v186, v109, v105, s77
    v_perm_b32 v187, v109, v105, s78
    v_perm_b32 v188, v117, v113, s77
    v_perm_b32 v189, v117, v113, s78
    v_perm_b32 v190, v125, v121, s77
    v_perm_b32 v191, v125, v121, s78
    v_perm_b32 v200, v102, v98, s77
    v_perm_b32 v201, v102, v98, s78
    v_perm_b32 v202, v110, v106, s77
    v_perm_b32 v203, v110, v106, s78
    v_perm_b32 v204, v118, v114, s77
    v_perm_b32 v205, v118, v114, s78
    v_perm_b32 v206, v126, v122, s77
    v_perm_b32 v207, v126, v122, s78
    v_perm_b32 v216, v103, v99, s77
    v_perm_b32 v217, v103, v99, s78
    v_perm_b32 v218, v111, v107, s77
    v_perm_b32 v219, v111, v107, s78
    v_perm_b32 v220, v119, v115, s77
    v_perm_b32 v221, v119, v115, s78
    v_perm_b32 v222, v127, v123, s77
    v_perm_b32 v223, v127, v123, s78
    s_waitcnt vmcnt(9)
    v_perm_b32 v168, v24, v20, s77
    v_perm_b32 v169, v24, v20, s78
    v_perm_b32 v170, v32, v28, s77
    v_perm_b32 v171, v32, v28, s78
    v_perm_b32 v172, v40, v36, s77
    v_perm_b32 v173, v40, v36, s78
    v_perm_b32 v174, v48, v44, s77
    v_perm_b32 v175, v48, v44, s78
    v_perm_b32 v92, v25, v21, s77
    v_perm_b32 v93, v25, v21, s78
    v_perm_b32 v94, v33, v29, s77
    v_perm_b32 v95, v33, v29, s78
    ds_write_b128 v134, v[92:95] offset:26624
    v_perm_b32 v84, v41, v37, s77
    v_perm_b32 v85, v41, v37, s78
    v_perm_b32 v86, v49, v45, s77
    v_perm_b32 v87, v49, v45, s78
    ds_write_b128 v134, v[84:87] offset:27648
    v_perm_b32 v88, v26, v22, s77
    v_perm_b32 v89, v26, v22, s78
    v_perm_b32 v90, v34, v30, s77
    v_perm_b32 v91, v34, v30, s78
    ds_write_b128 v134, v[88:91] offset:30720
    v_perm_b32 v92, v42, v38, s77
    v_perm_b32 v93, v42, v38, s78
    v_perm_b32 v94, v50, v46, s77
    v_perm_b32 v95, v50, v46, s78
    ds_write_b128 v134, v[92:95] offset:31744
    v_perm_b32 v84, v27, v23, s77
    v_perm_b32 v85, v27, v23, s78
    v_perm_b32 v86, v35, v31, s77
    v_perm_b32 v87, v35, v31, s78
    ds_write_b128 v134, v[84:87] offset:34816
    v_perm_b32 v88, v43, v39, s77
    v_perm_b32 v89, v43, v39, s78
    v_perm_b32 v90, v51, v47, s77
    v_perm_b32 v91, v51, v47, s78
    ds_write_b128 v134, v[88:91] offset:35840
    v_mov_b32 v3, 0
    v_lshlrev_b32 v4, 3, v0
    v_mov_b32 v6, 0
    v_mov_b32 v7, 0
    ds_write_b64 v4, v[6:7] offset:12288
    ds_write_b64 v4, v[6:7] offset:13312
    v_and_b32 v3, 31, v0
    v_lshlrev_b32 v3, 2, v3
    s_mov_b32 s80, 0x41000
L_c1_bar:
    buffer_load_dword v4, v3, s[36:39], s80 offen sc1
    s_waitcnt vmcnt(0)
    v_cmp_ne_u32 vcc, 1, v4
    s_cbranch_vccz L_c1_bar_ok
    s_sub_u32 s100, s100, 1
    s_mov_b32 s101, 10
    s_cbranch_scc1 L_fail
    s_branch L_c1_bar
L_c1_bar_ok:
    v_cmp_le_u32 vcc, 32, v8
    s_and_b32 s80, vcc_lo, 0xffff
    s_ff0_i32_b32 s56, s80
    s_mov_b32 s87, 0
    s_mov_b32 s91, 0
    s_mov_b32 s80, 0
    s_mov_b32 s89, 0x40000
    s_mov_b32 s88, 0x80000000
    s_mov_b32 s55, s89
    s_cmp_lg_u32 s56, 0
    s_cbranch_scc1 L_c1_kv0_ok
L_c1_kv0:
    s_mov_b32 s82, 0x40000
    v_lshlrev_b32 v128, 2, v140
    s_waitcnt vmcnt(0)
    buffer_load_dword v128, v128, s[36:39], s82 offen sc1
    s_waitcnt vmcnt(0)
    v_cmp_le_u32 vcc, 32, v128
    s_and_b32 s82, vcc_lo, 0xffff
    s_ff0_i32_b32 s56, s82
    s_cmp_lt_u32 s80, s56
    s_cbranch_scc1 L_c1_kv0_ok
    s_sub_u32 s100, s100, 1
    s_mov_b32 s101, 12
    s_cbranch_scc1 L_fail
    s_branch L_c1_kv0
L_c1_kv0_ok:
    s_cmp_lt_u32 s56, 2
    s_cselect_b32 s55, s89, s88
    buffer_load_dwordx4 v[88:91], v137, s[36:39], s50 offen offset:0 sc1
    buffer_load_dwordx4 v[92:95], v137, s[36:39], s50 offen offset:1024 sc1
    buffer_load_dwordx4 v[96:99], v137, s[36:39], s50 offen offset:2048 sc1
    buffer_load_dwordx4 v[100:103], v137, s[36:39], s50 offen offset:3072 sc1
    s_add_u32 s50, s50, 0x80000
    buffer_load_dwordx4 v[104:107], v140, s[36:39], s51 offen offset:0 sc1
    buffer_load_dwordx4 v[108:111], v140, s[36:39], s51 offen offset:1024 sc1
    s_add_u32 s51, s51, 0x80000
    s_add_u32 s52, s52, 0x80000
    buffer_load_dwordx3 v[128:130], v140, s[36:39], s52 offen offset:0 sc1
    buffer_load_dwordx3 v[128:130], v140, s[36:39], s52 offen offset:1024 sc1
    buffer_load_dwordx3 v[128:130], v140, s[36:39], s52 offen offset:2048 sc1
    buffer_load_dwordx3 v[128:130], v140, s[36:39], s52 offen offset:3072 sc1
    s_add_u32 s52, s52, 0x80000
    v_and_b32 v4, 31, v0
    v_lshlrev_b32 v133, 2, v4
    s_waitcnt lgkmcnt(0)
    ds_read_b128 v[56:59], v134 offset:0
    ds_read_b128 v[60:63], v134 offset:1024
    ds_read_b128 v[64:67], v134 offset:2048
    ds_read_b128 v[68:71], v134 offset:3072
    ds_read_b128 v[72:75], v134 offset:4096
    ds_read_b128 v[76:79], v134 offset:5120
    ds_read_b128 v[80:83], v134 offset:6144
    ds_read_b128 v[84:87], v134 offset:7168
    v_mov_b64 v[32:33], 0
    v_mov_b64 v[34:35], 0
    v_mov_b64 v[36:37], 0
    v_mov_b64 v[38:39], 0
    v_mov_b64 v[40:41], 0
    v_mov_b64 v[42:43], 0
    v_mov_b64 v[44:45], 0
    v_mov_b64 v[46:47], 0
    v_mov_b64 v[48:49], 0
    v_mov_b64 v[50:51], 0
    v_mov_b64 v[52:53], 0
    v_mov_b64 v[54:55], 0
    s_lshl_b32 s80, s34, 11
    s_add_u32 m0, s80, 0
    s_waitcnt vmcnt(0)
    s_barrier
    s_cmp_eq_u32 s34, 1
    s_cbranch_scc1 L_c1_enter1
    s_cmp_eq_u32 s34, 2
    s_cbranch_scc1 L_c1_enter2
    s_cmp_eq_u32 s34, 3
    s_cbranch_scc1 L_c1_enter3
L_c1_enter0:
    buffer_load_dword v114, v133, s[36:39], s65 offen sc1
    buffer_load_dwordx4 v140, s[36:39], s45 offen sc1 lds
    buffer_load_dwordx4 v140, s[36:39], s45 offen offset:1024 sc1 lds
    buffer_load_dword v115, v133, s[36:39], s65 offen sc1
    buffer_load_dwordx4 v140, s[36:39], s45 offen sc1 lds
    buffer_load_dwordx4 v140, s[36:39], s45 offen offset:1024 sc1 lds
    s_waitcnt vmcnt(0)
    .p2align 6
L_c1_w0_step:
    s_waitcnt vmcnt(5) lgkmcnt(0)
    v_cmp_ne_u32 vcc, s44, v114
    s_cbranch_vccnz L_c1_w0_spinA
    s_waitcnt vmcnt(3)
L_c1_w0_hit:
    s_barrier
    ds_read_b128 v[0:3], v140 offset:0
    ds_read_b128 v[4:7], v140 offset:1024
    s_waitcnt lgkmcnt(1)
    v_smfmac_f32_16x16x64_bf16 v[32:35], v[0:3], v[56:63], v131
    ds_read_b128 v[8:11], v140 offset:2048
    v_mov_b32 v124, s66
    v_smfmac_f32_16x16x64_bf16 v[36:39], v[0:3], a[40:47], v131
    s_waitcnt lgkmcnt(1)
    ds_read_b128 v[12:15], v140 offset:3072
    buffer_load_dwordx3 v[128:130], v140, s[36:39], s52 offen offset:0 sc1
    v_smfmac_f32_16x16x64_bf16 v[40:43], v[0:3], v[64:71], v131
    ds_read_b128 v[56:59], v134 offset:8192
    v_lshlrev_b32 v126, 2, v140
    v_smfmac_f32_16x16x64_bf16 v[44:47], v[0:3], a[112:119], v131
    ds_read_b128 v[60:63], v134 offset:9216
    v_smfmac_f32_16x16x64_bf16 v[32:35], v[4:7], v[72:79], v131
    ds_read_b128 v[64:67], v134 offset:10240
    buffer_load_dwordx3 v[128:130], v140, s[36:39], s52 offen offset:1024 sc1
    v_smfmac_f32_16x16x64_bf16 v[36:39], v[4:7], a[48:55], v131
    ds_read_b128 v[68:71], v134 offset:11264
    v_smfmac_f32_16x16x64_bf16 v[40:43], v[4:7], v[80:87], v131
    ds_read_b128 v[72:75], v134 offset:12288
    v_smfmac_f32_16x16x64_bf16 v[44:47], v[4:7], a[120:127], v131
    s_waitcnt lgkmcnt(6)
    ds_read_b128 v[76:79], v134 offset:13312
    buffer_load_dwordx3 v[128:130], v140, s[36:39], s52 offen offset:2048 sc1
    v_smfmac_f32_16x16x64_bf16 v[32:35], v[8:11], a[0:7], v131
    s_waitcnt lgkmcnt(4)
    ds_read_b128 v[80:83], v134 offset:14336
    v_smfmac_f32_16x16x64_bf16 v[36:39], v[8:11], v[56:63], v131
    ds_read_b128 v[84:87], v134 offset:15360
    v_smfmac_f32_16x16x64_bf16 v[40:43], v[8:11], a[80:87], v131
    ds_read_b128 v[56:59], v134 offset:16384
    buffer_load_dwordx3 v[128:130], v140, s[36:39], s52 offen offset:3072 sc1
    v_smfmac_f32_16x16x64_bf16 v[44:47], v[8:11], a[128:135], v131
    s_waitcnt lgkmcnt(9)
    ds_read_b128 v[60:63], v134 offset:17408
    v_smfmac_f32_16x16x64_bf16 v[32:35], v[12:15], a[8:15], v131
    s_waitcnt lgkmcnt(6)
    v_smfmac_f32_16x16x64_bf16 v[36:39], v[12:15], v[64:71], v131
    ds_read_b128 v[64:67], v134 offset:18432
    buffer_load_dword v128, v126, s[36:39], s55 offen sc1
    v_smfmac_f32_16x16x64_bf16 v[40:43], v[12:15], a[88:95], v131
    s_barrier
    ds_read_b128 v[16:19], v140 offset:4096
    v_smfmac_f32_16x16x64_bf16 v[44:47], v[12:15], a[136:143], v131
    s_waitcnt lgkmcnt(6)
    ds_read_b128 v[20:23], v140 offset:5120
    v_smfmac_f32_16x16x64_bf16 v[48:51], v[0:3], v[72:79], v131
    ds_read_b128 v[24:27], v140 offset:6144
    v_smfmac_f32_16x16x64_bf16 v[52:55], v[0:3], a[224:231], v131
    ds_read_b128 v[28:31], v140 offset:7168
    v_smfmac_f32_16x16x64_bf16 v[48:51], v[4:7], a[168:175], v131
    s_waitcnt lgkmcnt(3)
    ds_read_b128 v[68:71], v134 offset:19456
    v_smfmac_f32_16x16x64_bf16 v[32:35], v[16:19], a[16:23], v131
    s_waitcnt lgkmcnt(3)
    ds_read_b128 v[72:75], v134 offset:20480
    v_smfmac_f32_16x16x64_bf16 v[32:35], v[20:23], v[80:87], v131
    s_waitcnt lgkmcnt(3)
    ds_read_b128 v[76:79], v134 offset:21504
    v_smfmac_f32_16x16x64_bf16 v[32:35], v[24:27], a[24:31], v131
    s_waitcnt lgkmcnt(3)
    ds_read_b128 v[80:83], v134 offset:22528
    v_smfmac_f32_16x16x64_bf16 v[32:35], v[28:31], a[32:39], v131
    s_waitcnt lgkmcnt(9)
    ds_read_b128 v[84:87], v134 offset:23552
    buffer_store_dword v116, v142, s[36:39], s54 offen sc1
    v_smfmac_f32_16x16x64_bf16 v[36:39], v[16:19], v[56:63], v131
    v_smfmac_f32_16x16x64_bf16 v[36:39], v[20:23], a[56:63], v131
    buffer_store_dword v124, v142, s[36:39], s47 offen sc1
    v_add_f32 v32, v32, v34
    v_smfmac_f32_16x16x64_bf16 v[36:39], v[24:27], a[64:71], v131
    v_add_f32 v33, v33, v35
    v_smfmac_f32_16x16x64_bf16 v[36:39], v[28:31], a[72:79], v131
    s_waitcnt lgkmcnt(4)
    v_smfmac_f32_16x16x64_bf16 v[40:43], v[16:19], v[64:71], v131
    v_mov_b64 v[68:69], s[68:69]
    v_smfmac_f32_16x16x64_bf16 v[40:43], v[20:23], a[96:103], v131
    v_add_f32 v36, v36, v38
    v_add_f32 v37, v37, v39
    v_smfmac_f32_16x16x64_bf16 v[40:43], v[24:27], a[104:111], v131
    s_waitcnt lgkmcnt(2)
    v_cvt_pk_bf16_f32 v32, v32, v36
    v_cvt_pk_bf16_f32 v33, v33, v37
    v_smfmac_f32_16x16x64_bf16 v[40:43], v[28:31], v[72:79], v131
    ds_write2_b32 v135, v32, v33 offset0:0 offset1:4
    v_smfmac_f32_16x16x64_bf16 v[44:47], v[16:19], a[144:151], v131
    ds_read_b128 v[72:75], v134 offset:24576
    v_mov_b64 v[70:71], s[68:69]
    v_smfmac_f32_16x16x64_bf16 v[44:47], v[20:23], a[152:159], v131
    ds_read_b128 v[76:79], v134 offset:25600
    v_add_f32 v40, v40, v42
    v_smfmac_f32_16x16x64_bf16 v[44:47], v[24:27], a[160:167], v131
    s_waitcnt lgkmcnt(3)
    v_add_f32 v41, v41, v43
    v_smfmac_f32_16x16x64_bf16 v[44:47], v[28:31], v[80:87], v131
    ds_read_b128 v[80:83], v134 offset:26624
    v_smfmac_f32_16x16x64_bf16 v[52:55], v[4:7], a[232:239], v131
    s_waitcnt lgkmcnt(3)
    s_barrier
    ds_read_b128 v[112:115], v136 offset:8192
    v_smfmac_f32_16x16x64_bf16 v[48:51], v[8:11], a[176:183], v131
    ds_read_b128 v[116:119], v136 offset:9216
    v_add_f32 v44, v44, v46
    v_smfmac_f32_16x16x64_bf16 v[52:55], v[8:11], a[240:247], v131
    ds_read_b128 v[120:123], v136 offset:10240
    v_add_f32 v45, v45, v47
    v_cvt_pk_bf16_f32 v40, v40, v44
    v_smfmac_f32_16x16x64_bf16 v[48:51], v[12:15], a[184:191], v131
    ds_read_b128 v[124:127], v136 offset:11264
    v_cvt_pk_bf16_f32 v41, v41, v45
    v_smfmac_f32_16x16x64_bf16 v[52:55], v[12:15], a[248:255], v131
    s_waitcnt lgkmcnt(3)
    ds_write2_b32 v135, v40, v41 offset0:128 offset1:132
    v_mfma_f32_16x16x32_bf16 v[32:35], v[88:91], v[112:115], 0
    s_waitcnt lgkmcnt(3)
    ds_read_b128 v[84:87], v134 offset:27648
    v_mfma_f32_16x16x32_bf16 v[32:35], v[92:95], v[116:119], v[32:35]
    s_waitcnt lgkmcnt(3)
    buffer_load_dwordx4 v[88:91], v137, s[36:39], s50 offen offset:0 sc1
    v_mfma_f32_16x16x32_bf16 v[32:35], v[96:99], v[120:123], v[32:35]
    s_waitcnt lgkmcnt(2)
    buffer_load_dwordx4 v[92:95], v137, s[36:39], s50 offen offset:1024 sc1
    v_mfma_f32_16x16x32_bf16 v[32:35], v[100:103], v[124:127], v[32:35]
    s_waitcnt lgkmcnt(1)
    s_barrier
    ds_read_b128 v[0:3], v137 offset:8704
    v_smfmac_f32_16x16x64_bf16 v[48:51], v[16:19], a[192:199], v131
    ds_read_b128 v[4:7], v137 offset:9728
    buffer_load_dwordx4 v[96:99], v137, s[36:39], s50 offen offset:2048 sc1
    v_smfmac_f32_16x16x64_bf16 v[48:51], v[20:23], a[200:207], v131
    ds_read_b128 v[8:11], v137 offset:10752
    v_exp_f32 v36, v32
    v_smfmac_f32_16x16x64_bf16 v[48:51], v[24:27], a[208:215], v131
    s_waitcnt lgkmcnt(2)
    ds_read_b128 v[12:15], v137 offset:11776
    v_exp_f32 v37, v33
    v_mfma_f32_16x16x32_bf16 v[44:47], v[0:3], v[112:115], 0
    s_waitcnt lgkmcnt(2)
    buffer_load_dwordx4 v[100:103], v137, s[36:39], s50 offen offset:3072 sc1
    v_cvt_pk_bf16_f32 v36, v36, v37
    v_mfma_f32_16x16x32_bf16 v[44:47], v[4:7], v[116:119], v[44:47]
    s_waitcnt lgkmcnt(1)
    ds_write_b32 v136, v36 offset:12800
    v_mfma_f32_16x16x32_bf16 v[44:47], v[8:11], v[120:123], v[44:47]
    s_waitcnt lgkmcnt(1)
    v_mov_b64 v[0:1], 0
    v_mov_b64 v[2:3], 0
    v_mfma_f32_16x16x32_bf16 v[44:47], v[12:15], v[124:127], v[44:47]
    v_mov_b64 v[4:5], 0
    v_mov_b64 v[6:7], 0
    v_smfmac_f32_16x16x64_bf16 v[48:51], v[28:31], a[216:223], v131
    v_mov_b64 v[8:9], 0
    v_smfmac_f32_16x16x64_bf16 v[52:55], v[16:19], v[224:231], v131
    s_waitcnt lgkmcnt(0)
    s_barrier
    ds_read_b128 v[64:67], v136 offset:12800
    v_exp_f32 v46, v44
    v_smfmac_f32_16x16x64_bf16 v[52:55], v[20:23], v[232:239], v131
    ds_read_b128 v[56:59], v138 offset:12800
    v_add_f32 v48, v48, v50
    v_exp_f32 v47, v45
    v_smfmac_f32_16x16x64_bf16 v[52:55], v[24:27], v[240:247], v131
    ds_read_b128 v[60:63], v138 offset:12288
    v_add_f32 v49, v49, v51
    v_cvt_pk_bf16_f32 v46, v46, v47
    v_smfmac_f32_16x16x64_bf16 v[52:55], v[28:31], v[248:255], v131
    s_waitcnt lgkmcnt(2)
    v_cvt_pk_bf16_f32 v48, v48, v49
    v_mfma_f32_16x16x32_bf16 v[36:39], v[68:71], v[64:67], 0
    s_waitcnt lgkmcnt(1)
    v_cndmask_b32 v50, 0, v46, s[70:71]
    v_cndmask_b32 v51, v46, 0, s[70:71]
    v_mfma_f32_16x16x32_bf16 v[40:43], v[104:107], v[56:59], 0
    s_waitcnt lgkmcnt(0)
    v_add_f32 v52, v52, v54
    v_add_f32 v53, v53, v55
    v_mfma_f32_16x16x32_bf16 v[40:43], v[108:111], v[60:63], v[40:43]
    v_cvt_pk_bf16_f32 v49, v52, v53
    v_mfma_f32_16x16x16_bf16 v[36:39], v[68:69], v[50:51], v[36:39]
    v_mfma_f32_16x16x16_bf16 v[40:43], v[48:49], v[50:51], v[40:43]
    s_nop 3
    v_rcp_f32 v46, v36
    v_mov_b64 v[10:11], 0
    v_mov_b64 v[12:13], 0
    s_nop 0
    v_pk_mul_f32 v[40:41], v[40:41], v[46:47] op_sel_hi:[1,0]
    v_pk_mul_f32 v[42:43], v[42:43], v[46:47] op_sel_hi:[1,0]
    v_cvt_pk_bf16_f32 v40, v40, v41
    v_cvt_pk_bf16_f32 v41, v42, v43
    ds_write_b64 v139, v[40:41] offset:13824
    v_subrev_u32 v47, s74, v36
    v_cmp_lt_u32 vcc, s75, v47
    v_mov_b64 v[14:15], 0
    s_cbranch_vccnz L_c1_w0_fb
L_c1_w0_fbret:
    buffer_load_dwordx4 v[104:107], v140, s[36:39], s51 offen offset:0 sc1
    buffer_load_dwordx4 v[108:111], v140, s[36:39], s51 offen offset:1024 sc1
    s_waitcnt lgkmcnt(0)
    s_barrier
    ds_read_b128 v[112:115], v137 offset:13824
    ds_read_b128 v[116:119], v137 offset:14336
    ds_read_b128 v[120:123], v137 offset:14848
    ds_read_b128 v[124:127], v137 offset:15360
    s_waitcnt lgkmcnt(3)
    v_smfmac_f32_16x16x64_bf16 v[0:3], v[112:115], v[144:151], v131
    s_waitcnt lgkmcnt(2)
    v_smfmac_f32_16x16x64_bf16 v[0:3], v[116:119], v[152:159], v131
    s_waitcnt lgkmcnt(1)
    ds_read_b128 v[56:59], v134 offset:28672
    v_smfmac_f32_16x16x64_bf16 v[0:3], v[120:123], v[160:167], v131
    s_waitcnt lgkmcnt(1)
    ds_read_b128 v[60:63], v134 offset:29696
    v_smfmac_f32_16x16x64_bf16 v[0:3], v[124:127], v[168:175], v131
    s_add_u32 s84, s48, 4096
    ds_read_b128 v[64:67], v134 offset:30720
    v_smfmac_f32_16x16x64_bf16 v[4:7], v[112:115], v[176:183], v131
    ds_read_b128 v[68:71], v134 offset:31744
    v_smfmac_f32_16x16x64_bf16 v[4:7], v[116:119], v[72:79], v131
    ds_read_b128 v[72:75], v134 offset:32768
    v_cvt_pk_bf16_f32 v16, v0, v2
    v_cvt_pk_bf16_f32 v17, v1, v3
    v_smfmac_f32_16x16x64_bf16 v[4:7], v[120:123], v[184:191], v131
    ds_read_b128 v[76:79], v134 offset:33792
    v_bfi_b32 v16, 1, s87, v16
    v_bfi_b32 v17, 1, s87, v17
    v_smfmac_f32_16x16x64_bf16 v[4:7], v[124:127], v[80:87], v131
    ds_read_b128 v[80:83], v134 offset:34816
    buffer_store_dwordx2 v[16:17], v132, s[36:39], s48 offen offset:0 sc1
    v_smfmac_f32_16x16x64_bf16 v[8:11], v[112:115], v[192:199], v131
    s_waitcnt lgkmcnt(5)
    ds_read_b128 v[84:87], v134 offset:35840
    v_smfmac_f32_16x16x64_bf16 v[8:11], v[116:119], v[56:63], v131
    v_cvt_pk_bf16_f32 v18, v4, v6
    v_cvt_pk_bf16_f32 v19, v5, v7
    v_bfi_b32 v18, 1, s87, v18
    v_bfi_b32 v19, 1, s87, v19
    v_smfmac_f32_16x16x64_bf16 v[8:11], v[120:123], v[200:207], v131
    s_waitcnt lgkmcnt(4)
    buffer_store_dwordx2 v[18:19], v132, s[36:39], s48 offen offset:2048 sc1
    v_smfmac_f32_16x16x64_bf16 v[8:11], v[124:127], v[64:71], v131
    v_smfmac_f32_16x16x64_bf16 v[12:15], v[112:115], v[208:215], v131
    s_waitcnt lgkmcnt(2)
    v_smfmac_f32_16x16x64_bf16 v[12:15], v[116:119], v[72:79], v131
    v_cvt_pk_bf16_f32 v20, v8, v10
    v_smfmac_f32_16x16x64_bf16 v[12:15], v[120:123], v[216:223], v131
    s_waitcnt lgkmcnt(0)
    v_cvt_pk_bf16_f32 v21, v9, v11
    v_smfmac_f32_16x16x64_bf16 v[12:15], v[124:127], v[80:87], v131
    v_bfi_b32 v20, 1, s87, v20
    v_bfi_b32 v21, 1, s87, v21
    buffer_store_dwordx2 v[20:21], v132, s[36:39], s84 offen offset:0 sc1
    s_nop 3
    v_cvt_pk_bf16_f32 v22, v12, v14
    v_cvt_pk_bf16_f32 v23, v13, v15
    v_bfi_b32 v22, 1, s87, v22
    v_bfi_b32 v23, 1, s87, v23
    buffer_store_dwordx2 v[22:23], v132, s[36:39], s84 offen offset:2048 sc1
    v_mov_b64 v[40:41], 0
    v_mov_b64 v[42:43], 0
    v_mov_b64 v[44:45], 0
    v_mov_b64 v[46:47], 0
    v_mov_b64 v[48:49], 0
    v_mov_b64 v[50:51], 0
    v_mov_b64 v[52:53], 0
    v_mov_b64 v[54:55], 0
    ds_read_b128 v[56:59], v134 offset:0
    ds_read_b128 v[60:63], v134 offset:1024
    ds_read_b128 v[64:67], v134 offset:2048
    ds_read_b128 v[68:71], v134 offset:3072
    ds_read_b128 v[72:75], v134 offset:4096
    ds_read_b128 v[76:79], v134 offset:5120
    ds_read_b128 v[80:83], v134 offset:6144
    ds_read_b128 v[84:87], v134 offset:7168
    buffer_load_dword v32, v141, s[36:39], s57 offen sc1
    buffer_load_dword v33, v141, s[36:39], s58 offen sc1
    buffer_load_dword v34, v141, s[36:39], s59 offen sc1
    buffer_load_dword v35, v141, s[36:39], s60 offen sc1
    buffer_load_dword v36, v141, s[36:39], s61 offen sc1
    buffer_load_dword v37, v141, s[36:39], s62 offen sc1
    buffer_load_dword v38, v141, s[36:39], s63 offen sc1
    buffer_load_dword v39, v141, s[36:39], s64 offen sc1
    s_mov_b32 s80, s47
    s_mov_b32 s47, s45
    s_mov_b32 s45, s46
    s_mov_b32 s46, s80
    s_add_u32 s53, s53, 8192
    s_mov_b32 s54, s53
    s_add_u32 s44, s44, 1
    v_mov_b32 v112, v143
    v_mov_b32 v113, v143
    v_mov_b32 v114, v143
    v_mov_b32 v115, v143
    v_mov_b32 v2, s44
    s_waitcnt vmcnt(4)
L_c1_w0_p2w:
    v_mfma_f32_16x16x32_bf16 v[116:119], v[112:115], v[32:35], 0
    v_bitop3_b32 v0, v32, v33, s87 bitop3:0x7e
    v_bitop3_b32 v1, v34, v35, s87 bitop3:0x7e
    s_waitcnt vmcnt(0)
    v_mfma_f32_16x16x32_bf16 v[116:119], v[112:115], v[36:39], v[116:119]
    v_bitop3_b32 v3, v36, v37, s87 bitop3:0x7e
    v_bitop3_b32 v4, v38, v39, s87 bitop3:0x7e
    v_or3_b32 v0, v0, v1, v3
    v_bitop3_b32 v0, v0, v4, 1 bitop3:0xa8
    v_cmp_ne_u32 vcc, 0, v0
    s_cbranch_vccnz L_c1_w0_p2retry
L_c1_w0_p2ok:
    s_nop 0
    v_cvt_pk_bf16_f32 v116, v116, v117
    buffer_store_dword v116, v142, s[36:39], s45 offen sc1
    s_cmp_eq_u32 s44, 63
    s_cbranch_scc1 L_c1_fin
    s_nop 2
    buffer_store_dword v2, off, s[36:39], s90 sc1
    v_mov_b64 v[32:33], 0
    v_mov_b64 v[34:35], 0
    v_mov_b64 v[36:37], 0
    v_mov_b64 v[38:39], 0
    s_sub_u32 s95, s79, s48
    s_mov_b32 s82, s49
    s_mov_b32 s49, s48
    s_mov_b32 s48, s79
    s_mov_b32 s79, s49
    s_add_u32 s52, s52, 0x80000
    s_mov_b32 s91, 0
    s_add_u32 s50, s50, 524288
    s_add_u32 s51, s51, 524288
    v_cmp_le_u32 vcc, 32, v128
    s_and_b32 s80, vcc_lo, 0xffff
    s_ff0_i32_b32 s80, s80
    s_max_u32 s56, s56, s80
    s_add_u32 s80, s44, 4
    s_lshr_b32 s80, s80, 2
    s_min_u32 s80, s80, 15
    s_cmp_lt_u32 s80, s56
    s_cselect_b32 s55, s88, s89
    s_add_u32 s80, s44, 2
    s_lshr_b32 s80, s80, 2
    s_min_u32 s80, s80, 15
    s_cmp_lt_u32 s80, s56
    s_cbranch_scc0 L_c1_w0_kvwait
L_c1_w0_kvok:
    v_add_u32 v141, s95, v141
    s_bfe_i32 s87, s44, 0x10001
    s_nop 6
    buffer_load_dword v114, v133, s[36:39], s65 offen sc1
    buffer_load_dwordx4 v140, s[36:39], s45 offen sc1 lds
    buffer_load_dwordx4 v140, s[36:39], s45 offen offset:1024 sc1 lds
    s_nop 7
    s_nop 7
    s_nop 7
    buffer_load_dword v115, v133, s[36:39], s65 offen sc1
    buffer_load_dwordx4 v140, s[36:39], s45 offen sc1 lds
    buffer_load_dwordx4 v140, s[36:39], s45 offen offset:1024 sc1 lds
    s_branch L_c1_w0_step
L_c1_w0_spinA:
    buffer_load_dword v114, v133, s[36:39], s65 offen sc1
    buffer_load_dwordx4 v140, s[36:39], s45 offen sc1 lds
    buffer_load_dwordx4 v140, s[36:39], s45 offen offset:1024 sc1 lds
    s_waitcnt vmcnt(5)
    v_cmp_ne_u32 vcc, s44, v115
    s_cbranch_vccz L_c1_w0_spunA
    buffer_load_dword v115, v133, s[36:39], s65 offen sc1
    buffer_load_dwordx4 v140, s[36:39], s45 offen sc1 lds
    buffer_load_dwordx4 v140, s[36:39], s45 offen offset:1024 sc1 lds
    s_branch L_c1_w0_spin0
L_c1_w0_spunA:
    s_waitcnt vmcnt(3)
    s_branch L_c1_w0_hit
L_c1_w0_spin0:
    s_waitcnt vmcnt(5)
    v_cmp_ne_u32 vcc, s44, v114
    s_cbranch_vccz L_c1_w0_spun
L_c1_w0_spin1:
    buffer_load_dword v114, v133, s[36:39], s65 offen sc1
    buffer_load_dwordx4 v140, s[36:39], s45 offen sc1 lds
    buffer_load_dwordx4 v140, s[36:39], s45 offen offset:1024 sc1 lds
    s_waitcnt vmcnt(5)
    v_cmp_ne_u32 vcc, s44, v115
    s_cbranch_vccz L_c1_w0_spun
    buffer_load_dword v115, v133, s[36:39], s65 offen sc1
    buffer_load_dwordx4 v140, s[36:39], s45 offen sc1 lds
    buffer_load_dwordx4 v140, s[36:39], s45 offen offset:1024 sc1 lds
    s_sub_u32 s100, s100, 1
    s_mov_b32 s101, 12
    s_cbranch_scc1 L_fail
    s_branch L_c1_w0_spin0
L_c1_w0_spun:
    s_waitcnt vmcnt(3)
    s_branch L_c1_w0_hit
L_c1_w0_redo:
    s_mov_b32 s91, 1
    s_mov_b32 s54, 0x80000000
    s_sub_u32 s50, s50, 0x80000
    buffer_load_dwordx4 v[88:91], v137, s[36:39], s50 offen offset:0 sc1
    buffer_load_dwordx4 v[92:95], v137, s[36:39], s50 offen offset:1024 sc1
    buffer_load_dwordx4 v[96:99], v137, s[36:39], s50 offen offset:2048 sc1
    buffer_load_dwordx4 v[100:103], v137, s[36:39], s50 offen offset:3072 sc1
    s_add_u32 s50, s50, 0x80000
L_c1_w0_redo1:
    s_waitcnt vmcnt(0) lgkmcnt(0)
    s_barrier
    s_sub_u32 s100, s100, 1
    s_mov_b32 s101, 13
    s_cbranch_scc1 L_fail
    buffer_load_dwordx4 v140, s[36:39], s45 offen sc1 lds
    buffer_load_dwordx4 v140, s[36:39], s45 offen offset:1024 sc1 lds
    s_waitcnt vmcnt(0)
    s_barrier
    ds_read_b128 v[0:3], v140 offset:0
    ds_read_b128 v[4:7], v140 offset:1024
    ds_read_b128 v[8:11], v140 offset:2048
    ds_read_b128 v[12:15], v140 offset:3072
    ds_read_b128 v[16:19], v140 offset:4096
    ds_read_b128 v[20:23], v140 offset:5120
    ds_read_b128 v[24:27], v140 offset:6144
    ds_read_b128 v[28:31], v140 offset:7168
    s_waitcnt lgkmcnt(0)
    v_cmp_eq_u32 vcc, s66, v0
    s_cbranch_vccnz L_c1_w0_redo1
    v_cmp_eq_u32 vcc, s66, v1
    s_cbranch_vccnz L_c1_w0_redo1
    v_cmp_eq_u32 vcc, s66, v2
    s_cbranch_vccnz L_c1_w0_redo1
    v_cmp_eq_u32 vcc, s66, v3
    s_cbranch_vccnz L_c1_w0_redo1
    v_cmp_eq_u32 vcc, s66, v4
    s_cbranch_vccnz L_c1_w0_redo1
    v_cmp_eq_u32 vcc, s66, v5
    s_cbranch_vccnz L_c1_w0_redo1
    v_cmp_eq_u32 vcc, s66, v6
    s_cbranch_vccnz L_c1_w0_redo1
    v_cmp_eq_u32 vcc, s66, v7
    s_cbranch_vccnz L_c1_w0_redo1
    v_cmp_eq_u32 vcc, s66, v8
    s_cbranch_vccnz L_c1_w0_redo1
    v_cmp_eq_u32 vcc, s66, v9
    s_cbranch_vccnz L_c1_w0_redo1
    v_cmp_eq_u32 vcc, s66, v10
    s_cbranch_vccnz L_c1_w0_redo1
    v_cmp_eq_u32 vcc, s66, v11
    s_cbranch_vccnz L_c1_w0_redo1
    v_cmp_eq_u32 vcc, s66, v12
    s_cbranch_vccnz L_c1_w0_redo1
    v_cmp_eq_u32 vcc, s66, v13
    s_cbranch_vccnz L_c1_w0_redo1
    v_cmp_eq_u32 vcc, s66, v14
    s_cbranch_vccnz L_c1_w0_redo1
    v_cmp_eq_u32 vcc, s66, v15
    s_cbranch_vccnz L_c1_w0_redo1
    v_cmp_eq_u32 vcc, s66, v16
    s_cbranch_vccnz L_c1_w0_redo1
    v_cmp_eq_u32 vcc, s66, v17
    s_cbranch_vccnz L_c1_w0_redo1
    v_cmp_eq_u32 vcc, s66, v18
    s_cbranch_vccnz L_c1_w0_redo1
    v_cmp_eq_u32 vcc, s66, v19
    s_cbranch_vccnz L_c1_w0_redo1
    v_cmp_eq_u32 vcc, s66, v20
    s_cbranch_vccnz L_c1_w0_redo1
    v_cmp_eq_u32 vcc, s66, v21
    s_cbranch_vccnz L_c1_w0_redo1
    v_cmp_eq_u32 vcc, s66, v22
    s_cbranch_vccnz L_c1_w0_redo1
    v_cmp_eq_u32 vcc, s66, v23
    s_cbranch_vccnz L_c1_w0_redo1
    v_cmp_eq_u32 vcc, s66, v24
    s_cbranch_vccnz L_c1_w0_redo1
    v_cmp_eq_u32 vcc, s66, v25
    s_cbranch_vccnz L_c1_w0_redo1
    v_cmp_eq_u32 vcc, s66, v26
    s_cbranch_vccnz L_c1_w0_redo1
    v_cmp_eq_u32 vcc, s66, v27
    s_cbranch_vccnz L_c1_w0_redo1
    v_cmp_eq_u32 vcc, s66, v28
    s_cbranch_vccnz L_c1_w0_redo1
    v_cmp_eq_u32 vcc, s66, v29
    s_cbranch_vccnz L_c1_w0_redo1
    v_cmp_eq_u32 vcc, s66, v30
    s_cbranch_vccnz L_c1_w0_redo1
    v_cmp_eq_u32 vcc, s66, v31
    s_cbranch_vccnz L_c1_w0_redo1
    ds_read_b128 v[56:59], v134 offset:0
    ds_read_b128 v[60:63], v134 offset:1024
    ds_read_b128 v[64:67], v134 offset:2048
    ds_read_b128 v[68:71], v134 offset:3072
    ds_read_b128 v[72:75], v134 offset:4096
    ds_read_b128 v[76:79], v134 offset:5120
    ds_read_b128 v[80:83], v134 offset:6144
    ds_read_b128 v[84:87], v134 offset:7168
    v_mov_b64 v[32:33], 0
    v_mov_b64 v[34:35], 0
    v_mov_b64 v[36:37], 0
    v_mov_b64 v[38:39], 0
    v_mov_b64 v[40:41], 0
    v_mov_b64 v[42:43], 0
    v_mov_b64 v[44:45], 0
    v_mov_b64 v[46:47], 0
    v_mov_b64 v[48:49], 0
    v_mov_b64 v[50:51], 0
    v_mov_b64 v[52:53], 0
    v_mov_b64 v[54:55], 0
    v_mov_b32 v114, s44
    v_mov_b32 v115, s44
    v_mov_b32 v115, s44
    s_branch L_c1_w0_step
L_c1_w0_p2slow:
    v_cmp_eq_u32 vcc, s66, v32
    s_cbranch_vccnz L_c1_w0_p2retry
    v_cmp_eq_u32 vcc, s66, v33
    s_cbranch_vccnz L_c1_w0_p2retry
    v_cmp_eq_u32 vcc, s66, v34
    s_cbranch_vccnz L_c1_w0_p2retry
    v_cmp_eq_u32 vcc, s66, v35
    s_cbranch_vccnz L_c1_w0_p2retry
    v_cmp_eq_u32 vcc, s66, v36
    s_cbranch_vccnz L_c1_w0_p2retry
    v_cmp_eq_u32 vcc, s66, v37
    s_cbranch_vccnz L_c1_w0_p2retry
    v_cmp_eq_u32 vcc, s66, v38
    s_cbranch_vccnz L_c1_w0_p2retry
    v_cmp_eq_u32 vcc, s66, v39
    s_cbranch_vccnz L_c1_w0_p2retry
    s_branch L_c1_w0_p2ok
L_c1_w0_p2retry:
    s_sub_u32 s100, s100, 1
    s_mov_b32 s101, 14
    s_cbranch_scc1 L_fail
    buffer_load_dword v32, v141, s[36:39], s57 offen sc1
    buffer_load_dword v33, v141, s[36:39], s58 offen sc1
    buffer_load_dword v34, v141, s[36:39], s59 offen sc1
    buffer_load_dword v35, v141, s[36:39], s60 offen sc1
    buffer_load_dword v36, v141, s[36:39], s61 offen sc1
    buffer_load_dword v37, v141, s[36:39], s62 offen sc1
    buffer_load_dword v38, v141, s[36:39], s63 offen sc1
    buffer_load_dword v39, v141, s[36:39], s64 offen sc1
    s_waitcnt vmcnt(0)
    s_branch L_c1_w0_p2w
L_c1_w0_kvwait:
    s_mov_b32 s82, 0x40000
    v_lshlrev_b32 v128, 2, v140
    s_waitcnt vmcnt(0)
    buffer_load_dword v128, v128, s[36:39], s82 offen sc1
    s_waitcnt vmcnt(0)
    v_cmp_le_u32 vcc, 32, v128
    s_and_b32 s82, vcc_lo, 0xffff
    s_ff0_i32_b32 s56, s82
    s_cmp_lt_u32 s80, s56
    s_cbranch_scc1 L_c1_w0_kvwait_ok
    s_sub_u32 s100, s100, 1
    s_mov_b32 s101, 15
    s_cbranch_scc1 L_fail
    s_branch L_c1_w0_kvwait
L_c1_w0_kvwait_ok:
    s_branch L_c1_w0_kvok
L_c1_w0_fb:
    s_cmp_eq_u32 s91, 0
    s_cbranch_scc0 L_c1_w0_fb1
    v_cmp_u_f32 vcc, v36, v36
    s_cbranch_vccnz L_c1_w0_redo
L_c1_w0_fb1:
    s_waitcnt vmcnt(0)
    s_barrier
    ds_write_b64 v140, v[32:33] offset:0
    s_waitcnt lgkmcnt(0)
    s_barrier
    ds_read_b128 v[0:3], v140 offset:0
    ds_read_b128 v[4:7], v140 offset:1024
    v_mov_b32 v8, v44
    v_mov_b32 v9, v45
    s_waitcnt lgkmcnt(0)
    v_max3_f32 v10, v0, v1, v2
    v_max3_f32 v11, v3, v4, v5
    v_max3_f32 v10, v10, v6, v7
    v_max3_f32 v11, v11, v8, v9
    v_max_f32 v10, v10, v11
    v_mov_b32 v11, v10
    s_nop 1
    v_permlane32_swap_b32 v10, v11
    v_max_f32 v10, v10, v11
    v_mov_b32 v11, v10
    s_nop 1
    v_permlane16_swap_b32 v10, v11
    v_max_f32 v10, v10, v11
    v_sub_f32 v0, v0, v10
    v_sub_f32 v1, v1, v10
    v_sub_f32 v2, v2, v10
    v_sub_f32 v3, v3, v10
    v_sub_f32 v4, v4, v10
    v_sub_f32 v5, v5, v10
    v_sub_f32 v6, v6, v10
    v_sub_f32 v7, v7, v10
    v_sub_f32 v8, v8, v10
    v_sub_f32 v9, v9, v10
    v_exp_f32 v0, v0
    v_exp_f32 v1, v1
    v_exp_f32 v2, v2
    v_exp_f32 v3, v3
    v_exp_f32 v4, v4
    v_exp_f32 v5, v5
    v_exp_f32 v6, v6
    v_exp_f32 v7, v7
    v_exp_f32 v8, v8
    v_exp_f32 v9, v9
    v_cvt_pk_bf16_f32 v64, v0, v1
    v_cvt_pk_bf16_f32 v65, v2, v3
    v_cvt_pk_bf16_f32 v66, v4, v5
    v_cvt_pk_bf16_f32 v67, v6, v7
    v_cvt_pk_bf16_f32 v8, v8, v9
    v_cndmask_b32 v56, 0, v64, s[70:71]
    v_cndmask_b32 v60, v64, 0, s[70:71]
    v_cndmask_b32 v57, 0, v65, s[70:71]
    v_cndmask_b32 v61, v65, 0, s[70:71]
    v_cndmask_b32 v58, 0, v66, s[70:71]
    v_cndmask_b32 v62, v66, 0, s[70:71]
    v_cndmask_b32 v59, 0, v67, s[70:71]
    v_cndmask_b32 v63, v67, 0, s[70:71]
    v_cndmask_b32 v50, 0, v8, s[70:71]
    v_cndmask_b32 v51, v8, 0, s[70:71]
    v_mfma_f32_16x16x32_bf16 v[36:39], v[68:71], v[64:67], 0
    v_mfma_f32_16x16x32_bf16 v[40:43], v[104:107], v[56:59], 0
    v_mfma_f32_16x16x32_bf16 v[40:43], v[108:111], v[60:63], v[40:43]
    v_mfma_f32_16x16x16_bf16 v[36:39], v[68:69], v[50:51], v[36:39]
    v_mfma_f32_16x16x16_bf16 v[40:43], v[48:49], v[50:51], v[40:43]
    v_mov_b64 v[0:1], 0
    v_mov_b64 v[2:3], 0
    v_mov_b64 v[4:5], 0
    v_mov_b64 v[6:7], 0
    v_mov_b64 v[8:9], 0
    v_mov_b64 v[10:11], 0
    v_mov_b64 v[12:13], 0
    v_mov_b64 v[14:15], 0
    v_rcp_f32 v46, v36
    s_nop 0
    v_pk_mul_f32 v[40:41], v[40:41], v[46:47] op_sel_hi:[1,0]
    v_pk_mul_f32 v[42:43], v[42:43], v[46:47] op_sel_hi:[1,0]
    v_cvt_pk_bf16_f32 v40, v40, v41
    v_cvt_pk_bf16_f32 v41, v42, v43
    ds_write_b64 v139, v[40:41] offset:13824
    s_branch L_c1_w0_fbret
L_c1_enter1:
    buffer_load_dword v114, v133, s[36:39], s65 offen sc1
    buffer_load_dwordx4 v140, s[36:39], s45 offen sc1 lds
    buffer_load_dwordx4 v140, s[36:39], s45 offen offset:1024 sc1 lds
    buffer_load_dword v115, v133, s[36:39], s65 offen sc1
    buffer_load_dwordx4 v140, s[36:39], s45 offen sc1 lds
    buffer_load_dwordx4 v140, s[36:39], s45 offen offset:1024 sc1 lds
    s_waitcnt vmcnt(0)
    .p2align 6
L_c1_w1_step:
    s_waitcnt vmcnt(5) lgkmcnt(0)
    v_cmp_ne_u32 vcc, s44, v114
    s_cbranch_vccnz L_c1_w1_spinA
    s_waitcnt vmcnt(3)
L_c1_w1_hit:
    s_barrier
    ds_read_b128 v[0:3], v140 offset:0
    ds_read_b128 v[4:7], v140 offset:1024
    s_waitcnt lgkmcnt(1)
    v_smfmac_f32_16x16x64_bf16 v[32:35], v[0:3], v[56:63], v131
    ds_read_b128 v[8:11], v140 offset:2048
    v_mov_b32 v124, s66
    v_smfmac_f32_16x16x64_bf16 v[36:39], v[0:3], a[40:47], v131
    s_waitcnt lgkmcnt(1)
    ds_read_b128 v[12:15], v140 offset:3072
    v_lshlrev_b32 v126, 2, v140
    v_smfmac_f32_16x16x64_bf16 v[40:43], v[0:3], v[64:71], v131
    ds_read_b128 v[56:59], v134 offset:8192
    buffer_load_dwordx3 v[128:130], v140, s[36:39], s52 offen offset:0 sc1
    v_smfmac_f32_16x16x64_bf16 v[44:47], v[0:3], a[112:119], v131
    ds_read_b128 v[60:63], v134 offset:9216
    v_smfmac_f32_16x16x64_bf16 v[32:35], v[4:7], v[72:79], v131
    ds_read_b128 v[64:67], v134 offset:10240
    v_smfmac_f32_16x16x64_bf16 v[36:39], v[4:7], a[48:55], v131
    ds_read_b128 v[68:71], v134 offset:11264
    buffer_load_dwordx3 v[128:130], v140, s[36:39], s52 offen offset:1024 sc1
    v_smfmac_f32_16x16x64_bf16 v[40:43], v[4:7], v[80:87], v131
    ds_read_b128 v[72:75], v134 offset:12288
    v_smfmac_f32_16x16x64_bf16 v[44:47], v[4:7], a[120:127], v131
    s_waitcnt lgkmcnt(6)
    ds_read_b128 v[76:79], v134 offset:13312
    v_smfmac_f32_16x16x64_bf16 v[32:35], v[8:11], a[0:7], v131
    s_waitcnt lgkmcnt(4)
    ds_read_b128 v[80:83], v134 offset:14336
    buffer_load_dwordx3 v[128:130], v140, s[36:39], s52 offen offset:2048 sc1
    v_smfmac_f32_16x16x64_bf16 v[36:39], v[8:11], v[56:63], v131
    ds_read_b128 v[84:87], v134 offset:15360
    v_smfmac_f32_16x16x64_bf16 v[40:43], v[8:11], a[80:87], v131
    ds_read_b128 v[56:59], v134 offset:16384
    v_smfmac_f32_16x16x64_bf16 v[44:47], v[8:11], a[128:135], v131
    s_waitcnt lgkmcnt(9)
    ds_read_b128 v[60:63], v134 offset:17408
    buffer_load_dwordx3 v[128:130], v140, s[36:39], s52 offen offset:3072 sc1
    v_smfmac_f32_16x16x64_bf16 v[32:35], v[12:15], a[8:15], v131
    s_waitcnt lgkmcnt(6)
    v_smfmac_f32_16x16x64_bf16 v[36:39], v[12:15], v[64:71], v131
    ds_read_b128 v[64:67], v134 offset:18432
    v_smfmac_f32_16x16x64_bf16 v[40:43], v[12:15], a[88:95], v131
    s_barrier
    ds_read_b128 v[16:19], v140 offset:4096
    buffer_load_dword v128, v126, s[36:39], s55 offen sc1
    v_smfmac_f32_16x16x64_bf16 v[44:47], v[12:15], a[136:143], v131
    s_waitcnt lgkmcnt(6)
    ds_read_b128 v[20:23], v140 offset:5120
    v_smfmac_f32_16x16x64_bf16 v[48:51], v[0:3], v[72:79], v131
    ds_read_b128 v[24:27], v140 offset:6144
    v_smfmac_f32_16x16x64_bf16 v[52:55], v[0:3], a[224:231], v131
    ds_read_b128 v[28:31], v140 offset:7168
    v_smfmac_f32_16x16x64_bf16 v[48:51], v[4:7], a[168:175], v131
    s_waitcnt lgkmcnt(3)
    ds_read_b128 v[68:71], v134 offset:19456
    v_smfmac_f32_16x16x64_bf16 v[32:35], v[16:19], a[16:23], v131
    s_waitcnt lgkmcnt(3)
    ds_read_b128 v[72:75], v134 offset:20480
    v_smfmac_f32_16x16x64_bf16 v[32:35], v[20:23], v[80:87], v131
    s_waitcnt lgkmcnt(3)
    ds_read_b128 v[76:79], v134 offset:21504
    v_smfmac_f32_16x16x64_bf16 v[32:35], v[24:27], a[24:31], v131
    s_waitcnt lgkmcnt(3)
    ds_read_b128 v[80:83], v134 offset:22528
    v_smfmac_f32_16x16x64_bf16 v[32:35], v[28:31], a[32:39], v131
    s_waitcnt lgkmcnt(9)
    ds_read_b128 v[84:87], v134 offset:23552
    buffer_store_dword v116, v142, s[36:39], s54 offen sc1
    v_smfmac_f32_16x16x64_bf16 v[36:39], v[16:19], v[56:63], v131
    v_smfmac_f32_16x16x64_bf16 v[36:39], v[20:23], a[56:63], v131
    buffer_store_dword v124, v142, s[36:39], s47 offen sc1
    v_add_f32 v32, v32, v34
    v_smfmac_f32_16x16x64_bf16 v[36:39], v[24:27], a[64:71], v131
    v_add_f32 v33, v33, v35
    v_smfmac_f32_16x16x64_bf16 v[36:39], v[28:31], a[72:79], v131
    s_waitcnt lgkmcnt(4)
    v_smfmac_f32_16x16x64_bf16 v[40:43], v[16:19], v[64:71], v131
    v_mov_b64 v[68:69], s[68:69]
    v_smfmac_f32_16x16x64_bf16 v[40:43], v[20:23], a[96:103], v131
    v_add_f32 v36, v36, v38
    v_add_f32 v37, v37, v39
    v_smfmac_f32_16x16x64_bf16 v[40:43], v[24:27], a[104:111], v131
    s_waitcnt lgkmcnt(2)
    v_cvt_pk_bf16_f32 v32, v32, v36
    v_cvt_pk_bf16_f32 v33, v33, v37
    v_smfmac_f32_16x16x64_bf16 v[40:43], v[28:31], v[72:79], v131
    ds_write2_b32 v135, v32, v33 offset0:0 offset1:4
    v_smfmac_f32_16x16x64_bf16 v[44:47], v[16:19], a[144:151], v131
    ds_read_b128 v[72:75], v134 offset:24576
    v_mov_b64 v[70:71], s[68:69]
    v_smfmac_f32_16x16x64_bf16 v[44:47], v[20:23], a[152:159], v131
    ds_read_b128 v[76:79], v134 offset:25600
    v_add_f32 v40, v40, v42
    v_smfmac_f32_16x16x64_bf16 v[44:47], v[24:27], a[160:167], v131
    s_waitcnt lgkmcnt(3)
    v_add_f32 v41, v41, v43
    v_smfmac_f32_16x16x64_bf16 v[44:47], v[28:31], v[80:87], v131
    ds_read_b128 v[80:83], v134 offset:26624
    v_smfmac_f32_16x16x64_bf16 v[52:55], v[4:7], a[232:239], v131
    s_waitcnt lgkmcnt(3)
    s_barrier
    ds_read_b128 v[112:115], v136 offset:8192
    v_smfmac_f32_16x16x64_bf16 v[48:51], v[8:11], a[176:183], v131
    ds_read_b128 v[116:119], v136 offset:9216
    v_add_f32 v44, v44, v46
    v_smfmac_f32_16x16x64_bf16 v[52:55], v[8:11], a[240:247], v131
    ds_read_b128 v[120:123], v136 offset:10240
    v_add_f32 v45, v45, v47
    v_cvt_pk_bf16_f32 v40, v40, v44
    v_smfmac_f32_16x16x64_bf16 v[48:51], v[12:15], a[184:191], v131
    ds_read_b128 v[124:127], v136 offset:11264
    v_cvt_pk_bf16_f32 v41, v41, v45
    v_smfmac_f32_16x16x64_bf16 v[52:55], v[12:15], a[248:255], v131
    s_waitcnt lgkmcnt(3)
    ds_write2_b32 v135, v40, v41 offset0:128 offset1:132
    v_mfma_f32_16x16x32_bf16 v[32:35], v[88:91], v[112:115], 0
    s_waitcnt lgkmcnt(3)
    ds_read_b128 v[84:87], v134 offset:27648
    v_mfma_f32_16x16x32_bf16 v[32:35], v[92:95], v[116:119], v[32:35]
    s_waitcnt lgkmcnt(3)
    v_mfma_f32_16x16x32_bf16 v[32:35], v[96:99], v[120:123], v[32:35]
    s_waitcnt lgkmcnt(2)
    v_mfma_f32_16x16x32_bf16 v[32:35], v[100:103], v[124:127], v[32:35]
    s_waitcnt lgkmcnt(1)
    s_barrier
    ds_read_b128 v[0:3], v137 offset:8704
    v_smfmac_f32_16x16x64_bf16 v[48:51], v[16:19], a[192:199], v131
    ds_read_b128 v[4:7], v137 offset:9728
    v_smfmac_f32_16x16x64_bf16 v[48:51], v[20:23], a[200:207], v131
    ds_read_b128 v[8:11], v137 offset:10752
    v_exp_f32 v36, v32
    v_smfmac_f32_16x16x64_bf16 v[48:51], v[24:27], a[208:215], v131
    s_waitcnt lgkmcnt(2)
    ds_read_b128 v[12:15], v137 offset:11776
    v_exp_f32 v37, v33
    v_mfma_f32_16x16x32_bf16 v[44:47], v[0:3], v[112:115], 0
    s_waitcnt lgkmcnt(2)
    v_cvt_pk_bf16_f32 v36, v36, v37
    v_mfma_f32_16x16x32_bf16 v[44:47], v[4:7], v[116:119], v[44:47]
    s_waitcnt lgkmcnt(1)
    ds_write_b32 v136, v36 offset:12804
    v_mfma_f32_16x16x32_bf16 v[44:47], v[8:11], v[120:123], v[44:47]
    s_waitcnt lgkmcnt(1)
    v_mov_b64 v[0:1], 0
    v_mov_b64 v[2:3], 0
    v_mfma_f32_16x16x32_bf16 v[44:47], v[12:15], v[124:127], v[44:47]
    v_mov_b64 v[4:5], 0
    v_mov_b64 v[6:7], 0
    v_smfmac_f32_16x16x64_bf16 v[48:51], v[28:31], a[216:223], v131
    buffer_load_dwordx4 v[88:91], v137, s[36:39], s50 offen offset:0 sc1
    v_mov_b64 v[8:9], 0
    v_smfmac_f32_16x16x64_bf16 v[52:55], v[16:19], v[224:231], v131
    s_waitcnt lgkmcnt(0)
    s_barrier
    ds_read_b128 v[64:67], v136 offset:12800
    buffer_load_dwordx4 v[92:95], v137, s[36:39], s50 offen offset:1024 sc1
    v_exp_f32 v46, v44
    v_smfmac_f32_16x16x64_bf16 v[52:55], v[20:23], v[232:239], v131
    ds_read_b128 v[56:59], v138 offset:12800
    buffer_load_dwordx4 v[96:99], v137, s[36:39], s50 offen offset:2048 sc1
    v_add_f32 v48, v48, v50
    v_exp_f32 v47, v45
    v_smfmac_f32_16x16x64_bf16 v[52:55], v[24:27], v[240:247], v131
    ds_read_b128 v[60:63], v138 offset:12288
    v_add_f32 v49, v49, v51
    v_cvt_pk_bf16_f32 v46, v46, v47
    v_smfmac_f32_16x16x64_bf16 v[52:55], v[28:31], v[248:255], v131
    s_waitcnt lgkmcnt(2)
    buffer_load_dwordx4 v[100:103], v137, s[36:39], s50 offen offset:3072 sc1
    v_cvt_pk_bf16_f32 v48, v48, v49
    v_mfma_f32_16x16x32_bf16 v[36:39], v[68:71], v[64:67], 0
    s_waitcnt lgkmcnt(1)
    v_cndmask_b32 v50, 0, v46, s[70:71]
    v_cndmask_b32 v51, v46, 0, s[70:71]
    v_mfma_f32_16x16x32_bf16 v[40:43], v[104:107], v[56:59], 0
    s_waitcnt lgkmcnt(0)
    v_add_f32 v52, v52, v54
    v_add_f32 v53, v53, v55
    v_mfma_f32_16x16x32_bf16 v[40:43], v[108:111], v[60:63], v[40:43]
    v_cvt_pk_bf16_f32 v49, v52, v53
    v_mfma_f32_16x16x16_bf16 v[36:39], v[68:69], v[50:51], v[36:39]
    v_mfma_f32_16x16x16_bf16 v[40:43], v[48:49], v[50:51], v[40:43]
    s_nop 3
    v_rcp_f32 v46, v36
    v_mov_b64 v[10:11], 0
    v_mov_b64 v[12:13], 0
    s_nop 0
    v_pk_mul_f32 v[40:41], v[40:41], v[46:47] op_sel_hi:[1,0]
    v_pk_mul_f32 v[42:43], v[42:43], v[46:47] op_sel_hi:[1,0]
    v_cvt_pk_bf16_f32 v40, v40, v41
    v_cvt_pk_bf16_f32 v41, v42, v43
    ds_write_b64 v139, v[40:41] offset:14336
    v_subrev_u32 v47, s74, v36
    v_cmp_lt_u32 vcc, s75, v47
    v_mov_b64 v[14:15], 0
    s_cbranch_vccnz L_c1_w1_fb
L_c1_w1_fbret:
    buffer_load_dwordx4 v[104:107], v140, s[36:39], s51 offen offset:0 sc1
    buffer_load_dwordx4 v[108:111], v140, s[36:39], s51 offen offset:1024 sc1
    s_waitcnt lgkmcnt(0)
    s_barrier
    ds_read_b128 v[112:115], v137 offset:13824
    ds_read_b128 v[116:119], v137 offset:14336
    ds_read_b128 v[120:123], v137 offset:14848
    ds_read_b128 v[124:127], v137 offset:15360
    s_waitcnt lgkmcnt(3)
    v_smfmac_f32_16x16x64_bf16 v[0:3], v[112:115], v[144:151], v131
    s_waitcnt lgkmcnt(2)
    v_smfmac_f32_16x16x64_bf16 v[0:3], v[116:119], v[152:159], v131
    s_waitcnt lgkmcnt(1)
    ds_read_b128 v[56:59], v134 offset:28672
    v_smfmac_f32_16x16x64_bf16 v[0:3], v[120:123], v[160:167], v131
    s_waitcnt lgkmcnt(1)
    ds_read_b128 v[60:63], v134 offset:29696
    v_smfmac_f32_16x16x64_bf16 v[0:3], v[124:127], v[168:175], v131
    s_add_u32 s84, s48, 4096
    ds_read_b128 v[64:67], v134 offset:30720
    v_smfmac_f32_16x16x64_bf16 v[4:7], v[112:115], v[176:183], v131
    ds_read_b128 v[68:71], v134 offset:31744
    v_smfmac_f32_16x16x64_bf16 v[4:7], v[116:119], v[72:79], v131
    ds_read_b128 v[72:75], v134 offset:32768
    v_cvt_pk_bf16_f32 v16, v0, v2
    v_cvt_pk_bf16_f32 v17, v1, v3
    v_smfmac_f32_16x16x64_bf16 v[4:7], v[120:123], v[184:191], v131
    ds_read_b128 v[76:79], v134 offset:33792
    v_bfi_b32 v16, 1, s87, v16
    v_bfi_b32 v17, 1, s87, v17
    v_smfmac_f32_16x16x64_bf16 v[4:7], v[124:127], v[80:87], v131
    ds_read_b128 v[80:83], v134 offset:34816
    buffer_store_dwordx2 v[16:17], v132, s[36:39], s48 offen offset:0 sc1
    v_smfmac_f32_16x16x64_bf16 v[8:11], v[112:115], v[192:199], v131
    s_waitcnt lgkmcnt(5)
    ds_read_b128 v[84:87], v134 offset:35840
    v_smfmac_f32_16x16x64_bf16 v[8:11], v[116:119], v[56:63], v131
    v_cvt_pk_bf16_f32 v18, v4, v6
    v_cvt_pk_bf16_f32 v19, v5, v7
    v_bfi_b32 v18, 1, s87, v18
    v_bfi_b32 v19, 1, s87, v19
    v_smfmac_f32_16x16x64_bf16 v[8:11], v[120:123], v[200:207], v131
    s_waitcnt lgkmcnt(4)
    buffer_store_dwordx2 v[18:19], v132, s[36:39], s48 offen offset:2048 sc1
    v_smfmac_f32_16x16x64_bf16 v[8:11], v[124:127], v[64:71], v131
    v_smfmac_f32_16x16x64_bf16 v[12:15], v[112:115], v[208:215], v131
    s_waitcnt lgkmcnt(2)
    v_smfmac_f32_16x16x64_bf16 v[12:15], v[116:119], v[72:79], v131
    v_cvt_pk_bf16_f32 v20, v8, v10
    v_smfmac_f32_16x16x64_bf16 v[12:15], v[120:123], v[216:223], v131
    s_waitcnt lgkmcnt(0)
    v_cvt_pk_bf16_f32 v21, v9, v11
    v_smfmac_f32_16x16x64_bf16 v[12:15], v[124:127], v[80:87], v131
    v_bfi_b32 v20, 1, s87, v20
    v_bfi_b32 v21, 1, s87, v21
    buffer_store_dwordx2 v[20:21], v132, s[36:39], s84 offen offset:0 sc1
    s_nop 3
    v_cvt_pk_bf16_f32 v22, v12, v14
    v_cvt_pk_bf16_f32 v23, v13, v15
    v_bfi_b32 v22, 1, s87, v22
    v_bfi_b32 v23, 1, s87, v23
    buffer_store_dwordx2 v[22:23], v132, s[36:39], s84 offen offset:2048 sc1
    v_mov_b64 v[40:41], 0
    v_mov_b64 v[42:43], 0
    v_mov_b64 v[44:45], 0
    v_mov_b64 v[46:47], 0
    v_mov_b64 v[48:49], 0
    v_mov_b64 v[50:51], 0
    v_mov_b64 v[52:53], 0
    v_mov_b64 v[54:55], 0
    ds_read_b128 v[56:59], v134 offset:0
    ds_read_b128 v[60:63], v134 offset:1024
    ds_read_b128 v[64:67], v134 offset:2048
    ds_read_b128 v[68:71], v134 offset:3072
    ds_read_b128 v[72:75], v134 offset:4096
    ds_read_b128 v[76:79], v134 offset:5120
    ds_read_b128 v[80:83], v134 offset:6144
    ds_read_b128 v[84:87], v134 offset:7168
    s_sub_u32 s95, s79, s48
    s_mov_b32 s82, s49
    s_mov_b32 s49, s48
    s_mov_b32 s48, s79
    s_mov_b32 s79, s49
    s_add_u32 s52, s52, 0x80000
    s_mov_b32 s91, 0
    s_add_u32 s50, s50, 524288
    s_add_u32 s51, s51, 524288
    s_nop 7
    s_nop 0
    buffer_load_dword v32, v141, s[36:39], s57 offen sc1
    buffer_load_dword v33, v141, s[36:39], s58 offen sc1
    buffer_load_dword v34, v141, s[36:39], s59 offen sc1
    buffer_load_dword v35, v141, s[36:39], s60 offen sc1
    buffer_load_dword v36, v141, s[36:39], s61 offen sc1
    buffer_load_dword v37, v141, s[36:39], s62 offen sc1
    buffer_load_dword v38, v141, s[36:39], s63 offen sc1
    buffer_load_dword v39, v141, s[36:39], s64 offen sc1
    s_mov_b32 s80, s47
    s_mov_b32 s47, s45
    s_mov_b32 s45, s46
    s_mov_b32 s46, s80
    s_add_u32 s53, s53, 8192
    s_mov_b32 s54, s53
    s_add_u32 s44, s44, 1
    v_mov_b32 v112, v143
    v_mov_b32 v113, v143
    v_mov_b32 v114, v143
    v_mov_b32 v115, v143
    v_mov_b32 v2, s44
    s_waitcnt vmcnt(4)
L_c1_w1_p2w:
    v_mfma_f32_16x16x32_bf16 v[116:119], v[112:115], v[32:35], 0
    v_bitop3_b32 v0, v32, v33, s87 bitop3:0x7e
    v_bitop3_b32 v1, v34, v35, s87 bitop3:0x7e
    s_waitcnt vmcnt(0)
    v_mfma_f32_16x16x32_bf16 v[116:119], v[112:115], v[36:39], v[116:119]
    v_bitop3_b32 v3, v36, v37, s87 bitop3:0x7e
    v_bitop3_b32 v4, v38, v39, s87 bitop3:0x7e
    v_or3_b32 v0, v0, v1, v3
    v_bitop3_b32 v0, v0, v4, 1 bitop3:0xa8
    v_cmp_ne_u32 vcc, 0, v0
    s_cbranch_vccnz L_c1_w1_p2retry
L_c1_w1_p2ok:
    s_nop 0
    v_cvt_pk_bf16_f32 v116, v116, v117
    buffer_store_dword v116, v142, s[36:39], s45 offen sc1
    s_cmp_eq_u32 s44, 63
    s_cbranch_scc1 L_c1_fin
    s_nop 2
    buffer_store_dword v2, off, s[36:39], s90 sc1
    v_mov_b64 v[32:33], 0
    v_mov_b64 v[34:35], 0
    v_mov_b64 v[36:37], 0
    v_mov_b64 v[38:39], 0
    v_cmp_le_u32 vcc, 32, v128
    s_and_b32 s80, vcc_lo, 0xffff
    s_ff0_i32_b32 s80, s80
    s_max_u32 s56, s56, s80
    s_add_u32 s80, s44, 4
    s_lshr_b32 s80, s80, 2
    s_min_u32 s80, s80, 15
    s_cmp_lt_u32 s80, s56
    s_cselect_b32 s55, s88, s89
    s_add_u32 s80, s44, 2
    s_lshr_b32 s80, s80, 2
    s_min_u32 s80, s80, 15
    s_cmp_lt_u32 s80, s56
    s_cbranch_scc0 L_c1_w1_kvwait
L_c1_w1_kvok:
    v_add_u32 v141, s95, v141
    s_bfe_i32 s87, s44, 0x10001
    s_nop 7
    s_nop 5
    buffer_load_dword v114, v133, s[36:39], s65 offen sc1
    buffer_load_dwordx4 v140, s[36:39], s45 offen sc1 lds
    buffer_load_dwordx4 v140, s[36:39], s45 offen offset:1024 sc1 lds
    s_nop 7
    s_nop 7
    s_nop 7
    buffer_load_dword v115, v133, s[36:39], s65 offen sc1
    buffer_load_dwordx4 v140, s[36:39], s45 offen sc1 lds
    buffer_load_dwordx4 v140, s[36:39], s45 offen offset:1024 sc1 lds
    s_branch L_c1_w1_step
L_c1_w1_spinA:
    buffer_load_dword v114, v133, s[36:39], s65 offen sc1
    buffer_load_dwordx4 v140, s[36:39], s45 offen sc1 lds
    buffer_load_dwordx4 v140, s[36:39], s45 offen offset:1024 sc1 lds
    s_waitcnt vmcnt(5)
    v_cmp_ne_u32 vcc, s44, v115
    s_cbranch_vccz L_c1_w1_spunA
    buffer_load_dword v115, v133, s[36:39], s65 offen sc1
    buffer_load_dwordx4 v140, s[36:39], s45 offen sc1 lds
    buffer_load_dwordx4 v140, s[36:39], s45 offen offset:1024 sc1 lds
    s_branch L_c1_w1_spin0
L_c1_w1_spunA:
    s_waitcnt vmcnt(3)
    s_branch L_c1_w1_hit
L_c1_w1_spin0:
    s_waitcnt vmcnt(5)
    v_cmp_ne_u32 vcc, s44, v114
    s_cbranch_vccz L_c1_w1_spun
L_c1_w1_spin1:
    buffer_load_dword v114, v133, s[36:39], s65 offen sc1
    buffer_load_dwordx4 v140, s[36:39], s45 offen sc1 lds
    buffer_load_dwordx4 v140, s[36:39], s45 offen offset:1024 sc1 lds
    s_waitcnt vmcnt(5)
    v_cmp_ne_u32 vcc, s44, v115
    s_cbranch_vccz L_c1_w1_spun
    buffer_load_dword v115, v133, s[36:39], s65 offen sc1
    buffer_load_dwordx4 v140, s[36:39], s45 offen sc1 lds
    buffer_load_dwordx4 v140, s[36:39], s45 offen offset:1024 sc1 lds
    s_sub_u32 s100, s100, 1
    s_mov_b32 s101, 12
    s_cbranch_scc1 L_fail
    s_branch L_c1_w1_spin0
L_c1_w1_spun:
    s_waitcnt vmcnt(3)
    s_branch L_c1_w1_hit
L_c1_w1_redo:
    s_mov_b32 s91, 1
    s_mov_b32 s54, 0x80000000
    s_sub_u32 s50, s50, 0x80000
    buffer_load_dwordx4 v[88:91], v137, s[36:39], s50 offen offset:0 sc1
    buffer_load_dwordx4 v[92:95], v137, s[36:39], s50 offen offset:1024 sc1
    buffer_load_dwordx4 v[96:99], v137, s[36:39], s50 offen offset:2048 sc1
    buffer_load_dwordx4 v[100:103], v137, s[36:39], s50 offen offset:3072 sc1
    s_add_u32 s50, s50, 0x80000
L_c1_w1_redo1:
    s_waitcnt vmcnt(0) lgkmcnt(0)
    s_barrier
    s_sub_u32 s100, s100, 1
    s_mov_b32 s101, 13
    s_cbranch_scc1 L_fail
    buffer_load_dwordx4 v140, s[36:39], s45 offen sc1 lds
    buffer_load_dwordx4 v140, s[36:39], s45 offen offset:1024 sc1 lds
    s_waitcnt vmcnt(0)
    s_barrier
    ds_read_b128 v[0:3], v140 offset:0
    ds_read_b128 v[4:7], v140 offset:1024
    ds_read_b128 v[8:11], v140 offset:2048
    ds_read_b128 v[12:15], v140 offset:3072
    ds_read_b128 v[16:19], v140 offset:4096
    ds_read_b128 v[20:23], v140 offset:5120
    ds_read_b128 v[24:27], v140 offset:6144
    ds_read_b128 v[28:31], v140 offset:7168
    s_waitcnt lgkmcnt(0)
    v_cmp_eq_u32 vcc, s66, v0
    s_cbranch_vccnz L_c1_w1_redo1
    v_cmp_eq_u32 vcc, s66, v1
    s_cbranch_vccnz L_c1_w1_redo1
    v_cmp_eq_u32 vcc, s66, v2
    s_cbranch_vccnz L_c1_w1_redo1
    v_cmp_eq_u32 vcc, s66, v3
    s_cbranch_vccnz L_c1_w1_redo1
    v_cmp_eq_u32 vcc, s66, v4
    s_cbranch_vccnz L_c1_w1_redo1
    v_cmp_eq_u32 vcc, s66, v5
    s_cbranch_vccnz L_c1_w1_redo1
    v_cmp_eq_u32 vcc, s66, v6
    s_cbranch_vccnz L_c1_w1_redo1
    v_cmp_eq_u32 vcc, s66, v7
    s_cbranch_vccnz L_c1_w1_redo1
    v_cmp_eq_u32 vcc, s66, v8
    s_cbranch_vccnz L_c1_w1_redo1
    v_cmp_eq_u32 vcc, s66, v9
    s_cbranch_vccnz L_c1_w1_redo1
    v_cmp_eq_u32 vcc, s66, v10
    s_cbranch_vccnz L_c1_w1_redo1
    v_cmp_eq_u32 vcc, s66, v11
    s_cbranch_vccnz L_c1_w1_redo1
    v_cmp_eq_u32 vcc, s66, v12
    s_cbranch_vccnz L_c1_w1_redo1
    v_cmp_eq_u32 vcc, s66, v13
    s_cbranch_vccnz L_c1_w1_redo1
    v_cmp_eq_u32 vcc, s66, v14
    s_cbranch_vccnz L_c1_w1_redo1
    v_cmp_eq_u32 vcc, s66, v15
    s_cbranch_vccnz L_c1_w1_redo1
    v_cmp_eq_u32 vcc, s66, v16
    s_cbranch_vccnz L_c1_w1_redo1
    v_cmp_eq_u32 vcc, s66, v17
    s_cbranch_vccnz L_c1_w1_redo1
    v_cmp_eq_u32 vcc, s66, v18
    s_cbranch_vccnz L_c1_w1_redo1
    v_cmp_eq_u32 vcc, s66, v19
    s_cbranch_vccnz L_c1_w1_redo1
    v_cmp_eq_u32 vcc, s66, v20
    s_cbranch_vccnz L_c1_w1_redo1
    v_cmp_eq_u32 vcc, s66, v21
    s_cbranch_vccnz L_c1_w1_redo1
    v_cmp_eq_u32 vcc, s66, v22
    s_cbranch_vccnz L_c1_w1_redo1
    v_cmp_eq_u32 vcc, s66, v23
    s_cbranch_vccnz L_c1_w1_redo1
    v_cmp_eq_u32 vcc, s66, v24
    s_cbranch_vccnz L_c1_w1_redo1
    v_cmp_eq_u32 vcc, s66, v25
    s_cbranch_vccnz L_c1_w1_redo1
    v_cmp_eq_u32 vcc, s66, v26
    s_cbranch_vccnz L_c1_w1_redo1
    v_cmp_eq_u32 vcc, s66, v27
    s_cbranch_vccnz L_c1_w1_redo1
    v_cmp_eq_u32 vcc, s66, v28
    s_cbranch_vccnz L_c1_w1_redo1
    v_cmp_eq_u32 vcc, s66, v29
    s_cbranch_vccnz L_c1_w1_redo1
    v_cmp_eq_u32 vcc, s66, v30
    s_cbranch_vccnz L_c1_w1_redo1
    v_cmp_eq_u32 vcc, s66, v31
    s_cbranch_vccnz L_c1_w1_redo1
    ds_read_b128 v[56:59], v134 offset:0
    ds_read_b128 v[60:63], v134 offset:1024
    ds_read_b128 v[64:67], v134 offset:2048
    ds_read_b128 v[68:71], v134 offset:3072
    ds_read_b128 v[72:75], v134 offset:4096
    ds_read_b128 v[76:79], v134 offset:5120
    ds_read_b128 v[80:83], v134 offset:6144
    ds_read_b128 v[84:87], v134 offset:7168
    v_mov_b64 v[32:33], 0
    v_mov_b64 v[34:35], 0
    v_mov_b64 v[36:37], 0
    v_mov_b64 v[38:39], 0
    v_mov_b64 v[40:41], 0
    v_mov_b64 v[42:43], 0
    v_mov_b64 v[44:45], 0
    v_mov_b64 v[46:47], 0
    v_mov_b64 v[48:49], 0
    v_mov_b64 v[50:51], 0
    v_mov_b64 v[52:53], 0
    v_mov_b64 v[54:55], 0
    v_mov_b32 v114, s44
    v_mov_b32 v115, s44
    v_mov_b32 v115, s44
    s_branch L_c1_w1_step
L_c1_w1_p2slow:
    v_cmp_eq_u32 vcc, s66, v32
    s_cbranch_vccnz L_c1_w1_p2retry
    v_cmp_eq_u32 vcc, s66, v33
    s_cbranch_vccnz L_c1_w1_p2retry
    v_cmp_eq_u32 vcc, s66, v34
    s_cbranch_vccnz L_c1_w1_p2retry
    v_cmp_eq_u32 vcc, s66, v35
    s_cbranch_vccnz L_c1_w1_p2retry
    v_cmp_eq_u32 vcc, s66, v36
    s_cbranch_vccnz L_c1_w1_p2retry
    v_cmp_eq_u32 vcc, s66, v37
    s_cbranch_vccnz L_c1_w1_p2retry
    v_cmp_eq_u32 vcc, s66, v38
    s_cbranch_vccnz L_c1_w1_p2retry
    v_cmp_eq_u32 vcc, s66, v39
    s_cbranch_vccnz L_c1_w1_p2retry
    s_branch L_c1_w1_p2ok
L_c1_w1_p2retry:
    s_sub_u32 s100, s100, 1
    s_mov_b32 s101, 14
    s_cbranch_scc1 L_fail
    buffer_load_dword v32, v141, s[36:39], s57 offen sc1
    buffer_load_dword v33, v141, s[36:39], s58 offen sc1
    buffer_load_dword v34, v141, s[36:39], s59 offen sc1
    buffer_load_dword v35, v141, s[36:39], s60 offen sc1
    buffer_load_dword v36, v141, s[36:39], s61 offen sc1
    buffer_load_dword v37, v141, s[36:39], s62 offen sc1
    buffer_load_dword v38, v141, s[36:39], s63 offen sc1
    buffer_load_dword v39, v141, s[36:39], s64 offen sc1
    s_waitcnt vmcnt(0)
    s_branch L_c1_w1_p2w
L_c1_w1_kvwait:
    s_mov_b32 s82, 0x40000
    v_lshlrev_b32 v128, 2, v140
    s_waitcnt vmcnt(0)
    buffer_load_dword v128, v128, s[36:39], s82 offen sc1
    s_waitcnt vmcnt(0)
    v_cmp_le_u32 vcc, 32, v128
    s_and_b32 s82, vcc_lo, 0xffff
    s_ff0_i32_b32 s56, s82
    s_cmp_lt_u32 s80, s56
    s_cbranch_scc1 L_c1_w1_kvwait_ok
    s_sub_u32 s100, s100, 1
    s_mov_b32 s101, 15
    s_cbranch_scc1 L_fail
    s_branch L_c1_w1_kvwait
L_c1_w1_kvwait_ok:
    s_branch L_c1_w1_kvok
L_c1_w1_fb:
    s_cmp_eq_u32 s91, 0
    s_cbranch_scc0 L_c1_w1_fb1
    v_cmp_u_f32 vcc, v36, v36
    s_cbranch_vccnz L_c1_w1_redo
L_c1_w1_fb1:
    s_waitcnt vmcnt(0)
    s_barrier
    ds_write_b64 v140, v[32:33] offset:8
    s_waitcnt lgkmcnt(0)
    s_barrier
    ds_read_b128 v[0:3], v140 offset:0
    ds_read_b128 v[4:7], v140 offset:1024
    v_mov_b32 v8, v44
    v_mov_b32 v9, v45
    s_waitcnt lgkmcnt(0)
    v_max3_f32 v10, v0, v1, v2
    v_max3_f32 v11, v3, v4, v5
    v_max3_f32 v10, v10, v6, v7
    v_max3_f32 v11, v11, v8, v9
    v_max_f32 v10, v10, v11
    v_mov_b32 v11, v10
    s_nop 1
    v_permlane32_swap_b32 v10, v11
    v_max_f32 v10, v10, v11
    v_mov_b32 v11, v10
    s_nop 1
    v_permlane16_swap_b32 v10, v11
    v_max_f32 v10, v10, v11
    v_sub_f32 v0, v0, v10
    v_sub_f32 v1, v1, v10
    v_sub_f32 v2, v2, v10
    v_sub_f32 v3, v3, v10
    v_sub_f32 v4, v4, v10
    v_sub_f32 v5, v5, v10
    v_sub_f32 v6, v6, v10
    v_sub_f32 v7, v7, v10
    v_sub_f32 v8, v8, v10
    v_sub_f32 v9, v9, v10
    v_exp_f32 v0, v0
    v_exp_f32 v1, v1
    v_exp_f32 v2, v2
    v_exp_f32 v3, v3
    v_exp_f32 v4, v4
    v_exp_f32 v5, v5
    v_exp_f32 v6, v6
    v_exp_f32 v7, v7
    v_exp_f32 v8, v8
    v_exp_f32 v9, v9
    v_cvt_pk_bf16_f32 v64, v0, v1
    v_cvt_pk_bf16_f32 v65, v2, v3
    v_cvt_pk_bf16_f32 v66, v4, v5
    v_cvt_pk_bf16_f32 v67, v6, v7
    v_cvt_pk_bf16_f32 v8, v8, v9
    v_cndmask_b32 v56, 0, v64, s[70:71]
    v_cndmask_b32 v60, v64, 0, s[70:71]
    v_cndmask_b32 v57, 0, v65, s[70:71]
    v_cndmask_b32 v61, v65, 0, s[70:71]
    v_cndmask_b32 v58, 0, v66, s[70:71]
    v_cndmask_b32 v62, v66, 0, s[70:71]
    v_cndmask_b32 v59, 0, v67, s[70:71]
    v_cndmask_b32 v63, v67, 0, s[70:71]
    v_cndmask_b32 v50, 0, v8, s[70:71]
    v_cndmask_b32 v51, v8, 0, s[70:71]
    v_mfma_f32_16x16x32_bf16 v[36:39], v[68:71], v[64:67], 0
    v_mfma_f32_16x16x32_bf16 v[40:43], v[104:107], v[56:59], 0
    v_mfma_f32_16x16x32_bf16 v[40:43], v[108:111], v[60:63], v[40:43]
    v_mfma_f32_16x16x16_bf16 v[36:39], v[68:69], v[50:51], v[36:39]
    v_mfma_f32_16x16x16_bf16 v[40:43], v[48:49], v[50:51], v[40:43]
    v_mov_b64 v[0:1], 0
    v_mov_b64 v[2:3], 0
    v_mov_b64 v[4:5], 0
    v_mov_b64 v[6:7], 0
    v_mov_b64 v[8:9], 0
    v_mov_b64 v[10:11], 0
    v_mov_b64 v[12:13], 0
    v_mov_b64 v[14:15], 0
    v_rcp_f32 v46, v36
    s_nop 0
    v_pk_mul_f32 v[40:41], v[40:41], v[46:47] op_sel_hi:[1,0]
    v_pk_mul_f32 v[42:43], v[42:43], v[46:47] op_sel_hi:[1,0]
    v_cvt_pk_bf16_f32 v40, v40, v41
    v_cvt_pk_bf16_f32 v41, v42, v43
    ds_write_b64 v139, v[40:41] offset:14336
    s_branch L_c1_w1_fbret
L_c1_enter2:
    s_waitcnt vmcnt(0)
    .p2align 6
L_c1_w2_step:
    s_waitcnt lgkmcnt(0)
    s_barrier
    ds_read_b128 v[0:3], v140 offset:0
    ds_read_b128 v[4:7], v140 offset:1024
    buffer_load_dword v114, v133, s[36:39], s65 offen sc1
    buffer_load_dwordx4 v140, s[36:39], s45 offen sc1 lds
    buffer_load_dwordx4 v140, s[36:39], s45 offen offset:1024 sc1 lds
    s_waitcnt lgkmcnt(1)
    v_smfmac_f32_16x16x64_bf16 v[32:35], v[0:3], v[56:63], v131
    ds_read_b128 v[8:11], v140 offset:2048
    v_mov_b32 v124, s66
    v_smfmac_f32_16x16x64_bf16 v[36:39], v[0:3], a[40:47], v131
    s_waitcnt lgkmcnt(1)
    ds_read_b128 v[12:15], v140 offset:3072
    v_lshlrev_b32 v126, 2, v140
    v_smfmac_f32_16x16x64_bf16 v[40:43], v[0:3], v[64:71], v131
    ds_read_b128 v[56:59], v134 offset:8192
    v_smfmac_f32_16x16x64_bf16 v[44:47], v[0:3], a[112:119], v131
    ds_read_b128 v[60:63], v134 offset:9216
    buffer_load_dwordx3 v[128:130], v140, s[36:39], s52 offen offset:0 sc1
    v_smfmac_f32_16x16x64_bf16 v[32:35], v[4:7], v[72:79], v131
    ds_read_b128 v[64:67], v134 offset:10240
    v_smfmac_f32_16x16x64_bf16 v[36:39], v[4:7], a[48:55], v131
    ds_read_b128 v[68:71], v134 offset:11264
    v_smfmac_f32_16x16x64_bf16 v[40:43], v[4:7], v[80:87], v131
    ds_read_b128 v[72:75], v134 offset:12288
    buffer_load_dwordx3 v[128:130], v140, s[36:39], s52 offen offset:1024 sc1
    v_smfmac_f32_16x16x64_bf16 v[44:47], v[4:7], a[120:127], v131
    s_waitcnt lgkmcnt(6)
    ds_read_b128 v[76:79], v134 offset:13312
    v_smfmac_f32_16x16x64_bf16 v[32:35], v[8:11], a[0:7], v131
    s_waitcnt lgkmcnt(4)
    ds_read_b128 v[80:83], v134 offset:14336
    v_smfmac_f32_16x16x64_bf16 v[36:39], v[8:11], v[56:63], v131
    ds_read_b128 v[84:87], v134 offset:15360
    buffer_load_dwordx3 v[128:130], v140, s[36:39], s52 offen offset:2048 sc1
    v_smfmac_f32_16x16x64_bf16 v[40:43], v[8:11], a[80:87], v131
    ds_read_b128 v[56:59], v134 offset:16384
    v_smfmac_f32_16x16x64_bf16 v[44:47], v[8:11], a[128:135], v131
    s_waitcnt lgkmcnt(9)
    ds_read_b128 v[60:63], v134 offset:17408
    v_smfmac_f32_16x16x64_bf16 v[32:35], v[12:15], a[8:15], v131
    s_waitcnt lgkmcnt(6)
    buffer_load_dwordx3 v[128:130], v140, s[36:39], s52 offen offset:3072 sc1
    v_smfmac_f32_16x16x64_bf16 v[36:39], v[12:15], v[64:71], v131
    s_waitcnt vmcnt(6)
    v_cmp_ne_u32 vcc, s44, v114
    s_cbranch_vccnz L_c1_w2_spin1
L_c1_w2_hit:
    v_smfmac_f32_16x16x64_bf16 v[40:43], v[12:15], a[88:95], v131
    s_waitcnt vmcnt(4)
    s_barrier
    ds_read_b128 v[16:19], v140 offset:4096
    v_smfmac_f32_16x16x64_bf16 v[44:47], v[12:15], a[136:143], v131
    s_waitcnt lgkmcnt(5)
    ds_read_b128 v[20:23], v140 offset:5120
    buffer_load_dword v128, v126, s[36:39], s55 offen sc1
    v_smfmac_f32_16x16x64_bf16 v[48:51], v[0:3], v[72:79], v131
    ds_read_b128 v[24:27], v140 offset:6144
    v_smfmac_f32_16x16x64_bf16 v[52:55], v[0:3], a[224:231], v131
    ds_read_b128 v[28:31], v140 offset:7168
    v_smfmac_f32_16x16x64_bf16 v[48:51], v[4:7], a[168:175], v131
    s_waitcnt lgkmcnt(3)
    ds_read_b128 v[64:67], v134 offset:18432
    v_smfmac_f32_16x16x64_bf16 v[32:35], v[16:19], a[16:23], v131
    s_waitcnt lgkmcnt(3)
    ds_read_b128 v[68:71], v134 offset:19456
    v_smfmac_f32_16x16x64_bf16 v[32:35], v[20:23], v[80:87], v131
    s_waitcnt lgkmcnt(3)
    ds_read_b128 v[72:75], v134 offset:20480
    v_smfmac_f32_16x16x64_bf16 v[32:35], v[24:27], a[24:31], v131
    s_waitcnt lgkmcnt(3)
    ds_read_b128 v[76:79], v134 offset:21504
    v_smfmac_f32_16x16x64_bf16 v[32:35], v[28:31], a[32:39], v131
    s_waitcnt lgkmcnt(8)
    ds_read_b128 v[80:83], v134 offset:22528
    buffer_store_dword v116, v142, s[36:39], s54 offen sc1
    v_smfmac_f32_16x16x64_bf16 v[36:39], v[16:19], v[56:63], v131
    ds_read_b128 v[84:87], v134 offset:23552
    v_smfmac_f32_16x16x64_bf16 v[36:39], v[20:23], a[56:63], v131
    buffer_store_dword v124, v142, s[36:39], s47 offen sc1
    v_add_f32 v32, v32, v34
    v_smfmac_f32_16x16x64_bf16 v[36:39], v[24:27], a[64:71], v131
    v_add_f32 v33, v33, v35
    v_smfmac_f32_16x16x64_bf16 v[36:39], v[28:31], a[72:79], v131
    s_waitcnt lgkmcnt(4)
    v_smfmac_f32_16x16x64_bf16 v[40:43], v[16:19], v[64:71], v131
    v_mov_b64 v[68:69], s[68:69]
    v_smfmac_f32_16x16x64_bf16 v[40:43], v[20:23], a[96:103], v131
    v_add_f32 v36, v36, v38
    v_add_f32 v37, v37, v39
    v_smfmac_f32_16x16x64_bf16 v[40:43], v[24:27], a[104:111], v131
    s_waitcnt lgkmcnt(2)
    v_cvt_pk_bf16_f32 v32, v32, v36
    v_cvt_pk_bf16_f32 v33, v33, v37
    v_smfmac_f32_16x16x64_bf16 v[40:43], v[28:31], v[72:79], v131
    ds_write2_b32 v135, v32, v33 offset0:0 offset1:4
    v_smfmac_f32_16x16x64_bf16 v[44:47], v[16:19], a[144:151], v131
    ds_read_b128 v[72:75], v134 offset:24576
    v_mov_b64 v[70:71], s[68:69]
    v_smfmac_f32_16x16x64_bf16 v[44:47], v[20:23], a[152:159], v131
    ds_read_b128 v[76:79], v134 offset:25600
    v_add_f32 v40, v40, v42
    v_smfmac_f32_16x16x64_bf16 v[44:47], v[24:27], a[160:167], v131
    s_waitcnt lgkmcnt(3)
    v_add_f32 v41, v41, v43
    v_smfmac_f32_16x16x64_bf16 v[44:47], v[28:31], v[80:87], v131
    ds_read_b128 v[80:83], v134 offset:26624
    v_smfmac_f32_16x16x64_bf16 v[52:55], v[4:7], a[232:239], v131
    s_waitcnt lgkmcnt(3)
    s_barrier
    ds_read_b128 v[112:115], v136 offset:8192
    v_smfmac_f32_16x16x64_bf16 v[48:51], v[8:11], a[176:183], v131
    ds_read_b128 v[116:119], v136 offset:9216
    v_add_f32 v44, v44, v46
    v_smfmac_f32_16x16x64_bf16 v[52:55], v[8:11], a[240:247], v131
    ds_read_b128 v[120:123], v136 offset:10240
    v_add_f32 v45, v45, v47
    v_cvt_pk_bf16_f32 v40, v40, v44
    v_smfmac_f32_16x16x64_bf16 v[48:51], v[12:15], a[184:191], v131
    ds_read_b128 v[124:127], v136 offset:11264
    v_cvt_pk_bf16_f32 v41, v41, v45
    v_smfmac_f32_16x16x64_bf16 v[52:55], v[12:15], a[248:255], v131
    s_waitcnt lgkmcnt(3)
    ds_write2_b32 v135, v40, v41 offset0:128 offset1:132
    v_mfma_f32_16x16x32_bf16 v[32:35], v[88:91], v[112:115], 0
    s_waitcnt lgkmcnt(3)
    ds_read_b128 v[84:87], v134 offset:27648
    v_mfma_f32_16x16x32_bf16 v[32:35], v[92:95], v[116:119], v[32:35]
    s_waitcnt lgkmcnt(3)
    v_mfma_f32_16x16x32_bf16 v[32:35], v[96:99], v[120:123], v[32:35]
    s_waitcnt lgkmcnt(2)
    v_mfma_f32_16x16x32_bf16 v[32:35], v[100:103], v[124:127], v[32:35]
    s_waitcnt lgkmcnt(1)
    s_barrier
    ds_read_b128 v[0:3], v137 offset:8704
    buffer_load_dwordx4 v[88:91], v137, s[36:39], s50 offen offset:0 sc1
    v_smfmac_f32_16x16x64_bf16 v[48:51], v[16:19], a[192:199], v131
    ds_read_b128 v[4:7], v137 offset:9728
    v_smfmac_f32_16x16x64_bf16 v[48:51], v[20:23], a[200:207], v131
    ds_read_b128 v[8:11], v137 offset:10752
    buffer_load_dwordx4 v[92:95], v137, s[36:39], s50 offen offset:1024 sc1
    v_exp_f32 v36, v32
    v_smfmac_f32_16x16x64_bf16 v[48:51], v[24:27], a[208:215], v131
    s_waitcnt lgkmcnt(2)
    ds_read_b128 v[12:15], v137 offset:11776
    buffer_load_dwordx4 v[96:99], v137, s[36:39], s50 offen offset:2048 sc1
    v_exp_f32 v37, v33
    v_mfma_f32_16x16x32_bf16 v[44:47], v[0:3], v[112:115], 0
    s_waitcnt lgkmcnt(2)
    v_cvt_pk_bf16_f32 v36, v36, v37
    v_mfma_f32_16x16x32_bf16 v[44:47], v[4:7], v[116:119], v[44:47]
    s_waitcnt lgkmcnt(1)
    ds_write_b32 v136, v36 offset:12808
    buffer_load_dwordx4 v[100:103], v137, s[36:39], s50 offen offset:3072 sc1
    v_mfma_f32_16x16x32_bf16 v[44:47], v[8:11], v[120:123], v[44:47]
    s_waitcnt lgkmcnt(1)
    v_mov_b64 v[0:1], 0
    v_mov_b64 v[2:3], 0
    v_mfma_f32_16x16x32_bf16 v[44:47], v[12:15], v[124:127], v[44:47]
    v_mov_b64 v[4:5], 0
    v_mov_b64 v[6:7], 0
    v_smfmac_f32_16x16x64_bf16 v[48:51], v[28:31], a[216:223], v131
    v_mov_b64 v[8:9], 0
    v_smfmac_f32_16x16x64_bf16 v[52:55], v[16:19], v[224:231], v131
    s_waitcnt lgkmcnt(0)
    s_barrier
    ds_read_b128 v[64:67], v136 offset:12800
    v_exp_f32 v46, v44
    v_smfmac_f32_16x16x64_bf16 v[52:55], v[20:23], v[232:239], v131
    ds_read_b128 v[56:59], v138 offset:12800
    v_add_f32 v48, v48, v50
    v_exp_f32 v47, v45
    v_smfmac_f32_16x16x64_bf16 v[52:55], v[24:27], v[240:247], v131
    ds_read_b128 v[60:63], v138 offset:12288
    v_add_f32 v49, v49, v51
    v_cvt_pk_bf16_f32 v46, v46, v47
    v_smfmac_f32_16x16x64_bf16 v[52:55], v[28:31], v[248:255], v131
    s_waitcnt lgkmcnt(2)
    v_cvt_pk_bf16_f32 v48, v48, v49
    v_mfma_f32_16x16x32_bf16 v[36:39], v[68:71], v[64:67], 0
    s_waitcnt lgkmcnt(1)
    v_cndmask_b32 v50, 0, v46, s[70:71]
    v_cndmask_b32 v51, v46, 0, s[70:71]
    v_mfma_f32_16x16x32_bf16 v[40:43], v[104:107], v[56:59], 0
    s_waitcnt lgkmcnt(0)
    v_add_f32 v52, v52, v54
    v_add_f32 v53, v53, v55
    v_mfma_f32_16x16x32_bf16 v[40:43], v[108:111], v[60:63], v[40:43]
    v_cvt_pk_bf16_f32 v49, v52, v53
    v_mfma_f32_16x16x16_bf16 v[36:39], v[68:69], v[50:51], v[36:39]
    v_mfma_f32_16x16x16_bf16 v[40:43], v[48:49], v[50:51], v[40:43]
    s_nop 3
    v_rcp_f32 v46, v36
    v_mov_b64 v[10:11], 0
    v_mov_b64 v[12:13], 0
    s_nop 0
    v_pk_mul_f32 v[40:41], v[40:41], v[46:47] op_sel_hi:[1,0]
    v_pk_mul_f32 v[42:43], v[42:43], v[46:47] op_sel_hi:[1,0]
    v_cvt_pk_bf16_f32 v40, v40, v41
    v_cvt_pk_bf16_f32 v41, v42, v43
    ds_write_b64 v139, v[40:41] offset:14848
    v_subrev_u32 v47, s74, v36
    v_cmp_lt_u32 vcc, s75, v47
    v_mov_b64 v[14:15], 0
    s_cbranch_vccnz L_c1_w2_fb
L_c1_w2_fbret:
    buffer_load_dwordx4 v[104:107], v140, s[36:39], s51 offen offset:0 sc1
    buffer_load_dwordx4 v[108:111], v140, s[36:39], s51 offen offset:1024 sc1
    s_waitcnt lgkmcnt(0)
    s_barrier
    ds_read_b128 v[112:115], v137 offset:13824
    ds_read_b128 v[116:119], v137 offset:14336
    ds_read_b128 v[120:123], v137 offset:14848
    ds_read_b128 v[124:127], v137 offset:15360
    s_waitcnt lgkmcnt(3)
    v_smfmac_f32_16x16x64_bf16 v[0:3], v[112:115], v[144:151], v131
    s_waitcnt lgkmcnt(2)
    v_smfmac_f32_16x16x64_bf16 v[0:3], v[116:119], v[152:159], v131
    s_waitcnt lgkmcnt(1)
    ds_read_b128 v[56:59], v134 offset:28672
    v_smfmac_f32_16x16x64_bf16 v[0:3], v[120:123], v[160:167], v131
    s_waitcnt lgkmcnt(1)
    ds_read_b128 v[60:63], v134 offset:29696
    v_smfmac_f32_16x16x64_bf16 v[0:3], v[124:127], v[168:175], v131
    s_add_u32 s84, s48, 4096
    ds_read_b128 v[64:67], v134 offset:30720
    v_smfmac_f32_16x16x64_bf16 v[4:7], v[112:115], v[176:183], v131
    ds_read_b128 v[68:71], v134 offset:31744
    v_smfmac_f32_16x16x64_bf16 v[4:7], v[116:119], v[72:79], v131
    ds_read_b128 v[72:75], v134 offset:32768
    v_cvt_pk_bf16_f32 v16, v0, v2
    v_cvt_pk_bf16_f32 v17, v1, v3
    v_smfmac_f32_16x16x64_bf16 v[4:7], v[120:123], v[184:191], v131
    ds_read_b128 v[76:79], v134 offset:33792
    v_bfi_b32 v16, 1, s87, v16
    v_bfi_b32 v17, 1, s87, v17
    v_smfmac_f32_16x16x64_bf16 v[4:7], v[124:127], v[80:87], v131
    ds_read_b128 v[80:83], v134 offset:34816
    buffer_store_dwordx2 v[16:17], v132, s[36:39], s48 offen offset:0 sc1
    v_smfmac_f32_16x16x64_bf16 v[8:11], v[112:115], v[192:199], v131
    s_waitcnt lgkmcnt(5)
    ds_read_b128 v[84:87], v134 offset:35840
    v_smfmac_f32_16x16x64_bf16 v[8:11], v[116:119], v[56:63], v131
    v_cvt_pk_bf16_f32 v18, v4, v6
    v_cvt_pk_bf16_f32 v19, v5, v7
    v_bfi_b32 v18, 1, s87, v18
    v_bfi_b32 v19, 1, s87, v19
    v_smfmac_f32_16x16x64_bf16 v[8:11], v[120:123], v[200:207], v131
    s_waitcnt lgkmcnt(4)
    buffer_store_dwordx2 v[18:19], v132, s[36:39], s48 offen offset:2048 sc1
    v_smfmac_f32_16x16x64_bf16 v[8:11], v[124:127], v[64:71], v131
    v_smfmac_f32_16x16x64_bf16 v[12:15], v[112:115], v[208:215], v131
    s_waitcnt lgkmcnt(2)
    v_smfmac_f32_16x16x64_bf16 v[12:15], v[116:119], v[72:79], v131
    v_cvt_pk_bf16_f32 v20, v8, v10
    v_smfmac_f32_16x16x64_bf16 v[12:15], v[120:123], v[216:223], v131
    s_waitcnt lgkmcnt(0)
    v_cvt_pk_bf16_f32 v21, v9, v11
    v_smfmac_f32_16x16x64_bf16 v[12:15], v[124:127], v[80:87], v131
    v_bfi_b32 v20, 1, s87, v20
    v_bfi_b32 v21, 1, s87, v21
    buffer_store_dwordx2 v[20:21], v132, s[36:39], s84 offen offset:0 sc1
    s_nop 3
    v_cvt_pk_bf16_f32 v22, v12, v14
    v_cvt_pk_bf16_f32 v23, v13, v15
    v_bfi_b32 v22, 1, s87, v22
    v_bfi_b32 v23, 1, s87, v23
    buffer_store_dwordx2 v[22:23], v132, s[36:39], s84 offen offset:2048 sc1
    v_mov_b64 v[40:41], 0
    v_mov_b64 v[42:43], 0
    v_mov_b64 v[44:45], 0
    v_mov_b64 v[46:47], 0
    v_mov_b64 v[48:49], 0
    v_mov_b64 v[50:51], 0
    v_mov_b64 v[52:53], 0
    v_mov_b64 v[54:55], 0
    ds_read_b128 v[56:59], v134 offset:0
    ds_read_b128 v[60:63], v134 offset:1024
    ds_read_b128 v[64:67], v134 offset:2048
    ds_read_b128 v[68:71], v134 offset:3072
    ds_read_b128 v[72:75], v134 offset:4096
    ds_read_b128 v[76:79], v134 offset:5120
    ds_read_b128 v[80:83], v134 offset:6144
    ds_read_b128 v[84:87], v134 offset:7168
    s_sub_u32 s95, s79, s48
    s_mov_b32 s82, s49
    s_mov_b32 s49, s48
    s_mov_b32 s48, s79
    s_mov_b32 s79, s49
    s_add_u32 s52, s52, 0x80000
    s_mov_b32 s91, 0
    s_add_u32 s50, s50, 524288
    s_add_u32 s51, s51, 524288
    s_nop 7
    s_nop 7
    s_nop 7
    s_nop 7
    s_nop 7
    s_nop 2
    buffer_load_dword v32, v141, s[36:39], s57 offen sc1
    buffer_load_dword v33, v141, s[36:39], s58 offen sc1
    buffer_load_dword v34, v141, s[36:39], s59 offen sc1
    buffer_load_dword v35, v141, s[36:39], s60 offen sc1
    buffer_load_dword v36, v141, s[36:39], s61 offen sc1
    buffer_load_dword v37, v141, s[36:39], s62 offen sc1
    buffer_load_dword v38, v141, s[36:39], s63 offen sc1
    buffer_load_dword v39, v141, s[36:39], s64 offen sc1
    s_mov_b32 s80, s47
    s_mov_b32 s47, s45
    s_mov_b32 s45, s46
    s_mov_b32 s46, s80
    s_add_u32 s53, s53, 8192
    s_mov_b32 s54, s53
    s_add_u32 s44, s44, 1
    v_mov_b32 v112, v143
    v_mov_b32 v113, v143
    v_mov_b32 v114, v143
    v_mov_b32 v115, v143
    v_mov_b32 v2, s44
    s_waitcnt vmcnt(4)
L_c1_w2_p2w:
    v_mfma_f32_16x16x32_bf16 v[116:119], v[112:115], v[32:35], 0
    v_bitop3_b32 v0, v32, v33, s87 bitop3:0x7e
    v_bitop3_b32 v1, v34, v35, s87 bitop3:0x7e
    s_waitcnt vmcnt(0)
    v_mfma_f32_16x16x32_bf16 v[116:119], v[112:115], v[36:39], v[116:119]
    v_bitop3_b32 v3, v36, v37, s87 bitop3:0x7e
    v_bitop3_b32 v4, v38, v39, s87 bitop3:0x7e
    v_or3_b32 v0, v0, v1, v3
    v_bitop3_b32 v0, v0, v4, 1 bitop3:0xa8
    v_cmp_ne_u32 vcc, 0, v0
    s_cbranch_vccnz L_c1_w2_p2retry
L_c1_w2_p2ok:
    s_nop 0
    v_cvt_pk_bf16_f32 v116, v116, v117
    buffer_store_dword v116, v142, s[36:39], s45 offen sc1
    s_cmp_eq_u32 s44, 63
    s_cbranch_scc1 L_c1_fin
    s_nop 2
    buffer_store_dword v2, off, s[36:39], s90 sc1
    v_mov_b64 v[32:33], 0
    v_mov_b64 v[34:35], 0
    v_mov_b64 v[36:37], 0
    v_mov_b64 v[38:39], 0
    v_cmp_le_u32 vcc, 32, v128
    s_and_b32 s80, vcc_lo, 0xffff
    s_ff0_i32_b32 s80, s80
    s_max_u32 s56, s56, s80
    s_add_u32 s80, s44, 4
    s_lshr_b32 s80, s80, 2
    s_min_u32 s80, s80, 15
    s_cmp_lt_u32 s80, s56
    s_cselect_b32 s55, s88, s89
    s_add_u32 s80, s44, 2
    s_lshr_b32 s80, s80, 2
    s_min_u32 s80, s80, 15
    s_cmp_lt_u32 s80, s56
    s_cbranch_scc0 L_c1_w2_kvwait
L_c1_w2_kvok:
    v_add_u32 v141, s95, v141
    s_bfe_i32 s87, s44, 0x10001
    s_branch L_c1_w2_step
L_c1_w2_spin0:
    s_waitcnt vmcnt(2)
    v_cmp_ne_u32 vcc, s44, v114
    s_cbranch_vccz L_c1_w2_spun
L_c1_w2_spin1:
    buffer_load_dword v114, v133, s[36:39], s65 offen sc1
    buffer_load_dwordx4 v140, s[36:39], s45 offen sc1 lds
    buffer_load_dwordx4 v140, s[36:39], s45 offen offset:1024 sc1 lds
    s_sub_u32 s100, s100, 1
    s_mov_b32 s101, 12
    s_cbranch_scc1 L_fail
    s_branch L_c1_w2_spin0
L_c1_w2_spun:
    s_waitcnt vmcnt(0)
    s_branch L_c1_w2_hit
L_c1_w2_redo:
    s_mov_b32 s91, 1
    s_mov_b32 s54, 0x80000000
    s_sub_u32 s50, s50, 0x80000
    buffer_load_dwordx4 v[88:91], v137, s[36:39], s50 offen offset:0 sc1
    buffer_load_dwordx4 v[92:95], v137, s[36:39], s50 offen offset:1024 sc1
    buffer_load_dwordx4 v[96:99], v137, s[36:39], s50 offen offset:2048 sc1
    buffer_load_dwordx4 v[100:103], v137, s[36:39], s50 offen offset:3072 sc1
    s_add_u32 s50, s50, 0x80000
L_c1_w2_redo1:
    s_waitcnt vmcnt(0) lgkmcnt(0)
    s_barrier
    s_sub_u32 s100, s100, 1
    s_mov_b32 s101, 13
    s_cbranch_scc1 L_fail
    buffer_load_dwordx4 v140, s[36:39], s45 offen sc1 lds
    buffer_load_dwordx4 v140, s[36:39], s45 offen offset:1024 sc1 lds
    s_waitcnt vmcnt(0)
    s_barrier
    ds_read_b128 v[0:3], v140 offset:0
    ds_read_b128 v[4:7], v140 offset:1024
    ds_read_b128 v[8:11], v140 offset:2048
    ds_read_b128 v[12:15], v140 offset:3072
    ds_read_b128 v[16:19], v140 offset:4096
    ds_read_b128 v[20:23], v140 offset:5120
    ds_read_b128 v[24:27], v140 offset:6144
    ds_read_b128 v[28:31], v140 offset:7168
    s_waitcnt lgkmcnt(0)
    v_cmp_eq_u32 vcc, s66, v0
    s_cbranch_vccnz L_c1_w2_redo1
    v_cmp_eq_u32 vcc, s66, v1
    s_cbranch_vccnz L_c1_w2_redo1
    v_cmp_eq_u32 vcc, s66, v2
    s_cbranch_vccnz L_c1_w2_redo1
    v_cmp_eq_u32 vcc, s66, v3
    s_cbranch_vccnz L_c1_w2_redo1
    v_cmp_eq_u32 vcc, s66, v4
    s_cbranch_vccnz L_c1_w2_redo1
    v_cmp_eq_u32 vcc, s66, v5
    s_cbranch_vccnz L_c1_w2_redo1
    v_cmp_eq_u32 vcc, s66, v6
    s_cbranch_vccnz L_c1_w2_redo1
    v_cmp_eq_u32 vcc, s66, v7
    s_cbranch_vccnz L_c1_w2_redo1
    v_cmp_eq_u32 vcc, s66, v8
    s_cbranch_vccnz L_c1_w2_redo1
    v_cmp_eq_u32 vcc, s66, v9
    s_cbranch_vccnz L_c1_w2_redo1
    v_cmp_eq_u32 vcc, s66, v10
    s_cbranch_vccnz L_c1_w2_redo1
    v_cmp_eq_u32 vcc, s66, v11
    s_cbranch_vccnz L_c1_w2_redo1
    v_cmp_eq_u32 vcc, s66, v12
    s_cbranch_vccnz L_c1_w2_redo1
    v_cmp_eq_u32 vcc, s66, v13
    s_cbranch_vccnz L_c1_w2_redo1
    v_cmp_eq_u32 vcc, s66, v14
    s_cbranch_vccnz L_c1_w2_redo1
    v_cmp_eq_u32 vcc, s66, v15
    s_cbranch_vccnz L_c1_w2_redo1
    v_cmp_eq_u32 vcc, s66, v16
    s_cbranch_vccnz L_c1_w2_redo1
    v_cmp_eq_u32 vcc, s66, v17
    s_cbranch_vccnz L_c1_w2_redo1
    v_cmp_eq_u32 vcc, s66, v18
    s_cbranch_vccnz L_c1_w2_redo1
    v_cmp_eq_u32 vcc, s66, v19
    s_cbranch_vccnz L_c1_w2_redo1
    v_cmp_eq_u32 vcc, s66, v20
    s_cbranch_vccnz L_c1_w2_redo1
    v_cmp_eq_u32 vcc, s66, v21
    s_cbranch_vccnz L_c1_w2_redo1
    v_cmp_eq_u32 vcc, s66, v22
    s_cbranch_vccnz L_c1_w2_redo1
    v_cmp_eq_u32 vcc, s66, v23
    s_cbranch_vccnz L_c1_w2_redo1
    v_cmp_eq_u32 vcc, s66, v24
    s_cbranch_vccnz L_c1_w2_redo1
    v_cmp_eq_u32 vcc, s66, v25
    s_cbranch_vccnz L_c1_w2_redo1
    v_cmp_eq_u32 vcc, s66, v26
    s_cbranch_vccnz L_c1_w2_redo1
    v_cmp_eq_u32 vcc, s66, v27
    s_cbranch_vccnz L_c1_w2_redo1
    v_cmp_eq_u32 vcc, s66, v28
    s_cbranch_vccnz L_c1_w2_redo1
    v_cmp_eq_u32 vcc, s66, v29
    s_cbranch_vccnz L_c1_w2_redo1
    v_cmp_eq_u32 vcc, s66, v30
    s_cbranch_vccnz L_c1_w2_redo1
    v_cmp_eq_u32 vcc, s66, v31
    s_cbranch_vccnz L_c1_w2_redo1
    ds_read_b128 v[56:59], v134 offset:0
    ds_read_b128 v[60:63], v134 offset:1024
    ds_read_b128 v[64:67], v134 offset:2048
    ds_read_b128 v[68:71], v134 offset:3072
    ds_read_b128 v[72:75], v134 offset:4096
    ds_read_b128 v[76:79], v134 offset:5120
    ds_read_b128 v[80:83], v134 offset:6144
    ds_read_b128 v[84:87], v134 offset:7168
    v_mov_b64 v[32:33], 0
    v_mov_b64 v[34:35], 0
    v_mov_b64 v[36:37], 0
    v_mov_b64 v[38:39], 0
    v_mov_b64 v[40:41], 0
    v_mov_b64 v[42:43], 0
    v_mov_b64 v[44:45], 0
    v_mov_b64 v[46:47], 0
    v_mov_b64 v[48:49], 0
    v_mov_b64 v[50:51], 0
    v_mov_b64 v[52:53], 0
    v_mov_b64 v[54:55], 0
    v_mov_b32 v114, s44
    v_mov_b32 v115, s44
    s_branch L_c1_w2_step
L_c1_w2_p2slow:
    v_cmp_eq_u32 vcc, s66, v32
    s_cbranch_vccnz L_c1_w2_p2retry
    v_cmp_eq_u32 vcc, s66, v33
    s_cbranch_vccnz L_c1_w2_p2retry
    v_cmp_eq_u32 vcc, s66, v34
    s_cbranch_vccnz L_c1_w2_p2retry
    v_cmp_eq_u32 vcc, s66, v35
    s_cbranch_vccnz L_c1_w2_p2retry
    v_cmp_eq_u32 vcc, s66, v36
    s_cbranch_vccnz L_c1_w2_p2retry
    v_cmp_eq_u32 vcc, s66, v37
    s_cbranch_vccnz L_c1_w2_p2retry
    v_cmp_eq_u32 vcc, s66, v38
    s_cbranch_vccnz L_c1_w2_p2retry
    v_cmp_eq_u32 vcc, s66, v39
    s_cbranch_vccnz L_c1_w2_p2retry
    s_branch L_c1_w2_p2ok
L_c1_w2_p2retry:
    s_sub_u32 s100, s100, 1
    s_mov_b32 s101, 14
    s_cbranch_scc1 L_fail
    buffer_load_dword v32, v141, s[36:39], s57 offen sc1
    buffer_load_dword v33, v141, s[36:39], s58 offen sc1
    buffer_load_dword v34, v141, s[36:39], s59 offen sc1
    buffer_load_dword v35, v141, s[36:39], s60 offen sc1
    buffer_load_dword v36, v141, s[36:39], s61 offen sc1
    buffer_load_dword v37, v141, s[36:39], s62 offen sc1
    buffer_load_dword v38, v141, s[36:39], s63 offen sc1
    buffer_load_dword v39, v141, s[36:39], s64 offen sc1
    s_waitcnt vmcnt(0)
    s_branch L_c1_w2_p2w
L_c1_w2_kvwait:
    s_mov_b32 s82, 0x40000
    v_lshlrev_b32 v128, 2, v140
    s_waitcnt vmcnt(0)
    buffer_load_dword v128, v128, s[36:39], s82 offen sc1
    s_waitcnt vmcnt(0)
    v_cmp_le_u32 vcc, 32, v128
    s_and_b32 s82, vcc_lo, 0xffff
    s_ff0_i32_b32 s56, s82
    s_cmp_lt_u32 s80, s56
    s_cbranch_scc1 L_c1_w2_kvwait_ok
    s_sub_u32 s100, s100, 1
    s_mov_b32 s101, 15
    s_cbranch_scc1 L_fail
    s_branch L_c1_w2_kvwait
L_c1_w2_kvwait_ok:
    s_branch L_c1_w2_kvok
L_c1_w2_fb:
    s_cmp_eq_u32 s91, 0
    s_cbranch_scc0 L_c1_w2_fb1
    v_cmp_u_f32 vcc, v36, v36
    s_cbranch_vccnz L_c1_w2_redo
L_c1_w2_fb1:
    s_waitcnt vmcnt(0)
    s_barrier
    ds_write_b64 v140, v[32:33] offset:1024
    s_waitcnt lgkmcnt(0)
    s_barrier
    ds_read_b128 v[0:3], v140 offset:0
    ds_read_b128 v[4:7], v140 offset:1024
    v_mov_b32 v8, v44
    v_mov_b32 v9, v45
    s_waitcnt lgkmcnt(0)
    v_max3_f32 v10, v0, v1, v2
    v_max3_f32 v11, v3, v4, v5
    v_max3_f32 v10, v10, v6, v7
    v_max3_f32 v11, v11, v8, v9
    v_max_f32 v10, v10, v11
    v_mov_b32 v11, v10
    s_nop 1
    v_permlane32_swap_b32 v10, v11
    v_max_f32 v10, v10, v11
    v_mov_b32 v11, v10
    s_nop 1
    v_permlane16_swap_b32 v10, v11
    v_max_f32 v10, v10, v11
    v_sub_f32 v0, v0, v10
    v_sub_f32 v1, v1, v10
    v_sub_f32 v2, v2, v10
    v_sub_f32 v3, v3, v10
    v_sub_f32 v4, v4, v10
    v_sub_f32 v5, v5, v10
    v_sub_f32 v6, v6, v10
    v_sub_f32 v7, v7, v10
    v_sub_f32 v8, v8, v10
    v_sub_f32 v9, v9, v10
    v_exp_f32 v0, v0
    v_exp_f32 v1, v1
    v_exp_f32 v2, v2
    v_exp_f32 v3, v3
    v_exp_f32 v4, v4
    v_exp_f32 v5, v5
    v_exp_f32 v6, v6
    v_exp_f32 v7, v7
    v_exp_f32 v8, v8
    v_exp_f32 v9, v9
    v_cvt_pk_bf16_f32 v64, v0, v1
    v_cvt_pk_bf16_f32 v65, v2, v3
    v_cvt_pk_bf16_f32 v66, v4, v5
    v_cvt_pk_bf16_f32 v67, v6, v7
    v_cvt_pk_bf16_f32 v8, v8, v9
    v_cndmask_b32 v56, 0, v64, s[70:71]
    v_cndmask_b32 v60, v64, 0, s[70:71]
    v_cndmask_b32 v57, 0, v65, s[70:71]
    v_cndmask_b32 v61, v65, 0, s[70:71]
    v_cndmask_b32 v58, 0, v66, s[70:71]
    v_cndmask_b32 v62, v66, 0, s[70:71]
    v_cndmask_b32 v59, 0, v67, s[70:71]
    v_cndmask_b32 v63, v67, 0, s[70:71]
    v_cndmask_b32 v50, 0, v8, s[70:71]
    v_cndmask_b32 v51, v8, 0, s[70:71]
    v_mfma_f32_16x16x32_bf16 v[36:39], v[68:71], v[64:67], 0
    v_mfma_f32_16x16x32_bf16 v[40:43], v[104:107], v[56:59], 0
    v_mfma_f32_16x16x32_bf16 v[40:43], v[108:111], v[60:63], v[40:43]
    v_mfma_f32_16x16x16_bf16 v[36:39], v[68:69], v[50:51], v[36:39]
    v_mfma_f32_16x16x16_bf16 v[40:43], v[48:49], v[50:51], v[40:43]
    v_mov_b64 v[0:1], 0
    v_mov_b64 v[2:3], 0
    v_mov_b64 v[4:5], 0
    v_mov_b64 v[6:7], 0
    v_mov_b64 v[8:9], 0
    v_mov_b64 v[10:11], 0
    v_mov_b64 v[12:13], 0
    v_mov_b64 v[14:15], 0
    v_rcp_f32 v46, v36
    s_nop 0
    v_pk_mul_f32 v[40:41], v[40:41], v[46:47] op_sel_hi:[1,0]
    v_pk_mul_f32 v[42:43], v[42:43], v[46:47] op_sel_hi:[1,0]
    v_cvt_pk_bf16_f32 v40, v40, v41
    v_cvt_pk_bf16_f32 v41, v42, v43
    ds_write_b64 v139, v[40:41] offset:14848
    s_branch L_c1_w2_fbret
L_c1_enter3:
    s_waitcnt vmcnt(0)
    .p2align 6
L_c1_w3_step:
    s_waitcnt lgkmcnt(0)
    s_barrier
    ds_read_b128 v[0:3], v140 offset:0
    ds_read_b128 v[4:7], v140 offset:1024
    buffer_load_dword v114, v133, s[36:39], s65 offen sc1
    buffer_load_dwordx4 v140, s[36:39], s45 offen sc1 lds
    buffer_load_dwordx4 v140, s[36:39], s45 offen offset:1024 sc1 lds
    s_waitcnt lgkmcnt(1)
    v_smfmac_f32_16x16x64_bf16 v[32:35], v[0:3], v[56:63], v131
    ds_read_b128 v[8:11], v140 offset:2048
    buffer_load_dwordx3 v[128:130], v140, s[36:39], s52 offen offset:0 sc1
    v_mov_b32 v124, s66
    v_smfmac_f32_16x16x64_bf16 v[36:39], v[0:3], a[40:47], v131
    s_waitcnt lgkmcnt(1)
    ds_read_b128 v[12:15], v140 offset:3072
    v_lshlrev_b32 v126, 2, v140
    v_smfmac_f32_16x16x64_bf16 v[40:43], v[0:3], v[64:71], v131
    ds_read_b128 v[56:59], v134 offset:8192
    v_smfmac_f32_16x16x64_bf16 v[44:47], v[0:3], a[112:119], v131
    ds_read_b128 v[60:63], v134 offset:9216
    buffer_load_dwordx3 v[128:130], v140, s[36:39], s52 offen offset:1024 sc1
    v_smfmac_f32_16x16x64_bf16 v[32:35], v[4:7], v[72:79], v131
    ds_read_b128 v[64:67], v134 offset:10240
    v_smfmac_f32_16x16x64_bf16 v[36:39], v[4:7], a[48:55], v131
    ds_read_b128 v[68:71], v134 offset:11264
    v_smfmac_f32_16x16x64_bf16 v[40:43], v[4:7], v[80:87], v131
    ds_read_b128 v[72:75], v134 offset:12288
    buffer_load_dwordx3 v[128:130], v140, s[36:39], s52 offen offset:2048 sc1
    v_smfmac_f32_16x16x64_bf16 v[44:47], v[4:7], a[120:127], v131
    s_waitcnt lgkmcnt(6)
    ds_read_b128 v[76:79], v134 offset:13312
    v_smfmac_f32_16x16x64_bf16 v[32:35], v[8:11], a[0:7], v131
    s_waitcnt lgkmcnt(4)
    ds_read_b128 v[80:83], v134 offset:14336
    v_smfmac_f32_16x16x64_bf16 v[36:39], v[8:11], v[56:63], v131
    ds_read_b128 v[84:87], v134 offset:15360
    v_smfmac_f32_16x16x64_bf16 v[40:43], v[8:11], a[80:87], v131
    ds_read_b128 v[56:59], v134 offset:16384
    v_smfmac_f32_16x16x64_bf16 v[44:47], v[8:11], a[128:135], v131
    s_waitcnt lgkmcnt(9)
    ds_read_b128 v[60:63], v134 offset:17408
    v_smfmac_f32_16x16x64_bf16 v[32:35], v[12:15], a[8:15], v131
    s_waitcnt lgkmcnt(6)
    v_smfmac_f32_16x16x64_bf16 v[36:39], v[12:15], v[64:71], v131
    s_waitcnt vmcnt(5)
    v_cmp_ne_u32 vcc, s44, v114
    s_cbranch_vccnz L_c1_w3_spin1
L_c1_w3_hit:
    v_smfmac_f32_16x16x64_bf16 v[40:43], v[12:15], a[88:95], v131
    s_waitcnt vmcnt(3)
    s_barrier
    ds_read_b128 v[16:19], v140 offset:4096
    buffer_load_dwordx3 v[128:130], v140, s[36:39], s52 offen offset:3072 sc1
    v_smfmac_f32_16x16x64_bf16 v[44:47], v[12:15], a[136:143], v131
    s_waitcnt lgkmcnt(5)
    ds_read_b128 v[20:23], v140 offset:5120
    v_smfmac_f32_16x16x64_bf16 v[48:51], v[0:3], v[72:79], v131
    ds_read_b128 v[24:27], v140 offset:6144
    v_smfmac_f32_16x16x64_bf16 v[52:55], v[0:3], a[224:231], v131
    ds_read_b128 v[28:31], v140 offset:7168
    buffer_load_dword v128, v126, s[36:39], s55 offen sc1
    v_smfmac_f32_16x16x64_bf16 v[48:51], v[4:7], a[168:175], v131
    s_waitcnt lgkmcnt(3)
    ds_read_b128 v[64:67], v134 offset:18432
    v_smfmac_f32_16x16x64_bf16 v[32:35], v[16:19], a[16:23], v131
    s_waitcnt lgkmcnt(3)
    ds_read_b128 v[68:71], v134 offset:19456
    v_smfmac_f32_16x16x64_bf16 v[32:35], v[20:23], v[80:87], v131
    s_waitcnt lgkmcnt(3)
    ds_read_b128 v[72:75], v134 offset:20480
    v_smfmac_f32_16x16x64_bf16 v[32:35], v[24:27], a[24:31], v131
    s_waitcnt lgkmcnt(3)
    ds_read_b128 v[76:79], v134 offset:21504
    v_smfmac_f32_16x16x64_bf16 v[32:35], v[28:31], a[32:39], v131
    s_waitcnt lgkmcnt(8)
    ds_read_b128 v[80:83], v134 offset:22528
    v_smfmac_f32_16x16x64_bf16 v[36:39], v[16:19], v[56:63], v131
    ds_read_b128 v[84:87], v134 offset:23552
    buffer_store_dword v116, v142, s[36:39], s54 offen sc1
    v_smfmac_f32_16x16x64_bf16 v[36:39], v[20:23], a[56:63], v131
    v_add_f32 v32, v32, v34
    v_smfmac_f32_16x16x64_bf16 v[36:39], v[24:27], a[64:71], v131
    buffer_store_dword v124, v142, s[36:39], s47 offen sc1
    v_add_f32 v33, v33, v35
    v_smfmac_f32_16x16x64_bf16 v[36:39], v[28:31], a[72:79], v131
    s_waitcnt lgkmcnt(4)
    v_smfmac_f32_16x16x64_bf16 v[40:43], v[16:19], v[64:71], v131
    v_mov_b64 v[68:69], s[68:69]
    v_smfmac_f32_16x16x64_bf16 v[40:43], v[20:23], a[96:103], v131
    v_add_f32 v36, v36, v38
    v_add_f32 v37, v37, v39
    v_smfmac_f32_16x16x64_bf16 v[40:43], v[24:27], a[104:111], v131
    s_waitcnt lgkmcnt(2)
    v_cvt_pk_bf16_f32 v32, v32, v36
    v_cvt_pk_bf16_f32 v33, v33, v37
    v_smfmac_f32_16x16x64_bf16 v[40:43], v[28:31], v[72:79], v131
    ds_write2_b32 v135, v32, v33 offset0:0 offset1:4
    v_smfmac_f32_16x16x64_bf16 v[44:47], v[16:19], a[144:151], v131
    ds_read_b128 v[72:75], v134 offset:24576
    v_mov_b64 v[70:71], s[68:69]
    v_smfmac_f32_16x16x64_bf16 v[44:47], v[20:23], a[152:159], v131
    ds_read_b128 v[76:79], v134 offset:25600
    v_add_f32 v40, v40, v42
    v_smfmac_f32_16x16x64_bf16 v[44:47], v[24:27], a[160:167], v131
    s_waitcnt lgkmcnt(3)
    v_add_f32 v41, v41, v43
    v_smfmac_f32_16x16x64_bf16 v[44:47], v[28:31], v[80:87], v131
    ds_read_b128 v[80:83], v134 offset:26624
    v_smfmac_f32_16x16x64_bf16 v[52:55], v[4:7], a[232:239], v131
    s_waitcnt lgkmcnt(3)
    s_barrier
    ds_read_b128 v[112:115], v136 offset:8192
    v_smfmac_f32_16x16x64_bf16 v[48:51], v[8:11], a[176:183], v131
    ds_read_b128 v[116:119], v136 offset:9216
    v_add_f32 v44, v44, v46
    v_smfmac_f32_16x16x64_bf16 v[52:55], v[8:11], a[240:247], v131
    ds_read_b128 v[120:123], v136 offset:10240
    v_add_f32 v45, v45, v47
    v_cvt_pk_bf16_f32 v40, v40, v44
    v_smfmac_f32_16x16x64_bf16 v[48:51], v[12:15], a[184:191], v131
    ds_read_b128 v[124:127], v136 offset:11264
    v_cvt_pk_bf16_f32 v41, v41, v45
    v_smfmac_f32_16x16x64_bf16 v[52:55], v[12:15], a[248:255], v131
    s_waitcnt lgkmcnt(3)
    ds_write2_b32 v135, v40, v41 offset0:128 offset1:132
    v_mfma_f32_16x16x32_bf16 v[32:35], v[88:91], v[112:115], 0
    s_waitcnt lgkmcnt(3)
    ds_read_b128 v[84:87], v134 offset:27648
    v_mfma_f32_16x16x32_bf16 v[32:35], v[92:95], v[116:119], v[32:35]
    s_waitcnt lgkmcnt(3)
    v_mfma_f32_16x16x32_bf16 v[32:35], v[96:99], v[120:123], v[32:35]
    s_waitcnt lgkmcnt(2)
    v_mfma_f32_16x16x32_bf16 v[32:35], v[100:103], v[124:127], v[32:35]
    s_waitcnt lgkmcnt(1)
    s_barrier
    ds_read_b128 v[0:3], v137 offset:8704
    v_smfmac_f32_16x16x64_bf16 v[48:51], v[16:19], a[192:199], v131
    ds_read_b128 v[4:7], v137 offset:9728
    v_smfmac_f32_16x16x64_bf16 v[48:51], v[20:23], a[200:207], v131
    ds_read_b128 v[8:11], v137 offset:10752
    v_exp_f32 v36, v32
    v_smfmac_f32_16x16x64_bf16 v[48:51], v[24:27], a[208:215], v131
    s_waitcnt lgkmcnt(2)
    ds_read_b128 v[12:15], v137 offset:11776
    v_exp_f32 v37, v33
    v_mfma_f32_16x16x32_bf16 v[44:47], v[0:3], v[112:115], 0
    s_waitcnt lgkmcnt(2)
    v_cvt_pk_bf16_f32 v36, v36, v37
    v_mfma_f32_16x16x32_bf16 v[44:47], v[4:7], v[116:119], v[44:47]
    s_waitcnt lgkmcnt(1)
    ds_write_b32 v136, v36 offset:12812
    v_mfma_f32_16x16x32_bf16 v[44:47], v[8:11], v[120:123], v[44:47]
    s_waitcnt lgkmcnt(1)
    buffer_load_dwordx4 v[88:91], v137, s[36:39], s50 offen offset:0 sc1
    v_mov_b64 v[0:1], 0
    v_mov_b64 v[2:3], 0
    v_mfma_f32_16x16x32_bf16 v[44:47], v[12:15], v[124:127], v[44:47]
    buffer_load_dwordx4 v[92:95], v137, s[36:39], s50 offen offset:1024 sc1
    v_mov_b64 v[4:5], 0
    v_mov_b64 v[6:7], 0
    v_smfmac_f32_16x16x64_bf16 v[48:51], v[28:31], a[216:223], v131
    v_mov_b64 v[8:9], 0
    v_smfmac_f32_16x16x64_bf16 v[52:55], v[16:19], v[224:231], v131
    s_waitcnt lgkmcnt(0)
    s_barrier
    ds_read_b128 v[64:67], v136 offset:12800
    v_exp_f32 v46, v44
    v_smfmac_f32_16x16x64_bf16 v[52:55], v[20:23], v[232:239], v131
    ds_read_b128 v[56:59], v138 offset:12800
    v_add_f32 v48, v48, v50
    v_exp_f32 v47, v45
    v_smfmac_f32_16x16x64_bf16 v[52:55], v[24:27], v[240:247], v131
    ds_read_b128 v[60:63], v138 offset:12288
    buffer_load_dwordx4 v[96:99], v137, s[36:39], s50 offen offset:2048 sc1
    v_add_f32 v49, v49, v51
    v_cvt_pk_bf16_f32 v46, v46, v47
    v_smfmac_f32_16x16x64_bf16 v[52:55], v[28:31], v[248:255], v131
    s_waitcnt lgkmcnt(2)
    buffer_load_dwordx4 v[100:103], v137, s[36:39], s50 offen offset:3072 sc1
    v_cvt_pk_bf16_f32 v48, v48, v49
    v_mfma_f32_16x16x32_bf16 v[36:39], v[68:71], v[64:67], 0
    s_waitcnt lgkmcnt(1)
    v_cndmask_b32 v50, 0, v46, s[70:71]
    v_cndmask_b32 v51, v46, 0, s[70:71]
    v_mfma_f32_16x16x32_bf16 v[40:43], v[104:107], v[56:59], 0
    s_waitcnt lgkmcnt(0)
    v_add_f32 v52, v52, v54
    v_add_f32 v53, v53, v55
    v_mfma_f32_16x16x32_bf16 v[40:43], v[108:111], v[60:63], v[40:43]
    v_cvt_pk_bf16_f32 v49, v52, v53
    v_mfma_f32_16x16x16_bf16 v[36:39], v[68:69], v[50:51], v[36:39]
    v_mfma_f32_16x16x16_bf16 v[40:43], v[48:49], v[50:51], v[40:43]
    s_nop 3
    v_rcp_f32 v46, v36
    v_mov_b64 v[10:11], 0
    v_mov_b64 v[12:13], 0
    s_nop 0
    v_pk_mul_f32 v[40:41], v[40:41], v[46:47] op_sel_hi:[1,0]
    v_pk_mul_f32 v[42:43], v[42:43], v[46:47] op_sel_hi:[1,0]
    v_cvt_pk_bf16_f32 v40, v40, v41
    v_cvt_pk_bf16_f32 v41, v42, v43
    ds_write_b64 v139, v[40:41] offset:15360
    v_subrev_u32 v47, s74, v36
    v_cmp_lt_u32 vcc, s75, v47
    v_mov_b64 v[14:15], 0
    s_cbranch_vccnz L_c1_w3_fb
L_c1_w3_fbret:
    buffer_load_dwordx4 v[104:107], v140, s[36:39], s51 offen offset:0 sc1
    buffer_load_dwordx4 v[108:111], v140, s[36:39], s51 offen offset:1024 sc1
    s_waitcnt lgkmcnt(0)
    s_barrier
    ds_read_b128 v[112:115], v137 offset:13824
    ds_read_b128 v[116:119], v137 offset:14336
    ds_read_b128 v[120:123], v137 offset:14848
    ds_read_b128 v[124:127], v137 offset:15360
    s_waitcnt lgkmcnt(3)
    v_smfmac_f32_16x16x64_bf16 v[0:3], v[112:115], v[144:151], v131
    s_waitcnt lgkmcnt(2)
    v_smfmac_f32_16x16x64_bf16 v[0:3], v[116:119], v[152:159], v131
    s_waitcnt lgkmcnt(1)
    ds_read_b128 v[56:59], v134 offset:28672
    v_smfmac_f32_16x16x64_bf16 v[0:3], v[120:123], v[160:167], v131
    s_waitcnt lgkmcnt(1)
    ds_read_b128 v[60:63], v134 offset:29696
    v_smfmac_f32_16x16x64_bf16 v[0:3], v[124:127], v[168:175], v131
    s_add_u32 s84, s48, 4096
    ds_read_b128 v[64:67], v134 offset:30720
    v_smfmac_f32_16x16x64_bf16 v[4:7], v[112:115], v[176:183], v131
    ds_read_b128 v[68:71], v134 offset:31744
    v_smfmac_f32_16x16x64_bf16 v[4:7], v[116:119], v[72:79], v131
    ds_read_b128 v[72:75], v134 offset:32768
    v_cvt_pk_bf16_f32 v16, v0, v2
    v_cvt_pk_bf16_f32 v17, v1, v3
    v_smfmac_f32_16x16x64_bf16 v[4:7], v[120:123], v[184:191], v131
    ds_read_b128 v[76:79], v134 offset:33792
    v_bfi_b32 v16, 1, s87, v16
    v_bfi_b32 v17, 1, s87, v17
    v_smfmac_f32_16x16x64_bf16 v[4:7], v[124:127], v[80:87], v131
    ds_read_b128 v[80:83], v134 offset:34816
    buffer_store_dwordx2 v[16:17], v132, s[36:39], s48 offen offset:0 sc1
    v_smfmac_f32_16x16x64_bf16 v[8:11], v[112:115], v[192:199], v131
    s_waitcnt lgkmcnt(5)
    ds_read_b128 v[84:87], v134 offset:35840
    v_smfmac_f32_16x16x64_bf16 v[8:11], v[116:119], v[56:63], v131
    v_cvt_pk_bf16_f32 v18, v4, v6
    v_cvt_pk_bf16_f32 v19, v5, v7
    v_bfi_b32 v18, 1, s87, v18
    v_bfi_b32 v19, 1, s87, v19
    v_smfmac_f32_16x16x64_bf16 v[8:11], v[120:123], v[200:207], v131
    s_waitcnt lgkmcnt(4)
    buffer_store_dwordx2 v[18:19], v132, s[36:39], s48 offen offset:2048 sc1
    v_smfmac_f32_16x16x64_bf16 v[8:11], v[124:127], v[64:71], v131
    v_smfmac_f32_16x16x64_bf16 v[12:15], v[112:115], v[208:215], v131
    s_waitcnt lgkmcnt(2)
    v_smfmac_f32_16x16x64_bf16 v[12:15], v[116:119], v[72:79], v131
    v_cvt_pk_bf16_f32 v20, v8, v10
    v_smfmac_f32_16x16x64_bf16 v[12:15], v[120:123], v[216:223], v131
    s_waitcnt lgkmcnt(0)
    v_cvt_pk_bf16_f32 v21, v9, v11
    v_smfmac_f32_16x16x64_bf16 v[12:15], v[124:127], v[80:87], v131
    v_bfi_b32 v20, 1, s87, v20
    v_bfi_b32 v21, 1, s87, v21
    buffer_store_dwordx2 v[20:21], v132, s[36:39], s84 offen offset:0 sc1
    s_nop 3
    v_cvt_pk_bf16_f32 v22, v12, v14
    v_cvt_pk_bf16_f32 v23, v13, v15
    v_bfi_b32 v22, 1, s87, v22
    v_bfi_b32 v23, 1, s87, v23
    buffer_store_dwordx2 v[22:23], v132, s[36:39], s84 offen offset:2048 sc1
    v_mov_b64 v[40:41], 0
    v_mov_b64 v[42:43], 0
    v_mov_b64 v[44:45], 0
    v_mov_b64 v[46:47], 0
    v_mov_b64 v[48:49], 0
    v_mov_b64 v[50:51], 0
    v_mov_b64 v[52:53], 0
    v_mov_b64 v[54:55], 0
    ds_read_b128 v[56:59], v134 offset:0
    ds_read_b128 v[60:63], v134 offset:1024
    ds_read_b128 v[64:67], v134 offset:2048
    ds_read_b128 v[68:71], v134 offset:3072
    ds_read_b128 v[72:75], v134 offset:4096
    ds_read_b128 v[76:79], v134 offset:5120
    ds_read_b128 v[80:83], v134 offset:6144
    ds_read_b128 v[84:87], v134 offset:7168
    s_sub_u32 s95, s79, s48
    s_mov_b32 s82, s49
    s_mov_b32 s49, s48
    s_mov_b32 s48, s79
    s_mov_b32 s79, s49
    s_add_u32 s52, s52, 0x80000
    s_mov_b32 s91, 0
    s_add_u32 s50, s50, 524288
    s_add_u32 s51, s51, 524288
    s_nop 7
    s_nop 7
    s_nop 7
    s_nop 7
    s_nop 7
    s_nop 7
    s_nop 7
    s_nop 2
    buffer_load_dword v32, v141, s[36:39], s57 offen sc1
    buffer_load_dword v33, v141, s[36:39], s58 offen sc1
    buffer_load_dword v34, v141, s[36:39], s59 offen sc1
    buffer_load_dword v35, v141, s[36:39], s60 offen sc1
    buffer_load_dword v36, v141, s[36:39], s61 offen sc1
    buffer_load_dword v37, v141, s[36:39], s62 offen sc1
    buffer_load_dword v38, v141, s[36:39], s63 offen sc1
    buffer_load_dword v39, v141, s[36:39], s64 offen sc1
    s_mov_b32 s80, s47
    s_mov_b32 s47, s45
    s_mov_b32 s45, s46
    s_mov_b32 s46, s80
    s_add_u32 s53, s53, 8192
    s_mov_b32 s54, s53
    s_add_u32 s44, s44, 1
    v_mov_b32 v112, v143
    v_mov_b32 v113, v143
    v_mov_b32 v114, v143
    v_mov_b32 v115, v143
    v_mov_b32 v2, s44
    s_waitcnt vmcnt(4)
L_c1_w3_p2w:
    v_mfma_f32_16x16x32_bf16 v[116:119], v[112:115], v[32:35], 0
    v_bitop3_b32 v0, v32, v33, s87 bitop3:0x7e
    v_bitop3_b32 v1, v34, v35, s87 bitop3:0x7e
    s_waitcnt vmcnt(0)
    v_mfma_f32_16x16x32_bf16 v[116:119], v[112:115], v[36:39], v[116:119]
    v_bitop3_b32 v3, v36, v37, s87 bitop3:0x7e
    v_bitop3_b32 v4, v38, v39, s87 bitop3:0x7e
    v_or3_b32 v0, v0, v1, v3
    v_bitop3_b32 v0, v0, v4, 1 bitop3:0xa8
    v_cmp_ne_u32 vcc, 0, v0
    s_cbranch_vccnz L_c1_w3_p2retry
L_c1_w3_p2ok:
    s_nop 0
    v_cvt_pk_bf16_f32 v116, v116, v117
    buffer_store_dword v116, v142, s[36:39], s45 offen sc1
    s_cmp_eq_u32 s44, 63
    s_cbranch_scc1 L_c1_fin
    s_nop 2
    buffer_store_dword v2, off, s[36:39], s90 sc1
    v_mov_b64 v[32:33], 0
    v_mov_b64 v[34:35], 0
    v_mov_b64 v[36:37], 0
    v_mov_b64 v[38:39], 0
    v_cmp_le_u32 vcc, 32, v128
    s_and_b32 s80, vcc_lo, 0xffff
    s_ff0_i32_b32 s80, s80
    s_max_u32 s56, s56, s80
    s_add_u32 s80, s44, 4
    s_lshr_b32 s80, s80, 2
    s_min_u32 s80, s80, 15
    s_cmp_lt_u32 s80, s56
    s_cselect_b32 s55, s88, s89
    s_add_u32 s80, s44, 2
    s_lshr_b32 s80, s80, 2
    s_min_u32 s80, s80, 15
    s_cmp_lt_u32 s80, s56
    s_cbranch_scc0 L_c1_w3_kvwait
L_c1_w3_kvok:
    v_add_u32 v141, s95, v141
    s_bfe_i32 s87, s44, 0x10001
    s_branch L_c1_w3_step
L_c1_w3_spin0:
    s_waitcnt vmcnt(2)
    v_cmp_ne_u32 vcc, s44, v114
    s_cbranch_vccz L_c1_w3_spun
L_c1_w3_spin1:
    buffer_load_dword v114, v133, s[36:39], s65 offen sc1
    buffer_load_dwordx4 v140, s[36:39], s45 offen sc1 lds
    buffer_load_dwordx4 v140, s[36:39], s45 offen offset:1024 sc1 lds
    s_sub_u32 s100, s100, 1
    s_mov_b32 s101, 12
    s_cbranch_scc1 L_fail
    s_branch L_c1_w3_spin0
L_c1_w3_spun:
    s_waitcnt vmcnt(0)
    s_branch L_c1_w3_hit
L_c1_w3_redo:
    s_mov_b32 s91, 1
    s_mov_b32 s54, 0x80000000
    s_sub_u32 s50, s50, 0x80000
    buffer_load_dwordx4 v[88:91], v137, s[36:39], s50 offen offset:0 sc1
    buffer_load_dwordx4 v[92:95], v137, s[36:39], s50 offen offset:1024 sc1
    buffer_load_dwordx4 v[96:99], v137, s[36:39], s50 offen offset:2048 sc1
    buffer_load_dwordx4 v[100:103], v137, s[36:39], s50 offen offset:3072 sc1
    s_add_u32 s50, s50, 0x80000
L_c1_w3_redo1:
    s_waitcnt vmcnt(0) lgkmcnt(0)
    s_barrier
    s_sub_u32 s100, s100, 1
    s_mov_b32 s101, 13
    s_cbranch_scc1 L_fail
    buffer_load_dwordx4 v140, s[36:39], s45 offen sc1 lds
    buffer_load_dwordx4 v140, s[36:39], s45 offen offset:1024 sc1 lds
    s_waitcnt vmcnt(0)
    s_barrier
    ds_read_b128 v[0:3], v140 offset:0
    ds_read_b128 v[4:7], v140 offset:1024
    ds_read_b128 v[8:11], v140 offset:2048
    ds_read_b128 v[12:15], v140 offset:3072
    ds_read_b128 v[16:19], v140 offset:4096
    ds_read_b128 v[20:23], v140 offset:5120
    ds_read_b128 v[24:27], v140 offset:6144
    ds_read_b128 v[28:31], v140 offset:7168
    s_waitcnt lgkmcnt(0)
    v_cmp_eq_u32 vcc, s66, v0
    s_cbranch_vccnz L_c1_w3_redo1
    v_cmp_eq_u32 vcc, s66, v1
    s_cbranch_vccnz L_c1_w3_redo1
    v_cmp_eq_u32 vcc, s66, v2
    s_cbranch_vccnz L_c1_w3_redo1
    v_cmp_eq_u32 vcc, s66, v3
    s_cbranch_vccnz L_c1_w3_redo1
    v_cmp_eq_u32 vcc, s66, v4
    s_cbranch_vccnz L_c1_w3_redo1
    v_cmp_eq_u32 vcc, s66, v5
    s_cbranch_vccnz L_c1_w3_redo1
    v_cmp_eq_u32 vcc, s66, v6
    s_cbranch_vccnz L_c1_w3_redo1
    v_cmp_eq_u32 vcc, s66, v7
    s_cbranch_vccnz L_c1_w3_redo1
    v_cmp_eq_u32 vcc, s66, v8
    s_cbranch_vccnz L_c1_w3_redo1
    v_cmp_eq_u32 vcc, s66, v9
    s_cbranch_vccnz L_c1_w3_redo1
    v_cmp_eq_u32 vcc, s66, v10
    s_cbranch_vccnz L_c1_w3_redo1
    v_cmp_eq_u32 vcc, s66, v11
    s_cbranch_vccnz L_c1_w3_redo1
    v_cmp_eq_u32 vcc, s66, v12
    s_cbranch_vccnz L_c1_w3_redo1
    v_cmp_eq_u32 vcc, s66, v13
    s_cbranch_vccnz L_c1_w3_redo1
    v_cmp_eq_u32 vcc, s66, v14
    s_cbranch_vccnz L_c1_w3_redo1
    v_cmp_eq_u32 vcc, s66, v15
    s_cbranch_vccnz L_c1_w3_redo1
    v_cmp_eq_u32 vcc, s66, v16
    s_cbranch_vccnz L_c1_w3_redo1
    v_cmp_eq_u32 vcc, s66, v17
    s_cbranch_vccnz L_c1_w3_redo1
    v_cmp_eq_u32 vcc, s66, v18
    s_cbranch_vccnz L_c1_w3_redo1
    v_cmp_eq_u32 vcc, s66, v19
    s_cbranch_vccnz L_c1_w3_redo1
    v_cmp_eq_u32 vcc, s66, v20
    s_cbranch_vccnz L_c1_w3_redo1
    v_cmp_eq_u32 vcc, s66, v21
    s_cbranch_vccnz L_c1_w3_redo1
    v_cmp_eq_u32 vcc, s66, v22
    s_cbranch_vccnz L_c1_w3_redo1
    v_cmp_eq_u32 vcc, s66, v23
    s_cbranch_vccnz L_c1_w3_redo1
    v_cmp_eq_u32 vcc, s66, v24
    s_cbranch_vccnz L_c1_w3_redo1
    v_cmp_eq_u32 vcc, s66, v25
    s_cbranch_vccnz L_c1_w3_redo1
    v_cmp_eq_u32 vcc, s66, v26
    s_cbranch_vccnz L_c1_w3_redo1
    v_cmp_eq_u32 vcc, s66, v27
    s_cbranch_vccnz L_c1_w3_redo1
    v_cmp_eq_u32 vcc, s66, v28
    s_cbranch_vccnz L_c1_w3_redo1
    v_cmp_eq_u32 vcc, s66, v29
    s_cbranch_vccnz L_c1_w3_redo1
    v_cmp_eq_u32 vcc, s66, v30
    s_cbranch_vccnz L_c1_w3_redo1
    v_cmp_eq_u32 vcc, s66, v31
    s_cbranch_vccnz L_c1_w3_redo1
    ds_read_b128 v[56:59], v134 offset:0
    ds_read_b128 v[60:63], v134 offset:1024
    ds_read_b128 v[64:67], v134 offset:2048
    ds_read_b128 v[68:71], v134 offset:3072
    ds_read_b128 v[72:75], v134 offset:4096
    ds_read_b128 v[76:79], v134 offset:5120
    ds_read_b128 v[80:83], v134 offset:6144
    ds_read_b128 v[84:87], v134 offset:7168
    v_mov_b64 v[32:33], 0
    v_mov_b64 v[34:35], 0
    v_mov_b64 v[36:37], 0
    v_mov_b64 v[38:39], 0
    v_mov_b64 v[40:41], 0
    v_mov_b64 v[42:43], 0
    v_mov_b64 v[44:45], 0
    v_mov_b64 v[46:47], 0
    v_mov_b64 v[48:49], 0
    v_mov_b64 v[50:51], 0
    v_mov_b64 v[52:53], 0
    v_mov_b64 v[54:55], 0
    v_mov_b32 v114, s44
    v_mov_b32 v115, s44
    s_branch L_c1_w3_step
L_c1_w3_p2slow:
    v_cmp_eq_u32 vcc, s66, v32
    s_cbranch_vccnz L_c1_w3_p2retry
    v_cmp_eq_u32 vcc, s66, v33
    s_cbranch_vccnz L_c1_w3_p2retry
    v_cmp_eq_u32 vcc, s66, v34
    s_cbranch_vccnz L_c1_w3_p2retry
    v_cmp_eq_u32 vcc, s66, v35
    s_cbranch_vccnz L_c1_w3_p2retry
    v_cmp_eq_u32 vcc, s66, v36
    s_cbranch_vccnz L_c1_w3_p2retry
    v_cmp_eq_u32 vcc, s66, v37
    s_cbranch_vccnz L_c1_w3_p2retry
    v_cmp_eq_u32 vcc, s66, v38
    s_cbranch_vccnz L_c1_w3_p2retry
    v_cmp_eq_u32 vcc, s66, v39
    s_cbranch_vccnz L_c1_w3_p2retry
    s_branch L_c1_w3_p2ok
L_c1_w3_p2retry:
    s_sub_u32 s100, s100, 1
    s_mov_b32 s101, 14
    s_cbranch_scc1 L_fail
    buffer_load_dword v32, v141, s[36:39], s57 offen sc1
    buffer_load_dword v33, v141, s[36:39], s58 offen sc1
    buffer_load_dword v34, v141, s[36:39], s59 offen sc1
    buffer_load_dword v35, v141, s[36:39], s60 offen sc1
    buffer_load_dword v36, v141, s[36:39], s61 offen sc1
    buffer_load_dword v37, v141, s[36:39], s62 offen sc1
    buffer_load_dword v38, v141, s[36:39], s63 offen sc1
    buffer_load_dword v39, v141, s[36:39], s64 offen sc1
    s_waitcnt vmcnt(0)
    s_branch L_c1_w3_p2w
L_c1_w3_kvwait:
    s_mov_b32 s82, 0x40000
    v_lshlrev_b32 v128, 2, v140
    s_waitcnt vmcnt(0)
    buffer_load_dword v128, v128, s[36:39], s82 offen sc1
    s_waitcnt vmcnt(0)
    v_cmp_le_u32 vcc, 32, v128
    s_and_b32 s82, vcc_lo, 0xffff
    s_ff0_i32_b32 s56, s82
    s_cmp_lt_u32 s80, s56
    s_cbranch_scc1 L_c1_w3_kvwait_ok
    s_sub_u32 s100, s100, 1
    s_mov_b32 s101, 15
    s_cbranch_scc1 L_fail
    s_branch L_c1_w3_kvwait
L_c1_w3_kvwait_ok:
    s_branch L_c1_w3_kvok
L_c1_w3_fb:
    s_cmp_eq_u32 s91, 0
    s_cbranch_scc0 L_c1_w3_fb1
    v_cmp_u_f32 vcc, v36, v36
    s_cbranch_vccnz L_c1_w3_redo
L_c1_w3_fb1:
    s_waitcnt vmcnt(0)
    s_barrier
    ds_write_b64 v140, v[32:33] offset:1032
    s_waitcnt lgkmcnt(0)
    s_barrier
    ds_read_b128 v[0:3], v140 offset:0
    ds_read_b128 v[4:7], v140 offset:1024
    v_mov_b32 v8, v44
    v_mov_b32 v9, v45
    s_waitcnt lgkmcnt(0)
    v_max3_f32 v10, v0, v1, v2
    v_max3_f32 v11, v3, v4, v5
    v_max3_f32 v10, v10, v6, v7
    v_max3_f32 v11, v11, v8, v9
    v_max_f32 v10, v10, v11
    v_mov_b32 v11, v10
    s_nop 1
    v_permlane32_swap_b32 v10, v11
    v_max_f32 v10, v10, v11
    v_mov_b32 v11, v10
    s_nop 1
    v_permlane16_swap_b32 v10, v11
    v_max_f32 v10, v10, v11
    v_sub_f32 v0, v0, v10
    v_sub_f32 v1, v1, v10
    v_sub_f32 v2, v2, v10
    v_sub_f32 v3, v3, v10
    v_sub_f32 v4, v4, v10
    v_sub_f32 v5, v5, v10
    v_sub_f32 v6, v6, v10
    v_sub_f32 v7, v7, v10
    v_sub_f32 v8, v8, v10
    v_sub_f32 v9, v9, v10
    v_exp_f32 v0, v0
    v_exp_f32 v1, v1
    v_exp_f32 v2, v2
    v_exp_f32 v3, v3
    v_exp_f32 v4, v4
    v_exp_f32 v5, v5
    v_exp_f32 v6, v6
    v_exp_f32 v7, v7
    v_exp_f32 v8, v8
    v_exp_f32 v9, v9
    v_cvt_pk_bf16_f32 v64, v0, v1
    v_cvt_pk_bf16_f32 v65, v2, v3
    v_cvt_pk_bf16_f32 v66, v4, v5
    v_cvt_pk_bf16_f32 v67, v6, v7
    v_cvt_pk_bf16_f32 v8, v8, v9
    v_cndmask_b32 v56, 0, v64, s[70:71]
    v_cndmask_b32 v60, v64, 0, s[70:71]
    v_cndmask_b32 v57, 0, v65, s[70:71]
    v_cndmask_b32 v61, v65, 0, s[70:71]
    v_cndmask_b32 v58, 0, v66, s[70:71]
    v_cndmask_b32 v62, v66, 0, s[70:71]
    v_cndmask_b32 v59, 0, v67, s[70:71]
    v_cndmask_b32 v63, v67, 0, s[70:71]
    v_cndmask_b32 v50, 0, v8, s[70:71]
    v_cndmask_b32 v51, v8, 0, s[70:71]
    v_mfma_f32_16x16x32_bf16 v[36:39], v[68:71], v[64:67], 0
    v_mfma_f32_16x16x32_bf16 v[40:43], v[104:107], v[56:59], 0
    v_mfma_f32_16x16x32_bf16 v[40:43], v[108:111], v[60:63], v[40:43]
    v_mfma_f32_16x16x16_bf16 v[36:39], v[68:69], v[50:51], v[36:39]
    v_mfma_f32_16x16x16_bf16 v[40:43], v[48:49], v[50:51], v[40:43]
    v_mov_b64 v[0:1], 0
    v_mov_b64 v[2:3], 0
    v_mov_b64 v[4:5], 0
    v_mov_b64 v[6:7], 0
    v_mov_b64 v[8:9], 0
    v_mov_b64 v[10:11], 0
    v_mov_b64 v[12:13], 0
    v_mov_b64 v[14:15], 0
    v_rcp_f32 v46, v36
    s_nop 0
    v_pk_mul_f32 v[40:41], v[40:41], v[46:47] op_sel_hi:[1,0]
    v_pk_mul_f32 v[42:43], v[42:43], v[46:47] op_sel_hi:[1,0]
    v_cvt_pk_bf16_f32 v40, v40, v41
    v_cvt_pk_bf16_f32 v41, v42, v43
    ds_write_b64 v139, v[40:41] offset:15360
    s_branch L_c1_w3_fbret
L_c1_fin:
    buffer_store_dword v116, v142, s[36:39], s53 offen sc1
    s_waitcnt vmcnt(0)
    s_branch L_end
L_fail:
    s_mov_b64 exec, 1
    v_mov_b32 v0, s101
    v_mov_b32 v1, 0
    global_store_dword v1, v0, s[30:31] offset:16
    v_mov_b32 v0, s35
    global_store_dword v1, v0, s[30:31] offset:20
    s_waitcnt vmcnt(0)
L_end:
    s_endpgm
.section .rodata,"a"
.p2align 6
.amdhsa_kernel parallel_sum__memory_aug_recurrent_mem_tr__dense_activation_squared_relu__prompt_kernel
  .amdhsa_next_free_vgpr 512
  .amdhsa_next_free_sgpr 102
  .amdhsa_accum_offset 256
  .amdhsa_group_segment_fixed_size 0
  .amdhsa_kernarg_size 120
  .amdhsa_user_sgpr_count 2
  .amdhsa_user_sgpr_kernarg_segment_ptr 1
  .amdhsa_system_sgpr_workgroup_id_x 1
.end_amdhsa_kernel
```
